```python
import torch

def _softmax(x, axis=-1):
    return torch.softmax(x, dim=axis)

def _gelu(x):
    return torch.nn.functional.gelu(x, approximate='tanh')

def _silu(x):
    return torch.nn.functional.silu(x)

def _sigmoid(x):
    return torch.sigmoid(x)

def _layernorm(x, axis=-1, eps=1e-05):
    m = x.mean(dim=axis, keepdim=True)
    v = x.var(dim=axis, keepdim=True, unbiased=False)
    return (x - m) / torch.sqrt(v + eps)

def _scatter_add(tgt, idx, src, axis=0):
    return tgt.clone().index_add_(axis, idx, src)

def _segment_sum(src, seg, n):
    out = torch.zeros((n,) + src.shape[1:], dtype=src.dtype)
    return out.index_add_(0, seg, src)

def _pad(x, pw):
    flat = tuple((v for pair in reversed(pw) for v in pair))
    return torch.nn.functional.pad(x, flat)
kernel_name = 'adaLN_cond__compressed_kv_cla__swiglu_ffn__prompt'

def setup_inputs():

    _w = lambda a: (lambda t: t.to(torch.bfloat16) if t.is_floating_point() else t)(torch.as_tensor(a))

    def _A_setup():
        B, H, Sq, Sk, D, M = (1, 32, 2048, 2048, 128, 512)
        Dc = 4 * D
        return {'x': _w((lambda *s: torch.randn(*s, dtype=torch.bfloat16) * 0.05)(B, Sq, M)), 'c_kv': _w((lambda *s: torch.randn(*s, dtype=torch.bfloat16) * 1.6)(B, Sk, Dc)), 'w_q': _w((lambda *s: torch.randn(*s, dtype=torch.bfloat16) * 0.8)(M, H, D) * M ** (-0.5)), 'w_uk': _w((lambda *s: torch.randn(*s, dtype=torch.bfloat16) * 0.8)(Dc, H, D) * Dc ** (-0.5)), 'w_uv': _w((lambda *s: torch.randn(*s, dtype=torch.bfloat16) * 1.6)(Dc, H, D) * Dc ** (-0.5)), 'w_o': _w((lambda *s: torch.randn(*s, dtype=torch.bfloat16) * 1.6)(H, D, M) * (H * D) ** (-0.5))}
    _A_in = _A_setup()

    def _B_setup():
        B, S, D, F = (1, 2048, 512, 1792)
        return {'x': _w((lambda *s: torch.randn(*s, dtype=torch.bfloat16) * 0.05)(B, S, D)), 'w_gate': _w((lambda *s: torch.randn(*s, dtype=torch.bfloat16) * 0.05)(D, F)), 'w_up': _w((lambda *s: torch.randn(*s, dtype=torch.bfloat16) * 0.05)(D, F)), 'w_down': _w((lambda *s: torch.randn(*s, dtype=torch.bfloat16) * 0.05)(F, D))}
    _B_in = _B_setup()
    return {'A_x': _A_in['x'], 'A_c_kv': _A_in['c_kv'], 'A_w_q': _A_in['w_q'], 'A_w_uk': _A_in['w_uk'], 'A_w_uv': _A_in['w_uv'], 'A_w_o': _A_in['w_o'], 'B_x': _B_in['x'], 'B_w_gate': _B_in['w_gate'], 'B_w_up': _B_in['w_up'], 'B_w_down': _B_in['w_down'], 'c': _w((lambda *s: torch.randn(*s, dtype=torch.bfloat16) * 0.1)(1, 512) * 8.0), 'w_mod': _w((lambda *s: torch.randn(*s, dtype=torch.bfloat16) * 0.1)(512, 6 * 512) * 512 ** (-0.5) * 8.0)}

def reference(A_x, A_c_kv, A_w_q, A_w_uk, A_w_uv, A_w_o, B_x, B_w_gate, B_w_up, B_w_down, c, w_mod):

    def _A_ref(x, c_kv, w_q, w_uk, w_uv, w_o):
        B, Sq, M = (x.shape[0], x.shape[1], x.shape[2])
        Sk = c_kv.shape[1]
        H, D = (w_q.shape[1], w_q.shape[2])
        q = torch.einsum('bqm,mhd->bhqd', x, w_q)
        k = torch.einsum('bkc,chd->bhkd', c_kv, w_uk)
        v = torch.einsum('bkc,chd->bhkd', c_kv, w_uv)
        scores = torch.einsum('bhqd,bhkd->bhqk', q, k) * D ** (-0.5)
        off = Sk - Sq
        qi = torch.arange(Sq)[:, None]
        kj = torch.arange(Sk)[None, :]
        cmask = kj <= qi + off
        scores = torch.where(cmask[None, None], scores, -1000000000.0)
        p = _softmax(scores, axis=-1)
        ctx = torch.einsum('bhqk,bhkd->bhqd', p, v)
        return torch.einsum('bhqd,hdm->bqm', ctx, w_o)

    def _B_ref(x, w_gate, w_up, w_down):
        g = _silu(x @ w_gate)
        u = x @ w_up
        return g * u @ w_down
    x = A_x
    mod = (_silu(c) @ w_mod).reshape(c.shape[0], 6, 1, -1)
    sa, ca, ga, sb, cb, gb = (mod[:, 0].clone(), mod[:, 1].clone(), mod[:, 2].clone(), mod[:, 3].clone(), mod[:, 4].clone(), mod[:, 5].clone())
    h = _layernorm(x, axis=-1) * (1 + ca) + sa
    x = x + ga * _A_ref(h, A_c_kv, A_w_q, A_w_uk, A_w_uv, A_w_o)
    h = _layernorm(x, axis=-1) * (1 + cb) + sb
    x = x + gb * _B_ref(h, B_w_gate, B_w_up, B_w_down)
    return x
```

```asm
; @launch grid=(256,1,1) block=(256,1,1) lds=163840
.amdgcn_target "amdgcn-amd-amdhsa--gfx950"
.text
.globl adaLN_cond__compressed_kv_cla__swiglu_ffn__prompt_kernel
.p2align 8
.type adaLN_cond__compressed_kv_cla__swiglu_ffn__prompt_kernel,@function
adaLN_cond__compressed_kv_cla__swiglu_ffn__prompt_kernel:
  s_cmp_ge_u32 s2, 256
  s_cbranch_scc1 L_adaLN_cond__compressed_kv_cla__swiglu_ffn__prompt_kernel_end
  s_load_dwordx2 s[4:5], s[0:1], 0
  s_load_dwordx2 s[6:7], s[0:1], 8
  s_load_dwordx4 s[8:11], s[0:1], 24
  s_load_dwordx2 s[12:13], s[0:1], 112
  s_load_dwordx4 s[52:55], s[0:1], 80
  s_load_dwordx2 s[56:57], s[0:1], 104
  s_load_dwordx2 s[58:59], s[0:1], 16
  v_lshrrev_b32 v1, 6, v0
  v_and_b32 v2, 63, v0
  s_nop 0
  v_readfirstlane_b32 s3, v1
  s_waitcnt lgkmcnt(0)
  s_cmp_lg_u32 s3, 0
  s_cbranch_scc1 L_cpf_1
  s_getpc_b64 s[84:85]
L_pc_2:
  s_add_u32 s84, s84, L_adaLN_cond__compressed_kv_cla__swiglu_ffn__prompt_kernel_pf0-L_pc_2
  s_addc_u32 s85, s85, 0
  s_and_b32 s85, s85, 0xffff
  s_mov_b32 s86, L_adaLN_cond__compressed_kv_cla__swiglu_ffn__prompt_kernel_codeend-L_adaLN_cond__compressed_kv_cla__swiglu_ffn__prompt_kernel_pf0
  s_mov_b32 s87, 0x20000
  s_lshr_b32 s88, s2, 3
  s_mul_i32 s88, s88, 2560
  v_lshlrev_b32 v4, 7, v2
  v_cmp_gt_u32 vcc, 20, v2
  v_mov_b32 v120, 0x7fffffff
  s_nop 0
  v_cndmask_b32 v4, v120, v4, vcc
  buffer_load_dword v120, v4, s[84:87], s88 offen
L_cpf_1:
L_adaLN_cond__compressed_kv_cla__swiglu_ffn__prompt_kernel_pf0:
  s_mov_b32 s16, s4
  s_and_b32 s17, s5, 0xffff
  s_mov_b32 s18, 0x200000
  s_mov_b32 s19, 0x20000
  s_mov_b32 s20, s6
  s_and_b32 s21, s7, 0xffff
  s_mov_b32 s22, 0x200000
  s_mov_b32 s23, 0x20000
  s_mov_b32 s24, s8
  s_and_b32 s25, s9, 0xffff
  s_mov_b32 s26, 0x400000
  s_mov_b32 s27, 0x20000
  s_mov_b32 s28, s10
  s_and_b32 s29, s11, 0xffff
  s_mov_b32 s30, 0x400000
  s_mov_b32 s31, 0x20000
  s_mov_b32 s32, s12
  s_and_b32 s33, s13, 0xffff
  s_mov_b32 s34, 0x4000000
  s_mov_b32 s35, 0x20000
  s_and_b32 s39, s2, 7
  s_lshr_b32 s50, s2, 3
  s_lshr_b32 s36, s39, 1
  s_lshl_b32 s36, s36, 3
  s_and_b32 s37, s50, 7
  s_add_u32 s36, s36, s37
  s_and_b32 s37, s39, 1
  s_lshl_b32 s37, s37, 2
  s_lshr_b32 s50, s50, 3
  s_add_u32 s37, s37, s50
  v_lshlrev_b32 v3, 4, v2
  s_mov_b32 s60, s52
  s_and_b32 s61, s53, 0xffff
  s_mov_b32 s62, 0x400
  s_mov_b32 s63, 0x20000
  s_mov_b32 s64, s54
  s_and_b32 s65, s55, 0xffff
  s_mov_b32 s66, 0x300000
  s_mov_b32 s67, 0x20000
  s_mov_b32 s68, s56
  s_and_b32 s69, s57, 0xffff
  s_mov_b32 s70, 0x100
  s_mov_b32 s71, 0x20000
  s_lshr_b32 s39, s2, 3
  s_and_b32 s50, s39, 3
  s_lshr_b32 s39, s39, 2
  s_mul_i32 s39, s39, 3
  s_sub_u32 s51, s50, 1
  s_max_i32 s51, s51, 0
  s_add_u32 s39, s39, s51
  s_and_b32 s76, s2, 7
  s_lshr_b32 s51, s39, 2
  s_lshl_b32 s51, s51, 3
  s_add_u32 s76, s76, s51
  s_lshl_b32 s76, s76, 2
  s_and_b32 s39, s39, 3
  s_add_u32 s76, s76, s39
  s_cmp_eq_u32 s50, 1
  s_cselect_b32 s76, 192, s76
  s_lshl_b32 s39, s2, 14
  s_lshl_b32 s50, s3, 12
  s_add_u32 s39, s39, s50
  s_add_u32 s72, s58, s39
  s_addc_u32 s73, s59, 0
  s_and_b32 s73, s73, 0xffff
  s_mov_b32 s74, 4096
  s_mov_b32 s75, 0x20000
  s_lshl_b32 s38, s2, 3
  s_lshl_b32 s39, s3, 1
  s_add_u32 s38, s38, s39
  v_lshrrev_b32 v12, 3, v2
  v_and_b32 v13, 7, v2
  v_lshrrev_b32 v14, 1, v12
  v_xor_b32 v13, v13, v14
  v_lshlrev_b32 v13, 4, v13
  v_lshl_add_u32 v13, v12, 10, v13
  v_xor_b32 v14, 64, v13
  v_add_u32 v96, 0, v13
  v_add_u32 v97, 7168, v14
  v_add_u32 v98, 14336, v13
  v_add_u32 v99, 21504, v14
  v_add_u32 v100, 32768, v13
  v_add_u32 v101, 39936, v14
  v_add_u32 v102, 47104, v13
  v_add_u32 v103, 54272, v14
  v_lshrrev_b32 v12, 4, v2
  v_and_b32 v13, 15, v2
  v_lshrrev_b32 v14, 1, v13
  v_xor_b32 v14, v14, v12
  v_lshlrev_b32 v14, 5, v14
  v_and_b32 v15, 1, v13
  v_lshl_add_u32 v14, v15, 4, v14
  v_lshl_add_u32 v14, v12, 13, v14
  v_xor_b32 v15, 128, v14
  v_add_u32 v104, 0, v14
  v_add_u32 v105, 31744, v14
  v_add_u32 v106, 63488, v15
  v_add_u32 v107, 95232, v15
  s_mul_i32 s40, s3, 24576
  s_add_u32 s40, s40, 65536
  s_lshl_b32 s41, s37, 18
  s_lshl_b32 s39, s3, 16
  s_add_u32 s41, s41, s39
  s_lshl_b32 s42, s3, 17
  s_lshl_b32 s39, s36, 8
  s_add_u32 s42, s42, s39
  s_and_b32 s77, s3, 1
  s_lshl_b32 s77, s77, 12
  s_lshl_b32 s44, s3, 12
  s_lshl_b32 s45, s36, 5
  s_lshl_b32 s39, s37, 2
  s_add_u32 s45, s45, s39
  s_add_u32 s45, s45, s3
  s_lshl_b32 s45, s45, 15
  s_add_u32 s45, s45, 0x2000000
  s_mov_b32 s49, 0x3e0293ee
  s_lshr_b32 s39, s2, 3
  s_and_b32 s78, s39, 7
  s_lshr_b32 s39, s39, 3
  s_lshl_b32 s39, s39, 1
  s_add_u32 s78, s78, s39
  s_and_b32 s78, s78, 7
  v_lshlrev_b32 v118, 10, v2
  s_lshr_b32 s39, s2, 3
  s_and_b32 s39, s39, 3
  s_lshl_b32 s39, s39, 16
  s_lshl_b32 s50, s37, 18
  s_add_u32 s39, s39, s50
  s_lshl_b32 s50, s3, 8
  s_add_u32 s39, s39, s50
  s_add_u32 s46, s78, 0
  s_and_b32 s46, s46, 7
  s_lshl_b32 s46, s46, 7
  s_add_u32 s46, s46, s41
  s_add_u32 m0, s40, 0
  s_nop 0
  buffer_load_dwordx4 v96, s[20:23], s46 offen offset:0  lds
  buffer_load_dwordx4 v97, s[20:23], s46 offen offset:1024  lds
  buffer_load_dwordx4 v98, s[20:23], s46 offen offset:2048  lds
  buffer_load_dwordx4 v99, s[20:23], s46 offen offset:3072  lds
  s_add_u32 m0, s40, 4096
  s_nop 0
  buffer_load_dwordx4 v100, s[20:23], s46 offen offset:0  lds
  buffer_load_dwordx4 v101, s[20:23], s46 offen offset:1024  lds
  buffer_load_dwordx4 v102, s[20:23], s46 offen offset:2048  lds
  buffer_load_dwordx4 v103, s[20:23], s46 offen offset:3072  lds
  s_add_u32 s47, s78, 0
  s_and_b32 s47, s47, 7
  s_lshl_b32 s47, s47, 19
  s_add_u32 s47, s47, s42
  s_add_u32 m0, s44, 0
  s_nop 0
  buffer_load_dwordx4 v104, s[24:27], s47 offen offset:0  lds
  buffer_load_dwordx4 v105, s[24:27], s47 offen offset:1024  lds
  buffer_load_dwordx4 v106, s[24:27], s47 offen offset:2048  lds
  buffer_load_dwordx4 v107, s[24:27], s47 offen offset:3072  lds
  v_lshrrev_b32 v12, 4, v2
  v_bfe_u32 v13, v2, 2, 2
  v_and_b32 v14, 3, v2
  v_lshl_add_u32 v15, v12, 3, v13
  v_and_b32 v16, 1, v12
  v_lshl_add_u32 v16, v16, 2, v13
  v_lshlrev_b32 v16, 5, v16
  v_lshlrev_b32 v17, 8, v15
  v_lshl_add_u32 v17, v14, 3, v17
  v_xor_b32 v18, 0, v16
  v_add_u32 v4, v17, v18
  v_xor_b32 v18, 32, v16
  v_add_u32 v5, v17, v18
  v_xor_b32 v18, 64, v16
  v_add_u32 v6, v17, v18
  v_xor_b32 v18, 96, v16
  v_add_u32 v7, v17, v18
  v_xor_b32 v18, 128, v16
  v_add_u32 v8, v17, v18
  v_xor_b32 v18, 160, v16
  v_add_u32 v9, v17, v18
  v_xor_b32 v18, 192, v16
  v_add_u32 v10, v17, v18
  v_xor_b32 v18, 224, v16
  v_add_u32 v11, v17, v18
  v_and_b32 v12, 15, v2
  v_lshrrev_b32 v13, 4, v2
  v_lshrrev_b32 v14, 1, v12
  v_xor_b32 v13, v13, v14
  v_lshlrev_b32 v13, 4, v13
  v_lshl_add_u32 v13, v12, 7, v13
  v_add_u32 v116, s40, v13
  v_xor_b32 v117, 64, v116
  s_add_u32 s46, s78, 1
  s_and_b32 s46, s46, 7
  s_lshl_b32 s46, s46, 7
  s_add_u32 s46, s46, s41
  s_add_u32 m0, s40, 8192
  s_nop 0
  buffer_load_dwordx4 v96, s[20:23], s46 offen offset:0  lds
  buffer_load_dwordx4 v97, s[20:23], s46 offen offset:1024  lds
  buffer_load_dwordx4 v98, s[20:23], s46 offen offset:2048  lds
  buffer_load_dwordx4 v99, s[20:23], s46 offen offset:3072  lds
  s_add_u32 m0, s40, 12288
  s_nop 0
  buffer_load_dwordx4 v100, s[20:23], s46 offen offset:0  lds
  buffer_load_dwordx4 v101, s[20:23], s46 offen offset:1024  lds
  buffer_load_dwordx4 v102, s[20:23], s46 offen offset:2048  lds
  buffer_load_dwordx4 v103, s[20:23], s46 offen offset:3072  lds
  s_add_u32 s47, s78, 1
  s_and_b32 s47, s47, 7
  s_lshl_b32 s47, s47, 19
  s_add_u32 s47, s47, s42
  s_add_u32 m0, s44, 16384
  s_nop 0
  buffer_load_dwordx4 v104, s[24:27], s47 offen offset:0  lds
  buffer_load_dwordx4 v105, s[24:27], s47 offen offset:1024  lds
  buffer_load_dwordx4 v106, s[24:27], s47 offen offset:2048  lds
  buffer_load_dwordx4 v107, s[24:27], s47 offen offset:3072  lds
  s_add_u32 s46, s78, 2
  s_and_b32 s46, s46, 7
  s_lshl_b32 s46, s46, 7
  s_add_u32 s46, s46, s41
  s_add_u32 m0, s40, 16384
  s_nop 0
  buffer_load_dwordx4 v96, s[20:23], s46 offen offset:0  lds
  buffer_load_dwordx4 v97, s[20:23], s46 offen offset:1024  lds
  buffer_load_dwordx4 v98, s[20:23], s46 offen offset:2048  lds
  buffer_load_dwordx4 v99, s[20:23], s46 offen offset:3072  lds
  s_add_u32 m0, s40, 20480
  s_nop 0
  buffer_load_dwordx4 v100, s[20:23], s46 offen offset:0  lds
  buffer_load_dwordx4 v101, s[20:23], s46 offen offset:1024  lds
  buffer_load_dwordx4 v102, s[20:23], s46 offen offset:2048  lds
  buffer_load_dwordx4 v103, s[20:23], s46 offen offset:3072  lds
  s_add_u32 s47, s78, 2
  s_and_b32 s47, s47, 7
  s_lshl_b32 s47, s47, 19
  s_add_u32 s47, s47, s42
  s_add_u32 m0, s44, 32768
  s_nop 0
  buffer_load_dwordx4 v104, s[24:27], s47 offen offset:0  lds
  buffer_load_dwordx4 v105, s[24:27], s47 offen offset:1024  lds
  buffer_load_dwordx4 v106, s[24:27], s47 offen offset:2048  lds
  buffer_load_dwordx4 v107, s[24:27], s47 offen offset:3072  lds
  s_cmp_ge_u32 s76, 192
  s_cbranch_scc1 L_m1_3
  v_lshrrev_b32 v12, 1, v0
  v_lshlrev_b32 v13, 1, v12
  buffer_load_ushort a240, v13, s[60:63], 0 offen offset:0
  buffer_load_ushort a241, v13, s[60:63], 0 offen offset:256
  buffer_load_ushort a242, v13, s[60:63], 0 offen offset:512
  buffer_load_ushort a243, v13, s[60:63], 0 offen offset:768
  v_mul_u32_u24 v13, 6144, v12
  v_and_b32 v14, 1, v0
  v_lshl_add_u32 v13, v14, 4, v13
  s_lshl_b32 s39, s76, 5
  buffer_load_dwordx4 a[224:227], v13, s[64:67], s39 offen
  s_add_u32 s39, s39, 786432
  buffer_load_dwordx4 a[228:231], v13, s[64:67], s39 offen
  s_add_u32 s39, s39, 786432
  buffer_load_dwordx4 a[232:235], v13, s[64:67], s39 offen
  s_add_u32 s39, s39, 786432
  buffer_load_dwordx4 a[236:239], v13, s[64:67], s39 offen
L_m1_3:
  v_mov_b32 v1, 0
  v_cmp_eq_u32 vcc, 0, v2
  v_mov_b32 v28, 0x1000
  s_nop 0
  v_cndmask_b32 v28, v28, v1, vcc
  v_and_b32 v30, 7, v2
  v_lshlrev_b32 v30, 7, v30
  s_waitcnt vmcnt(24)
  s_barrier
  ds_read_b64_tr_b16 v[32:33], v4 offset:0
  ds_read_b64_tr_b16 v[34:35], v4 offset:1024
  ds_read_b64_tr_b16 v[36:37], v5 offset:0
  ds_read_b64_tr_b16 v[38:39], v5 offset:1024
  ds_read_b64_tr_b16 v[40:41], v6 offset:0
  ds_read_b64_tr_b16 v[42:43], v6 offset:1024
  ds_read_b64_tr_b16 v[44:45], v7 offset:0
  ds_read_b64_tr_b16 v[46:47], v7 offset:1024
  ds_read_b64_tr_b16 v[48:49], v8 offset:0
  ds_read_b64_tr_b16 v[50:51], v8 offset:1024
  ds_read_b64_tr_b16 v[52:53], v9 offset:0
  ds_read_b64_tr_b16 v[54:55], v9 offset:1024
  ds_read_b64_tr_b16 v[56:57], v10 offset:0
  ds_read_b64_tr_b16 v[58:59], v10 offset:1024
  ds_read_b64_tr_b16 v[60:61], v11 offset:0
  ds_read_b64_tr_b16 v[62:63], v11 offset:1024
  ds_read_b128 a[0:3], v116 offset:0
  ds_read_b128 a[4:7], v116 offset:2048
  ds_read_b128 a[8:11], v116 offset:4096
  ds_read_b128 a[12:15], v116 offset:6144
  s_waitcnt lgkmcnt(0)
  v_mfma_f32_16x16x32_bf16 v[128:131], v[32:35], a[0:3], 0
  ds_read_b64_tr_b16 v[64:65], v4 offset:8192
  v_mfma_f32_16x16x32_bf16 v[136:139], v[32:35], a[4:7], 0
  ds_read_b64_tr_b16 v[66:67], v4 offset:9216
  v_mfma_f32_16x16x32_bf16 v[144:147], v[32:35], a[8:11], 0
  ds_read_b128 a[16:19], v117 offset:0
  v_mfma_f32_16x16x32_bf16 v[152:155], v[32:35], a[12:15], 0
  v_mfma_f32_16x16x32_bf16 v[132:135], v[36:39], a[0:3], 0
  ds_read_b128 a[20:23], v117 offset:2048
  v_mfma_f32_16x16x32_bf16 v[140:143], v[36:39], a[4:7], 0
  ds_read_b128 a[24:27], v117 offset:4096
  v_mfma_f32_16x16x32_bf16 v[148:151], v[36:39], a[8:11], 0
  ds_read_b128 a[28:31], v117 offset:6144
  v_mfma_f32_16x16x32_bf16 v[156:159], v[36:39], a[12:15], 0
  ds_read_b64_tr_b16 v[68:69], v5 offset:8192
  v_mfma_f32_16x16x32_bf16 v[160:163], v[40:43], a[0:3], 0
  v_mfma_f32_16x16x32_bf16 v[168:171], v[40:43], a[4:7], 0
  ds_read_b64_tr_b16 v[70:71], v5 offset:9216
  v_mfma_f32_16x16x32_bf16 v[176:179], v[40:43], a[8:11], 0
  ds_read_b64_tr_b16 v[72:73], v6 offset:8192
  v_mfma_f32_16x16x32_bf16 v[184:187], v[40:43], a[12:15], 0
  ds_read_b64_tr_b16 v[74:75], v6 offset:9216
  v_mfma_f32_16x16x32_bf16 v[164:167], v[44:47], a[0:3], 0
  ds_read_b64_tr_b16 v[76:77], v7 offset:8192
  v_mfma_f32_16x16x32_bf16 v[172:175], v[44:47], a[4:7], 0
  v_mfma_f32_16x16x32_bf16 v[180:183], v[44:47], a[8:11], 0
  ds_read_b64_tr_b16 v[78:79], v7 offset:9216
  v_mfma_f32_16x16x32_bf16 v[188:191], v[44:47], a[12:15], 0
  ds_read_b64_tr_b16 v[80:81], v8 offset:8192
  v_mfma_f32_16x16x32_bf16 v[192:195], v[48:51], a[0:3], 0
  ds_read_b64_tr_b16 v[82:83], v8 offset:9216
  v_mfma_f32_16x16x32_bf16 v[200:203], v[48:51], a[4:7], 0
  ds_read_b64_tr_b16 v[84:85], v9 offset:8192
  v_mfma_f32_16x16x32_bf16 v[208:211], v[48:51], a[8:11], 0
  v_mfma_f32_16x16x32_bf16 v[216:219], v[48:51], a[12:15], 0
  ds_read_b64_tr_b16 v[86:87], v9 offset:9216
  v_mfma_f32_16x16x32_bf16 v[196:199], v[52:55], a[0:3], 0
  ds_read_b64_tr_b16 v[88:89], v10 offset:8192
  v_mfma_f32_16x16x32_bf16 v[204:207], v[52:55], a[4:7], 0
  ds_read_b64_tr_b16 v[90:91], v10 offset:9216
  v_mfma_f32_16x16x32_bf16 v[212:215], v[52:55], a[8:11], 0
  ds_read_b64_tr_b16 v[92:93], v11 offset:8192
  v_mfma_f32_16x16x32_bf16 v[220:223], v[52:55], a[12:15], 0
  v_mfma_f32_16x16x32_bf16 v[224:227], v[56:59], a[0:3], 0
  ds_read_b64_tr_b16 v[94:95], v11 offset:9216
  v_mfma_f32_16x16x32_bf16 v[232:235], v[56:59], a[4:7], 0
  v_mfma_f32_16x16x32_bf16 v[240:243], v[56:59], a[8:11], 0
  v_mfma_f32_16x16x32_bf16 v[248:251], v[56:59], a[12:15], 0
  v_mfma_f32_16x16x32_bf16 v[228:231], v[60:63], a[0:3], 0
  v_mfma_f32_16x16x32_bf16 v[236:239], v[60:63], a[4:7], 0
  v_mfma_f32_16x16x32_bf16 v[244:247], v[60:63], a[8:11], 0
  v_mfma_f32_16x16x32_bf16 v[252:255], v[60:63], a[12:15], 0
  s_waitcnt lgkmcnt(0)
  s_waitcnt vmcnt(12)
  s_barrier
  v_mfma_f32_16x16x32_bf16 v[128:131], v[64:67], a[16:19], v[128:131]
  ds_read_b64_tr_b16 v[32:33], v4 offset:16384
  v_mfma_f32_16x16x32_bf16 v[136:139], v[64:67], a[20:23], v[136:139]
  ds_read_b64_tr_b16 v[34:35], v4 offset:17408
  v_mfma_f32_16x16x32_bf16 v[144:147], v[64:67], a[24:27], v[144:147]
  ds_read_b128 a[32:35], v116 offset:8192
  s_add_u32 s46, s78, 3
  s_and_b32 s46, s46, 7
  s_lshl_b32 s46, s46, 7
  s_add_u32 s46, s46, s41
  s_add_u32 m0, s40, 0
  v_mfma_f32_16x16x32_bf16 v[152:155], v[64:67], a[28:31], v[152:155]
  buffer_load_dwordx4 v96, s[20:23], s46 offen offset:0  lds
  v_mfma_f32_16x16x32_bf16 v[132:135], v[68:71], a[16:19], v[132:135]
  ds_read_b128 a[36:39], v116 offset:10240
  v_mfma_f32_16x16x32_bf16 v[140:143], v[68:71], a[20:23], v[140:143]
  ds_read_b128 a[40:43], v116 offset:12288
  v_mfma_f32_16x16x32_bf16 v[148:151], v[68:71], a[24:27], v[148:151]
  ds_read_b128 a[44:47], v116 offset:14336
  v_mfma_f32_16x16x32_bf16 v[156:159], v[68:71], a[28:31], v[156:159]
  ds_read_b64_tr_b16 v[36:37], v5 offset:16384
  v_mfma_f32_16x16x32_bf16 v[160:163], v[72:75], a[16:19], v[160:163]
  buffer_load_dwordx4 v97, s[20:23], s46 offen offset:1024  lds
  v_mfma_f32_16x16x32_bf16 v[168:171], v[72:75], a[20:23], v[168:171]
  ds_read_b64_tr_b16 v[38:39], v5 offset:17408
  v_mfma_f32_16x16x32_bf16 v[176:179], v[72:75], a[24:27], v[176:179]
  ds_read_b64_tr_b16 v[40:41], v6 offset:16384
  v_mfma_f32_16x16x32_bf16 v[184:187], v[72:75], a[28:31], v[184:187]
  ds_read_b64_tr_b16 v[42:43], v6 offset:17408
  v_mfma_f32_16x16x32_bf16 v[164:167], v[76:79], a[16:19], v[164:167]
  ds_read_b64_tr_b16 v[44:45], v7 offset:16384
  v_mfma_f32_16x16x32_bf16 v[172:175], v[76:79], a[20:23], v[172:175]
  buffer_load_dwordx4 v98, s[20:23], s46 offen offset:2048  lds
  v_mfma_f32_16x16x32_bf16 v[180:183], v[76:79], a[24:27], v[180:183]
  ds_read_b64_tr_b16 v[46:47], v7 offset:17408
  v_mfma_f32_16x16x32_bf16 v[188:191], v[76:79], a[28:31], v[188:191]
  ds_read_b64_tr_b16 v[48:49], v8 offset:16384
  v_mfma_f32_16x16x32_bf16 v[192:195], v[80:83], a[16:19], v[192:195]
  ds_read_b64_tr_b16 v[50:51], v8 offset:17408
  v_mfma_f32_16x16x32_bf16 v[200:203], v[80:83], a[20:23], v[200:203]
  ds_read_b64_tr_b16 v[52:53], v9 offset:16384
  v_mfma_f32_16x16x32_bf16 v[208:211], v[80:83], a[24:27], v[208:211]
  buffer_load_dwordx4 v99, s[20:23], s46 offen offset:3072  lds
  v_mfma_f32_16x16x32_bf16 v[216:219], v[80:83], a[28:31], v[216:219]
  ds_read_b64_tr_b16 v[54:55], v9 offset:17408
  v_mfma_f32_16x16x32_bf16 v[196:199], v[84:87], a[16:19], v[196:199]
  ds_read_b64_tr_b16 v[56:57], v10 offset:16384
  v_mfma_f32_16x16x32_bf16 v[204:207], v[84:87], a[20:23], v[204:207]
  ds_read_b64_tr_b16 v[58:59], v10 offset:17408
  v_mfma_f32_16x16x32_bf16 v[212:215], v[84:87], a[24:27], v[212:215]
  ds_read_b64_tr_b16 v[60:61], v11 offset:16384
  s_add_u32 m0, s40, 4096
  v_mfma_f32_16x16x32_bf16 v[220:223], v[84:87], a[28:31], v[220:223]
  buffer_load_dwordx4 v100, s[20:23], s46 offen offset:0  lds
  v_mfma_f32_16x16x32_bf16 v[224:227], v[88:91], a[16:19], v[224:227]
  ds_read_b64_tr_b16 v[62:63], v11 offset:17408
  v_mfma_f32_16x16x32_bf16 v[232:235], v[88:91], a[20:23], v[232:235]
  v_mfma_f32_16x16x32_bf16 v[240:243], v[88:91], a[24:27], v[240:243]
  v_mfma_f32_16x16x32_bf16 v[248:251], v[88:91], a[28:31], v[248:251]
  v_mfma_f32_16x16x32_bf16 v[228:231], v[92:95], a[16:19], v[228:231]
  buffer_load_dwordx4 v101, s[20:23], s46 offen offset:1024  lds
  v_mfma_f32_16x16x32_bf16 v[236:239], v[92:95], a[20:23], v[236:239]
  v_mfma_f32_16x16x32_bf16 v[244:247], v[92:95], a[24:27], v[244:247]
  v_mfma_f32_16x16x32_bf16 v[252:255], v[92:95], a[28:31], v[252:255]
  s_waitcnt lgkmcnt(0)
  s_waitcnt vmcnt(6)
  s_cmp_ge_u32 s76, 192
  s_cbranch_scc1 L_m2_4
  v_accvgpr_read_b32 v20, a240
  v_lshlrev_b32 v20, 16, v20
  v_mul_f32 v26, 0xbfb8aa3b, v20
  v_exp_f32 v26, v26
  s_nop 0
  v_add_f32 v26, 1.0, v26
  v_rcp_f32 v26, v26
  s_nop 0
  v_mul_f32 v20, v20, v26
  v_cvt_pk_bf16_f32 v20, v20, v20
  v_lshlrev_b32 v20, 16, v20
  v_accvgpr_read_b32 v21, a241
  v_lshlrev_b32 v21, 16, v21
  v_mul_f32 v26, 0xbfb8aa3b, v21
  v_exp_f32 v26, v26
  s_nop 0
  v_add_f32 v26, 1.0, v26
  v_rcp_f32 v26, v26
  s_nop 0
  v_mul_f32 v21, v21, v26
  v_cvt_pk_bf16_f32 v21, v21, v21
  v_lshlrev_b32 v21, 16, v21
  v_accvgpr_read_b32 v22, a242
  v_lshlrev_b32 v22, 16, v22
  v_mul_f32 v26, 0xbfb8aa3b, v22
  v_exp_f32 v26, v26
  s_nop 0
  v_add_f32 v26, 1.0, v26
  v_rcp_f32 v26, v26
  s_nop 0
  v_mul_f32 v22, v22, v26
  v_cvt_pk_bf16_f32 v22, v22, v22
  v_lshlrev_b32 v22, 16, v22
  v_accvgpr_read_b32 v23, a243
  v_lshlrev_b32 v23, 16, v23
  v_mul_f32 v26, 0xbfb8aa3b, v23
  v_exp_f32 v26, v26
  s_nop 0
  v_add_f32 v26, 1.0, v26
  v_rcp_f32 v26, v26
  s_nop 0
  v_mul_f32 v23, v23, v26
  v_cvt_pk_bf16_f32 v23, v23, v23
  v_lshlrev_b32 v23, 16, v23
  v_accvgpr_read_b32 v27, a224
  v_lshlrev_b32 v26, 16, v27
  v_and_b32 v27, 0xffff0000, v27
  v_mul_f32 v12, v20, v26
  v_mul_f32 v13, v20, v27
  v_accvgpr_read_b32 v27, a225
  v_lshlrev_b32 v26, 16, v27
  v_and_b32 v27, 0xffff0000, v27
  v_mul_f32 v14, v20, v26
  v_mul_f32 v15, v20, v27
  v_accvgpr_read_b32 v27, a226
  v_lshlrev_b32 v26, 16, v27
  v_and_b32 v27, 0xffff0000, v27
  v_mul_f32 v16, v20, v26
  v_mul_f32 v17, v20, v27
  v_accvgpr_read_b32 v27, a227
  v_lshlrev_b32 v26, 16, v27
  v_and_b32 v27, 0xffff0000, v27
  v_mul_f32 v18, v20, v26
  v_mul_f32 v19, v20, v27
  v_accvgpr_read_b32 v27, a228
  v_lshlrev_b32 v26, 16, v27
  v_and_b32 v27, 0xffff0000, v27
  v_fmac_f32 v12, v21, v26
  v_fmac_f32 v13, v21, v27
  v_accvgpr_read_b32 v27, a229
  v_lshlrev_b32 v26, 16, v27
  v_and_b32 v27, 0xffff0000, v27
  v_fmac_f32 v14, v21, v26
  v_fmac_f32 v15, v21, v27
  v_accvgpr_read_b32 v27, a230
  v_lshlrev_b32 v26, 16, v27
  v_and_b32 v27, 0xffff0000, v27
  v_fmac_f32 v16, v21, v26
  v_fmac_f32 v17, v21, v27
  v_accvgpr_read_b32 v27, a231
  v_lshlrev_b32 v26, 16, v27
  v_and_b32 v27, 0xffff0000, v27
  v_fmac_f32 v18, v21, v26
  v_fmac_f32 v19, v21, v27
  v_accvgpr_read_b32 v27, a232
  v_lshlrev_b32 v26, 16, v27
  v_and_b32 v27, 0xffff0000, v27
  v_fmac_f32 v12, v22, v26
  v_fmac_f32 v13, v22, v27
  v_accvgpr_read_b32 v27, a233
  v_lshlrev_b32 v26, 16, v27
  v_and_b32 v27, 0xffff0000, v27
  v_fmac_f32 v14, v22, v26
  v_fmac_f32 v15, v22, v27
  v_accvgpr_read_b32 v27, a234
  v_lshlrev_b32 v26, 16, v27
  v_and_b32 v27, 0xffff0000, v27
  v_fmac_f32 v16, v22, v26
  v_fmac_f32 v17, v22, v27
  v_accvgpr_read_b32 v27, a235
  v_lshlrev_b32 v26, 16, v27
  v_and_b32 v27, 0xffff0000, v27
  v_fmac_f32 v18, v22, v26
  v_fmac_f32 v19, v22, v27
  v_accvgpr_read_b32 v27, a236
  v_lshlrev_b32 v26, 16, v27
  v_and_b32 v27, 0xffff0000, v27
  v_fmac_f32 v12, v23, v26
  v_fmac_f32 v13, v23, v27
  v_accvgpr_read_b32 v27, a237
  v_lshlrev_b32 v26, 16, v27
  v_and_b32 v27, 0xffff0000, v27
  v_fmac_f32 v14, v23, v26
  v_fmac_f32 v15, v23, v27
  v_accvgpr_read_b32 v27, a238
  v_lshlrev_b32 v26, 16, v27
  v_and_b32 v27, 0xffff0000, v27
  v_fmac_f32 v16, v23, v26
  v_fmac_f32 v17, v23, v27
  v_accvgpr_read_b32 v27, a239
  v_lshlrev_b32 v26, 16, v27
  v_and_b32 v27, 0xffff0000, v27
  v_fmac_f32 v18, v23, v26
  v_fmac_f32 v19, v23, v27
  v_add_f32_dpp v12, v12, v12 quad_perm:[2,3,0,1] row_mask:0xf bank_mask:0xf
  v_add_f32_dpp v13, v13, v13 quad_perm:[2,3,0,1] row_mask:0xf bank_mask:0xf
  v_add_f32_dpp v14, v14, v14 quad_perm:[2,3,0,1] row_mask:0xf bank_mask:0xf
  v_add_f32_dpp v15, v15, v15 quad_perm:[2,3,0,1] row_mask:0xf bank_mask:0xf
  v_add_f32_dpp v16, v16, v16 quad_perm:[2,3,0,1] row_mask:0xf bank_mask:0xf
  v_add_f32_dpp v17, v17, v17 quad_perm:[2,3,0,1] row_mask:0xf bank_mask:0xf
  v_add_f32_dpp v18, v18, v18 quad_perm:[2,3,0,1] row_mask:0xf bank_mask:0xf
  v_add_f32_dpp v19, v19, v19 quad_perm:[2,3,0,1] row_mask:0xf bank_mask:0xf
  v_add_f32_dpp v12, v12, v12 row_ror:4 row_mask:0xf bank_mask:0xf
  v_add_f32_dpp v13, v13, v13 row_ror:4 row_mask:0xf bank_mask:0xf
  v_add_f32_dpp v14, v14, v14 row_ror:4 row_mask:0xf bank_mask:0xf
  v_add_f32_dpp v15, v15, v15 row_ror:4 row_mask:0xf bank_mask:0xf
  v_add_f32_dpp v16, v16, v16 row_ror:4 row_mask:0xf bank_mask:0xf
  v_add_f32_dpp v17, v17, v17 row_ror:4 row_mask:0xf bank_mask:0xf
  v_add_f32_dpp v18, v18, v18 row_ror:4 row_mask:0xf bank_mask:0xf
  v_add_f32_dpp v19, v19, v19 row_ror:4 row_mask:0xf bank_mask:0xf
  v_add_f32_dpp v12, v12, v12 row_ror:8 row_mask:0xf bank_mask:0xf
  v_add_f32_dpp v13, v13, v13 row_ror:8 row_mask:0xf bank_mask:0xf
  v_add_f32_dpp v14, v14, v14 row_ror:8 row_mask:0xf bank_mask:0xf
  v_add_f32_dpp v15, v15, v15 row_ror:8 row_mask:0xf bank_mask:0xf
  v_add_f32_dpp v16, v16, v16 row_ror:8 row_mask:0xf bank_mask:0xf
  v_add_f32_dpp v17, v17, v17 row_ror:8 row_mask:0xf bank_mask:0xf
  v_add_f32_dpp v18, v18, v18 row_ror:8 row_mask:0xf bank_mask:0xf
  v_add_f32_dpp v19, v19, v19 row_ror:8 row_mask:0xf bank_mask:0xf
  v_mov_b32 v118, v12
  v_mov_b32 v119, v13
  v_mov_b32 v120, v14
  v_mov_b32 v121, v15
  v_mov_b32 v122, v16
  v_mov_b32 v123, v17
  v_mov_b32 v124, v18
  v_mov_b32 v125, v19
  s_nop 0
  v_permlane16_swap_b32 v12, v118
  v_permlane16_swap_b32 v13, v119
  v_permlane16_swap_b32 v14, v120
  v_permlane16_swap_b32 v15, v121
  v_permlane16_swap_b32 v16, v122
  v_permlane16_swap_b32 v17, v123
  v_permlane16_swap_b32 v18, v124
  v_permlane16_swap_b32 v19, v125
  s_nop 0
  v_add_f32 v12, v12, v118
  v_add_f32 v13, v13, v119
  v_add_f32 v14, v14, v120
  v_add_f32 v15, v15, v121
  v_add_f32 v16, v16, v122
  v_add_f32 v17, v17, v123
  v_add_f32 v18, v18, v124
  v_add_f32 v19, v19, v125
  v_mov_b32 v118, v12
  v_mov_b32 v119, v13
  v_mov_b32 v120, v14
  v_mov_b32 v121, v15
  v_mov_b32 v122, v16
  v_mov_b32 v123, v17
  v_mov_b32 v124, v18
  v_mov_b32 v125, v19
  s_nop 0
  v_permlane32_swap_b32 v12, v118
  v_permlane32_swap_b32 v13, v119
  v_permlane32_swap_b32 v14, v120
  v_permlane32_swap_b32 v15, v121
  v_permlane32_swap_b32 v16, v122
  v_permlane32_swap_b32 v17, v123
  v_permlane32_swap_b32 v18, v124
  v_permlane32_swap_b32 v19, v125
  s_nop 0
  v_add_f32 v12, v12, v118
  v_add_f32 v13, v13, v119
  v_add_f32 v14, v14, v120
  v_add_f32 v15, v15, v121
  v_add_f32 v16, v16, v122
  v_add_f32 v17, v17, v123
  v_add_f32 v18, v18, v124
  v_add_f32 v19, v19, v125
  v_and_b32 v24, 1, v2
  v_lshlrev_b32 v24, 5, v24
  s_lshl_b32 s39, s3, 6
  s_add_u32 s39, s39, 49152
  v_add_u32 v24, s39, v24
  v_cmp_gt_u32 vcc, 2, v2
  s_and_saveexec_b64 s[50:51], vcc
  s_cbranch_execz L_mw_5
  ds_write_b128 v24, v[12:15]
  ds_write_b128 v24, v[16:19] offset:16
L_mw_5:
  s_mov_b64 exec, s[50:51]
  s_waitcnt lgkmcnt(0)
  s_barrier
  s_cmp_lg_u32 s3, 0
  s_cbranch_scc1 L_mf_6
  v_lshlrev_b32 v24, 2, v2
  v_add_u32 v25, 49152, v24
  ds_read_b32 v20, v25 offset:0
  ds_read_b32 v21, v25 offset:64
  ds_read_b32 v22, v25 offset:128
  ds_read_b32 v23, v25 offset:192
  s_waitcnt lgkmcnt(0)
  v_add_f32 v20, v20, v21
  v_add_f32 v22, v22, v23
  v_add_f32 v20, v20, v22
  v_cvt_pk_bf16_f32 v20, v20, v20
  v_lshlrev_b32 v20, 16, v20
  v_cmp_gt_u32 vcc, 16, v2
  s_and_saveexec_b64 s[50:51], vcc
  s_cbranch_execz L_mx_7
  s_lshl_b32 s39, s76, 6
  s_add_u32 s39, s39, 0
  buffer_store_dword v20, v24, s[32:35], s39 offen sc1
  s_cmp_lt_u32 s76, 64
  s_cbranch_scc0 L_zc_8
  s_lshl_b32 s39, s76, 8
  s_add_u32 s39, s39, 294912
  v_mov_b32 v21, 0
  v_mov_b32 v22, 0
  buffer_store_dword v21, v22, s[32:35], s39 offen sc1
  s_add_u32 s39, s39, 16384
  buffer_store_dword v21, v22, s[32:35], s39 offen sc1
L_zc_8:
  s_cmp_lt_u32 s76, 64
  s_cbranch_scc0 L_mpk_9
  v_add_f32 v21, 1.0, v20
  v_cvt_pk_bf16_f32 v21, v21, v21
  v_lshrrev_b32 v22, 16, v20
  s_cmp_ge_u32 s76, 32
  s_cselect_b64 vcc, -1, 0
  v_cndmask_b32 v21, v22, v21, vcc
  v_lshlrev_b32 v25, 1, v2
  s_lshl_b32 s39, s76, 5
  s_add_u32 s39, s39, 14336
  buffer_store_short v21, v25, s[32:35], s39 offen sc1
L_mpk_9:
  s_sub_u32 s39, s76, 96
  s_cmp_lt_u32 s39, 64
  s_cbranch_scc0 L_mx_7
  s_lshr_b32 s48, s39, 5
  v_add_f32 v21, 1.0, v20
  v_cvt_pk_bf16_f32 v21, v21, v21
  v_lshrrev_b32 v22, 16, v20
  s_cmp_eq_u32 s48, 1
  s_cmp_eq_u32 s48, 1
  s_cselect_b64 vcc, -1, 0
  v_cndmask_b32 v21, v22, v21, vcc
  s_and_b32 s39, s39, 31
  s_lshl_b32 s39, s39, 4
  v_add_u32 v25, s39, v2
  v_lshrrev_b32 v118, 5, v25
  v_lshlrev_b32 v118, 10, v118
  v_bfe_u32 v119, v25, 3, 2
  v_lshl_add_u32 v118, v119, 8, v118
  v_and_b32 v119, 7, v25
  v_lshl_add_u32 v118, v119, 1, v118
  s_xor_b32 s48, s48, 1
  s_lshl_b32 s48, s48, 4
  s_add_u32 s48, s48, 49152
  buffer_store_short v21, v118, s[32:35], s48 offen sc1
L_mx_7:
  s_mov_b64 exec, s[50:51]
L_mf_6:
L_m2_4:
  v_mfma_f32_16x16x32_bf16 v[128:131], v[32:35], a[32:35], v[128:131]
  ds_read_b64_tr_b16 v[64:65], v4 offset:24576
  v_mfma_f32_16x16x32_bf16 v[136:139], v[32:35], a[36:39], v[136:139]
  ds_read_b64_tr_b16 v[66:67], v4 offset:25600
  v_mfma_f32_16x16x32_bf16 v[144:147], v[32:35], a[40:43], v[144:147]
  ds_read_b128 a[48:51], v117 offset:8192
  v_mfma_f32_16x16x32_bf16 v[152:155], v[32:35], a[44:47], v[152:155]
  buffer_load_dwordx4 v102, s[20:23], s46 offen offset:2048  lds
  v_mfma_f32_16x16x32_bf16 v[132:135], v[36:39], a[32:35], v[132:135]
  ds_read_b128 a[52:55], v117 offset:10240
  v_mfma_f32_16x16x32_bf16 v[140:143], v[36:39], a[36:39], v[140:143]
  ds_read_b128 a[56:59], v117 offset:12288
  v_mfma_f32_16x16x32_bf16 v[148:151], v[36:39], a[40:43], v[148:151]
  ds_read_b128 a[60:63], v117 offset:14336
  v_mfma_f32_16x16x32_bf16 v[156:159], v[36:39], a[44:47], v[156:159]
  ds_read_b64_tr_b16 v[68:69], v5 offset:24576
  v_mfma_f32_16x16x32_bf16 v[160:163], v[40:43], a[32:35], v[160:163]
  buffer_load_dwordx4 v103, s[20:23], s46 offen offset:3072  lds
  v_mfma_f32_16x16x32_bf16 v[168:171], v[40:43], a[36:39], v[168:171]
  ds_read_b64_tr_b16 v[70:71], v5 offset:25600
  v_mfma_f32_16x16x32_bf16 v[176:179], v[40:43], a[40:43], v[176:179]
  ds_read_b64_tr_b16 v[72:73], v6 offset:24576
  v_mfma_f32_16x16x32_bf16 v[184:187], v[40:43], a[44:47], v[184:187]
  ds_read_b64_tr_b16 v[74:75], v6 offset:25600
  v_mfma_f32_16x16x32_bf16 v[164:167], v[44:47], a[32:35], v[164:167]
  ds_read_b64_tr_b16 v[76:77], v7 offset:24576
  s_add_u32 s47, s78, 4
  s_and_b32 s47, s47, 7
  s_lshl_b32 s47, s47, 19
  s_add_u32 s47, s47, s42
  s_add_u32 m0, s44, 0
  v_mfma_f32_16x16x32_bf16 v[172:175], v[44:47], a[36:39], v[172:175]
  buffer_load_dwordx4 v104, s[24:27], s47 offen offset:0  lds
  v_mfma_f32_16x16x32_bf16 v[180:183], v[44:47], a[40:43], v[180:183]
  ds_read_b64_tr_b16 v[78:79], v7 offset:25600
  v_mfma_f32_16x16x32_bf16 v[188:191], v[44:47], a[44:47], v[188:191]
  ds_read_b64_tr_b16 v[80:81], v8 offset:24576
  v_mfma_f32_16x16x32_bf16 v[192:195], v[48:51], a[32:35], v[192:195]
  ds_read_b64_tr_b16 v[82:83], v8 offset:25600
  v_mfma_f32_16x16x32_bf16 v[200:203], v[48:51], a[36:39], v[200:203]
  ds_read_b64_tr_b16 v[84:85], v9 offset:24576
  v_mfma_f32_16x16x32_bf16 v[208:211], v[48:51], a[40:43], v[208:211]
  buffer_load_dwordx4 v105, s[24:27], s47 offen offset:1024  lds
  v_mfma_f32_16x16x32_bf16 v[216:219], v[48:51], a[44:47], v[216:219]
  ds_read_b64_tr_b16 v[86:87], v9 offset:25600
  v_mfma_f32_16x16x32_bf16 v[196:199], v[52:55], a[32:35], v[196:199]
  ds_read_b64_tr_b16 v[88:89], v10 offset:24576
  v_mfma_f32_16x16x32_bf16 v[204:207], v[52:55], a[36:39], v[204:207]
  ds_read_b64_tr_b16 v[90:91], v10 offset:25600
  v_mfma_f32_16x16x32_bf16 v[212:215], v[52:55], a[40:43], v[212:215]
  ds_read_b64_tr_b16 v[92:93], v11 offset:24576
  v_mfma_f32_16x16x32_bf16 v[220:223], v[52:55], a[44:47], v[220:223]
  buffer_load_dwordx4 v106, s[24:27], s47 offen offset:2048  lds
  v_mfma_f32_16x16x32_bf16 v[224:227], v[56:59], a[32:35], v[224:227]
  ds_read_b64_tr_b16 v[94:95], v11 offset:25600
  v_mfma_f32_16x16x32_bf16 v[232:235], v[56:59], a[36:39], v[232:235]
  v_mfma_f32_16x16x32_bf16 v[240:243], v[56:59], a[40:43], v[240:243]
  v_mfma_f32_16x16x32_bf16 v[248:251], v[56:59], a[44:47], v[248:251]
  v_mfma_f32_16x16x32_bf16 v[228:231], v[60:63], a[32:35], v[228:231]
  buffer_load_dwordx4 v107, s[24:27], s47 offen offset:3072  lds
  v_mfma_f32_16x16x32_bf16 v[236:239], v[60:63], a[36:39], v[236:239]
  v_mfma_f32_16x16x32_bf16 v[244:247], v[60:63], a[40:43], v[244:247]
  v_mfma_f32_16x16x32_bf16 v[252:255], v[60:63], a[44:47], v[252:255]
  s_waitcnt lgkmcnt(0)
  s_waitcnt vmcnt(12)
  s_barrier
  v_mfma_f32_16x16x32_bf16 v[128:131], v[64:67], a[48:51], v[128:131]
  ds_read_b64_tr_b16 v[32:33], v4 offset:32768
  v_mfma_f32_16x16x32_bf16 v[136:139], v[64:67], a[52:55], v[136:139]
  ds_read_b64_tr_b16 v[34:35], v4 offset:33792
  v_mfma_f32_16x16x32_bf16 v[144:147], v[64:67], a[56:59], v[144:147]
  ds_read_b128 a[64:67], v116 offset:16384
  s_add_u32 s47, s78, 3
  s_and_b32 s47, s47, 7
  s_lshl_b32 s47, s47, 19
  s_add_u32 s47, s47, s42
  s_add_u32 m0, s44, 49152
  v_mfma_f32_16x16x32_bf16 v[152:155], v[64:67], a[60:63], v[152:155]
  buffer_load_dwordx4 v104, s[24:27], s47 offen offset:0  lds
  v_mfma_f32_16x16x32_bf16 v[132:135], v[68:71], a[48:51], v[132:135]
  ds_read_b128 a[68:71], v116 offset:18432
  v_mfma_f32_16x16x32_bf16 v[140:143], v[68:71], a[52:55], v[140:143]
  ds_read_b128 a[72:75], v116 offset:20480
  v_mfma_f32_16x16x32_bf16 v[148:151], v[68:71], a[56:59], v[148:151]
  ds_read_b128 a[76:79], v116 offset:22528
  v_mfma_f32_16x16x32_bf16 v[156:159], v[68:71], a[60:63], v[156:159]
  ds_read_b64_tr_b16 v[36:37], v5 offset:32768
  v_mfma_f32_16x16x32_bf16 v[160:163], v[72:75], a[48:51], v[160:163]
  buffer_load_dwordx4 v105, s[24:27], s47 offen offset:1024  lds
  v_mfma_f32_16x16x32_bf16 v[168:171], v[72:75], a[52:55], v[168:171]
  ds_read_b64_tr_b16 v[38:39], v5 offset:33792
  v_mfma_f32_16x16x32_bf16 v[176:179], v[72:75], a[56:59], v[176:179]
  ds_read_b64_tr_b16 v[40:41], v6 offset:32768
  v_mfma_f32_16x16x32_bf16 v[184:187], v[72:75], a[60:63], v[184:187]
  ds_read_b64_tr_b16 v[42:43], v6 offset:33792
  v_mfma_f32_16x16x32_bf16 v[164:167], v[76:79], a[48:51], v[164:167]
  ds_read_b64_tr_b16 v[44:45], v7 offset:32768
  v_mfma_f32_16x16x32_bf16 v[172:175], v[76:79], a[52:55], v[172:175]
  buffer_load_dwordx4 v106, s[24:27], s47 offen offset:2048  lds
  v_mfma_f32_16x16x32_bf16 v[180:183], v[76:79], a[56:59], v[180:183]
  ds_read_b64_tr_b16 v[46:47], v7 offset:33792
  v_mfma_f32_16x16x32_bf16 v[188:191], v[76:79], a[60:63], v[188:191]
  ds_read_b64_tr_b16 v[48:49], v8 offset:32768
  v_mfma_f32_16x16x32_bf16 v[192:195], v[80:83], a[48:51], v[192:195]
  ds_read_b64_tr_b16 v[50:51], v8 offset:33792
  v_mfma_f32_16x16x32_bf16 v[200:203], v[80:83], a[52:55], v[200:203]
  ds_read_b64_tr_b16 v[52:53], v9 offset:32768
  v_mfma_f32_16x16x32_bf16 v[208:211], v[80:83], a[56:59], v[208:211]
  buffer_load_dwordx4 v107, s[24:27], s47 offen offset:3072  lds
  v_mfma_f32_16x16x32_bf16 v[216:219], v[80:83], a[60:63], v[216:219]
  ds_read_b64_tr_b16 v[54:55], v9 offset:33792
  v_mfma_f32_16x16x32_bf16 v[196:199], v[84:87], a[48:51], v[196:199]
  ds_read_b64_tr_b16 v[56:57], v10 offset:32768
  v_mfma_f32_16x16x32_bf16 v[204:207], v[84:87], a[52:55], v[204:207]
  ds_read_b64_tr_b16 v[58:59], v10 offset:33792
  v_mfma_f32_16x16x32_bf16 v[212:215], v[84:87], a[56:59], v[212:215]
  ds_read_b64_tr_b16 v[60:61], v11 offset:32768
  s_add_u32 s46, s78, 4
  s_and_b32 s46, s46, 7
  s_lshl_b32 s46, s46, 7
  s_add_u32 s46, s46, s41
  s_add_u32 m0, s40, 8192
  v_mfma_f32_16x16x32_bf16 v[220:223], v[84:87], a[60:63], v[220:223]
  buffer_load_dwordx4 v96, s[20:23], s46 offen offset:0  lds
  v_mfma_f32_16x16x32_bf16 v[224:227], v[88:91], a[48:51], v[224:227]
  ds_read_b64_tr_b16 v[62:63], v11 offset:33792
  v_mfma_f32_16x16x32_bf16 v[232:235], v[88:91], a[52:55], v[232:235]
  v_mfma_f32_16x16x32_bf16 v[240:243], v[88:91], a[56:59], v[240:243]
  v_mfma_f32_16x16x32_bf16 v[248:251], v[88:91], a[60:63], v[248:251]
  v_mfma_f32_16x16x32_bf16 v[228:231], v[92:95], a[48:51], v[228:231]
  buffer_load_dwordx4 v97, s[20:23], s46 offen offset:1024  lds
  v_mfma_f32_16x16x32_bf16 v[236:239], v[92:95], a[52:55], v[236:239]
  v_mfma_f32_16x16x32_bf16 v[244:247], v[92:95], a[56:59], v[244:247]
  v_mfma_f32_16x16x32_bf16 v[252:255], v[92:95], a[60:63], v[252:255]
  s_waitcnt lgkmcnt(0)
  v_mfma_f32_16x16x32_bf16 v[128:131], v[32:35], a[64:67], v[128:131]
  ds_read_b64_tr_b16 v[64:65], v4 offset:40960
  v_mfma_f32_16x16x32_bf16 v[136:139], v[32:35], a[68:71], v[136:139]
  ds_read_b64_tr_b16 v[66:67], v4 offset:41984
  v_mfma_f32_16x16x32_bf16 v[144:147], v[32:35], a[72:75], v[144:147]
  ds_read_b128 a[80:83], v117 offset:16384
  v_mfma_f32_16x16x32_bf16 v[152:155], v[32:35], a[76:79], v[152:155]
  buffer_load_dwordx4 v98, s[20:23], s46 offen offset:2048  lds
  v_mfma_f32_16x16x32_bf16 v[132:135], v[36:39], a[64:67], v[132:135]
  ds_read_b128 a[84:87], v117 offset:18432
  v_mfma_f32_16x16x32_bf16 v[140:143], v[36:39], a[68:71], v[140:143]
  ds_read_b128 a[88:91], v117 offset:20480
  v_mfma_f32_16x16x32_bf16 v[148:151], v[36:39], a[72:75], v[148:151]
  ds_read_b128 a[92:95], v117 offset:22528
  v_mfma_f32_16x16x32_bf16 v[156:159], v[36:39], a[76:79], v[156:159]
  ds_read_b64_tr_b16 v[68:69], v5 offset:40960
  v_mfma_f32_16x16x32_bf16 v[160:163], v[40:43], a[64:67], v[160:163]
  buffer_load_dwordx4 v99, s[20:23], s46 offen offset:3072  lds
  v_mfma_f32_16x16x32_bf16 v[168:171], v[40:43], a[68:71], v[168:171]
  ds_read_b64_tr_b16 v[70:71], v5 offset:41984
  v_mfma_f32_16x16x32_bf16 v[176:179], v[40:43], a[72:75], v[176:179]
  ds_read_b64_tr_b16 v[72:73], v6 offset:40960
  v_mfma_f32_16x16x32_bf16 v[184:187], v[40:43], a[76:79], v[184:187]
  ds_read_b64_tr_b16 v[74:75], v6 offset:41984
  v_mfma_f32_16x16x32_bf16 v[164:167], v[44:47], a[64:67], v[164:167]
  ds_read_b64_tr_b16 v[76:77], v7 offset:40960
  s_add_u32 m0, s40, 12288
  v_mfma_f32_16x16x32_bf16 v[172:175], v[44:47], a[68:71], v[172:175]
  buffer_load_dwordx4 v100, s[20:23], s46 offen offset:0  lds
  v_mfma_f32_16x16x32_bf16 v[180:183], v[44:47], a[72:75], v[180:183]
  ds_read_b64_tr_b16 v[78:79], v7 offset:41984
  v_mfma_f32_16x16x32_bf16 v[188:191], v[44:47], a[76:79], v[188:191]
  ds_read_b64_tr_b16 v[80:81], v8 offset:40960
  v_mfma_f32_16x16x32_bf16 v[192:195], v[48:51], a[64:67], v[192:195]
  ds_read_b64_tr_b16 v[82:83], v8 offset:41984
  v_mfma_f32_16x16x32_bf16 v[200:203], v[48:51], a[68:71], v[200:203]
  ds_read_b64_tr_b16 v[84:85], v9 offset:40960
  v_mfma_f32_16x16x32_bf16 v[208:211], v[48:51], a[72:75], v[208:211]
  buffer_load_dwordx4 v101, s[20:23], s46 offen offset:1024  lds
  v_mfma_f32_16x16x32_bf16 v[216:219], v[48:51], a[76:79], v[216:219]
  ds_read_b64_tr_b16 v[86:87], v9 offset:41984
  v_mfma_f32_16x16x32_bf16 v[196:199], v[52:55], a[64:67], v[196:199]
  ds_read_b64_tr_b16 v[88:89], v10 offset:40960
  v_mfma_f32_16x16x32_bf16 v[204:207], v[52:55], a[68:71], v[204:207]
  ds_read_b64_tr_b16 v[90:91], v10 offset:41984
  v_mfma_f32_16x16x32_bf16 v[212:215], v[52:55], a[72:75], v[212:215]
  ds_read_b64_tr_b16 v[92:93], v11 offset:40960
  v_mfma_f32_16x16x32_bf16 v[220:223], v[52:55], a[76:79], v[220:223]
  buffer_load_dwordx4 v102, s[20:23], s46 offen offset:2048  lds
  v_mfma_f32_16x16x32_bf16 v[224:227], v[56:59], a[64:67], v[224:227]
  ds_read_b64_tr_b16 v[94:95], v11 offset:41984
  v_mfma_f32_16x16x32_bf16 v[232:235], v[56:59], a[68:71], v[232:235]
  v_mfma_f32_16x16x32_bf16 v[240:243], v[56:59], a[72:75], v[240:243]
  v_mfma_f32_16x16x32_bf16 v[248:251], v[56:59], a[76:79], v[248:251]
  v_mfma_f32_16x16x32_bf16 v[228:231], v[60:63], a[64:67], v[228:231]
  buffer_load_dwordx4 v103, s[20:23], s46 offen offset:3072  lds
  v_mfma_f32_16x16x32_bf16 v[236:239], v[60:63], a[68:71], v[236:239]
  v_mfma_f32_16x16x32_bf16 v[244:247], v[60:63], a[72:75], v[244:247]
  v_mfma_f32_16x16x32_bf16 v[252:255], v[60:63], a[76:79], v[252:255]
  s_waitcnt lgkmcnt(0)
  s_waitcnt vmcnt(8)
  s_barrier
  v_mfma_f32_16x16x32_bf16 v[128:131], v[64:67], a[80:83], v[128:131]
  ds_read_b64_tr_b16 v[32:33], v4 offset:49152
  v_mfma_f32_16x16x32_bf16 v[136:139], v[64:67], a[84:87], v[136:139]
  ds_read_b64_tr_b16 v[34:35], v4 offset:50176
  v_mfma_f32_16x16x32_bf16 v[144:147], v[64:67], a[88:91], v[144:147]
  ds_read_b128 a[96:99], v116 offset:0
  s_add_u32 s47, s78, 5
  s_and_b32 s47, s47, 7
  s_lshl_b32 s47, s47, 19
  s_add_u32 s47, s47, s42
  s_add_u32 m0, s44, 16384
  v_mfma_f32_16x16x32_bf16 v[152:155], v[64:67], a[92:95], v[152:155]
  buffer_load_dwordx4 v104, s[24:27], s47 offen offset:0  lds
  v_mfma_f32_16x16x32_bf16 v[132:135], v[68:71], a[80:83], v[132:135]
  ds_read_b128 a[100:103], v116 offset:2048
  v_mfma_f32_16x16x32_bf16 v[140:143], v[68:71], a[84:87], v[140:143]
  ds_read_b128 a[104:107], v116 offset:4096
  v_mfma_f32_16x16x32_bf16 v[148:151], v[68:71], a[88:91], v[148:151]
  ds_read_b128 a[108:111], v116 offset:6144
  v_mfma_f32_16x16x32_bf16 v[156:159], v[68:71], a[92:95], v[156:159]
  ds_read_b64_tr_b16 v[36:37], v5 offset:49152
  v_mfma_f32_16x16x32_bf16 v[160:163], v[72:75], a[80:83], v[160:163]
  buffer_load_dwordx4 v105, s[24:27], s47 offen offset:1024  lds
  v_mfma_f32_16x16x32_bf16 v[168:171], v[72:75], a[84:87], v[168:171]
  ds_read_b64_tr_b16 v[38:39], v5 offset:50176
  v_mfma_f32_16x16x32_bf16 v[176:179], v[72:75], a[88:91], v[176:179]
  ds_read_b64_tr_b16 v[40:41], v6 offset:49152
  v_mfma_f32_16x16x32_bf16 v[184:187], v[72:75], a[92:95], v[184:187]
  ds_read_b64_tr_b16 v[42:43], v6 offset:50176
  v_mfma_f32_16x16x32_bf16 v[164:167], v[76:79], a[80:83], v[164:167]
  ds_read_b64_tr_b16 v[44:45], v7 offset:49152
  v_mfma_f32_16x16x32_bf16 v[172:175], v[76:79], a[84:87], v[172:175]
  buffer_load_dwordx4 v106, s[24:27], s47 offen offset:2048  lds
  v_mfma_f32_16x16x32_bf16 v[180:183], v[76:79], a[88:91], v[180:183]
  ds_read_b64_tr_b16 v[46:47], v7 offset:50176
  v_mfma_f32_16x16x32_bf16 v[188:191], v[76:79], a[92:95], v[188:191]
  ds_read_b64_tr_b16 v[48:49], v8 offset:49152
  v_mfma_f32_16x16x32_bf16 v[192:195], v[80:83], a[80:83], v[192:195]
  ds_read_b64_tr_b16 v[50:51], v8 offset:50176
  v_mfma_f32_16x16x32_bf16 v[200:203], v[80:83], a[84:87], v[200:203]
  ds_read_b64_tr_b16 v[52:53], v9 offset:49152
  v_mfma_f32_16x16x32_bf16 v[208:211], v[80:83], a[88:91], v[208:211]
  buffer_load_dwordx4 v107, s[24:27], s47 offen offset:3072  lds
  v_mfma_f32_16x16x32_bf16 v[216:219], v[80:83], a[92:95], v[216:219]
  ds_read_b64_tr_b16 v[54:55], v9 offset:50176
  v_mfma_f32_16x16x32_bf16 v[196:199], v[84:87], a[80:83], v[196:199]
  ds_read_b64_tr_b16 v[56:57], v10 offset:49152
  v_mfma_f32_16x16x32_bf16 v[204:207], v[84:87], a[84:87], v[204:207]
  ds_read_b64_tr_b16 v[58:59], v10 offset:50176
  v_mfma_f32_16x16x32_bf16 v[212:215], v[84:87], a[88:91], v[212:215]
  ds_read_b64_tr_b16 v[60:61], v11 offset:49152
  s_add_u32 s46, s78, 5
  s_and_b32 s46, s46, 7
  s_lshl_b32 s46, s46, 7
  s_add_u32 s46, s46, s41
  s_add_u32 m0, s40, 16384
  v_mfma_f32_16x16x32_bf16 v[220:223], v[84:87], a[92:95], v[220:223]
  buffer_load_dwordx4 v96, s[20:23], s46 offen offset:0  lds
  v_mfma_f32_16x16x32_bf16 v[224:227], v[88:91], a[80:83], v[224:227]
  ds_read_b64_tr_b16 v[62:63], v11 offset:50176
  v_mfma_f32_16x16x32_bf16 v[232:235], v[88:91], a[84:87], v[232:235]
  v_mfma_f32_16x16x32_bf16 v[240:243], v[88:91], a[88:91], v[240:243]
  v_mfma_f32_16x16x32_bf16 v[248:251], v[88:91], a[92:95], v[248:251]
  v_mfma_f32_16x16x32_bf16 v[228:231], v[92:95], a[80:83], v[228:231]
  buffer_load_dwordx4 v97, s[20:23], s46 offen offset:1024  lds
  v_mfma_f32_16x16x32_bf16 v[236:239], v[92:95], a[84:87], v[236:239]
  v_mfma_f32_16x16x32_bf16 v[244:247], v[92:95], a[88:91], v[244:247]
  v_mfma_f32_16x16x32_bf16 v[252:255], v[92:95], a[92:95], v[252:255]
  s_waitcnt lgkmcnt(0)
  s_cmp_lt_u32 s76, 64
  s_cbranch_scc0 L_sig_10
  s_cmp_eq_u32 s3, 0
  s_cbranch_scc0 L_sig_10
  v_mov_b32 v29, 1
  buffer_atomic_add v29, v28, s[68:71], 0 offen sc1
L_sig_10:
  v_mfma_f32_16x16x32_bf16 v[128:131], v[32:35], a[96:99], v[128:131]
  ds_read_b64_tr_b16 v[64:65], v4 offset:57344
  v_mfma_f32_16x16x32_bf16 v[136:139], v[32:35], a[100:103], v[136:139]
  ds_read_b64_tr_b16 v[66:67], v4 offset:58368
  v_mfma_f32_16x16x32_bf16 v[144:147], v[32:35], a[104:107], v[144:147]
  ds_read_b128 a[112:115], v117 offset:0
  v_mfma_f32_16x16x32_bf16 v[152:155], v[32:35], a[108:111], v[152:155]
  buffer_load_dwordx4 v98, s[20:23], s46 offen offset:2048  lds
  v_mfma_f32_16x16x32_bf16 v[132:135], v[36:39], a[96:99], v[132:135]
  ds_read_b128 a[116:119], v117 offset:2048
  v_mfma_f32_16x16x32_bf16 v[140:143], v[36:39], a[100:103], v[140:143]
  ds_read_b128 a[120:123], v117 offset:4096
  v_mfma_f32_16x16x32_bf16 v[148:151], v[36:39], a[104:107], v[148:151]
  ds_read_b128 a[124:127], v117 offset:6144
  v_mfma_f32_16x16x32_bf16 v[156:159], v[36:39], a[108:111], v[156:159]
  ds_read_b64_tr_b16 v[68:69], v5 offset:57344
  v_mfma_f32_16x16x32_bf16 v[160:163], v[40:43], a[96:99], v[160:163]
  buffer_load_dwordx4 v99, s[20:23], s46 offen offset:3072  lds
  v_mfma_f32_16x16x32_bf16 v[168:171], v[40:43], a[100:103], v[168:171]
  ds_read_b64_tr_b16 v[70:71], v5 offset:58368
  v_mfma_f32_16x16x32_bf16 v[176:179], v[40:43], a[104:107], v[176:179]
  ds_read_b64_tr_b16 v[72:73], v6 offset:57344
  v_mfma_f32_16x16x32_bf16 v[184:187], v[40:43], a[108:111], v[184:187]
  ds_read_b64_tr_b16 v[74:75], v6 offset:58368
  v_mfma_f32_16x16x32_bf16 v[164:167], v[44:47], a[96:99], v[164:167]
  ds_read_b64_tr_b16 v[76:77], v7 offset:57344
  s_add_u32 m0, s40, 20480
  v_mfma_f32_16x16x32_bf16 v[172:175], v[44:47], a[100:103], v[172:175]
  buffer_load_dwordx4 v100, s[20:23], s46 offen offset:0  lds
  v_mfma_f32_16x16x32_bf16 v[180:183], v[44:47], a[104:107], v[180:183]
  ds_read_b64_tr_b16 v[78:79], v7 offset:58368
  v_mfma_f32_16x16x32_bf16 v[188:191], v[44:47], a[108:111], v[188:191]
  ds_read_b64_tr_b16 v[80:81], v8 offset:57344
  v_mfma_f32_16x16x32_bf16 v[192:195], v[48:51], a[96:99], v[192:195]
  ds_read_b64_tr_b16 v[82:83], v8 offset:58368
  v_mfma_f32_16x16x32_bf16 v[200:203], v[48:51], a[100:103], v[200:203]
  ds_read_b64_tr_b16 v[84:85], v9 offset:57344
  v_mfma_f32_16x16x32_bf16 v[208:211], v[48:51], a[104:107], v[208:211]
  buffer_load_dwordx4 v101, s[20:23], s46 offen offset:1024  lds
  v_mfma_f32_16x16x32_bf16 v[216:219], v[48:51], a[108:111], v[216:219]
  ds_read_b64_tr_b16 v[86:87], v9 offset:58368
  v_mfma_f32_16x16x32_bf16 v[196:199], v[52:55], a[96:99], v[196:199]
  ds_read_b64_tr_b16 v[88:89], v10 offset:57344
  v_mfma_f32_16x16x32_bf16 v[204:207], v[52:55], a[100:103], v[204:207]
  ds_read_b64_tr_b16 v[90:91], v10 offset:58368
  v_mfma_f32_16x16x32_bf16 v[212:215], v[52:55], a[104:107], v[212:215]
  ds_read_b64_tr_b16 v[92:93], v11 offset:57344
  v_mfma_f32_16x16x32_bf16 v[220:223], v[52:55], a[108:111], v[220:223]
  buffer_load_dwordx4 v102, s[20:23], s46 offen offset:2048  lds
  v_mfma_f32_16x16x32_bf16 v[224:227], v[56:59], a[96:99], v[224:227]
  ds_read_b64_tr_b16 v[94:95], v11 offset:58368
  v_mfma_f32_16x16x32_bf16 v[232:235], v[56:59], a[100:103], v[232:235]
  v_mfma_f32_16x16x32_bf16 v[240:243], v[56:59], a[104:107], v[240:243]
  v_mfma_f32_16x16x32_bf16 v[248:251], v[56:59], a[108:111], v[248:251]
  v_mfma_f32_16x16x32_bf16 v[228:231], v[60:63], a[96:99], v[228:231]
  buffer_load_dwordx4 v103, s[20:23], s46 offen offset:3072  lds
  v_mfma_f32_16x16x32_bf16 v[236:239], v[60:63], a[100:103], v[236:239]
  v_mfma_f32_16x16x32_bf16 v[244:247], v[60:63], a[104:107], v[244:247]
  v_mfma_f32_16x16x32_bf16 v[252:255], v[60:63], a[108:111], v[252:255]
  s_waitcnt lgkmcnt(0)
  s_barrier
  s_waitcnt vmcnt(12)
  v_mfma_f32_16x16x32_bf16 v[128:131], v[64:67], a[112:115], v[128:131]
  ds_read_b64_tr_b16 v[32:33], v4 offset:0
  v_mfma_f32_16x16x32_bf16 v[136:139], v[64:67], a[116:119], v[136:139]
  ds_read_b64_tr_b16 v[34:35], v4 offset:1024
  v_mfma_f32_16x16x32_bf16 v[144:147], v[64:67], a[120:123], v[144:147]
  ds_read_b128 a[128:131], v116 offset:8192
  s_add_u32 s47, s78, 6
  s_and_b32 s47, s47, 7
  s_lshl_b32 s47, s47, 19
  s_add_u32 s47, s47, s42
  s_add_u32 m0, s44, 32768
  v_mfma_f32_16x16x32_bf16 v[152:155], v[64:67], a[124:127], v[152:155]
  buffer_load_dwordx4 v104, s[24:27], s47 offen offset:0  lds
  v_mfma_f32_16x16x32_bf16 v[132:135], v[68:71], a[112:115], v[132:135]
  ds_read_b128 a[132:135], v116 offset:10240
  v_mfma_f32_16x16x32_bf16 v[140:143], v[68:71], a[116:119], v[140:143]
  ds_read_b128 a[136:139], v116 offset:12288
  v_mfma_f32_16x16x32_bf16 v[148:151], v[68:71], a[120:123], v[148:151]
  ds_read_b128 a[140:143], v116 offset:14336
  v_mfma_f32_16x16x32_bf16 v[156:159], v[68:71], a[124:127], v[156:159]
  ds_read_b64_tr_b16 v[36:37], v5 offset:0
  v_mfma_f32_16x16x32_bf16 v[160:163], v[72:75], a[112:115], v[160:163]
  buffer_load_dwordx4 v105, s[24:27], s47 offen offset:1024  lds
  v_mfma_f32_16x16x32_bf16 v[168:171], v[72:75], a[116:119], v[168:171]
  ds_read_b64_tr_b16 v[38:39], v5 offset:1024
  v_mfma_f32_16x16x32_bf16 v[176:179], v[72:75], a[120:123], v[176:179]
  ds_read_b64_tr_b16 v[40:41], v6 offset:0
  v_mfma_f32_16x16x32_bf16 v[184:187], v[72:75], a[124:127], v[184:187]
  ds_read_b64_tr_b16 v[42:43], v6 offset:1024
  v_mfma_f32_16x16x32_bf16 v[164:167], v[76:79], a[112:115], v[164:167]
  ds_read_b64_tr_b16 v[44:45], v7 offset:0
  v_mfma_f32_16x16x32_bf16 v[172:175], v[76:79], a[116:119], v[172:175]
  buffer_load_dwordx4 v106, s[24:27], s47 offen offset:2048  lds
  v_mfma_f32_16x16x32_bf16 v[180:183], v[76:79], a[120:123], v[180:183]
  ds_read_b64_tr_b16 v[46:47], v7 offset:1024
  v_mfma_f32_16x16x32_bf16 v[188:191], v[76:79], a[124:127], v[188:191]
  ds_read_b64_tr_b16 v[48:49], v8 offset:0
  v_mfma_f32_16x16x32_bf16 v[192:195], v[80:83], a[112:115], v[192:195]
  ds_read_b64_tr_b16 v[50:51], v8 offset:1024
  v_mfma_f32_16x16x32_bf16 v[200:203], v[80:83], a[116:119], v[200:203]
  ds_read_b64_tr_b16 v[52:53], v9 offset:0
  v_mfma_f32_16x16x32_bf16 v[208:211], v[80:83], a[120:123], v[208:211]
  buffer_load_dwordx4 v107, s[24:27], s47 offen offset:3072  lds
  v_mfma_f32_16x16x32_bf16 v[216:219], v[80:83], a[124:127], v[216:219]
  ds_read_b64_tr_b16 v[54:55], v9 offset:1024
  v_mfma_f32_16x16x32_bf16 v[196:199], v[84:87], a[112:115], v[196:199]
  ds_read_b64_tr_b16 v[56:57], v10 offset:0
  v_mfma_f32_16x16x32_bf16 v[204:207], v[84:87], a[116:119], v[204:207]
  ds_read_b64_tr_b16 v[58:59], v10 offset:1024
  v_mfma_f32_16x16x32_bf16 v[212:215], v[84:87], a[120:123], v[212:215]
  ds_read_b64_tr_b16 v[60:61], v11 offset:0
  s_add_u32 s46, s78, 6
  s_and_b32 s46, s46, 7
  s_lshl_b32 s46, s46, 7
  s_add_u32 s46, s46, s41
  s_add_u32 m0, s40, 0
  v_mfma_f32_16x16x32_bf16 v[220:223], v[84:87], a[124:127], v[220:223]
  buffer_load_dwordx4 v96, s[20:23], s46 offen offset:0  lds
  v_mfma_f32_16x16x32_bf16 v[224:227], v[88:91], a[112:115], v[224:227]
  ds_read_b64_tr_b16 v[62:63], v11 offset:1024
  v_mfma_f32_16x16x32_bf16 v[232:235], v[88:91], a[116:119], v[232:235]
  v_mfma_f32_16x16x32_bf16 v[240:243], v[88:91], a[120:123], v[240:243]
  v_mfma_f32_16x16x32_bf16 v[248:251], v[88:91], a[124:127], v[248:251]
  v_mfma_f32_16x16x32_bf16 v[228:231], v[92:95], a[112:115], v[228:231]
  buffer_load_dwordx4 v97, s[20:23], s46 offen offset:1024  lds
  v_mfma_f32_16x16x32_bf16 v[236:239], v[92:95], a[116:119], v[236:239]
  v_mfma_f32_16x16x32_bf16 v[244:247], v[92:95], a[120:123], v[244:247]
  v_mfma_f32_16x16x32_bf16 v[252:255], v[92:95], a[124:127], v[252:255]
  s_waitcnt lgkmcnt(0)
  v_mfma_f32_16x16x32_bf16 v[128:131], v[32:35], a[128:131], v[128:131]
  ds_read_b64_tr_b16 v[64:65], v4 offset:8192
  v_mfma_f32_16x16x32_bf16 v[136:139], v[32:35], a[132:135], v[136:139]
  ds_read_b64_tr_b16 v[66:67], v4 offset:9216
  v_mfma_f32_16x16x32_bf16 v[144:147], v[32:35], a[136:139], v[144:147]
  ds_read_b128 a[144:147], v117 offset:8192
  v_mfma_f32_16x16x32_bf16 v[152:155], v[32:35], a[140:143], v[152:155]
  buffer_load_dwordx4 v98, s[20:23], s46 offen offset:2048  lds
  v_mfma_f32_16x16x32_bf16 v[132:135], v[36:39], a[128:131], v[132:135]
  ds_read_b128 a[148:151], v117 offset:10240
  v_mfma_f32_16x16x32_bf16 v[140:143], v[36:39], a[132:135], v[140:143]
  ds_read_b128 a[152:155], v117 offset:12288
  v_mfma_f32_16x16x32_bf16 v[148:151], v[36:39], a[136:139], v[148:151]
  ds_read_b128 a[156:159], v117 offset:14336
  v_mfma_f32_16x16x32_bf16 v[156:159], v[36:39], a[140:143], v[156:159]
  ds_read_b64_tr_b16 v[68:69], v5 offset:8192
  v_mfma_f32_16x16x32_bf16 v[160:163], v[40:43], a[128:131], v[160:163]
  buffer_load_dwordx4 v99, s[20:23], s46 offen offset:3072  lds
  v_mfma_f32_16x16x32_bf16 v[168:171], v[40:43], a[132:135], v[168:171]
  ds_read_b64_tr_b16 v[70:71], v5 offset:9216
  v_mfma_f32_16x16x32_bf16 v[176:179], v[40:43], a[136:139], v[176:179]
  ds_read_b64_tr_b16 v[72:73], v6 offset:8192
  v_mfma_f32_16x16x32_bf16 v[184:187], v[40:43], a[140:143], v[184:187]
  ds_read_b64_tr_b16 v[74:75], v6 offset:9216
  v_mfma_f32_16x16x32_bf16 v[164:167], v[44:47], a[128:131], v[164:167]
  ds_read_b64_tr_b16 v[76:77], v7 offset:8192
  s_add_u32 m0, s40, 4096
  v_mfma_f32_16x16x32_bf16 v[172:175], v[44:47], a[132:135], v[172:175]
  buffer_load_dwordx4 v100, s[20:23], s46 offen offset:0  lds
  v_mfma_f32_16x16x32_bf16 v[180:183], v[44:47], a[136:139], v[180:183]
  ds_read_b64_tr_b16 v[78:79], v7 offset:9216
  v_mfma_f32_16x16x32_bf16 v[188:191], v[44:47], a[140:143], v[188:191]
  ds_read_b64_tr_b16 v[80:81], v8 offset:8192
  v_mfma_f32_16x16x32_bf16 v[192:195], v[48:51], a[128:131], v[192:195]
  ds_read_b64_tr_b16 v[82:83], v8 offset:9216
  v_mfma_f32_16x16x32_bf16 v[200:203], v[48:51], a[132:135], v[200:203]
  ds_read_b64_tr_b16 v[84:85], v9 offset:8192
  v_mfma_f32_16x16x32_bf16 v[208:211], v[48:51], a[136:139], v[208:211]
  buffer_load_dwordx4 v101, s[20:23], s46 offen offset:1024  lds
  v_mfma_f32_16x16x32_bf16 v[216:219], v[48:51], a[140:143], v[216:219]
  ds_read_b64_tr_b16 v[86:87], v9 offset:9216
  v_mfma_f32_16x16x32_bf16 v[196:199], v[52:55], a[128:131], v[196:199]
  ds_read_b64_tr_b16 v[88:89], v10 offset:8192
  v_mfma_f32_16x16x32_bf16 v[204:207], v[52:55], a[132:135], v[204:207]
  ds_read_b64_tr_b16 v[90:91], v10 offset:9216
  v_mfma_f32_16x16x32_bf16 v[212:215], v[52:55], a[136:139], v[212:215]
  ds_read_b64_tr_b16 v[92:93], v11 offset:8192
  v_mfma_f32_16x16x32_bf16 v[220:223], v[52:55], a[140:143], v[220:223]
  buffer_load_dwordx4 v102, s[20:23], s46 offen offset:2048  lds
  v_mfma_f32_16x16x32_bf16 v[224:227], v[56:59], a[128:131], v[224:227]
  ds_read_b64_tr_b16 v[94:95], v11 offset:9216
  v_mfma_f32_16x16x32_bf16 v[232:235], v[56:59], a[132:135], v[232:235]
  v_mfma_f32_16x16x32_bf16 v[240:243], v[56:59], a[136:139], v[240:243]
  v_mfma_f32_16x16x32_bf16 v[248:251], v[56:59], a[140:143], v[248:251]
  v_mfma_f32_16x16x32_bf16 v[228:231], v[60:63], a[128:131], v[228:231]
  buffer_load_dwordx4 v103, s[20:23], s46 offen offset:3072  lds
  v_mfma_f32_16x16x32_bf16 v[236:239], v[60:63], a[132:135], v[236:239]
  v_mfma_f32_16x16x32_bf16 v[244:247], v[60:63], a[136:139], v[244:247]
  v_mfma_f32_16x16x32_bf16 v[252:255], v[60:63], a[140:143], v[252:255]
  s_waitcnt lgkmcnt(0)
  s_waitcnt vmcnt(20)
  s_barrier
  s_waitcnt vmcnt(12)
  v_mfma_f32_16x16x32_bf16 v[128:131], v[64:67], a[144:147], v[128:131]
  ds_read_b64_tr_b16 v[32:33], v4 offset:16384
  v_mfma_f32_16x16x32_bf16 v[136:139], v[64:67], a[148:151], v[136:139]
  ds_read_b64_tr_b16 v[34:35], v4 offset:17408
  v_mfma_f32_16x16x32_bf16 v[144:147], v[64:67], a[152:155], v[144:147]
  ds_read_b128 a[160:163], v116 offset:16384
  s_add_u32 s47, s78, 7
  s_and_b32 s47, s47, 7
  s_lshl_b32 s47, s47, 19
  s_add_u32 s47, s47, s42
  s_add_u32 m0, s44, 49152
  v_mfma_f32_16x16x32_bf16 v[152:155], v[64:67], a[156:159], v[152:155]
  buffer_load_dwordx4 v104, s[24:27], s47 offen offset:0  lds
  v_mfma_f32_16x16x32_bf16 v[132:135], v[68:71], a[144:147], v[132:135]
  ds_read_b128 a[164:167], v116 offset:18432
  v_mfma_f32_16x16x32_bf16 v[140:143], v[68:71], a[148:151], v[140:143]
  ds_read_b128 a[168:171], v116 offset:20480
  v_mfma_f32_16x16x32_bf16 v[148:151], v[68:71], a[152:155], v[148:151]
  ds_read_b128 a[172:175], v116 offset:22528
  v_mfma_f32_16x16x32_bf16 v[156:159], v[68:71], a[156:159], v[156:159]
  ds_read_b64_tr_b16 v[36:37], v5 offset:16384
  v_mfma_f32_16x16x32_bf16 v[160:163], v[72:75], a[144:147], v[160:163]
  buffer_load_dwordx4 v105, s[24:27], s47 offen offset:1024  lds
  v_mfma_f32_16x16x32_bf16 v[168:171], v[72:75], a[148:151], v[168:171]
  ds_read_b64_tr_b16 v[38:39], v5 offset:17408
  v_mfma_f32_16x16x32_bf16 v[176:179], v[72:75], a[152:155], v[176:179]
  ds_read_b64_tr_b16 v[40:41], v6 offset:16384
  v_mfma_f32_16x16x32_bf16 v[184:187], v[72:75], a[156:159], v[184:187]
  ds_read_b64_tr_b16 v[42:43], v6 offset:17408
  v_mfma_f32_16x16x32_bf16 v[164:167], v[76:79], a[144:147], v[164:167]
  ds_read_b64_tr_b16 v[44:45], v7 offset:16384
  v_mfma_f32_16x16x32_bf16 v[172:175], v[76:79], a[148:151], v[172:175]
  buffer_load_dwordx4 v106, s[24:27], s47 offen offset:2048  lds
  v_mfma_f32_16x16x32_bf16 v[180:183], v[76:79], a[152:155], v[180:183]
  ds_read_b64_tr_b16 v[46:47], v7 offset:17408
  v_mfma_f32_16x16x32_bf16 v[188:191], v[76:79], a[156:159], v[188:191]
  ds_read_b64_tr_b16 v[48:49], v8 offset:16384
  v_mfma_f32_16x16x32_bf16 v[192:195], v[80:83], a[144:147], v[192:195]
  ds_read_b64_tr_b16 v[50:51], v8 offset:17408
  v_mfma_f32_16x16x32_bf16 v[200:203], v[80:83], a[148:151], v[200:203]
  ds_read_b64_tr_b16 v[52:53], v9 offset:16384
  v_mfma_f32_16x16x32_bf16 v[208:211], v[80:83], a[152:155], v[208:211]
  buffer_load_dwordx4 v107, s[24:27], s47 offen offset:3072  lds
  v_mfma_f32_16x16x32_bf16 v[216:219], v[80:83], a[156:159], v[216:219]
  ds_read_b64_tr_b16 v[54:55], v9 offset:17408
  v_mfma_f32_16x16x32_bf16 v[196:199], v[84:87], a[144:147], v[196:199]
  ds_read_b64_tr_b16 v[56:57], v10 offset:16384
  v_mfma_f32_16x16x32_bf16 v[204:207], v[84:87], a[148:151], v[204:207]
  ds_read_b64_tr_b16 v[58:59], v10 offset:17408
  v_mfma_f32_16x16x32_bf16 v[212:215], v[84:87], a[152:155], v[212:215]
  ds_read_b64_tr_b16 v[60:61], v11 offset:16384
  s_add_u32 s46, s78, 7
  s_and_b32 s46, s46, 7
  s_lshl_b32 s46, s46, 7
  s_add_u32 s46, s46, s41
  s_add_u32 m0, s40, 8192
  v_mfma_f32_16x16x32_bf16 v[220:223], v[84:87], a[156:159], v[220:223]
  buffer_load_dwordx4 v96, s[20:23], s46 offen offset:0  lds
  v_mfma_f32_16x16x32_bf16 v[224:227], v[88:91], a[144:147], v[224:227]
  ds_read_b64_tr_b16 v[62:63], v11 offset:17408
  v_mfma_f32_16x16x32_bf16 v[232:235], v[88:91], a[148:151], v[232:235]
  v_mfma_f32_16x16x32_bf16 v[240:243], v[88:91], a[152:155], v[240:243]
  v_mfma_f32_16x16x32_bf16 v[248:251], v[88:91], a[156:159], v[248:251]
  v_mfma_f32_16x16x32_bf16 v[228:231], v[92:95], a[144:147], v[228:231]
  buffer_load_dwordx4 v97, s[20:23], s46 offen offset:1024  lds
  v_mfma_f32_16x16x32_bf16 v[236:239], v[92:95], a[148:151], v[236:239]
  v_mfma_f32_16x16x32_bf16 v[244:247], v[92:95], a[152:155], v[244:247]
  v_mfma_f32_16x16x32_bf16 v[252:255], v[92:95], a[156:159], v[252:255]
  s_waitcnt lgkmcnt(0)
  v_mfma_f32_16x16x32_bf16 v[128:131], v[32:35], a[160:163], v[128:131]
  ds_read_b64_tr_b16 v[64:65], v4 offset:24576
  v_mfma_f32_16x16x32_bf16 v[136:139], v[32:35], a[164:167], v[136:139]
  ds_read_b64_tr_b16 v[66:67], v4 offset:25600
  v_mfma_f32_16x16x32_bf16 v[144:147], v[32:35], a[168:171], v[144:147]
  ds_read_b128 a[176:179], v117 offset:16384
  v_mfma_f32_16x16x32_bf16 v[152:155], v[32:35], a[172:175], v[152:155]
  buffer_load_dwordx4 v98, s[20:23], s46 offen offset:2048  lds
  v_mfma_f32_16x16x32_bf16 v[132:135], v[36:39], a[160:163], v[132:135]
  ds_read_b128 a[180:183], v117 offset:18432
  v_mfma_f32_16x16x32_bf16 v[140:143], v[36:39], a[164:167], v[140:143]
  ds_read_b128 a[184:187], v117 offset:20480
  v_mfma_f32_16x16x32_bf16 v[148:151], v[36:39], a[168:171], v[148:151]
  ds_read_b128 a[188:191], v117 offset:22528
  v_mfma_f32_16x16x32_bf16 v[156:159], v[36:39], a[172:175], v[156:159]
  ds_read_b64_tr_b16 v[68:69], v5 offset:24576
  v_mfma_f32_16x16x32_bf16 v[160:163], v[40:43], a[160:163], v[160:163]
  buffer_load_dwordx4 v99, s[20:23], s46 offen offset:3072  lds
  v_mfma_f32_16x16x32_bf16 v[168:171], v[40:43], a[164:167], v[168:171]
  ds_read_b64_tr_b16 v[70:71], v5 offset:25600
  v_mfma_f32_16x16x32_bf16 v[176:179], v[40:43], a[168:171], v[176:179]
  ds_read_b64_tr_b16 v[72:73], v6 offset:24576
  v_mfma_f32_16x16x32_bf16 v[184:187], v[40:43], a[172:175], v[184:187]
  ds_read_b64_tr_b16 v[74:75], v6 offset:25600
  v_mfma_f32_16x16x32_bf16 v[164:167], v[44:47], a[160:163], v[164:167]
  ds_read_b64_tr_b16 v[76:77], v7 offset:24576
  s_add_u32 m0, s40, 12288
  v_mfma_f32_16x16x32_bf16 v[172:175], v[44:47], a[164:167], v[172:175]
  buffer_load_dwordx4 v100, s[20:23], s46 offen offset:0  lds
  v_mfma_f32_16x16x32_bf16 v[180:183], v[44:47], a[168:171], v[180:183]
  ds_read_b64_tr_b16 v[78:79], v7 offset:25600
  v_mfma_f32_16x16x32_bf16 v[188:191], v[44:47], a[172:175], v[188:191]
  ds_read_b64_tr_b16 v[80:81], v8 offset:24576
  v_mfma_f32_16x16x32_bf16 v[192:195], v[48:51], a[160:163], v[192:195]
  ds_read_b64_tr_b16 v[82:83], v8 offset:25600
  v_mfma_f32_16x16x32_bf16 v[200:203], v[48:51], a[164:167], v[200:203]
  ds_read_b64_tr_b16 v[84:85], v9 offset:24576
  v_mfma_f32_16x16x32_bf16 v[208:211], v[48:51], a[168:171], v[208:211]
  buffer_load_dwordx4 v101, s[20:23], s46 offen offset:1024  lds
  v_mfma_f32_16x16x32_bf16 v[216:219], v[48:51], a[172:175], v[216:219]
  ds_read_b64_tr_b16 v[86:87], v9 offset:25600
  v_mfma_f32_16x16x32_bf16 v[196:199], v[52:55], a[160:163], v[196:199]
  ds_read_b64_tr_b16 v[88:89], v10 offset:24576
  v_mfma_f32_16x16x32_bf16 v[204:207], v[52:55], a[164:167], v[204:207]
  ds_read_b64_tr_b16 v[90:91], v10 offset:25600
  v_mfma_f32_16x16x32_bf16 v[212:215], v[52:55], a[168:171], v[212:215]
  ds_read_b64_tr_b16 v[92:93], v11 offset:24576
  v_mfma_f32_16x16x32_bf16 v[220:223], v[52:55], a[172:175], v[220:223]
  buffer_load_dwordx4 v102, s[20:23], s46 offen offset:2048  lds
  v_mfma_f32_16x16x32_bf16 v[224:227], v[56:59], a[160:163], v[224:227]
  ds_read_b64_tr_b16 v[94:95], v11 offset:25600
  v_mfma_f32_16x16x32_bf16 v[232:235], v[56:59], a[164:167], v[232:235]
  v_mfma_f32_16x16x32_bf16 v[240:243], v[56:59], a[168:171], v[240:243]
  v_mfma_f32_16x16x32_bf16 v[248:251], v[56:59], a[172:175], v[248:251]
  v_mfma_f32_16x16x32_bf16 v[228:231], v[60:63], a[160:163], v[228:231]
  buffer_load_dwordx4 v103, s[20:23], s46 offen offset:3072  lds
  v_mfma_f32_16x16x32_bf16 v[236:239], v[60:63], a[164:167], v[236:239]
  v_mfma_f32_16x16x32_bf16 v[244:247], v[60:63], a[168:171], v[244:247]
  v_mfma_f32_16x16x32_bf16 v[252:255], v[60:63], a[172:175], v[252:255]
  s_waitcnt lgkmcnt(0)
  s_waitcnt vmcnt(20)
  s_barrier
  s_waitcnt vmcnt(12)
  v_mfma_f32_16x16x32_bf16 v[128:131], v[64:67], a[176:179], v[128:131]
  ds_read_b64_tr_b16 v[32:33], v4 offset:32768
  v_mfma_f32_16x16x32_bf16 v[136:139], v[64:67], a[180:183], v[136:139]
  ds_read_b64_tr_b16 v[34:35], v4 offset:33792
  v_mfma_f32_16x16x32_bf16 v[144:147], v[64:67], a[184:187], v[144:147]
  ds_read_b128 a[192:195], v116 offset:0
  s_add_u32 s47, s78, 0
  s_and_b32 s47, s47, 7
  s_lshl_b32 s47, s47, 19
  s_add_u32 s47, s47, s42
  s_add_u32 m0, s44, 0
  v_mfma_f32_16x16x32_bf16 v[152:155], v[64:67], a[188:191], v[152:155]
  buffer_load_dwordx4 v104, s[28:31], s47 offen offset:0  lds
  v_mfma_f32_16x16x32_bf16 v[132:135], v[68:71], a[176:179], v[132:135]
  ds_read_b128 a[196:199], v116 offset:2048
  v_mfma_f32_16x16x32_bf16 v[140:143], v[68:71], a[180:183], v[140:143]
  ds_read_b128 a[200:203], v116 offset:4096
  v_mfma_f32_16x16x32_bf16 v[148:151], v[68:71], a[184:187], v[148:151]
  ds_read_b128 a[204:207], v116 offset:6144
  v_mfma_f32_16x16x32_bf16 v[156:159], v[68:71], a[188:191], v[156:159]
  ds_read_b64_tr_b16 v[36:37], v5 offset:32768
  v_mfma_f32_16x16x32_bf16 v[160:163], v[72:75], a[176:179], v[160:163]
  buffer_load_dwordx4 v105, s[28:31], s47 offen offset:1024  lds
  v_mfma_f32_16x16x32_bf16 v[168:171], v[72:75], a[180:183], v[168:171]
  ds_read_b64_tr_b16 v[38:39], v5 offset:33792
  v_mfma_f32_16x16x32_bf16 v[176:179], v[72:75], a[184:187], v[176:179]
  ds_read_b64_tr_b16 v[40:41], v6 offset:32768
  v_mfma_f32_16x16x32_bf16 v[184:187], v[72:75], a[188:191], v[184:187]
  ds_read_b64_tr_b16 v[42:43], v6 offset:33792
  v_mfma_f32_16x16x32_bf16 v[164:167], v[76:79], a[176:179], v[164:167]
  ds_read_b64_tr_b16 v[44:45], v7 offset:32768
  v_mfma_f32_16x16x32_bf16 v[172:175], v[76:79], a[180:183], v[172:175]
  buffer_load_dwordx4 v106, s[28:31], s47 offen offset:2048  lds
  v_mfma_f32_16x16x32_bf16 v[180:183], v[76:79], a[184:187], v[180:183]
  ds_read_b64_tr_b16 v[46:47], v7 offset:33792
  v_mfma_f32_16x16x32_bf16 v[188:191], v[76:79], a[188:191], v[188:191]
  ds_read_b64_tr_b16 v[48:49], v8 offset:32768
  v_mfma_f32_16x16x32_bf16 v[192:195], v[80:83], a[176:179], v[192:195]
  ds_read_b64_tr_b16 v[50:51], v8 offset:33792
  v_mfma_f32_16x16x32_bf16 v[200:203], v[80:83], a[180:183], v[200:203]
  ds_read_b64_tr_b16 v[52:53], v9 offset:32768
  v_mfma_f32_16x16x32_bf16 v[208:211], v[80:83], a[184:187], v[208:211]
  buffer_load_dwordx4 v107, s[28:31], s47 offen offset:3072  lds
  v_mfma_f32_16x16x32_bf16 v[216:219], v[80:83], a[188:191], v[216:219]
  ds_read_b64_tr_b16 v[54:55], v9 offset:33792
  v_mfma_f32_16x16x32_bf16 v[196:199], v[84:87], a[176:179], v[196:199]
  ds_read_b64_tr_b16 v[56:57], v10 offset:32768
  v_mfma_f32_16x16x32_bf16 v[204:207], v[84:87], a[180:183], v[204:207]
  ds_read_b64_tr_b16 v[58:59], v10 offset:33792
  v_mfma_f32_16x16x32_bf16 v[212:215], v[84:87], a[184:187], v[212:215]
  ds_read_b64_tr_b16 v[60:61], v11 offset:32768
  s_add_u32 s47, s78, 1
  s_and_b32 s47, s47, 7
  s_lshl_b32 s47, s47, 19
  s_add_u32 s47, s47, s42
  s_add_u32 m0, s44, 16384
  v_mfma_f32_16x16x32_bf16 v[220:223], v[84:87], a[188:191], v[220:223]
  buffer_load_dwordx4 v104, s[28:31], s47 offen offset:0  lds
  v_mfma_f32_16x16x32_bf16 v[224:227], v[88:91], a[176:179], v[224:227]
  ds_read_b64_tr_b16 v[62:63], v11 offset:33792
  v_mfma_f32_16x16x32_bf16 v[232:235], v[88:91], a[180:183], v[232:235]
  v_mfma_f32_16x16x32_bf16 v[240:243], v[88:91], a[184:187], v[240:243]
  v_mfma_f32_16x16x32_bf16 v[248:251], v[88:91], a[188:191], v[248:251]
  v_mfma_f32_16x16x32_bf16 v[228:231], v[92:95], a[176:179], v[228:231]
  buffer_load_dwordx4 v105, s[28:31], s47 offen offset:1024  lds
  v_mfma_f32_16x16x32_bf16 v[236:239], v[92:95], a[180:183], v[236:239]
  v_mfma_f32_16x16x32_bf16 v[244:247], v[92:95], a[184:187], v[244:247]
  v_mfma_f32_16x16x32_bf16 v[252:255], v[92:95], a[188:191], v[252:255]
  s_waitcnt lgkmcnt(0)
  v_mfma_f32_16x16x32_bf16 v[128:131], v[32:35], a[192:195], v[128:131]
  ds_read_b64_tr_b16 v[64:65], v4 offset:40960
  v_mfma_f32_16x16x32_bf16 v[136:139], v[32:35], a[196:199], v[136:139]
  ds_read_b64_tr_b16 v[66:67], v4 offset:41984
  v_mfma_f32_16x16x32_bf16 v[144:147], v[32:35], a[200:203], v[144:147]
  ds_read_b128 a[208:211], v117 offset:0
  v_mfma_f32_16x16x32_bf16 v[152:155], v[32:35], a[204:207], v[152:155]
  buffer_load_dwordx4 v106, s[28:31], s47 offen offset:2048  lds
  v_mfma_f32_16x16x32_bf16 v[132:135], v[36:39], a[192:195], v[132:135]
  ds_read_b128 a[212:215], v117 offset:2048
  v_mfma_f32_16x16x32_bf16 v[140:143], v[36:39], a[196:199], v[140:143]
  ds_read_b128 a[216:219], v117 offset:4096
  v_mfma_f32_16x16x32_bf16 v[148:151], v[36:39], a[200:203], v[148:151]
  ds_read_b128 a[220:223], v117 offset:6144
  v_mfma_f32_16x16x32_bf16 v[156:159], v[36:39], a[204:207], v[156:159]
  ds_read_b64_tr_b16 v[68:69], v5 offset:40960
  v_mfma_f32_16x16x32_bf16 v[160:163], v[40:43], a[192:195], v[160:163]
  buffer_load_dwordx4 v107, s[28:31], s47 offen offset:3072  lds
  v_mfma_f32_16x16x32_bf16 v[168:171], v[40:43], a[196:199], v[168:171]
  ds_read_b64_tr_b16 v[70:71], v5 offset:41984
  v_mfma_f32_16x16x32_bf16 v[176:179], v[40:43], a[200:203], v[176:179]
  ds_read_b64_tr_b16 v[72:73], v6 offset:40960
  v_mfma_f32_16x16x32_bf16 v[184:187], v[40:43], a[204:207], v[184:187]
  ds_read_b64_tr_b16 v[74:75], v6 offset:41984
  v_mfma_f32_16x16x32_bf16 v[164:167], v[44:47], a[192:195], v[164:167]
  ds_read_b64_tr_b16 v[76:77], v7 offset:40960
  s_add_u32 s47, s78, 2
  s_and_b32 s47, s47, 7
  s_lshl_b32 s47, s47, 19
  s_add_u32 s47, s47, s42
  s_mov_b32 s43, 81920
  s_cmp_ge_u32 s3, 2
  s_cselect_b32 s43, 106496, s43
  s_add_u32 m0, s43, s77
  v_mfma_f32_16x16x32_bf16 v[172:175], v[44:47], a[196:199], v[172:175]
  buffer_load_dwordx4 v104, s[28:31], s47 offen offset:0  lds
  v_mfma_f32_16x16x32_bf16 v[180:183], v[44:47], a[200:203], v[180:183]
  ds_read_b64_tr_b16 v[78:79], v7 offset:41984
  v_mfma_f32_16x16x32_bf16 v[188:191], v[44:47], a[204:207], v[188:191]
  ds_read_b64_tr_b16 v[80:81], v8 offset:40960
  v_mfma_f32_16x16x32_bf16 v[192:195], v[48:51], a[192:195], v[192:195]
  ds_read_b64_tr_b16 v[82:83], v8 offset:41984
  v_mfma_f32_16x16x32_bf16 v[200:203], v[48:51], a[196:199], v[200:203]
  ds_read_b64_tr_b16 v[84:85], v9 offset:40960
  v_mfma_f32_16x16x32_bf16 v[208:211], v[48:51], a[200:203], v[208:211]
  buffer_load_dwordx4 v105, s[28:31], s47 offen offset:1024  lds
  v_mfma_f32_16x16x32_bf16 v[216:219], v[48:51], a[204:207], v[216:219]
  ds_read_b64_tr_b16 v[86:87], v9 offset:41984
  v_mfma_f32_16x16x32_bf16 v[196:199], v[52:55], a[192:195], v[196:199]
  ds_read_b64_tr_b16 v[88:89], v10 offset:40960
  v_mfma_f32_16x16x32_bf16 v[204:207], v[52:55], a[196:199], v[204:207]
  ds_read_b64_tr_b16 v[90:91], v10 offset:41984
  v_mfma_f32_16x16x32_bf16 v[212:215], v[52:55], a[200:203], v[212:215]
  ds_read_b64_tr_b16 v[92:93], v11 offset:40960
  v_mfma_f32_16x16x32_bf16 v[220:223], v[52:55], a[204:207], v[220:223]
  buffer_load_dwordx4 v106, s[28:31], s47 offen offset:2048  lds
  v_mfma_f32_16x16x32_bf16 v[224:227], v[56:59], a[192:195], v[224:227]
  ds_read_b64_tr_b16 v[94:95], v11 offset:41984
  v_mfma_f32_16x16x32_bf16 v[232:235], v[56:59], a[196:199], v[232:235]
  v_mfma_f32_16x16x32_bf16 v[240:243], v[56:59], a[200:203], v[240:243]
  v_mfma_f32_16x16x32_bf16 v[248:251], v[56:59], a[204:207], v[248:251]
  v_mfma_f32_16x16x32_bf16 v[228:231], v[60:63], a[192:195], v[228:231]
  buffer_load_dwordx4 v107, s[28:31], s47 offen offset:3072  lds
  v_mfma_f32_16x16x32_bf16 v[236:239], v[60:63], a[196:199], v[236:239]
  v_mfma_f32_16x16x32_bf16 v[244:247], v[60:63], a[200:203], v[244:247]
  v_mfma_f32_16x16x32_bf16 v[252:255], v[60:63], a[204:207], v[252:255]
  s_waitcnt lgkmcnt(0)
  s_waitcnt vmcnt(20)
  s_barrier
  s_waitcnt vmcnt(12)
  v_mfma_f32_16x16x32_bf16 v[128:131], v[64:67], a[208:211], v[128:131]
  ds_read_b64_tr_b16 v[32:33], v4 offset:49152
  v_mfma_f32_16x16x32_bf16 v[136:139], v[64:67], a[212:215], v[136:139]
  ds_read_b64_tr_b16 v[34:35], v4 offset:50176
  v_mfma_f32_16x16x32_bf16 v[144:147], v[64:67], a[216:219], v[144:147]
  ds_read_b128 a[224:227], v116 offset:8192
  s_add_u32 s47, s78, 3
  s_and_b32 s47, s47, 7
  s_lshl_b32 s47, s47, 19
  s_add_u32 s47, s47, s42
  s_mov_b32 s43, 131072
  s_cmp_ge_u32 s3, 2
  s_cselect_b32 s43, 155648, s43
  s_add_u32 m0, s43, s77
  v_mfma_f32_16x16x32_bf16 v[152:155], v[64:67], a[220:223], v[152:155]
  buffer_load_dwordx4 v104, s[28:31], s47 offen offset:0  lds
  v_mfma_f32_16x16x32_bf16 v[132:135], v[68:71], a[208:211], v[132:135]
  ds_read_b128 a[228:231], v116 offset:10240
  v_mfma_f32_16x16x32_bf16 v[140:143], v[68:71], a[212:215], v[140:143]
  ds_read_b128 a[232:235], v116 offset:12288
  v_mfma_f32_16x16x32_bf16 v[148:151], v[68:71], a[216:219], v[148:151]
  ds_read_b128 a[236:239], v116 offset:14336
  v_mfma_f32_16x16x32_bf16 v[156:159], v[68:71], a[220:223], v[156:159]
  ds_read_b64_tr_b16 v[36:37], v5 offset:49152
  v_mfma_f32_16x16x32_bf16 v[160:163], v[72:75], a[208:211], v[160:163]
  buffer_load_dwordx4 v105, s[28:31], s47 offen offset:1024  lds
  v_mfma_f32_16x16x32_bf16 v[168:171], v[72:75], a[212:215], v[168:171]
  ds_read_b64_tr_b16 v[38:39], v5 offset:50176
  v_mfma_f32_16x16x32_bf16 v[176:179], v[72:75], a[216:219], v[176:179]
  ds_read_b64_tr_b16 v[40:41], v6 offset:49152
  v_mfma_f32_16x16x32_bf16 v[184:187], v[72:75], a[220:223], v[184:187]
  ds_read_b64_tr_b16 v[42:43], v6 offset:50176
  v_mfma_f32_16x16x32_bf16 v[164:167], v[76:79], a[208:211], v[164:167]
  ds_read_b64_tr_b16 v[44:45], v7 offset:49152
  v_mfma_f32_16x16x32_bf16 v[172:175], v[76:79], a[212:215], v[172:175]
  buffer_load_dwordx4 v106, s[28:31], s47 offen offset:2048  lds
  v_mfma_f32_16x16x32_bf16 v[180:183], v[76:79], a[216:219], v[180:183]
  ds_read_b64_tr_b16 v[46:47], v7 offset:50176
  v_mfma_f32_16x16x32_bf16 v[188:191], v[76:79], a[220:223], v[188:191]
  ds_read_b64_tr_b16 v[48:49], v8 offset:49152
  v_mfma_f32_16x16x32_bf16 v[192:195], v[80:83], a[208:211], v[192:195]
  ds_read_b64_tr_b16 v[50:51], v8 offset:50176
  v_mfma_f32_16x16x32_bf16 v[200:203], v[80:83], a[212:215], v[200:203]
  ds_read_b64_tr_b16 v[52:53], v9 offset:49152
  v_mfma_f32_16x16x32_bf16 v[208:211], v[80:83], a[216:219], v[208:211]
  buffer_load_dwordx4 v107, s[28:31], s47 offen offset:3072  lds
  v_mfma_f32_16x16x32_bf16 v[216:219], v[80:83], a[220:223], v[216:219]
  ds_read_b64_tr_b16 v[54:55], v9 offset:50176
  v_mfma_f32_16x16x32_bf16 v[196:199], v[84:87], a[208:211], v[196:199]
  ds_read_b64_tr_b16 v[56:57], v10 offset:49152
  v_mfma_f32_16x16x32_bf16 v[204:207], v[84:87], a[212:215], v[204:207]
  ds_read_b64_tr_b16 v[58:59], v10 offset:50176
  v_mfma_f32_16x16x32_bf16 v[212:215], v[84:87], a[216:219], v[212:215]
  ds_read_b64_tr_b16 v[60:61], v11 offset:49152
  v_mfma_f32_16x16x32_bf16 v[220:223], v[84:87], a[220:223], v[220:223]
  buffer_load_dword v29, v1, s[68:71], 0 offen sc1
  v_mfma_f32_16x16x32_bf16 v[224:227], v[88:91], a[208:211], v[224:227]
  ds_read_b64_tr_b16 v[62:63], v11 offset:50176
  v_mfma_f32_16x16x32_bf16 v[232:235], v[88:91], a[212:215], v[232:235]
  v_mfma_f32_16x16x32_bf16 v[240:243], v[88:91], a[216:219], v[240:243]
  v_mfma_f32_16x16x32_bf16 v[248:251], v[88:91], a[220:223], v[248:251]
  s_add_u32 s47, s78, 4
  s_and_b32 s47, s47, 7
  s_lshl_b32 s47, s47, 19
  s_add_u32 s47, s47, s42
  s_add_u32 m0, s44, 32768
  v_mfma_f32_16x16x32_bf16 v[228:231], v[92:95], a[208:211], v[228:231]
  buffer_load_dwordx4 v104, s[28:31], s47 offen offset:0  lds
  v_mfma_f32_16x16x32_bf16 v[236:239], v[92:95], a[212:215], v[236:239]
  v_mfma_f32_16x16x32_bf16 v[244:247], v[92:95], a[216:219], v[244:247]
  v_mfma_f32_16x16x32_bf16 v[252:255], v[92:95], a[220:223], v[252:255]
  s_waitcnt lgkmcnt(0)
  s_waitcnt vmcnt(1)
  v_readfirstlane_b32 s50, v29
  s_mov_b32 s51, 0
  s_nop 2
  s_cmp_ge_u32 s50, 64
  s_cbranch_scc1 L_pok_11
L_psp_12:
  buffer_load_dword v29, v1, s[68:71], 0 offen sc1
  s_waitcnt vmcnt(0)
  v_readfirstlane_b32 s50, v29
  s_add_u32 s51, s51, 1
  s_nop 2
  s_cmp_ge_u32 s50, 64
  s_cbranch_scc1 L_pok_11
  s_cmp_lt_u32 s51, 0x40000
  s_cbranch_scc1 L_psp_12
L_pok_11:
  s_lshl_b32 s39, s38, 10
  buffer_load_dwordx4 v[20:23], v3, s[16:19], s39 offen
  buffer_load_dwordx4 v[24:27], v3, s[16:19], s39 offen offset:1024
  s_mov_b32 s39, 14336
  buffer_load_dwordx4 v[12:15], v3, s[32:35], s39 offen sc1
  buffer_load_dwordx4 v[16:19], v3, s[32:35], s39 offen offset:1024 sc1
  v_mfma_f32_16x16x32_bf16 v[128:131], v[32:35], a[224:227], v[128:131]
  ds_read_b64_tr_b16 v[64:65], v4 offset:57344
  v_mfma_f32_16x16x32_bf16 v[136:139], v[32:35], a[228:231], v[136:139]
  ds_read_b64_tr_b16 v[66:67], v4 offset:58368
  v_mfma_f32_16x16x32_bf16 v[144:147], v[32:35], a[232:235], v[144:147]
  ds_read_b128 a[240:243], v117 offset:8192
  v_mfma_f32_16x16x32_bf16 v[152:155], v[32:35], a[236:239], v[152:155]
  buffer_load_dwordx4 v105, s[28:31], s47 offen offset:1024  lds
  v_mfma_f32_16x16x32_bf16 v[132:135], v[36:39], a[224:227], v[132:135]
  ds_read_b128 a[244:247], v117 offset:10240
  v_mfma_f32_16x16x32_bf16 v[140:143], v[36:39], a[228:231], v[140:143]
  ds_read_b128 a[248:251], v117 offset:12288
  v_mfma_f32_16x16x32_bf16 v[148:151], v[36:39], a[232:235], v[148:151]
  ds_read_b128 a[252:255], v117 offset:14336
  v_mfma_f32_16x16x32_bf16 v[156:159], v[36:39], a[236:239], v[156:159]
  ds_read_b64_tr_b16 v[68:69], v5 offset:57344
  v_mfma_f32_16x16x32_bf16 v[160:163], v[40:43], a[224:227], v[160:163]
  buffer_load_dwordx4 v106, s[28:31], s47 offen offset:2048  lds
  v_mfma_f32_16x16x32_bf16 v[168:171], v[40:43], a[228:231], v[168:171]
  ds_read_b64_tr_b16 v[70:71], v5 offset:58368
  v_mfma_f32_16x16x32_bf16 v[176:179], v[40:43], a[232:235], v[176:179]
  ds_read_b64_tr_b16 v[72:73], v6 offset:57344
  v_mfma_f32_16x16x32_bf16 v[184:187], v[40:43], a[236:239], v[184:187]
  ds_read_b64_tr_b16 v[74:75], v6 offset:58368
  v_mfma_f32_16x16x32_bf16 v[164:167], v[44:47], a[224:227], v[164:167]
  ds_read_b64_tr_b16 v[76:77], v7 offset:57344
  v_mfma_f32_16x16x32_bf16 v[172:175], v[44:47], a[228:231], v[172:175]
  buffer_load_dwordx4 v107, s[28:31], s47 offen offset:3072  lds
  v_mfma_f32_16x16x32_bf16 v[180:183], v[44:47], a[232:235], v[180:183]
  ds_read_b64_tr_b16 v[78:79], v7 offset:58368
  v_mfma_f32_16x16x32_bf16 v[188:191], v[44:47], a[236:239], v[188:191]
  ds_read_b64_tr_b16 v[80:81], v8 offset:57344
  v_mfma_f32_16x16x32_bf16 v[192:195], v[48:51], a[224:227], v[192:195]
  ds_read_b64_tr_b16 v[82:83], v8 offset:58368
  v_mfma_f32_16x16x32_bf16 v[200:203], v[48:51], a[228:231], v[200:203]
  ds_read_b64_tr_b16 v[84:85], v9 offset:57344
  s_add_u32 s47, s78, 5
  s_and_b32 s47, s47, 7
  s_lshl_b32 s47, s47, 19
  s_add_u32 s47, s47, s42
  s_mov_b32 s43, 65536
  s_cmp_ge_u32 s3, 2
  s_cselect_b32 s43, 90112, s43
  s_add_u32 m0, s43, s77
  v_mfma_f32_16x16x32_bf16 v[208:211], v[48:51], a[232:235], v[208:211]
  buffer_load_dwordx4 v104, s[28:31], s47 offen offset:0  lds
  v_mfma_f32_16x16x32_bf16 v[216:219], v[48:51], a[236:239], v[216:219]
  ds_read_b64_tr_b16 v[86:87], v9 offset:58368
  v_mfma_f32_16x16x32_bf16 v[196:199], v[52:55], a[224:227], v[196:199]
  ds_read_b64_tr_b16 v[88:89], v10 offset:57344
  v_mfma_f32_16x16x32_bf16 v[204:207], v[52:55], a[228:231], v[204:207]
  ds_read_b64_tr_b16 v[90:91], v10 offset:58368
  v_mfma_f32_16x16x32_bf16 v[212:215], v[52:55], a[232:235], v[212:215]
  ds_read_b64_tr_b16 v[92:93], v11 offset:57344
  v_mfma_f32_16x16x32_bf16 v[220:223], v[52:55], a[236:239], v[220:223]
  buffer_load_dwordx4 v105, s[28:31], s47 offen offset:1024  lds
  v_mfma_f32_16x16x32_bf16 v[224:227], v[56:59], a[224:227], v[224:227]
  ds_read_b64_tr_b16 v[94:95], v11 offset:58368
  v_mfma_f32_16x16x32_bf16 v[232:235], v[56:59], a[228:231], v[232:235]
  v_mfma_f32_16x16x32_bf16 v[240:243], v[56:59], a[232:235], v[240:243]
  v_mfma_f32_16x16x32_bf16 v[248:251], v[56:59], a[236:239], v[248:251]
  v_mfma_f32_16x16x32_bf16 v[228:231], v[60:63], a[224:227], v[228:231]
  buffer_load_dwordx4 v106, s[28:31], s47 offen offset:2048  lds
  v_mfma_f32_16x16x32_bf16 v[236:239], v[60:63], a[228:231], v[236:239]
  v_mfma_f32_16x16x32_bf16 v[244:247], v[60:63], a[232:235], v[244:247]
  v_mfma_f32_16x16x32_bf16 v[252:255], v[60:63], a[236:239], v[252:255]
  s_waitcnt lgkmcnt(0)
  s_barrier
  v_mfma_f32_16x16x32_bf16 v[128:131], v[64:67], a[240:243], v[128:131]
  ds_read_b64_tr_b16 v[32:33], v4 offset:0
  v_mfma_f32_16x16x32_bf16 v[136:139], v[64:67], a[244:247], v[136:139]
  buffer_load_dwordx4 v107, s[28:31], s47 offen offset:3072  lds
  v_mfma_f32_16x16x32_bf16 v[144:147], v[64:67], a[248:251], v[144:147]
  ds_read_b64_tr_b16 v[34:35], v4 offset:1024
  v_mfma_f32_16x16x32_bf16 v[152:155], v[64:67], a[252:255], v[152:155]
  ds_read_b64_tr_b16 v[36:37], v5 offset:0
  s_add_u32 s47, s78, 6
  s_and_b32 s47, s47, 7
  s_lshl_b32 s47, s47, 19
  s_add_u32 s47, s47, s42
  s_mov_b32 s43, 114688
  s_cmp_ge_u32 s3, 2
  s_cselect_b32 s43, 139264, s43
  s_add_u32 m0, s43, s77
  v_mfma_f32_16x16x32_bf16 v[132:135], v[68:71], a[240:243], v[132:135]
  buffer_load_dwordx4 v104, s[28:31], s47 offen offset:0  lds
  v_mfma_f32_16x16x32_bf16 v[140:143], v[68:71], a[244:247], v[140:143]
  ds_read_b64_tr_b16 v[38:39], v5 offset:1024
  v_mfma_f32_16x16x32_bf16 v[148:151], v[68:71], a[248:251], v[148:151]
  ds_read_b64_tr_b16 v[40:41], v6 offset:0
  v_mfma_f32_16x16x32_bf16 v[156:159], v[68:71], a[252:255], v[156:159]
  buffer_load_dwordx4 v105, s[28:31], s47 offen offset:1024  lds
  v_mfma_f32_16x16x32_bf16 v[160:163], v[72:75], a[240:243], v[160:163]
  ds_read_b64_tr_b16 v[42:43], v6 offset:1024
  v_mfma_f32_16x16x32_bf16 v[168:171], v[72:75], a[244:247], v[168:171]
  ds_read_b64_tr_b16 v[44:45], v7 offset:0
  v_mfma_f32_16x16x32_bf16 v[176:179], v[72:75], a[248:251], v[176:179]
  buffer_load_dwordx4 v106, s[28:31], s47 offen offset:2048  lds
  v_mfma_f32_16x16x32_bf16 v[184:187], v[72:75], a[252:255], v[184:187]
  ds_read_b64_tr_b16 v[46:47], v7 offset:1024
  v_mfma_f32_16x16x32_bf16 v[164:167], v[76:79], a[240:243], v[164:167]
  v_mfma_f32_16x16x32_bf16 v[172:175], v[76:79], a[244:247], v[172:175]
  buffer_load_dwordx4 v107, s[28:31], s47 offen offset:3072  lds
  v_mfma_f32_16x16x32_bf16 v[180:183], v[76:79], a[248:251], v[180:183]
  v_mfma_f32_16x16x32_bf16 v[188:191], v[76:79], a[252:255], v[188:191]
  s_add_u32 s47, s78, 7
  s_and_b32 s47, s47, 7
  s_lshl_b32 s47, s47, 19
  s_add_u32 s47, s47, s42
  s_add_u32 m0, s44, 49152
  v_mfma_f32_16x16x32_bf16 v[192:195], v[80:83], a[240:243], v[192:195]
  buffer_load_dwordx4 v104, s[28:31], s47 offen offset:0  lds
  v_mfma_f32_16x16x32_bf16 v[200:203], v[80:83], a[244:247], v[200:203]
  v_mfma_f32_16x16x32_bf16 v[208:211], v[80:83], a[248:251], v[208:211]
  v_mfma_f32_16x16x32_bf16 v[216:219], v[80:83], a[252:255], v[216:219]
  buffer_load_dwordx4 v105, s[28:31], s47 offen offset:1024  lds
  v_mfma_f32_16x16x32_bf16 v[196:199], v[84:87], a[240:243], v[196:199]
  v_mfma_f32_16x16x32_bf16 v[204:207], v[84:87], a[244:247], v[204:207]
  v_mfma_f32_16x16x32_bf16 v[212:215], v[84:87], a[248:251], v[212:215]
  buffer_load_dwordx4 v106, s[28:31], s47 offen offset:2048  lds
  v_mfma_f32_16x16x32_bf16 v[220:223], v[84:87], a[252:255], v[220:223]
  v_mfma_f32_16x16x32_bf16 v[224:227], v[88:91], a[240:243], v[224:227]
  v_mfma_f32_16x16x32_bf16 v[232:235], v[88:91], a[244:247], v[232:235]
  buffer_load_dwordx4 v107, s[28:31], s47 offen offset:3072  lds
  v_mfma_f32_16x16x32_bf16 v[240:243], v[88:91], a[248:251], v[240:243]
  v_mfma_f32_16x16x32_bf16 v[248:251], v[88:91], a[252:255], v[248:251]
  v_mfma_f32_16x16x32_bf16 v[228:231], v[92:95], a[240:243], v[228:231]
  v_mfma_f32_16x16x32_bf16 v[236:239], v[92:95], a[244:247], v[236:239]
  v_mfma_f32_16x16x32_bf16 v[244:247], v[92:95], a[248:251], v[244:247]
  v_mfma_f32_16x16x32_bf16 v[252:255], v[92:95], a[252:255], v[252:255]
  s_waitcnt lgkmcnt(0)
  v_mfma_f32_16x16x32_bf16 v[64:67], a[0:3], v[32:35], 0
  ds_read_b64_tr_b16 v[48:49], v4 offset:8192
  v_mfma_f32_16x16x32_bf16 v[68:71], a[4:7], v[32:35], 0
  ds_read_b64_tr_b16 v[50:51], v4 offset:9216
  v_mfma_f32_16x16x32_bf16 v[96:99], a[8:11], v[32:35], 0
  ds_read_b64_tr_b16 v[52:53], v5 offset:8192
  v_mul_f32 v224, s49, v224
  v_mfma_f32_16x16x32_bf16 v[100:103], a[12:15], v[32:35], 0
  ds_read_b64_tr_b16 v[54:55], v5 offset:9216
  v_mul_f32 v225, s49, v225
  v_mfma_f32_16x16x32_bf16 v[72:75], a[0:3], v[36:39], 0
  ds_read_b64_tr_b16 v[56:57], v6 offset:8192
  v_mul_f32 v226, s49, v226
  v_mfma_f32_16x16x32_bf16 v[76:79], a[4:7], v[36:39], 0
  ds_read_b64_tr_b16 v[58:59], v6 offset:9216
  v_mul_f32 v227, s49, v227
  v_mfma_f32_16x16x32_bf16 v[104:107], a[8:11], v[36:39], 0
  ds_read_b64_tr_b16 v[60:61], v7 offset:8192
  v_mul_f32 v228, s49, v228
  v_mfma_f32_16x16x32_bf16 v[108:111], a[12:15], v[36:39], 0
  ds_read_b64_tr_b16 v[62:63], v7 offset:9216
  v_mul_f32 v229, s49, v229
  v_mfma_f32_16x16x32_bf16 v[80:83], a[0:3], v[40:43], 0
  v_mul_f32 v230, s49, v230
  v_mul_f32 v231, s49, v231
  v_mfma_f32_16x16x32_bf16 v[84:87], a[4:7], v[40:43], 0
  v_cvt_pk_bf16_f32 v224, v224, v225
  v_cvt_pk_bf16_f32 v225, v226, v227
  v_mfma_f32_16x16x32_bf16 v[112:115], a[8:11], v[40:43], 0
  v_cvt_pk_bf16_f32 v226, v228, v229
  v_cvt_pk_bf16_f32 v227, v230, v231
  v_mfma_f32_16x16x32_bf16 v[116:119], a[12:15], v[40:43], 0
  v_mul_f32 v232, s49, v232
  v_mul_f32 v233, s49, v233
  v_mfma_f32_16x16x32_bf16 v[88:91], a[0:3], v[44:47], 0
  v_mul_f32 v234, s49, v234
  v_mfma_f32_16x16x32_bf16 v[92:95], a[4:7], v[44:47], 0
  v_mfma_f32_16x16x32_bf16 v[120:123], a[8:11], v[44:47], 0
  v_mfma_f32_16x16x32_bf16 v[124:127], a[12:15], v[44:47], 0
  s_waitcnt lgkmcnt(0)
  s_barrier
  v_mfma_f32_16x16x32_bf16 v[64:67], a[16:19], v[48:51], v[64:67]
  ds_read_b64_tr_b16 v[32:33], v4 offset:16384
  v_mfma_f32_16x16x32_bf16 v[68:71], a[20:23], v[48:51], v[68:71]
  ds_read_b64_tr_b16 v[34:35], v4 offset:17408
  v_mul_f32 v235, s49, v235
  v_mfma_f32_16x16x32_bf16 v[96:99], a[24:27], v[48:51], v[96:99]
  ds_read_b64_tr_b16 v[36:37], v5 offset:16384
  v_mul_f32 v236, s49, v236
  v_mfma_f32_16x16x32_bf16 v[100:103], a[28:31], v[48:51], v[100:103]
  ds_read_b64_tr_b16 v[38:39], v5 offset:17408
  v_mul_f32 v237, s49, v237
  v_mfma_f32_16x16x32_bf16 v[72:75], a[16:19], v[52:55], v[72:75]
  ds_read_b64_tr_b16 v[40:41], v6 offset:16384
  v_mul_f32 v238, s49, v238
  v_mfma_f32_16x16x32_bf16 v[76:79], a[20:23], v[52:55], v[76:79]
  ds_read_b64_tr_b16 v[42:43], v6 offset:17408
  v_mul_f32 v239, s49, v239
  v_mfma_f32_16x16x32_bf16 v[104:107], a[24:27], v[52:55], v[104:107]
  ds_read_b64_tr_b16 v[44:45], v7 offset:16384
  v_cvt_pk_bf16_f32 v232, v232, v233
  v_mfma_f32_16x16x32_bf16 v[108:111], a[28:31], v[52:55], v[108:111]
  ds_read_b64_tr_b16 v[46:47], v7 offset:17408
  v_cvt_pk_bf16_f32 v233, v234, v235
  v_mfma_f32_16x16x32_bf16 v[80:83], a[16:19], v[56:59], v[80:83]
  v_cvt_pk_bf16_f32 v234, v236, v237
  v_cvt_pk_bf16_f32 v235, v238, v239
  v_mfma_f32_16x16x32_bf16 v[84:87], a[20:23], v[56:59], v[84:87]
  v_mul_f32 v240, s49, v240
  v_mul_f32 v241, s49, v241
  v_mfma_f32_16x16x32_bf16 v[112:115], a[24:27], v[56:59], v[112:115]
  v_mul_f32 v242, s49, v242
  v_mul_f32 v243, s49, v243
  v_mfma_f32_16x16x32_bf16 v[116:119], a[28:31], v[56:59], v[116:119]
  v_mul_f32 v244, s49, v244
  v_mul_f32 v245, s49, v245
  v_mfma_f32_16x16x32_bf16 v[88:91], a[16:19], v[60:63], v[88:91]
  v_mfma_f32_16x16x32_bf16 v[92:95], a[20:23], v[60:63], v[92:95]
  v_mfma_f32_16x16x32_bf16 v[120:123], a[24:27], v[60:63], v[120:123]
  v_mfma_f32_16x16x32_bf16 v[124:127], a[28:31], v[60:63], v[124:127]
  s_waitcnt lgkmcnt(0)
  v_mfma_f32_16x16x32_bf16 v[64:67], a[32:35], v[32:35], v[64:67]
  ds_read_b64_tr_b16 v[48:49], v4 offset:24576
  v_mfma_f32_16x16x32_bf16 v[68:71], a[36:39], v[32:35], v[68:71]
  ds_read_b64_tr_b16 v[50:51], v4 offset:25600
  v_mul_f32 v246, s49, v246
  v_mfma_f32_16x16x32_bf16 v[96:99], a[40:43], v[32:35], v[96:99]
  ds_read_b64_tr_b16 v[52:53], v5 offset:24576
  v_mul_f32 v247, s49, v247
  v_mfma_f32_16x16x32_bf16 v[100:103], a[44:47], v[32:35], v[100:103]
  ds_read_b64_tr_b16 v[54:55], v5 offset:25600
  v_cvt_pk_bf16_f32 v240, v240, v241
  v_mfma_f32_16x16x32_bf16 v[72:75], a[32:35], v[36:39], v[72:75]
  ds_read_b64_tr_b16 v[56:57], v6 offset:24576
  v_cvt_pk_bf16_f32 v241, v242, v243
  v_mfma_f32_16x16x32_bf16 v[76:79], a[36:39], v[36:39], v[76:79]
  ds_read_b64_tr_b16 v[58:59], v6 offset:25600
  v_cvt_pk_bf16_f32 v242, v244, v245
  v_mfma_f32_16x16x32_bf16 v[104:107], a[40:43], v[36:39], v[104:107]
  ds_read_b64_tr_b16 v[60:61], v7 offset:24576
  v_cvt_pk_bf16_f32 v243, v246, v247
  v_mfma_f32_16x16x32_bf16 v[108:111], a[44:47], v[36:39], v[108:111]
  ds_read_b64_tr_b16 v[62:63], v7 offset:25600
  v_mul_f32 v248, s49, v248
  v_mfma_f32_16x16x32_bf16 v[80:83], a[32:35], v[40:43], v[80:83]
  v_mul_f32 v249, s49, v249
  v_mul_f32 v250, s49, v250
  v_mfma_f32_16x16x32_bf16 v[84:87], a[36:39], v[40:43], v[84:87]
  v_mul_f32 v251, s49, v251
  v_mul_f32 v252, s49, v252
  v_mfma_f32_16x16x32_bf16 v[112:115], a[40:43], v[40:43], v[112:115]
  v_mul_f32 v253, s49, v253
  v_mul_f32 v254, s49, v254
  v_mfma_f32_16x16x32_bf16 v[116:119], a[44:47], v[40:43], v[116:119]
  v_mul_f32 v255, s49, v255
  v_cvt_pk_bf16_f32 v248, v248, v249
  v_mfma_f32_16x16x32_bf16 v[88:91], a[32:35], v[44:47], v[88:91]
  v_mfma_f32_16x16x32_bf16 v[92:95], a[36:39], v[44:47], v[92:95]
  v_mfma_f32_16x16x32_bf16 v[120:123], a[40:43], v[44:47], v[120:123]
  v_mfma_f32_16x16x32_bf16 v[124:127], a[44:47], v[44:47], v[124:127]
  s_waitcnt lgkmcnt(0)
  s_barrier
  v_add_u32 v4, 0x10000, v4
  v_add_u32 v5, 0x10000, v5
  v_add_u32 v6, 0x10000, v6
  v_add_u32 v7, 0x10000, v7
  v_mfma_f32_16x16x32_bf16 v[64:67], a[48:51], v[48:51], v[64:67]
  ds_read_b64_tr_b16 v[32:33], v4 offset:16384
  v_mfma_f32_16x16x32_bf16 v[68:71], a[52:55], v[48:51], v[68:71]
  ds_read_b64_tr_b16 v[34:35], v4 offset:17408
  v_cvt_pk_bf16_f32 v249, v250, v251
  v_mfma_f32_16x16x32_bf16 v[96:99], a[56:59], v[48:51], v[96:99]
  ds_read_b64_tr_b16 v[36:37], v5 offset:16384
  v_cvt_pk_bf16_f32 v250, v252, v253
  v_mfma_f32_16x16x32_bf16 v[100:103], a[60:63], v[48:51], v[100:103]
  ds_read_b64_tr_b16 v[38:39], v5 offset:17408
  v_cvt_pk_bf16_f32 v251, v254, v255
  v_mfma_f32_16x16x32_bf16 v[72:75], a[48:51], v[52:55], v[72:75]
  ds_read_b64_tr_b16 v[40:41], v6 offset:16384
  v_mul_f32 v192, s49, v192
  v_mfma_f32_16x16x32_bf16 v[76:79], a[52:55], v[52:55], v[76:79]
  ds_read_b64_tr_b16 v[42:43], v6 offset:17408
  v_mul_f32 v193, s49, v193
  v_mfma_f32_16x16x32_bf16 v[104:107], a[56:59], v[52:55], v[104:107]
  ds_read_b64_tr_b16 v[44:45], v7 offset:16384
  v_mul_f32 v194, s49, v194
  v_mfma_f32_16x16x32_bf16 v[108:111], a[60:63], v[52:55], v[108:111]
  ds_read_b64_tr_b16 v[46:47], v7 offset:17408
  v_mul_f32 v195, s49, v195
  v_mfma_f32_16x16x32_bf16 v[80:83], a[48:51], v[56:59], v[80:83]
  v_mul_f32 v196, s49, v196
  v_mul_f32 v197, s49, v197
  v_mfma_f32_16x16x32_bf16 v[84:87], a[52:55], v[56:59], v[84:87]
  v_mul_f32 v198, s49, v198
  v_mul_f32 v199, s49, v199
  v_mfma_f32_16x16x32_bf16 v[112:115], a[56:59], v[56:59], v[112:115]
  v_cvt_pk_bf16_f32 v192, v192, v193
  v_cvt_pk_bf16_f32 v193, v194, v195
  v_mfma_f32_16x16x32_bf16 v[116:119], a[60:63], v[56:59], v[116:119]
  s_add_u32 s48, s45, 3072
  buffer_store_dwordx4 v[224:227], v3, s[32:35], s48 offen sc1
  v_mfma_f32_16x16x32_bf16 v[88:91], a[48:51], v[60:63], v[88:91]
  v_cvt_pk_bf16_f32 v194, v196, v197
  v_cvt_pk_bf16_f32 v195, v198, v199
  v_mfma_f32_16x16x32_bf16 v[92:95], a[52:55], v[60:63], v[92:95]
  v_mfma_f32_16x16x32_bf16 v[120:123], a[56:59], v[60:63], v[120:123]
  s_add_u32 s48, s45, 7168
  buffer_store_dwordx4 v[232:235], v3, s[32:35], s48 offen sc1
  v_mfma_f32_16x16x32_bf16 v[124:127], a[60:63], v[60:63], v[124:127]
  s_waitcnt lgkmcnt(0)
  s_waitcnt vmcnt(17)
  v_mfma_f32_16x16x32_bf16 v[64:67], a[64:67], v[32:35], v[64:67]
  ds_read_b64_tr_b16 v[48:49], v4 offset:40960
  v_mfma_f32_16x16x32_bf16 v[68:71], a[68:71], v[32:35], v[68:71]
  ds_read_b64_tr_b16 v[50:51], v4 offset:41984
  v_mul_f32 v200, s49, v200
  v_mfma_f32_16x16x32_bf16 v[96:99], a[72:75], v[32:35], v[96:99]
  ds_read_b64_tr_b16 v[52:53], v5 offset:40960
  v_mul_f32 v201, s49, v201
  v_mfma_f32_16x16x32_bf16 v[100:103], a[76:79], v[32:35], v[100:103]
  ds_read_b64_tr_b16 v[54:55], v5 offset:41984
  v_mul_f32 v202, s49, v202
  v_mfma_f32_16x16x32_bf16 v[72:75], a[64:67], v[36:39], v[72:75]
  ds_read_b64_tr_b16 v[56:57], v6 offset:40960
  v_mul_f32 v203, s49, v203
  v_mfma_f32_16x16x32_bf16 v[76:79], a[68:71], v[36:39], v[76:79]
  ds_read_b64_tr_b16 v[58:59], v6 offset:41984
  v_mul_f32 v204, s49, v204
  v_mfma_f32_16x16x32_bf16 v[104:107], a[72:75], v[36:39], v[104:107]
  ds_read_b64_tr_b16 v[60:61], v7 offset:40960
  v_mul_f32 v205, s49, v205
  v_mfma_f32_16x16x32_bf16 v[108:111], a[76:79], v[36:39], v[108:111]
  ds_read_b64_tr_b16 v[62:63], v7 offset:41984
  v_mul_f32 v206, s49, v206
  v_mfma_f32_16x16x32_bf16 v[80:83], a[64:67], v[40:43], v[80:83]
  v_mul_f32 v207, s49, v207
  v_cvt_pk_bf16_f32 v200, v200, v201
  v_mfma_f32_16x16x32_bf16 v[84:87], a[68:71], v[40:43], v[84:87]
  v_cvt_pk_bf16_f32 v201, v202, v203
  v_cvt_pk_bf16_f32 v202, v204, v205
  v_mfma_f32_16x16x32_bf16 v[112:115], a[72:75], v[40:43], v[112:115]
  v_cvt_pk_bf16_f32 v203, v206, v207
  v_mul_f32 v208, s49, v208
  v_mfma_f32_16x16x32_bf16 v[116:119], a[76:79], v[40:43], v[116:119]
  s_add_u32 s48, s45, 11264
  buffer_store_dwordx4 v[240:243], v3, s[32:35], s48 offen sc1
  v_mfma_f32_16x16x32_bf16 v[88:91], a[64:67], v[44:47], v[88:91]
  v_mul_f32 v209, s49, v209
  v_mul_f32 v210, s49, v210
  v_mfma_f32_16x16x32_bf16 v[92:95], a[68:71], v[44:47], v[92:95]
  v_mfma_f32_16x16x32_bf16 v[120:123], a[72:75], v[44:47], v[120:123]
  s_add_u32 s48, s45, 15360
  buffer_store_dwordx4 v[248:251], v3, s[32:35], s48 offen sc1
  v_mfma_f32_16x16x32_bf16 v[124:127], a[76:79], v[44:47], v[124:127]
  s_waitcnt lgkmcnt(0)
  s_barrier
  v_add_u32 v4, 0x10000, v4
  v_add_u32 v5, 0x10000, v5
  v_add_u32 v6, 0x10000, v6
  v_add_u32 v7, 0x10000, v7
  v_mfma_f32_16x16x32_bf16 v[64:67], a[80:83], v[48:51], v[64:67]
  ds_read_b64_tr_b16 v[32:33], v4 offset:0
  v_mfma_f32_16x16x32_bf16 v[68:71], a[84:87], v[48:51], v[68:71]
  ds_read_b64_tr_b16 v[34:35], v4 offset:1024
  v_mul_f32 v211, s49, v211
  v_mfma_f32_16x16x32_bf16 v[96:99], a[88:91], v[48:51], v[96:99]
  ds_read_b64_tr_b16 v[36:37], v5 offset:0
  v_mul_f32 v212, s49, v212
  v_mfma_f32_16x16x32_bf16 v[100:103], a[92:95], v[48:51], v[100:103]
  ds_read_b64_tr_b16 v[38:39], v5 offset:1024
  v_mul_f32 v213, s49, v213
  v_mfma_f32_16x16x32_bf16 v[72:75], a[80:83], v[52:55], v[72:75]
  ds_read_b64_tr_b16 v[40:41], v6 offset:0
  v_mul_f32 v214, s49, v214
  v_mfma_f32_16x16x32_bf16 v[76:79], a[84:87], v[52:55], v[76:79]
  ds_read_b64_tr_b16 v[42:43], v6 offset:1024
  v_mul_f32 v215, s49, v215
  v_mfma_f32_16x16x32_bf16 v[104:107], a[88:91], v[52:55], v[104:107]
  ds_read_b64_tr_b16 v[44:45], v7 offset:0
  v_cvt_pk_bf16_f32 v208, v208, v209
  v_mfma_f32_16x16x32_bf16 v[108:111], a[92:95], v[52:55], v[108:111]
  ds_read_b64_tr_b16 v[46:47], v7 offset:1024
  v_cvt_pk_bf16_f32 v209, v210, v211
  v_mfma_f32_16x16x32_bf16 v[80:83], a[80:83], v[56:59], v[80:83]
  v_cvt_pk_bf16_f32 v210, v212, v213
  v_cvt_pk_bf16_f32 v211, v214, v215
  v_mfma_f32_16x16x32_bf16 v[84:87], a[84:87], v[56:59], v[84:87]
  v_mul_f32 v216, s49, v216
  v_mul_f32 v217, s49, v217
  v_mfma_f32_16x16x32_bf16 v[112:115], a[88:91], v[56:59], v[112:115]
  v_mul_f32 v218, s49, v218
  v_mul_f32 v219, s49, v219
  v_mfma_f32_16x16x32_bf16 v[116:119], a[92:95], v[56:59], v[116:119]
  s_add_u32 s48, s45, 2048
  buffer_store_dwordx4 v[192:195], v3, s[32:35], s48 offen sc1
  v_mfma_f32_16x16x32_bf16 v[88:91], a[80:83], v[60:63], v[88:91]
  v_mul_f32 v220, s49, v220
  v_mul_f32 v221, s49, v221
  v_mfma_f32_16x16x32_bf16 v[92:95], a[84:87], v[60:63], v[92:95]
  v_mfma_f32_16x16x32_bf16 v[120:123], a[88:91], v[60:63], v[120:123]
  s_add_u32 s48, s45, 6144
  buffer_store_dwordx4 v[200:203], v3, s[32:35], s48 offen sc1
  v_mfma_f32_16x16x32_bf16 v[124:127], a[92:95], v[60:63], v[124:127]
  s_waitcnt lgkmcnt(0)
  v_mfma_f32_16x16x32_bf16 v[64:67], a[96:99], v[32:35], v[64:67]
  ds_read_b64_tr_b16 v[48:49], v4 offset:24576
  v_mfma_f32_16x16x32_bf16 v[68:71], a[100:103], v[32:35], v[68:71]
  ds_read_b64_tr_b16 v[50:51], v4 offset:25600
  v_mul_f32 v222, s49, v222
  v_mfma_f32_16x16x32_bf16 v[96:99], a[104:107], v[32:35], v[96:99]
  ds_read_b64_tr_b16 v[52:53], v5 offset:24576
  v_mul_f32 v223, s49, v223
  v_mfma_f32_16x16x32_bf16 v[100:103], a[108:111], v[32:35], v[100:103]
  ds_read_b64_tr_b16 v[54:55], v5 offset:25600
  v_cvt_pk_bf16_f32 v216, v216, v217
  v_mfma_f32_16x16x32_bf16 v[72:75], a[96:99], v[36:39], v[72:75]
  ds_read_b64_tr_b16 v[56:57], v6 offset:24576
  v_cvt_pk_bf16_f32 v217, v218, v219
  v_mfma_f32_16x16x32_bf16 v[76:79], a[100:103], v[36:39], v[76:79]
  ds_read_b64_tr_b16 v[58:59], v6 offset:25600
  v_cvt_pk_bf16_f32 v218, v220, v221
  v_mfma_f32_16x16x32_bf16 v[104:107], a[104:107], v[36:39], v[104:107]
  ds_read_b64_tr_b16 v[60:61], v7 offset:24576
  v_cvt_pk_bf16_f32 v219, v222, v223
  v_mfma_f32_16x16x32_bf16 v[108:111], a[108:111], v[36:39], v[108:111]
  ds_read_b64_tr_b16 v[62:63], v7 offset:25600
  v_mul_f32 v160, s49, v160
  v_mfma_f32_16x16x32_bf16 v[80:83], a[96:99], v[40:43], v[80:83]
  v_mul_f32 v161, s49, v161
  v_mul_f32 v162, s49, v162
  v_mfma_f32_16x16x32_bf16 v[84:87], a[100:103], v[40:43], v[84:87]
  v_mul_f32 v163, s49, v163
  v_mul_f32 v164, s49, v164
  v_mfma_f32_16x16x32_bf16 v[112:115], a[104:107], v[40:43], v[112:115]
  v_mul_f32 v165, s49, v165
  v_mul_f32 v166, s49, v166
  v_mfma_f32_16x16x32_bf16 v[116:119], a[108:111], v[40:43], v[116:119]
  v_mul_f32 v167, s49, v167
  v_cvt_pk_bf16_f32 v160, v160, v161
  v_mfma_f32_16x16x32_bf16 v[88:91], a[96:99], v[44:47], v[88:91]
  v_mfma_f32_16x16x32_bf16 v[92:95], a[100:103], v[44:47], v[92:95]
  v_mfma_f32_16x16x32_bf16 v[120:123], a[104:107], v[44:47], v[120:123]
  s_add_u32 s48, s45, 10240
  buffer_store_dwordx4 v[208:211], v3, s[32:35], s48 offen sc1
  v_mfma_f32_16x16x32_bf16 v[124:127], a[108:111], v[44:47], v[124:127]
  s_waitcnt lgkmcnt(0)
  s_waitcnt vmcnt(19)
  s_barrier
  v_subrev_u32 v4, 0x20000, v4
  v_subrev_u32 v5, 0x20000, v5
  v_subrev_u32 v6, 0x20000, v6
  v_subrev_u32 v7, 0x20000, v7
  v_mfma_f32_16x16x32_bf16 v[64:67], a[112:115], v[48:51], v[64:67]
  ds_read_b64_tr_b16 v[32:33], v4 offset:32768
  v_mfma_f32_16x16x32_bf16 v[68:71], a[116:119], v[48:51], v[68:71]
  ds_read_b64_tr_b16 v[34:35], v4 offset:33792
  v_cvt_pk_bf16_f32 v161, v162, v163
  v_mfma_f32_16x16x32_bf16 v[96:99], a[120:123], v[48:51], v[96:99]
  ds_read_b64_tr_b16 v[36:37], v5 offset:32768
  v_cvt_pk_bf16_f32 v162, v164, v165
  v_mfma_f32_16x16x32_bf16 v[100:103], a[124:127], v[48:51], v[100:103]
  ds_read_b64_tr_b16 v[38:39], v5 offset:33792
  v_cvt_pk_bf16_f32 v163, v166, v167
  v_mfma_f32_16x16x32_bf16 v[72:75], a[112:115], v[52:55], v[72:75]
  ds_read_b64_tr_b16 v[40:41], v6 offset:32768
  v_mul_f32 v168, s49, v168
  v_mfma_f32_16x16x32_bf16 v[76:79], a[116:119], v[52:55], v[76:79]
  ds_read_b64_tr_b16 v[42:43], v6 offset:33792
  v_mul_f32 v169, s49, v169
  v_mfma_f32_16x16x32_bf16 v[104:107], a[120:123], v[52:55], v[104:107]
  ds_read_b64_tr_b16 v[44:45], v7 offset:32768
  v_mul_f32 v170, s49, v170
  v_mfma_f32_16x16x32_bf16 v[108:111], a[124:127], v[52:55], v[108:111]
  ds_read_b64_tr_b16 v[46:47], v7 offset:33792
  v_mul_f32 v171, s49, v171
  v_mfma_f32_16x16x32_bf16 v[80:83], a[112:115], v[56:59], v[80:83]
  v_mul_f32 v172, s49, v172
  v_mul_f32 v173, s49, v173
  v_mfma_f32_16x16x32_bf16 v[84:87], a[116:119], v[56:59], v[84:87]
  v_mul_f32 v174, s49, v174
  v_mul_f32 v175, s49, v175
  v_mfma_f32_16x16x32_bf16 v[112:115], a[120:123], v[56:59], v[112:115]
  v_cvt_pk_bf16_f32 v168, v168, v169
  v_cvt_pk_bf16_f32 v169, v170, v171
  v_mfma_f32_16x16x32_bf16 v[116:119], a[124:127], v[56:59], v[116:119]
  v_cvt_pk_bf16_f32 v170, v172, v173
  v_cvt_pk_bf16_f32 v171, v174, v175
  v_mfma_f32_16x16x32_bf16 v[88:91], a[112:115], v[60:63], v[88:91]
  v_mfma_f32_16x16x32_bf16 v[92:95], a[116:119], v[60:63], v[92:95]
  v_mfma_f32_16x16x32_bf16 v[120:123], a[120:123], v[60:63], v[120:123]
  s_add_u32 s48, s45, 14336
  buffer_store_dwordx4 v[216:219], v3, s[32:35], s48 offen sc1
  v_mfma_f32_16x16x32_bf16 v[124:127], a[124:127], v[60:63], v[124:127]
  s_waitcnt lgkmcnt(0)
  v_mfma_f32_16x16x32_bf16 v[64:67], a[128:131], v[32:35], v[64:67]
  ds_read_b64_tr_b16 v[48:49], v4 offset:40960
  v_mfma_f32_16x16x32_bf16 v[68:71], a[132:135], v[32:35], v[68:71]
  ds_read_b64_tr_b16 v[50:51], v4 offset:41984
  v_mul_f32 v176, s49, v176
  v_mfma_f32_16x16x32_bf16 v[96:99], a[136:139], v[32:35], v[96:99]
  ds_read_b64_tr_b16 v[52:53], v5 offset:40960
  v_mul_f32 v177, s49, v177
  v_mfma_f32_16x16x32_bf16 v[100:103], a[140:143], v[32:35], v[100:103]
  ds_read_b64_tr_b16 v[54:55], v5 offset:41984
  v_mul_f32 v178, s49, v178
  v_mfma_f32_16x16x32_bf16 v[72:75], a[128:131], v[36:39], v[72:75]
  ds_read_b64_tr_b16 v[56:57], v6 offset:40960
  v_mul_f32 v179, s49, v179
  v_mfma_f32_16x16x32_bf16 v[76:79], a[132:135], v[36:39], v[76:79]
  ds_read_b64_tr_b16 v[58:59], v6 offset:41984
  v_mul_f32 v180, s49, v180
  v_mfma_f32_16x16x32_bf16 v[104:107], a[136:139], v[36:39], v[104:107]
  ds_read_b64_tr_b16 v[60:61], v7 offset:40960
  v_mul_f32 v181, s49, v181
  v_mfma_f32_16x16x32_bf16 v[108:111], a[140:143], v[36:39], v[108:111]
  ds_read_b64_tr_b16 v[62:63], v7 offset:41984
  v_mul_f32 v182, s49, v182
  v_mfma_f32_16x16x32_bf16 v[80:83], a[128:131], v[40:43], v[80:83]
  v_mul_f32 v183, s49, v183
  v_cvt_pk_bf16_f32 v176, v176, v177
  v_mfma_f32_16x16x32_bf16 v[84:87], a[132:135], v[40:43], v[84:87]
  v_cvt_pk_bf16_f32 v177, v178, v179
  v_cvt_pk_bf16_f32 v178, v180, v181
  v_mfma_f32_16x16x32_bf16 v[112:115], a[136:139], v[40:43], v[112:115]
  v_cvt_pk_bf16_f32 v179, v182, v183
  v_mul_f32 v184, s49, v184
  v_mfma_f32_16x16x32_bf16 v[116:119], a[140:143], v[40:43], v[116:119]
  v_mul_f32 v185, s49, v185
  v_mul_f32 v186, s49, v186
  v_mfma_f32_16x16x32_bf16 v[88:91], a[128:131], v[44:47], v[88:91]
  v_mfma_f32_16x16x32_bf16 v[92:95], a[132:135], v[44:47], v[92:95]
  v_mfma_f32_16x16x32_bf16 v[120:123], a[136:139], v[44:47], v[120:123]
  s_add_u32 s48, s45, 1024
  buffer_store_dwordx4 v[160:163], v3, s[32:35], s48 offen sc1
  v_mfma_f32_16x16x32_bf16 v[124:127], a[140:143], v[44:47], v[124:127]
  s_waitcnt lgkmcnt(0)
  s_waitcnt vmcnt(17)
  s_barrier
  v_add_u32 v4, 0x10000, v4
  v_add_u32 v5, 0x10000, v5
  v_add_u32 v6, 0x10000, v6
  v_add_u32 v7, 0x10000, v7
  v_mfma_f32_16x16x32_bf16 v[64:67], a[144:147], v[48:51], v[64:67]
  ds_read_b64_tr_b16 v[32:33], v4 offset:0
  v_lshlrev_b32 v200, 16, v16
  v_mfma_f32_16x16x32_bf16 v[68:71], a[148:151], v[48:51], v[68:71]
  ds_read_b64_tr_b16 v[34:35], v4 offset:1024
  v_mul_f32 v187, s49, v187
  v_mfma_f32_16x16x32_bf16 v[96:99], a[152:155], v[48:51], v[96:99]
  ds_read_b64_tr_b16 v[36:37], v5 offset:0
  v_mul_f32 v188, s49, v188
  v_mfma_f32_16x16x32_bf16 v[100:103], a[156:159], v[48:51], v[100:103]
  ds_read_b64_tr_b16 v[38:39], v5 offset:1024
  v_mul_f32 v189, s49, v189
  v_mfma_f32_16x16x32_bf16 v[72:75], a[144:147], v[52:55], v[72:75]
  ds_read_b64_tr_b16 v[40:41], v6 offset:0
  v_mul_f32 v190, s49, v190
  v_mfma_f32_16x16x32_bf16 v[76:79], a[148:151], v[52:55], v[76:79]
  ds_read_b64_tr_b16 v[42:43], v6 offset:1024
  v_mul_f32 v191, s49, v191
  v_mfma_f32_16x16x32_bf16 v[104:107], a[152:155], v[52:55], v[104:107]
  ds_read_b64_tr_b16 v[44:45], v7 offset:0
  v_cvt_pk_bf16_f32 v184, v184, v185
  v_mfma_f32_16x16x32_bf16 v[108:111], a[156:159], v[52:55], v[108:111]
  ds_read_b64_tr_b16 v[46:47], v7 offset:1024
  v_cvt_pk_bf16_f32 v185, v186, v187
  v_mfma_f32_16x16x32_bf16 v[80:83], a[144:147], v[56:59], v[80:83]
  v_cvt_pk_bf16_f32 v186, v188, v189
  v_cvt_pk_bf16_f32 v187, v190, v191
  v_mfma_f32_16x16x32_bf16 v[84:87], a[148:151], v[56:59], v[84:87]
  v_mul_f32 v128, s49, v128
  v_mul_f32 v129, s49, v129
  v_mfma_f32_16x16x32_bf16 v[112:115], a[152:155], v[56:59], v[112:115]
  v_mul_f32 v130, s49, v130
  v_mul_f32 v131, s49, v131
  v_mfma_f32_16x16x32_bf16 v[116:119], a[156:159], v[56:59], v[116:119]
  s_add_u32 s48, s45, 5120
  buffer_store_dwordx4 v[168:171], v3, s[32:35], s48 offen sc1
  v_mfma_f32_16x16x32_bf16 v[88:91], a[144:147], v[60:63], v[88:91]
  v_mul_f32 v132, s49, v132
  v_mul_f32 v133, s49, v133
  v_mfma_f32_16x16x32_bf16 v[92:95], a[148:151], v[60:63], v[92:95]
  v_and_b32 v201, 0xffff0000, v16
  v_lshlrev_b32 v192, 16, v12
  v_mfma_f32_16x16x32_bf16 v[120:123], a[152:155], v[60:63], v[120:123]
  s_add_u32 s48, s45, 9216
  buffer_store_dwordx4 v[176:179], v3, s[32:35], s48 offen sc1
  v_mfma_f32_16x16x32_bf16 v[124:127], a[156:159], v[60:63], v[124:127]
  s_waitcnt lgkmcnt(0)
  v_mfma_f32_16x16x32_bf16 v[64:67], a[160:163], v[32:35], v[64:67]
  ds_read_b64_tr_b16 v[48:49], v4 offset:24576
  v_and_b32 v193, 0xffff0000, v12
  v_mfma_f32_16x16x32_bf16 v[68:71], a[164:167], v[32:35], v[68:71]
  ds_read_b64_tr_b16 v[50:51], v4 offset:25600
  v_mul_f32 v134, s49, v134
  v_mfma_f32_16x16x32_bf16 v[96:99], a[168:171], v[32:35], v[96:99]
  ds_read_b64_tr_b16 v[52:53], v5 offset:24576
  v_mul_f32 v135, s49, v135
  v_mfma_f32_16x16x32_bf16 v[100:103], a[172:175], v[32:35], v[100:103]
  ds_read_b64_tr_b16 v[54:55], v5 offset:25600
  v_cvt_pk_bf16_f32 v128, v128, v129
  v_mfma_f32_16x16x32_bf16 v[72:75], a[160:163], v[36:39], v[72:75]
  ds_read_b64_tr_b16 v[56:57], v6 offset:24576
  v_cvt_pk_bf16_f32 v129, v130, v131
  v_mfma_f32_16x16x32_bf16 v[76:79], a[164:167], v[36:39], v[76:79]
  ds_read_b64_tr_b16 v[58:59], v6 offset:25600
  v_cvt_pk_bf16_f32 v130, v132, v133
  v_mfma_f32_16x16x32_bf16 v[104:107], a[168:171], v[36:39], v[104:107]
  ds_read_b64_tr_b16 v[60:61], v7 offset:24576
  v_cvt_pk_bf16_f32 v131, v134, v135
  v_mfma_f32_16x16x32_bf16 v[108:111], a[172:175], v[36:39], v[108:111]
  ds_read_b64_tr_b16 v[62:63], v7 offset:25600
  v_mul_f32 v136, s49, v136
  v_mfma_f32_16x16x32_bf16 v[80:83], a[160:163], v[40:43], v[80:83]
  v_mul_f32 v137, s49, v137
  v_mul_f32 v138, s49, v138
  v_mfma_f32_16x16x32_bf16 v[84:87], a[164:167], v[40:43], v[84:87]
  v_mul_f32 v139, s49, v139
  v_mul_f32 v140, s49, v140
  v_mfma_f32_16x16x32_bf16 v[112:115], a[168:171], v[40:43], v[112:115]
  v_mul_f32 v141, s49, v141
  v_mul_f32 v142, s49, v142
  v_mfma_f32_16x16x32_bf16 v[116:119], a[172:175], v[40:43], v[116:119]
  v_mul_f32 v143, s49, v143
  v_cvt_pk_bf16_f32 v136, v136, v137
  v_mfma_f32_16x16x32_bf16 v[88:91], a[160:163], v[44:47], v[88:91]
  v_lshlrev_b32 v202, 16, v17
  v_and_b32 v203, 0xffff0000, v17
  v_mfma_f32_16x16x32_bf16 v[92:95], a[164:167], v[44:47], v[92:95]
  v_lshlrev_b32 v194, 16, v13
  v_and_b32 v195, 0xffff0000, v13
  v_mfma_f32_16x16x32_bf16 v[120:123], a[168:171], v[44:47], v[120:123]
  s_add_u32 s48, s45, 13312
  buffer_store_dwordx4 v[184:187], v3, s[32:35], s48 offen sc1
  v_mfma_f32_16x16x32_bf16 v[124:127], a[172:175], v[44:47], v[124:127]
  s_waitcnt lgkmcnt(0)
  s_waitcnt vmcnt(16)
  s_barrier
  v_mfma_f32_16x16x32_bf16 v[64:67], a[176:179], v[48:51], v[64:67]
  ds_read_b64_tr_b16 v[32:33], v4 offset:49152
  v_lshlrev_b32 v204, 16, v18
  v_mfma_f32_16x16x32_bf16 v[68:71], a[180:183], v[48:51], v[68:71]
  ds_read_b64_tr_b16 v[34:35], v4 offset:50176
  v_cvt_pk_bf16_f32 v137, v138, v139
  v_mfma_f32_16x16x32_bf16 v[96:99], a[184:187], v[48:51], v[96:99]
  ds_read_b64_tr_b16 v[36:37], v5 offset:49152
  v_cvt_pk_bf16_f32 v138, v140, v141
  v_mfma_f32_16x16x32_bf16 v[100:103], a[188:191], v[48:51], v[100:103]
  ds_read_b64_tr_b16 v[38:39], v5 offset:50176
  v_cvt_pk_bf16_f32 v139, v142, v143
  v_mfma_f32_16x16x32_bf16 v[72:75], a[176:179], v[52:55], v[72:75]
  ds_read_b64_tr_b16 v[40:41], v6 offset:49152
  v_mul_f32 v144, s49, v144
  v_mfma_f32_16x16x32_bf16 v[76:79], a[180:183], v[52:55], v[76:79]
  ds_read_b64_tr_b16 v[42:43], v6 offset:50176
  v_mul_f32 v145, s49, v145
  v_mfma_f32_16x16x32_bf16 v[104:107], a[184:187], v[52:55], v[104:107]
  ds_read_b64_tr_b16 v[44:45], v7 offset:49152
  v_mul_f32 v146, s49, v146
  v_mfma_f32_16x16x32_bf16 v[108:111], a[188:191], v[52:55], v[108:111]
  ds_read_b64_tr_b16 v[46:47], v7 offset:50176
  v_mul_f32 v147, s49, v147
  v_mfma_f32_16x16x32_bf16 v[80:83], a[176:179], v[56:59], v[80:83]
  v_mul_f32 v148, s49, v148
  v_mul_f32 v149, s49, v149
  v_mfma_f32_16x16x32_bf16 v[84:87], a[180:183], v[56:59], v[84:87]
  v_mul_f32 v150, s49, v150
  v_mul_f32 v151, s49, v151
  v_mfma_f32_16x16x32_bf16 v[112:115], a[184:187], v[56:59], v[112:115]
  v_cvt_pk_bf16_f32 v144, v144, v145
  v_cvt_pk_bf16_f32 v145, v146, v147
  v_mfma_f32_16x16x32_bf16 v[116:119], a[188:191], v[56:59], v[116:119]
  v_cvt_pk_bf16_f32 v146, v148, v149
  v_cvt_pk_bf16_f32 v147, v150, v151
  v_mfma_f32_16x16x32_bf16 v[88:91], a[176:179], v[60:63], v[88:91]
  v_and_b32 v205, 0xffff0000, v18
  v_lshlrev_b32 v196, 16, v14
  v_mfma_f32_16x16x32_bf16 v[92:95], a[180:183], v[60:63], v[92:95]
  v_and_b32 v197, 0xffff0000, v14
  v_lshlrev_b32 v206, 16, v19
  v_mfma_f32_16x16x32_bf16 v[120:123], a[184:187], v[60:63], v[120:123]
  s_add_u32 s48, s45, 0
  buffer_store_dwordx4 v[128:131], v3, s[32:35], s48 offen sc1
  v_mfma_f32_16x16x32_bf16 v[124:127], a[188:191], v[60:63], v[124:127]
  s_waitcnt lgkmcnt(0)
  v_add_u32 v4, 0x10000, v4
  v_add_u32 v5, 0x10000, v5
  v_add_u32 v6, 0x10000, v6
  v_add_u32 v7, 0x10000, v7
  v_mfma_f32_16x16x32_bf16 v[64:67], a[192:195], v[32:35], v[64:67]
  ds_read_b64_tr_b16 v[48:49], v4 offset:8192
  v_and_b32 v207, 0xffff0000, v19
  v_mfma_f32_16x16x32_bf16 v[68:71], a[196:199], v[32:35], v[68:71]
  ds_read_b64_tr_b16 v[50:51], v4 offset:9216
  v_mul_f32 v152, s49, v152
  v_mfma_f32_16x16x32_bf16 v[96:99], a[200:203], v[32:35], v[96:99]
  ds_read_b64_tr_b16 v[52:53], v5 offset:8192
  v_mul_f32 v153, s49, v153
  v_mfma_f32_16x16x32_bf16 v[100:103], a[204:207], v[32:35], v[100:103]
  ds_read_b64_tr_b16 v[54:55], v5 offset:9216
  v_mul_f32 v154, s49, v154
  v_mfma_f32_16x16x32_bf16 v[72:75], a[192:195], v[36:39], v[72:75]
  ds_read_b64_tr_b16 v[56:57], v6 offset:8192
  v_mul_f32 v155, s49, v155
  v_mfma_f32_16x16x32_bf16 v[76:79], a[196:199], v[36:39], v[76:79]
  ds_read_b64_tr_b16 v[58:59], v6 offset:9216
  v_mul_f32 v156, s49, v156
  v_mfma_f32_16x16x32_bf16 v[104:107], a[200:203], v[36:39], v[104:107]
  ds_read_b64_tr_b16 v[60:61], v7 offset:8192
  v_mul_f32 v157, s49, v157
  v_mfma_f32_16x16x32_bf16 v[108:111], a[204:207], v[36:39], v[108:111]
  ds_read_b64_tr_b16 v[62:63], v7 offset:9216
  v_mul_f32 v158, s49, v158
  v_mfma_f32_16x16x32_bf16 v[80:83], a[192:195], v[40:43], v[80:83]
  v_mul_f32 v159, s49, v159
  v_cvt_pk_bf16_f32 v152, v152, v153
  v_mfma_f32_16x16x32_bf16 v[84:87], a[196:199], v[40:43], v[84:87]
  v_cvt_pk_bf16_f32 v153, v154, v155
  v_cvt_pk_bf16_f32 v154, v156, v157
  v_mfma_f32_16x16x32_bf16 v[112:115], a[200:203], v[40:43], v[112:115]
  v_cvt_pk_bf16_f32 v155, v158, v159
  v_lshlrev_b32 v198, 16, v15
  v_mfma_f32_16x16x32_bf16 v[116:119], a[204:207], v[40:43], v[116:119]
  v_and_b32 v199, 0xffff0000, v15
  v_lshlrev_b32 v216, 16, v20
  v_mfma_f32_16x16x32_bf16 v[88:91], a[192:195], v[44:47], v[88:91]
  v_and_b32 v217, 0xffff0000, v20
  v_lshlrev_b32 v218, 16, v21
  v_mfma_f32_16x16x32_bf16 v[92:95], a[196:199], v[44:47], v[92:95]
  v_and_b32 v219, 0xffff0000, v21
  v_lshlrev_b32 v220, 16, v22
  v_mfma_f32_16x16x32_bf16 v[120:123], a[200:203], v[44:47], v[120:123]
  s_add_u32 s48, s45, 4096
  buffer_store_dwordx4 v[136:139], v3, s[32:35], s48 offen sc1
  v_mfma_f32_16x16x32_bf16 v[124:127], a[204:207], v[44:47], v[124:127]
  s_waitcnt lgkmcnt(0)
  s_waitcnt vmcnt(14)
  s_barrier
  v_subrev_u32 v4, 0x20000, v4
  v_subrev_u32 v5, 0x20000, v5
  v_subrev_u32 v6, 0x20000, v6
  v_subrev_u32 v7, 0x20000, v7
  v_mfma_f32_16x16x32_bf16 v[64:67], a[208:211], v[48:51], v[64:67]
  ds_read_b64_tr_b16 v[32:33], v4 offset:49152
  v_and_b32 v221, 0xffff0000, v22
  v_mfma_f32_16x16x32_bf16 v[68:71], a[212:215], v[48:51], v[68:71]
  ds_read_b64_tr_b16 v[34:35], v4 offset:50176
  v_lshlrev_b32 v222, 16, v23
  v_mfma_f32_16x16x32_bf16 v[96:99], a[216:219], v[48:51], v[96:99]
  ds_read_b64_tr_b16 v[36:37], v5 offset:49152
  v_and_b32 v223, 0xffff0000, v23
  v_mfma_f32_16x16x32_bf16 v[100:103], a[220:223], v[48:51], v[100:103]
  ds_read_b64_tr_b16 v[38:39], v5 offset:50176
  v_lshlrev_b32 v224, 16, v24
  v_mfma_f32_16x16x32_bf16 v[72:75], a[208:211], v[52:55], v[72:75]
  ds_read_b64_tr_b16 v[40:41], v6 offset:49152
  v_and_b32 v225, 0xffff0000, v24
  v_mfma_f32_16x16x32_bf16 v[76:79], a[212:215], v[52:55], v[76:79]
  ds_read_b64_tr_b16 v[42:43], v6 offset:50176
  v_lshlrev_b32 v226, 16, v25
  v_mfma_f32_16x16x32_bf16 v[104:107], a[216:219], v[52:55], v[104:107]
  ds_read_b64_tr_b16 v[44:45], v7 offset:49152
  v_and_b32 v227, 0xffff0000, v25
  v_mfma_f32_16x16x32_bf16 v[108:111], a[220:223], v[52:55], v[108:111]
  ds_read_b64_tr_b16 v[46:47], v7 offset:50176
  v_lshlrev_b32 v228, 16, v26
  v_mfma_f32_16x16x32_bf16 v[80:83], a[208:211], v[56:59], v[80:83]
  v_and_b32 v229, 0xffff0000, v26
  v_lshlrev_b32 v230, 16, v27
  v_mfma_f32_16x16x32_bf16 v[84:87], a[212:215], v[56:59], v[84:87]
  v_and_b32 v231, 0xffff0000, v27
  v_add_f32 v232, v216, v217
  v_mfma_f32_16x16x32_bf16 v[112:115], a[216:219], v[56:59], v[112:115]
  v_mul_f32 v234, v216, v216
  v_fmac_f32 v234, v217, v217
  v_mfma_f32_16x16x32_bf16 v[116:119], a[220:223], v[56:59], v[116:119]
  s_add_u32 s48, s45, 8192
  buffer_store_dwordx4 v[144:147], v3, s[32:35], s48 offen sc1
  v_mfma_f32_16x16x32_bf16 v[88:91], a[208:211], v[60:63], v[88:91]
  v_add_f32 v233, v224, v225
  v_mul_f32 v235, v224, v224
  v_mfma_f32_16x16x32_bf16 v[92:95], a[212:215], v[60:63], v[92:95]
  v_fmac_f32 v235, v225, v225
  v_add_f32 v232, v232, v218
  v_mfma_f32_16x16x32_bf16 v[120:123], a[216:219], v[60:63], v[120:123]
  s_add_u32 s48, s45, 12288
  buffer_store_dwordx4 v[152:155], v3, s[32:35], s48 offen sc1
  v_mfma_f32_16x16x32_bf16 v[124:127], a[220:223], v[60:63], v[124:127]
  s_waitcnt lgkmcnt(0)
  v_mfma_f32_16x16x32_bf16 v[64:67], a[224:227], v[32:35], v[64:67]
  ds_read_b64_tr_b16 v[48:49], v4 offset:57344
  v_fmac_f32 v234, v218, v218
  v_mfma_f32_16x16x32_bf16 v[68:71], a[228:231], v[32:35], v[68:71]
  ds_read_b64_tr_b16 v[50:51], v4 offset:58368
  v_add_f32 v233, v233, v226
  v_mfma_f32_16x16x32_bf16 v[96:99], a[232:235], v[32:35], v[96:99]
  ds_read_b64_tr_b16 v[52:53], v5 offset:57344
  v_fmac_f32 v235, v226, v226
  v_mfma_f32_16x16x32_bf16 v[100:103], a[236:239], v[32:35], v[100:103]
  ds_read_b64_tr_b16 v[54:55], v5 offset:58368
  v_add_f32 v232, v232, v219
  v_mfma_f32_16x16x32_bf16 v[72:75], a[224:227], v[36:39], v[72:75]
  ds_read_b64_tr_b16 v[56:57], v6 offset:57344
  v_fmac_f32 v234, v219, v219
  v_mfma_f32_16x16x32_bf16 v[76:79], a[228:231], v[36:39], v[76:79]
  ds_read_b64_tr_b16 v[58:59], v6 offset:58368
  v_add_f32 v233, v233, v227
  v_mfma_f32_16x16x32_bf16 v[104:107], a[232:235], v[36:39], v[104:107]
  ds_read_b64_tr_b16 v[60:61], v7 offset:57344
  v_fmac_f32 v235, v227, v227
  v_mfma_f32_16x16x32_bf16 v[108:111], a[236:239], v[36:39], v[108:111]
  ds_read_b64_tr_b16 v[62:63], v7 offset:58368
  v_add_f32 v232, v232, v220
  v_mfma_f32_16x16x32_bf16 v[80:83], a[224:227], v[40:43], v[80:83]
  v_fmac_f32 v234, v220, v220
  v_add_f32 v233, v233, v228
  v_mfma_f32_16x16x32_bf16 v[84:87], a[228:231], v[40:43], v[84:87]
  v_fmac_f32 v235, v228, v228
  v_add_f32 v232, v232, v221
  v_mfma_f32_16x16x32_bf16 v[112:115], a[232:235], v[40:43], v[112:115]
  v_fmac_f32 v234, v221, v221
  v_add_f32 v233, v233, v229
  v_mfma_f32_16x16x32_bf16 v[116:119], a[236:239], v[40:43], v[116:119]
  v_fmac_f32 v235, v229, v229
  v_add_f32 v232, v232, v222
  v_mfma_f32_16x16x32_bf16 v[88:91], a[224:227], v[44:47], v[88:91]
  v_fmac_f32 v234, v222, v222
  v_add_f32 v233, v233, v230
  v_mfma_f32_16x16x32_bf16 v[92:95], a[228:231], v[44:47], v[92:95]
  v_fmac_f32 v235, v230, v230
  v_add_f32 v232, v232, v223
  v_mfma_f32_16x16x32_bf16 v[120:123], a[232:235], v[44:47], v[120:123]
  v_fmac_f32 v234, v223, v223
  v_add_f32 v233, v233, v231
  v_mfma_f32_16x16x32_bf16 v[124:127], a[236:239], v[44:47], v[124:127]
  s_waitcnt lgkmcnt(0)
  v_mfma_f32_16x16x32_bf16 v[64:67], a[240:243], v[48:51], v[64:67]
  ds_read_b64_tr_b16 v[32:33], v8 offset:0
  v_fmac_f32 v235, v231, v231
  v_mfma_f32_16x16x32_bf16 v[68:71], a[244:247], v[48:51], v[68:71]
  ds_read_b64_tr_b16 v[34:35], v8 offset:1024
  v_mfma_f32_16x16x32_bf16 v[96:99], a[248:251], v[48:51], v[96:99]
  ds_read_b64_tr_b16 v[36:37], v9 offset:0
  v_add_f32_dpp v232, v232, v232 quad_perm:[1,0,3,2] row_mask:0xf bank_mask:0xf
  v_mfma_f32_16x16x32_bf16 v[100:103], a[252:255], v[48:51], v[100:103]
  ds_read_b64_tr_b16 v[38:39], v9 offset:1024
  v_add_f32_dpp v234, v234, v234 quad_perm:[1,0,3,2] row_mask:0xf bank_mask:0xf
  v_mfma_f32_16x16x32_bf16 v[72:75], a[240:243], v[52:55], v[72:75]
  ds_read_b64_tr_b16 v[40:41], v10 offset:0
  v_add_f32_dpp v233, v233, v233 quad_perm:[1,0,3,2] row_mask:0xf bank_mask:0xf
  v_mfma_f32_16x16x32_bf16 v[76:79], a[244:247], v[52:55], v[76:79]
  ds_read_b64_tr_b16 v[42:43], v10 offset:1024
  v_add_f32_dpp v235, v235, v235 quad_perm:[1,0,3,2] row_mask:0xf bank_mask:0xf
  v_mfma_f32_16x16x32_bf16 v[104:107], a[248:251], v[52:55], v[104:107]
  ds_read_b64_tr_b16 v[44:45], v11 offset:0
  v_mfma_f32_16x16x32_bf16 v[108:111], a[252:255], v[52:55], v[108:111]
  ds_read_b64_tr_b16 v[46:47], v11 offset:1024
  v_add_f32_dpp v232, v232, v232 quad_perm:[2,3,0,1] row_mask:0xf bank_mask:0xf
  v_mfma_f32_16x16x32_bf16 v[80:83], a[240:243], v[56:59], v[80:83]
  v_add_f32_dpp v234, v234, v234 quad_perm:[2,3,0,1] row_mask:0xf bank_mask:0xf
  v_add_f32_dpp v233, v233, v233 quad_perm:[2,3,0,1] row_mask:0xf bank_mask:0xf
  v_mfma_f32_16x16x32_bf16 v[84:87], a[244:247], v[56:59], v[84:87]
  v_add_f32_dpp v235, v235, v235 quad_perm:[2,3,0,1] row_mask:0xf bank_mask:0xf
  v_mfma_f32_16x16x32_bf16 v[112:115], a[248:251], v[56:59], v[112:115]
  v_mfma_f32_16x16x32_bf16 v[116:119], a[252:255], v[56:59], v[116:119]
  v_add_f32_dpp v232, v232, v232 row_half_mirror row_mask:0xf bank_mask:0xf
  v_add_f32_dpp v234, v234, v234 row_half_mirror row_mask:0xf bank_mask:0xf
  v_mfma_f32_16x16x32_bf16 v[88:91], a[240:243], v[60:63], v[88:91]
  v_add_f32_dpp v233, v233, v233 row_half_mirror row_mask:0xf bank_mask:0xf
  v_add_f32_dpp v235, v235, v235 row_half_mirror row_mask:0xf bank_mask:0xf
  v_mfma_f32_16x16x32_bf16 v[92:95], a[244:247], v[60:63], v[92:95]
  v_mfma_f32_16x16x32_bf16 v[120:123], a[248:251], v[60:63], v[120:123]
  v_add_f32_dpp v232, v232, v232 row_mirror row_mask:0xf bank_mask:0xf
  v_add_f32_dpp v234, v234, v234 row_mirror row_mask:0xf bank_mask:0xf
  v_mfma_f32_16x16x32_bf16 v[124:127], a[252:255], v[60:63], v[124:127]
  s_waitcnt lgkmcnt(0)
  v_mfma_f32_16x16x32_bf16 v[128:131], a[0:3], v[32:35], 0
  ds_read_b64_tr_b16 v[48:49], v8 offset:8192
  v_add_f32_dpp v233, v233, v233 row_mirror row_mask:0xf bank_mask:0xf
  v_mfma_f32_16x16x32_bf16 v[132:135], a[4:7], v[32:35], 0
  ds_read_b64_tr_b16 v[50:51], v8 offset:9216
  v_add_f32_dpp v235, v235, v235 row_mirror row_mask:0xf bank_mask:0xf
  v_mfma_f32_16x16x32_bf16 v[160:163], a[8:11], v[32:35], 0
  ds_read_b64_tr_b16 v[52:53], v9 offset:8192
  v_cvt_pk_bf16_f32 v64, v64, v65
  v_mfma_f32_16x16x32_bf16 v[164:167], a[12:15], v[32:35], 0
  ds_read_b64_tr_b16 v[54:55], v9 offset:9216
  v_cvt_pk_bf16_f32 v65, v66, v67
  v_mfma_f32_16x16x32_bf16 v[136:139], a[0:3], v[36:39], 0
  ds_read_b64_tr_b16 v[56:57], v10 offset:8192
  v_cvt_pk_bf16_f32 v66, v68, v69
  v_mfma_f32_16x16x32_bf16 v[140:143], a[4:7], v[36:39], 0
  ds_read_b64_tr_b16 v[58:59], v10 offset:9216
  v_cvt_pk_bf16_f32 v67, v70, v71
  v_mfma_f32_16x16x32_bf16 v[168:171], a[8:11], v[36:39], 0
  ds_read_b64_tr_b16 v[60:61], v11 offset:8192
  v_mov_b32 v242, v232
  v_mfma_f32_16x16x32_bf16 v[172:175], a[12:15], v[36:39], 0
  ds_read_b64_tr_b16 v[62:63], v11 offset:9216
  v_mov_b32 v243, v234
  v_mfma_f32_16x16x32_bf16 v[144:147], a[0:3], v[40:43], 0
  v_mov_b32 v244, v233
  v_mov_b32 v245, v235
  v_mfma_f32_16x16x32_bf16 v[148:151], a[4:7], v[40:43], 0
  v_mfma_f32_16x16x32_bf16 v[176:179], a[8:11], v[40:43], 0
  v_permlane16_swap_b32 v232, v242
  v_permlane16_swap_b32 v234, v243
  v_mfma_f32_16x16x32_bf16 v[180:183], a[12:15], v[40:43], 0
  v_permlane16_swap_b32 v233, v244
  v_permlane16_swap_b32 v235, v245
  v_mfma_f32_16x16x32_bf16 v[152:155], a[0:3], v[44:47], 0
  v_mfma_f32_16x16x32_bf16 v[156:159], a[4:7], v[44:47], 0
  v_add_f32 v232, v232, v242
  v_add_f32 v234, v234, v243
  v_mfma_f32_16x16x32_bf16 v[184:187], a[8:11], v[44:47], 0
  v_add_f32 v233, v233, v244
  v_add_f32 v235, v235, v245
  v_mfma_f32_16x16x32_bf16 v[188:191], a[12:15], v[44:47], 0
  s_waitcnt lgkmcnt(0)
  v_mfma_f32_16x16x32_bf16 v[128:131], a[16:19], v[48:51], v[128:131]
  ds_read_b64_tr_b16 v[32:33], v8 offset:16384
  v_mov_b32 v242, v232
  v_mfma_f32_16x16x32_bf16 v[132:135], a[20:23], v[48:51], v[132:135]
  ds_read_b64_tr_b16 v[34:35], v8 offset:17408
  v_mov_b32 v243, v234
  v_mfma_f32_16x16x32_bf16 v[160:163], a[24:27], v[48:51], v[160:163]
  ds_read_b64_tr_b16 v[36:37], v9 offset:16384
  v_mov_b32 v244, v233
  v_mfma_f32_16x16x32_bf16 v[164:167], a[28:31], v[48:51], v[164:167]
  ds_read_b64_tr_b16 v[38:39], v9 offset:17408
  v_mov_b32 v245, v235
  v_mfma_f32_16x16x32_bf16 v[136:139], a[16:19], v[52:55], v[136:139]
  ds_read_b64_tr_b16 v[40:41], v10 offset:16384
  v_mfma_f32_16x16x32_bf16 v[140:143], a[20:23], v[52:55], v[140:143]
  ds_read_b64_tr_b16 v[42:43], v10 offset:17408
  v_permlane32_swap_b32 v232, v242
  v_mfma_f32_16x16x32_bf16 v[168:171], a[24:27], v[52:55], v[168:171]
  ds_read_b64_tr_b16 v[44:45], v11 offset:16384
  v_permlane32_swap_b32 v234, v243
  v_mfma_f32_16x16x32_bf16 v[172:175], a[28:31], v[52:55], v[172:175]
  ds_read_b64_tr_b16 v[46:47], v11 offset:17408
  v_permlane32_swap_b32 v233, v244
  v_mfma_f32_16x16x32_bf16 v[144:147], a[16:19], v[56:59], v[144:147]
  v_permlane32_swap_b32 v235, v245
  v_mfma_f32_16x16x32_bf16 v[148:151], a[20:23], v[56:59], v[148:151]
  v_mfma_f32_16x16x32_bf16 v[176:179], a[24:27], v[56:59], v[176:179]
  v_add_f32 v232, v232, v242
  v_add_f32 v234, v234, v243
  v_mfma_f32_16x16x32_bf16 v[180:183], a[28:31], v[56:59], v[180:183]
  v_add_f32 v233, v233, v244
  v_add_f32 v235, v235, v245
  v_mfma_f32_16x16x32_bf16 v[152:155], a[16:19], v[60:63], v[152:155]
  v_mul_f32 v232, 0x3b000000, v232
  v_mul_f32 v234, 0x3b000000, v234
  v_mfma_f32_16x16x32_bf16 v[156:159], a[20:23], v[60:63], v[156:159]
  v_mul_f32 v233, 0x3b000000, v233
  v_mul_f32 v235, 0x3b000000, v235
  v_mfma_f32_16x16x32_bf16 v[184:187], a[24:27], v[60:63], v[184:187]
  s_add_u32 s48, s45, 16384
  buffer_store_dwordx4 v[64:67], v3, s[32:35], s48 offen sc1
  v_mfma_f32_16x16x32_bf16 v[188:191], a[28:31], v[60:63], v[188:191]
  s_waitcnt lgkmcnt(0)
  v_mfma_f32_16x16x32_bf16 v[128:131], a[32:35], v[32:35], v[128:131]
  ds_read_b64_tr_b16 v[48:49], v8 offset:24576
  v_fma_f32 v234, -v232, v232, v234
  v_mfma_f32_16x16x32_bf16 v[132:135], a[36:39], v[32:35], v[132:135]
  ds_read_b64_tr_b16 v[50:51], v8 offset:25600
  v_cvt_pk_bf16_f32 v72, v72, v73
  v_mfma_f32_16x16x32_bf16 v[160:163], a[40:43], v[32:35], v[160:163]
  ds_read_b64_tr_b16 v[52:53], v9 offset:24576
  v_cvt_pk_bf16_f32 v73, v74, v75
  v_mfma_f32_16x16x32_bf16 v[164:167], a[44:47], v[32:35], v[164:167]
  ds_read_b64_tr_b16 v[54:55], v9 offset:25600
  v_cvt_pk_bf16_f32 v74, v76, v77
  v_mfma_f32_16x16x32_bf16 v[136:139], a[32:35], v[36:39], v[136:139]
  ds_read_b64_tr_b16 v[56:57], v10 offset:24576
  v_cvt_pk_bf16_f32 v75, v78, v79
  v_mfma_f32_16x16x32_bf16 v[140:143], a[36:39], v[36:39], v[140:143]
  ds_read_b64_tr_b16 v[58:59], v10 offset:25600
  v_fma_f32 v235, -v233, v233, v235
  v_mfma_f32_16x16x32_bf16 v[168:171], a[40:43], v[36:39], v[168:171]
  ds_read_b64_tr_b16 v[60:61], v11 offset:24576
  v_max_f32 v234, 0, v234
  v_mfma_f32_16x16x32_bf16 v[172:175], a[44:47], v[36:39], v[172:175]
  ds_read_b64_tr_b16 v[62:63], v11 offset:25600
  v_max_f32 v235, 0, v235
  v_mfma_f32_16x16x32_bf16 v[144:147], a[32:35], v[40:43], v[144:147]
  v_cvt_pk_bf16_f32 v242, v232, v233
  v_cvt_pk_bf16_f32 v243, v234, v235
  v_mfma_f32_16x16x32_bf16 v[148:151], a[36:39], v[40:43], v[148:151]
  v_lshlrev_b32 v238, 16, v242
  v_and_b32 v239, 0xffff0000, v242
  v_mfma_f32_16x16x32_bf16 v[176:179], a[40:43], v[40:43], v[176:179]
  v_lshlrev_b32 v234, 16, v243
  v_and_b32 v235, 0xffff0000, v243
  v_mfma_f32_16x16x32_bf16 v[180:183], a[44:47], v[40:43], v[180:183]
  v_add_f32 v234, 0x3727c5ac, v234
  v_add_f32 v235, 0x3727c5ac, v235
  v_mfma_f32_16x16x32_bf16 v[152:155], a[32:35], v[44:47], v[152:155]
  v_cvt_pk_bf16_f32 v242, v234, v235
  v_lshlrev_b32 v234, 16, v242
  v_mfma_f32_16x16x32_bf16 v[156:159], a[36:39], v[44:47], v[156:159]
  v_and_b32 v235, 0xffff0000, v242
  v_mfma_f32_16x16x32_bf16 v[184:187], a[40:43], v[44:47], v[184:187]
  v_sqrt_f32 v234, v234
  v_mfma_f32_16x16x32_bf16 v[188:191], a[44:47], v[44:47], v[188:191]
  s_waitcnt lgkmcnt(0)
  v_add_u32 v8, 0x10000, v8
  v_add_u32 v9, 0x10000, v9
  v_add_u32 v10, 0x10000, v10
  v_add_u32 v11, 0x10000, v11
  v_mfma_f32_16x16x32_bf16 v[128:131], a[48:51], v[48:51], v[128:131]
  ds_read_b64_tr_b16 v[32:33], v8 offset:16384
  v_mfma_f32_16x16x32_bf16 v[132:135], a[52:55], v[48:51], v[132:135]
  ds_read_b64_tr_b16 v[34:35], v8 offset:17408
  v_mfma_f32_16x16x32_bf16 v[160:163], a[56:59], v[48:51], v[160:163]
  ds_read_b64_tr_b16 v[36:37], v9 offset:16384
  v_mfma_f32_16x16x32_bf16 v[164:167], a[60:63], v[48:51], v[164:167]
  ds_read_b64_tr_b16 v[38:39], v9 offset:17408
  v_mfma_f32_16x16x32_bf16 v[136:139], a[48:51], v[52:55], v[136:139]
  ds_read_b64_tr_b16 v[40:41], v10 offset:16384
  v_mfma_f32_16x16x32_bf16 v[140:143], a[52:55], v[52:55], v[140:143]
  ds_read_b64_tr_b16 v[42:43], v10 offset:17408
  v_mfma_f32_16x16x32_bf16 v[168:171], a[56:59], v[52:55], v[168:171]
  ds_read_b64_tr_b16 v[44:45], v11 offset:16384
  v_mfma_f32_16x16x32_bf16 v[172:175], a[60:63], v[52:55], v[172:175]
  ds_read_b64_tr_b16 v[46:47], v11 offset:17408
  v_mfma_f32_16x16x32_bf16 v[144:147], a[48:51], v[56:59], v[144:147]
  v_sqrt_f32 v235, v235
  v_mfma_f32_16x16x32_bf16 v[148:151], a[52:55], v[56:59], v[148:151]
  v_cvt_pk_bf16_f32 v242, v234, v235
  v_lshlrev_b32 v234, 16, v242
  v_mfma_f32_16x16x32_bf16 v[176:179], a[56:59], v[56:59], v[176:179]
  v_and_b32 v235, 0xffff0000, v242
  v_mfma_f32_16x16x32_bf16 v[180:183], a[60:63], v[56:59], v[180:183]
  v_rcp_f32 v240, v234
  v_mfma_f32_16x16x32_bf16 v[152:155], a[48:51], v[60:63], v[152:155]
  v_rcp_f32 v241, v235
  v_mfma_f32_16x16x32_bf16 v[156:159], a[52:55], v[60:63], v[156:159]
  v_sub_f32 v216, v216, v238
  v_sub_f32 v217, v217, v238
  v_mfma_f32_16x16x32_bf16 v[184:187], a[56:59], v[60:63], v[184:187]
  s_add_u32 s48, s45, 17408
  buffer_store_dwordx4 v[72:75], v3, s[32:35], s48 offen sc1
  v_mfma_f32_16x16x32_bf16 v[188:191], a[60:63], v[60:63], v[188:191]
  s_waitcnt lgkmcnt(0)
  v_mfma_f32_16x16x32_bf16 v[128:131], a[64:67], v[32:35], v[128:131]
  ds_read_b64_tr_b16 v[48:49], v8 offset:40960
  v_sub_f32 v218, v218, v238
  v_mfma_f32_16x16x32_bf16 v[132:135], a[68:71], v[32:35], v[132:135]
  ds_read_b64_tr_b16 v[50:51], v8 offset:41984
  v_cvt_pk_bf16_f32 v80, v80, v81
  v_mfma_f32_16x16x32_bf16 v[160:163], a[72:75], v[32:35], v[160:163]
  ds_read_b64_tr_b16 v[52:53], v9 offset:40960
  v_cvt_pk_bf16_f32 v81, v82, v83
  v_mfma_f32_16x16x32_bf16 v[164:167], a[76:79], v[32:35], v[164:167]
  ds_read_b64_tr_b16 v[54:55], v9 offset:41984
  v_cvt_pk_bf16_f32 v82, v84, v85
  v_mfma_f32_16x16x32_bf16 v[136:139], a[64:67], v[36:39], v[136:139]
  ds_read_b64_tr_b16 v[56:57], v10 offset:40960
  v_cvt_pk_bf16_f32 v83, v86, v87
  v_mfma_f32_16x16x32_bf16 v[140:143], a[68:71], v[36:39], v[140:143]
  ds_read_b64_tr_b16 v[58:59], v10 offset:41984
  v_sub_f32 v219, v219, v238
  v_mfma_f32_16x16x32_bf16 v[168:171], a[72:75], v[36:39], v[168:171]
  ds_read_b64_tr_b16 v[60:61], v11 offset:40960
  v_sub_f32 v220, v220, v238
  v_mfma_f32_16x16x32_bf16 v[172:175], a[76:79], v[36:39], v[172:175]
  ds_read_b64_tr_b16 v[62:63], v11 offset:41984
  v_sub_f32 v221, v221, v238
  v_mfma_f32_16x16x32_bf16 v[144:147], a[64:67], v[40:43], v[144:147]
  v_sub_f32 v222, v222, v238
  v_sub_f32 v223, v223, v238
  v_mfma_f32_16x16x32_bf16 v[148:151], a[68:71], v[40:43], v[148:151]
  v_cvt_pk_bf16_f32 v242, v216, v217
  v_cvt_pk_bf16_f32 v243, v218, v219
  v_mfma_f32_16x16x32_bf16 v[176:179], a[72:75], v[40:43], v[176:179]
  v_cvt_pk_bf16_f32 v244, v220, v221
  v_cvt_pk_bf16_f32 v245, v222, v223
  v_mfma_f32_16x16x32_bf16 v[180:183], a[76:79], v[40:43], v[180:183]
  v_lshlrev_b32 v216, 16, v242
  v_and_b32 v217, 0xffff0000, v242
  v_mfma_f32_16x16x32_bf16 v[152:155], a[64:67], v[44:47], v[152:155]
  v_lshlrev_b32 v218, 16, v243
  v_and_b32 v219, 0xffff0000, v243
  v_mfma_f32_16x16x32_bf16 v[156:159], a[68:71], v[44:47], v[156:159]
  v_lshlrev_b32 v220, 16, v244
  v_and_b32 v221, 0xffff0000, v244
  v_mfma_f32_16x16x32_bf16 v[184:187], a[72:75], v[44:47], v[184:187]
  v_lshlrev_b32 v222, 16, v245
  v_and_b32 v223, 0xffff0000, v245
  v_mfma_f32_16x16x32_bf16 v[188:191], a[76:79], v[44:47], v[188:191]
  s_waitcnt lgkmcnt(0)
  v_add_u32 v8, 0x10000, v8
  v_add_u32 v9, 0x10000, v9
  v_add_u32 v10, 0x10000, v10
  v_add_u32 v11, 0x10000, v11
  v_mfma_f32_16x16x32_bf16 v[128:131], a[80:83], v[48:51], v[128:131]
  ds_read_b64_tr_b16 v[32:33], v8 offset:0
  v_mul_f32 v216, v216, v240
  v_mfma_f32_16x16x32_bf16 v[132:135], a[84:87], v[48:51], v[132:135]
  ds_read_b64_tr_b16 v[34:35], v8 offset:1024
  v_mul_f32 v217, v217, v240
  v_mfma_f32_16x16x32_bf16 v[160:163], a[88:91], v[48:51], v[160:163]
  ds_read_b64_tr_b16 v[36:37], v9 offset:0
  v_mul_f32 v218, v218, v240
  v_mfma_f32_16x16x32_bf16 v[164:167], a[92:95], v[48:51], v[164:167]
  ds_read_b64_tr_b16 v[38:39], v9 offset:1024
  v_mul_f32 v219, v219, v240
  v_mfma_f32_16x16x32_bf16 v[136:139], a[80:83], v[52:55], v[136:139]
  ds_read_b64_tr_b16 v[40:41], v10 offset:0
  v_mul_f32 v220, v220, v240
  v_mfma_f32_16x16x32_bf16 v[140:143], a[84:87], v[52:55], v[140:143]
  ds_read_b64_tr_b16 v[42:43], v10 offset:1024
  v_mul_f32 v221, v221, v240
  v_mfma_f32_16x16x32_bf16 v[168:171], a[88:91], v[52:55], v[168:171]
  ds_read_b64_tr_b16 v[44:45], v11 offset:0
  v_mul_f32 v222, v222, v240
  v_mfma_f32_16x16x32_bf16 v[172:175], a[92:95], v[52:55], v[172:175]
  ds_read_b64_tr_b16 v[46:47], v11 offset:1024
  v_mul_f32 v223, v223, v240
  v_mfma_f32_16x16x32_bf16 v[144:147], a[80:83], v[56:59], v[144:147]
  v_cvt_pk_bf16_f32 v242, v216, v217
  v_cvt_pk_bf16_f32 v243, v218, v219
  v_mfma_f32_16x16x32_bf16 v[148:151], a[84:87], v[56:59], v[148:151]
  v_cvt_pk_bf16_f32 v244, v220, v221
  v_cvt_pk_bf16_f32 v245, v222, v223
  v_mfma_f32_16x16x32_bf16 v[176:179], a[88:91], v[56:59], v[176:179]
  v_lshlrev_b32 v216, 16, v242
  v_and_b32 v217, 0xffff0000, v242
  v_mfma_f32_16x16x32_bf16 v[180:183], a[92:95], v[56:59], v[180:183]
  v_lshlrev_b32 v218, 16, v243
  v_and_b32 v219, 0xffff0000, v243
  v_mfma_f32_16x16x32_bf16 v[152:155], a[80:83], v[60:63], v[152:155]
  v_lshlrev_b32 v220, 16, v244
  v_and_b32 v221, 0xffff0000, v244
  v_mfma_f32_16x16x32_bf16 v[156:159], a[84:87], v[60:63], v[156:159]
  v_lshlrev_b32 v222, 16, v245
  v_and_b32 v223, 0xffff0000, v245
  v_mfma_f32_16x16x32_bf16 v[184:187], a[88:91], v[60:63], v[184:187]
  s_add_u32 s48, s45, 18432
  buffer_store_dwordx4 v[80:83], v3, s[32:35], s48 offen sc1
  v_mfma_f32_16x16x32_bf16 v[188:191], a[92:95], v[60:63], v[188:191]
  s_waitcnt lgkmcnt(0)
  v_mfma_f32_16x16x32_bf16 v[128:131], a[96:99], v[32:35], v[128:131]
  ds_read_b64_tr_b16 v[48:49], v8 offset:24576
  v_mul_f32 v216, v216, v200
  v_mfma_f32_16x16x32_bf16 v[132:135], a[100:103], v[32:35], v[132:135]
  ds_read_b64_tr_b16 v[50:51], v8 offset:25600
  v_cvt_pk_bf16_f32 v88, v88, v89
  v_mfma_f32_16x16x32_bf16 v[160:163], a[104:107], v[32:35], v[160:163]
  ds_read_b64_tr_b16 v[52:53], v9 offset:24576
  v_cvt_pk_bf16_f32 v89, v90, v91
  v_mfma_f32_16x16x32_bf16 v[164:167], a[108:111], v[32:35], v[164:167]
  ds_read_b64_tr_b16 v[54:55], v9 offset:25600
  v_cvt_pk_bf16_f32 v90, v92, v93
  v_mfma_f32_16x16x32_bf16 v[136:139], a[96:99], v[36:39], v[136:139]
  ds_read_b64_tr_b16 v[56:57], v10 offset:24576
  v_cvt_pk_bf16_f32 v91, v94, v95
  v_mfma_f32_16x16x32_bf16 v[140:143], a[100:103], v[36:39], v[140:143]
  ds_read_b64_tr_b16 v[58:59], v10 offset:25600
  v_mul_f32 v217, v217, v201
  v_mfma_f32_16x16x32_bf16 v[168:171], a[104:107], v[36:39], v[168:171]
  ds_read_b64_tr_b16 v[60:61], v11 offset:24576
  v_mul_f32 v218, v218, v202
  v_mfma_f32_16x16x32_bf16 v[172:175], a[108:111], v[36:39], v[172:175]
  ds_read_b64_tr_b16 v[62:63], v11 offset:25600
  v_mul_f32 v219, v219, v203
  v_mfma_f32_16x16x32_bf16 v[144:147], a[96:99], v[40:43], v[144:147]
  v_mul_f32 v220, v220, v204
  v_mul_f32 v221, v221, v205
  v_mfma_f32_16x16x32_bf16 v[148:151], a[100:103], v[40:43], v[148:151]
  v_mul_f32 v222, v222, v206
  v_mul_f32 v223, v223, v207
  v_mfma_f32_16x16x32_bf16 v[176:179], a[104:107], v[40:43], v[176:179]
  v_cvt_pk_bf16_f32 v242, v216, v217
  v_cvt_pk_bf16_f32 v243, v218, v219
  v_mfma_f32_16x16x32_bf16 v[180:183], a[108:111], v[40:43], v[180:183]
  v_cvt_pk_bf16_f32 v244, v220, v221
  v_cvt_pk_bf16_f32 v245, v222, v223
  v_mfma_f32_16x16x32_bf16 v[152:155], a[96:99], v[44:47], v[152:155]
  v_lshlrev_b32 v216, 16, v242
  v_and_b32 v217, 0xffff0000, v242
  v_mfma_f32_16x16x32_bf16 v[156:159], a[100:103], v[44:47], v[156:159]
  v_lshlrev_b32 v218, 16, v243
  v_and_b32 v219, 0xffff0000, v243
  v_mfma_f32_16x16x32_bf16 v[184:187], a[104:107], v[44:47], v[184:187]
  v_lshlrev_b32 v220, 16, v244
  v_and_b32 v221, 0xffff0000, v244
  v_mfma_f32_16x16x32_bf16 v[188:191], a[108:111], v[44:47], v[188:191]
  s_waitcnt lgkmcnt(0)
  v_subrev_u32 v8, 0x20000, v8
  v_subrev_u32 v9, 0x20000, v9
  v_subrev_u32 v10, 0x20000, v10
  v_subrev_u32 v11, 0x20000, v11
  v_mfma_f32_16x16x32_bf16 v[128:131], a[112:115], v[48:51], v[128:131]
  ds_read_b64_tr_b16 v[32:33], v8 offset:32768
  v_lshlrev_b32 v222, 16, v245
  v_mfma_f32_16x16x32_bf16 v[132:135], a[116:119], v[48:51], v[132:135]
  ds_read_b64_tr_b16 v[34:35], v8 offset:33792
  v_and_b32 v223, 0xffff0000, v245
  v_mfma_f32_16x16x32_bf16 v[160:163], a[120:123], v[48:51], v[160:163]
  ds_read_b64_tr_b16 v[36:37], v9 offset:32768
  v_add_f32 v216, v216, v192
  v_mfma_f32_16x16x32_bf16 v[164:167], a[124:127], v[48:51], v[164:167]
  ds_read_b64_tr_b16 v[38:39], v9 offset:33792
  v_add_f32 v217, v217, v193
  v_mfma_f32_16x16x32_bf16 v[136:139], a[112:115], v[52:55], v[136:139]
  ds_read_b64_tr_b16 v[40:41], v10 offset:32768
  v_add_f32 v218, v218, v194
  v_mfma_f32_16x16x32_bf16 v[140:143], a[116:119], v[52:55], v[140:143]
  ds_read_b64_tr_b16 v[42:43], v10 offset:33792
  v_add_f32 v219, v219, v195
  v_mfma_f32_16x16x32_bf16 v[168:171], a[120:123], v[52:55], v[168:171]
  ds_read_b64_tr_b16 v[44:45], v11 offset:32768
  v_add_f32 v220, v220, v196
  v_mfma_f32_16x16x32_bf16 v[172:175], a[124:127], v[52:55], v[172:175]
  ds_read_b64_tr_b16 v[46:47], v11 offset:33792
  v_add_f32 v221, v221, v197
  v_mfma_f32_16x16x32_bf16 v[144:147], a[112:115], v[56:59], v[144:147]
  v_add_f32 v222, v222, v198
  v_add_f32 v223, v223, v199
  v_mfma_f32_16x16x32_bf16 v[148:151], a[116:119], v[56:59], v[148:151]
  v_cvt_pk_bf16_f32 v20, v216, v217
  v_cvt_pk_bf16_f32 v21, v218, v219
  v_mfma_f32_16x16x32_bf16 v[176:179], a[120:123], v[56:59], v[176:179]
  v_cvt_pk_bf16_f32 v22, v220, v221
  v_cvt_pk_bf16_f32 v23, v222, v223
  v_mfma_f32_16x16x32_bf16 v[180:183], a[124:127], v[56:59], v[180:183]
  v_sub_f32 v224, v224, v239
  v_sub_f32 v225, v225, v239
  v_mfma_f32_16x16x32_bf16 v[152:155], a[112:115], v[60:63], v[152:155]
  v_sub_f32 v226, v226, v239
  v_sub_f32 v227, v227, v239
  v_mfma_f32_16x16x32_bf16 v[156:159], a[116:119], v[60:63], v[156:159]
  v_sub_f32 v228, v228, v239
  v_sub_f32 v229, v229, v239
  v_mfma_f32_16x16x32_bf16 v[184:187], a[120:123], v[60:63], v[184:187]
  s_add_u32 s48, s45, 19456
  buffer_store_dwordx4 v[88:91], v3, s[32:35], s48 offen sc1
  v_mfma_f32_16x16x32_bf16 v[188:191], a[124:127], v[60:63], v[188:191]
  s_waitcnt lgkmcnt(0)
  v_mfma_f32_16x16x32_bf16 v[128:131], a[128:131], v[32:35], v[128:131]
  ds_read_b64_tr_b16 v[48:49], v8 offset:40960
  v_sub_f32 v230, v230, v239
  v_mfma_f32_16x16x32_bf16 v[132:135], a[132:135], v[32:35], v[132:135]
  ds_read_b64_tr_b16 v[50:51], v8 offset:41984
  v_cvt_pk_bf16_f32 v96, v96, v97
  v_mfma_f32_16x16x32_bf16 v[160:163], a[136:139], v[32:35], v[160:163]
  ds_read_b64_tr_b16 v[52:53], v9 offset:40960
  v_cvt_pk_bf16_f32 v97, v98, v99
  v_mfma_f32_16x16x32_bf16 v[164:167], a[140:143], v[32:35], v[164:167]
  ds_read_b64_tr_b16 v[54:55], v9 offset:41984
  v_cvt_pk_bf16_f32 v98, v100, v101
  v_mfma_f32_16x16x32_bf16 v[136:139], a[128:131], v[36:39], v[136:139]
  ds_read_b64_tr_b16 v[56:57], v10 offset:40960
  v_cvt_pk_bf16_f32 v99, v102, v103
  v_mfma_f32_16x16x32_bf16 v[140:143], a[132:135], v[36:39], v[140:143]
  ds_read_b64_tr_b16 v[58:59], v10 offset:41984
  v_sub_f32 v231, v231, v239
  v_mfma_f32_16x16x32_bf16 v[168:171], a[136:139], v[36:39], v[168:171]
  ds_read_b64_tr_b16 v[60:61], v11 offset:40960
  v_cvt_pk_bf16_f32 v242, v224, v225
  v_mfma_f32_16x16x32_bf16 v[172:175], a[140:143], v[36:39], v[172:175]
  ds_read_b64_tr_b16 v[62:63], v11 offset:41984
  v_cvt_pk_bf16_f32 v243, v226, v227
  v_mfma_f32_16x16x32_bf16 v[144:147], a[128:131], v[40:43], v[144:147]
  v_cvt_pk_bf16_f32 v244, v228, v229
  v_cvt_pk_bf16_f32 v245, v230, v231
  v_mfma_f32_16x16x32_bf16 v[148:151], a[132:135], v[40:43], v[148:151]
  v_lshlrev_b32 v224, 16, v242
  v_and_b32 v225, 0xffff0000, v242
  v_mfma_f32_16x16x32_bf16 v[176:179], a[136:139], v[40:43], v[176:179]
  v_lshlrev_b32 v226, 16, v243
  v_and_b32 v227, 0xffff0000, v243
  v_mfma_f32_16x16x32_bf16 v[180:183], a[140:143], v[40:43], v[180:183]
  v_lshlrev_b32 v228, 16, v244
  v_and_b32 v229, 0xffff0000, v244
  v_mfma_f32_16x16x32_bf16 v[152:155], a[128:131], v[44:47], v[152:155]
  v_lshlrev_b32 v230, 16, v245
  v_and_b32 v231, 0xffff0000, v245
  v_mfma_f32_16x16x32_bf16 v[156:159], a[132:135], v[44:47], v[156:159]
  v_mul_f32 v224, v224, v241
  v_mul_f32 v225, v225, v241
  v_mfma_f32_16x16x32_bf16 v[184:187], a[136:139], v[44:47], v[184:187]
  v_mul_f32 v226, v226, v241
  v_mul_f32 v227, v227, v241
  v_mfma_f32_16x16x32_bf16 v[188:191], a[140:143], v[44:47], v[188:191]
  s_waitcnt lgkmcnt(0)
  v_add_u32 v8, 0x10000, v8
  v_add_u32 v9, 0x10000, v9
  v_add_u32 v10, 0x10000, v10
  v_add_u32 v11, 0x10000, v11
  v_mfma_f32_16x16x32_bf16 v[128:131], a[144:147], v[48:51], v[128:131]
  ds_read_b64_tr_b16 v[32:33], v8 offset:0
  v_mul_f32 v228, v228, v241
  v_mfma_f32_16x16x32_bf16 v[132:135], a[148:151], v[48:51], v[132:135]
  ds_read_b64_tr_b16 v[34:35], v8 offset:1024
  v_mul_f32 v229, v229, v241
  v_mfma_f32_16x16x32_bf16 v[160:163], a[152:155], v[48:51], v[160:163]
  ds_read_b64_tr_b16 v[36:37], v9 offset:0
  v_mul_f32 v230, v230, v241
  v_mfma_f32_16x16x32_bf16 v[164:167], a[156:159], v[48:51], v[164:167]
  ds_read_b64_tr_b16 v[38:39], v9 offset:1024
  v_mul_f32 v231, v231, v241
  v_mfma_f32_16x16x32_bf16 v[136:139], a[144:147], v[52:55], v[136:139]
  ds_read_b64_tr_b16 v[40:41], v10 offset:0
  v_cvt_pk_bf16_f32 v242, v224, v225
  v_mfma_f32_16x16x32_bf16 v[140:143], a[148:151], v[52:55], v[140:143]
  ds_read_b64_tr_b16 v[42:43], v10 offset:1024
  v_cvt_pk_bf16_f32 v243, v226, v227
  v_mfma_f32_16x16x32_bf16 v[168:171], a[152:155], v[52:55], v[168:171]
  ds_read_b64_tr_b16 v[44:45], v11 offset:0
  v_cvt_pk_bf16_f32 v244, v228, v229
  v_mfma_f32_16x16x32_bf16 v[172:175], a[156:159], v[52:55], v[172:175]
  ds_read_b64_tr_b16 v[46:47], v11 offset:1024
  v_cvt_pk_bf16_f32 v245, v230, v231
  v_mfma_f32_16x16x32_bf16 v[144:147], a[144:147], v[56:59], v[144:147]
  v_lshlrev_b32 v224, 16, v242
  v_and_b32 v225, 0xffff0000, v242
  v_mfma_f32_16x16x32_bf16 v[148:151], a[148:151], v[56:59], v[148:151]
  v_lshlrev_b32 v226, 16, v243
  v_and_b32 v227, 0xffff0000, v243
  v_mfma_f32_16x16x32_bf16 v[176:179], a[152:155], v[56:59], v[176:179]
  v_lshlrev_b32 v228, 16, v244
  v_and_b32 v229, 0xffff0000, v244
  v_mfma_f32_16x16x32_bf16 v[180:183], a[156:159], v[56:59], v[180:183]
  v_lshlrev_b32 v230, 16, v245
  v_and_b32 v231, 0xffff0000, v245
  v_mfma_f32_16x16x32_bf16 v[152:155], a[144:147], v[60:63], v[152:155]
  v_mul_f32 v224, v224, v200
  v_mul_f32 v225, v225, v201
  v_mfma_f32_16x16x32_bf16 v[156:159], a[148:151], v[60:63], v[156:159]
  v_mul_f32 v226, v226, v202
  v_mul_f32 v227, v227, v203
  v_mfma_f32_16x16x32_bf16 v[184:187], a[152:155], v[60:63], v[184:187]
  s_add_u32 s48, s45, 24576
  buffer_store_dwordx4 v[96:99], v3, s[32:35], s48 offen sc1
  v_mfma_f32_16x16x32_bf16 v[188:191], a[156:159], v[60:63], v[188:191]
  s_waitcnt lgkmcnt(0)
  v_mfma_f32_16x16x32_bf16 v[128:131], a[160:163], v[32:35], v[128:131]
  ds_read_b64_tr_b16 v[48:49], v8 offset:24576
  v_mul_f32 v228, v228, v204
  v_mfma_f32_16x16x32_bf16 v[132:135], a[164:167], v[32:35], v[132:135]
  ds_read_b64_tr_b16 v[50:51], v8 offset:25600
  v_cvt_pk_bf16_f32 v104, v104, v105
  v_mfma_f32_16x16x32_bf16 v[160:163], a[168:171], v[32:35], v[160:163]
  ds_read_b64_tr_b16 v[52:53], v9 offset:24576
  v_cvt_pk_bf16_f32 v105, v106, v107
  v_mfma_f32_16x16x32_bf16 v[164:167], a[172:175], v[32:35], v[164:167]
  ds_read_b64_tr_b16 v[54:55], v9 offset:25600
  v_cvt_pk_bf16_f32 v106, v108, v109
  v_mfma_f32_16x16x32_bf16 v[136:139], a[160:163], v[36:39], v[136:139]
  ds_read_b64_tr_b16 v[56:57], v10 offset:24576
  v_cvt_pk_bf16_f32 v107, v110, v111
  v_mfma_f32_16x16x32_bf16 v[140:143], a[164:167], v[36:39], v[140:143]
  ds_read_b64_tr_b16 v[58:59], v10 offset:25600
  v_mul_f32 v229, v229, v205
  v_mfma_f32_16x16x32_bf16 v[168:171], a[168:171], v[36:39], v[168:171]
  ds_read_b64_tr_b16 v[60:61], v11 offset:24576
  v_mul_f32 v230, v230, v206
  v_mfma_f32_16x16x32_bf16 v[172:175], a[172:175], v[36:39], v[172:175]
  ds_read_b64_tr_b16 v[62:63], v11 offset:25600
  v_mul_f32 v231, v231, v207
  v_mfma_f32_16x16x32_bf16 v[144:147], a[160:163], v[40:43], v[144:147]
  v_cvt_pk_bf16_f32 v242, v224, v225
  v_cvt_pk_bf16_f32 v243, v226, v227
  v_mfma_f32_16x16x32_bf16 v[148:151], a[164:167], v[40:43], v[148:151]
  v_cvt_pk_bf16_f32 v244, v228, v229
  v_cvt_pk_bf16_f32 v245, v230, v231
  v_mfma_f32_16x16x32_bf16 v[176:179], a[168:171], v[40:43], v[176:179]
  v_lshlrev_b32 v224, 16, v242
  v_and_b32 v225, 0xffff0000, v242
  v_mfma_f32_16x16x32_bf16 v[180:183], a[172:175], v[40:43], v[180:183]
  v_lshlrev_b32 v226, 16, v243
  v_and_b32 v227, 0xffff0000, v243
  v_mfma_f32_16x16x32_bf16 v[152:155], a[160:163], v[44:47], v[152:155]
  v_lshlrev_b32 v228, 16, v244
  v_and_b32 v229, 0xffff0000, v244
  v_mfma_f32_16x16x32_bf16 v[156:159], a[164:167], v[44:47], v[156:159]
  v_lshlrev_b32 v230, 16, v245
  v_and_b32 v231, 0xffff0000, v245
  v_mfma_f32_16x16x32_bf16 v[184:187], a[168:171], v[44:47], v[184:187]
  v_add_f32 v224, v224, v192
  v_add_f32 v225, v225, v193
  v_mfma_f32_16x16x32_bf16 v[188:191], a[172:175], v[44:47], v[188:191]
  s_waitcnt lgkmcnt(0)
  v_mfma_f32_16x16x32_bf16 v[128:131], a[176:179], v[48:51], v[128:131]
  ds_read_b64_tr_b16 v[32:33], v8 offset:49152
  v_add_f32 v226, v226, v194
  v_mfma_f32_16x16x32_bf16 v[132:135], a[180:183], v[48:51], v[132:135]
  ds_read_b64_tr_b16 v[34:35], v8 offset:50176
  v_add_f32 v227, v227, v195
  v_mfma_f32_16x16x32_bf16 v[160:163], a[184:187], v[48:51], v[160:163]
  ds_read_b64_tr_b16 v[36:37], v9 offset:49152
  v_add_f32 v228, v228, v196
  v_mfma_f32_16x16x32_bf16 v[164:167], a[188:191], v[48:51], v[164:167]
  ds_read_b64_tr_b16 v[38:39], v9 offset:50176
  v_add_f32 v229, v229, v197
  v_mfma_f32_16x16x32_bf16 v[136:139], a[176:179], v[52:55], v[136:139]
  ds_read_b64_tr_b16 v[40:41], v10 offset:49152
  v_add_f32 v230, v230, v198
  v_mfma_f32_16x16x32_bf16 v[140:143], a[180:183], v[52:55], v[140:143]
  ds_read_b64_tr_b16 v[42:43], v10 offset:50176
  v_add_f32 v231, v231, v199
  v_mfma_f32_16x16x32_bf16 v[168:171], a[184:187], v[52:55], v[168:171]
  ds_read_b64_tr_b16 v[44:45], v11 offset:49152
  v_cvt_pk_bf16_f32 v24, v224, v225
  v_mfma_f32_16x16x32_bf16 v[172:175], a[188:191], v[52:55], v[172:175]
  ds_read_b64_tr_b16 v[46:47], v11 offset:50176
  v_cvt_pk_bf16_f32 v25, v226, v227
  v_mfma_f32_16x16x32_bf16 v[144:147], a[176:179], v[56:59], v[144:147]
  v_cvt_pk_bf16_f32 v26, v228, v229
  v_cvt_pk_bf16_f32 v27, v230, v231
  v_mfma_f32_16x16x32_bf16 v[148:151], a[180:183], v[56:59], v[148:151]
  v_mfma_f32_16x16x32_bf16 v[176:179], a[184:187], v[56:59], v[176:179]
  v_mfma_f32_16x16x32_bf16 v[180:183], a[188:191], v[56:59], v[180:183]
  v_mfma_f32_16x16x32_bf16 v[152:155], a[176:179], v[60:63], v[152:155]
  v_mfma_f32_16x16x32_bf16 v[156:159], a[180:183], v[60:63], v[156:159]
  v_mfma_f32_16x16x32_bf16 v[184:187], a[184:187], v[60:63], v[184:187]
  s_add_u32 s48, s45, 25600
  buffer_store_dwordx4 v[104:107], v3, s[32:35], s48 offen sc1
  v_mfma_f32_16x16x32_bf16 v[188:191], a[188:191], v[60:63], v[188:191]
  s_waitcnt lgkmcnt(0)
  v_add_u32 v8, 0x10000, v8
  v_add_u32 v9, 0x10000, v9
  v_add_u32 v10, 0x10000, v10
  v_add_u32 v11, 0x10000, v11
  v_mfma_f32_16x16x32_bf16 v[128:131], a[192:195], v[32:35], v[128:131]
  ds_read_b64_tr_b16 v[48:49], v8 offset:8192
  v_mfma_f32_16x16x32_bf16 v[132:135], a[196:199], v[32:35], v[132:135]
  ds_read_b64_tr_b16 v[50:51], v8 offset:9216
  v_cvt_pk_bf16_f32 v112, v112, v113
  v_mfma_f32_16x16x32_bf16 v[160:163], a[200:203], v[32:35], v[160:163]
  ds_read_b64_tr_b16 v[52:53], v9 offset:8192
  v_cvt_pk_bf16_f32 v113, v114, v115
  v_mfma_f32_16x16x32_bf16 v[164:167], a[204:207], v[32:35], v[164:167]
  ds_read_b64_tr_b16 v[54:55], v9 offset:9216
  v_cvt_pk_bf16_f32 v114, v116, v117
  v_mfma_f32_16x16x32_bf16 v[136:139], a[192:195], v[36:39], v[136:139]
  ds_read_b64_tr_b16 v[56:57], v10 offset:8192
  v_cvt_pk_bf16_f32 v115, v118, v119
  v_mfma_f32_16x16x32_bf16 v[140:143], a[196:199], v[36:39], v[140:143]
  ds_read_b64_tr_b16 v[58:59], v10 offset:9216
  v_mfma_f32_16x16x32_bf16 v[168:171], a[200:203], v[36:39], v[168:171]
  ds_read_b64_tr_b16 v[60:61], v11 offset:8192
  v_mfma_f32_16x16x32_bf16 v[172:175], a[204:207], v[36:39], v[172:175]
  ds_read_b64_tr_b16 v[62:63], v11 offset:9216
  v_mfma_f32_16x16x32_bf16 v[144:147], a[192:195], v[40:43], v[144:147]
  v_mfma_f32_16x16x32_bf16 v[148:151], a[196:199], v[40:43], v[148:151]
  v_mfma_f32_16x16x32_bf16 v[176:179], a[200:203], v[40:43], v[176:179]
  v_mfma_f32_16x16x32_bf16 v[180:183], a[204:207], v[40:43], v[180:183]
  v_mfma_f32_16x16x32_bf16 v[152:155], a[192:195], v[44:47], v[152:155]
  v_mfma_f32_16x16x32_bf16 v[156:159], a[196:199], v[44:47], v[156:159]
  v_mfma_f32_16x16x32_bf16 v[184:187], a[200:203], v[44:47], v[184:187]
  v_mfma_f32_16x16x32_bf16 v[188:191], a[204:207], v[44:47], v[188:191]
  s_waitcnt lgkmcnt(0)
  v_subrev_u32 v8, 0x20000, v8
  v_subrev_u32 v9, 0x20000, v9
  v_subrev_u32 v10, 0x20000, v10
  v_subrev_u32 v11, 0x20000, v11
  v_mfma_f32_16x16x32_bf16 v[128:131], a[208:211], v[48:51], v[128:131]
  ds_read_b64_tr_b16 v[32:33], v8 offset:49152
  v_mfma_f32_16x16x32_bf16 v[132:135], a[212:215], v[48:51], v[132:135]
  ds_read_b64_tr_b16 v[34:35], v8 offset:50176
  v_mfma_f32_16x16x32_bf16 v[160:163], a[216:219], v[48:51], v[160:163]
  ds_read_b64_tr_b16 v[36:37], v9 offset:49152
  v_mfma_f32_16x16x32_bf16 v[164:167], a[220:223], v[48:51], v[164:167]
  ds_read_b64_tr_b16 v[38:39], v9 offset:50176
  v_mfma_f32_16x16x32_bf16 v[136:139], a[208:211], v[52:55], v[136:139]
  ds_read_b64_tr_b16 v[40:41], v10 offset:49152
  v_mfma_f32_16x16x32_bf16 v[140:143], a[212:215], v[52:55], v[140:143]
  ds_read_b64_tr_b16 v[42:43], v10 offset:50176
  v_mfma_f32_16x16x32_bf16 v[168:171], a[216:219], v[52:55], v[168:171]
  ds_read_b64_tr_b16 v[44:45], v11 offset:49152
  v_mfma_f32_16x16x32_bf16 v[172:175], a[220:223], v[52:55], v[172:175]
  ds_read_b64_tr_b16 v[46:47], v11 offset:50176
  v_mfma_f32_16x16x32_bf16 v[144:147], a[208:211], v[56:59], v[144:147]
  v_mfma_f32_16x16x32_bf16 v[148:151], a[212:215], v[56:59], v[148:151]
  v_mfma_f32_16x16x32_bf16 v[176:179], a[216:219], v[56:59], v[176:179]
  v_mfma_f32_16x16x32_bf16 v[180:183], a[220:223], v[56:59], v[180:183]
  v_mfma_f32_16x16x32_bf16 v[152:155], a[208:211], v[60:63], v[152:155]
  v_mfma_f32_16x16x32_bf16 v[156:159], a[212:215], v[60:63], v[156:159]
  v_mfma_f32_16x16x32_bf16 v[184:187], a[216:219], v[60:63], v[184:187]
  s_add_u32 s48, s45, 26624
  buffer_store_dwordx4 v[112:115], v3, s[32:35], s48 offen sc1
  v_mfma_f32_16x16x32_bf16 v[188:191], a[220:223], v[60:63], v[188:191]
  s_waitcnt lgkmcnt(0)
  v_mfma_f32_16x16x32_bf16 v[128:131], a[224:227], v[32:35], v[128:131]
  ds_read_b64_tr_b16 v[48:49], v8 offset:57344
  v_mfma_f32_16x16x32_bf16 v[132:135], a[228:231], v[32:35], v[132:135]
  ds_read_b64_tr_b16 v[50:51], v8 offset:58368
  v_cvt_pk_bf16_f32 v120, v120, v121
  v_mfma_f32_16x16x32_bf16 v[160:163], a[232:235], v[32:35], v[160:163]
  ds_read_b64_tr_b16 v[52:53], v9 offset:57344
  v_cvt_pk_bf16_f32 v121, v122, v123
  v_mfma_f32_16x16x32_bf16 v[164:167], a[236:239], v[32:35], v[164:167]
  ds_read_b64_tr_b16 v[54:55], v9 offset:58368
  v_cvt_pk_bf16_f32 v122, v124, v125
  v_mfma_f32_16x16x32_bf16 v[136:139], a[224:227], v[36:39], v[136:139]
  ds_read_b64_tr_b16 v[56:57], v10 offset:57344
  v_cvt_pk_bf16_f32 v123, v126, v127
  v_mfma_f32_16x16x32_bf16 v[140:143], a[228:231], v[36:39], v[140:143]
  ds_read_b64_tr_b16 v[58:59], v10 offset:58368
  v_mfma_f32_16x16x32_bf16 v[168:171], a[232:235], v[36:39], v[168:171]
  ds_read_b64_tr_b16 v[60:61], v11 offset:57344
  v_mfma_f32_16x16x32_bf16 v[172:175], a[236:239], v[36:39], v[172:175]
  ds_read_b64_tr_b16 v[62:63], v11 offset:58368
  v_mfma_f32_16x16x32_bf16 v[144:147], a[224:227], v[40:43], v[144:147]
  v_mfma_f32_16x16x32_bf16 v[148:151], a[228:231], v[40:43], v[148:151]
  v_mfma_f32_16x16x32_bf16 v[176:179], a[232:235], v[40:43], v[176:179]
  v_mfma_f32_16x16x32_bf16 v[180:183], a[236:239], v[40:43], v[180:183]
  v_mfma_f32_16x16x32_bf16 v[152:155], a[224:227], v[44:47], v[152:155]
  v_mfma_f32_16x16x32_bf16 v[156:159], a[228:231], v[44:47], v[156:159]
  v_mfma_f32_16x16x32_bf16 v[184:187], a[232:235], v[44:47], v[184:187]
  v_mfma_f32_16x16x32_bf16 v[188:191], a[236:239], v[44:47], v[188:191]
  s_waitcnt lgkmcnt(0)
  v_mfma_f32_16x16x32_bf16 v[128:131], a[240:243], v[48:51], v[128:131]
  v_mfma_f32_16x16x32_bf16 v[132:135], a[244:247], v[48:51], v[132:135]
  v_mfma_f32_16x16x32_bf16 v[160:163], a[248:251], v[48:51], v[160:163]
  v_mfma_f32_16x16x32_bf16 v[164:167], a[252:255], v[48:51], v[164:167]
  v_mfma_f32_16x16x32_bf16 v[136:139], a[240:243], v[52:55], v[136:139]
  v_mfma_f32_16x16x32_bf16 v[140:143], a[244:247], v[52:55], v[140:143]
  v_mfma_f32_16x16x32_bf16 v[168:171], a[248:251], v[52:55], v[168:171]
  v_mfma_f32_16x16x32_bf16 v[172:175], a[252:255], v[52:55], v[172:175]
  v_mfma_f32_16x16x32_bf16 v[144:147], a[240:243], v[56:59], v[144:147]
  v_mfma_f32_16x16x32_bf16 v[148:151], a[244:247], v[56:59], v[148:151]
  v_mfma_f32_16x16x32_bf16 v[176:179], a[248:251], v[56:59], v[176:179]
  v_mfma_f32_16x16x32_bf16 v[180:183], a[252:255], v[56:59], v[180:183]
  v_mfma_f32_16x16x32_bf16 v[152:155], a[240:243], v[60:63], v[152:155]
  v_mfma_f32_16x16x32_bf16 v[156:159], a[244:247], v[60:63], v[156:159]
  v_mfma_f32_16x16x32_bf16 v[184:187], a[248:251], v[60:63], v[184:187]
  s_add_u32 s48, s45, 27648
  buffer_store_dwordx4 v[120:123], v3, s[32:35], s48 offen sc1
  v_mfma_f32_16x16x32_bf16 v[188:191], a[252:255], v[60:63], v[188:191]
  s_waitcnt lgkmcnt(0)
  s_nop 7
  v_lshlrev_b32 v12, 7, v2
  s_lshl_b32 s39, s3, 5
  s_add_u32 s39, s39, 73728
  v_add_u32 v12, s39, v12
  ds_write_b128 v12, v[20:23]
  ds_write_b128 v12, v[24:27] offset:16
  s_waitcnt lgkmcnt(0)
  s_barrier
  s_lshl_b32 s39, s3, 11
  s_add_u32 s39, s39, 73728
  v_add_u32 v12, s39, v3
  ds_read_b128 v[20:23], v12
  ds_read_b128 v[24:27], v12 offset:1024
  v_lshrrev_b32 v13, 3, v2
  v_lshlrev_b32 v13, 8, v13
  v_and_b32 v14, 7, v2
  v_lshl_add_u32 v13, v14, 4, v13
  s_lshr_b32 s39, s2, 1
  s_lshl_b32 s39, s39, 14
  s_and_b32 s48, s2, 1
  s_lshl_b32 s48, s48, 7
  s_add_u32 s39, s39, s48
  s_lshl_b32 s48, s3, 12
  s_add_u32 s39, s39, s48
  s_add_u32 s39, s39, 0x100000
  s_waitcnt lgkmcnt(0)
  buffer_store_dwordx4 v[20:23], v13, s[32:35], s39 offen sc1
  buffer_store_dwordx4 v[24:27], v13, s[32:35], s39 offen offset:2048 sc1
  v_cvt_pk_bf16_f32 v128, v128, v129
  v_cvt_pk_bf16_f32 v129, v130, v131
  v_cvt_pk_bf16_f32 v130, v132, v133
  v_cvt_pk_bf16_f32 v131, v134, v135
  s_nop 0
  s_add_u32 s48, s45, 20480
  buffer_store_dwordx4 v[128:131], v3, s[32:35], s48 offen sc1
  v_cvt_pk_bf16_f32 v136, v136, v137
  v_cvt_pk_bf16_f32 v137, v138, v139
  v_cvt_pk_bf16_f32 v138, v140, v141
  v_cvt_pk_bf16_f32 v139, v142, v143
  s_nop 0
  s_add_u32 s48, s45, 21504
  buffer_store_dwordx4 v[136:139], v3, s[32:35], s48 offen sc1
  v_cvt_pk_bf16_f32 v144, v144, v145
  v_cvt_pk_bf16_f32 v145, v146, v147
  v_cvt_pk_bf16_f32 v146, v148, v149
  v_cvt_pk_bf16_f32 v147, v150, v151
  s_nop 0
  s_add_u32 s48, s45, 22528
  buffer_store_dwordx4 v[144:147], v3, s[32:35], s48 offen sc1
  v_cvt_pk_bf16_f32 v152, v152, v153
  v_cvt_pk_bf16_f32 v153, v154, v155
  v_cvt_pk_bf16_f32 v154, v156, v157
  v_cvt_pk_bf16_f32 v155, v158, v159
  s_nop 0
  s_add_u32 s48, s45, 23552
  buffer_store_dwordx4 v[152:155], v3, s[32:35], s48 offen sc1
  v_cvt_pk_bf16_f32 v160, v160, v161
  v_cvt_pk_bf16_f32 v161, v162, v163
  v_cvt_pk_bf16_f32 v162, v164, v165
  v_cvt_pk_bf16_f32 v163, v166, v167
  s_nop 0
  s_add_u32 s48, s45, 28672
  buffer_store_dwordx4 v[160:163], v3, s[32:35], s48 offen sc1
  v_cvt_pk_bf16_f32 v168, v168, v169
  v_cvt_pk_bf16_f32 v169, v170, v171
  v_cvt_pk_bf16_f32 v170, v172, v173
  v_cvt_pk_bf16_f32 v171, v174, v175
  s_nop 0
  s_add_u32 s48, s45, 29696
  buffer_store_dwordx4 v[168:171], v3, s[32:35], s48 offen sc1
  v_cvt_pk_bf16_f32 v176, v176, v177
  v_cvt_pk_bf16_f32 v177, v178, v179
  v_cvt_pk_bf16_f32 v178, v180, v181
  v_cvt_pk_bf16_f32 v179, v182, v183
  s_nop 0
  s_add_u32 s48, s45, 30720
  buffer_store_dwordx4 v[176:179], v3, s[32:35], s48 offen sc1
  v_cvt_pk_bf16_f32 v184, v184, v185
  v_cvt_pk_bf16_f32 v185, v186, v187
  v_cvt_pk_bf16_f32 v186, v188, v189
  v_cvt_pk_bf16_f32 v187, v190, v191
  s_nop 0
  s_add_u32 s48, s45, 31744
  buffer_store_dwordx4 v[184:187], v3, s[32:35], s48 offen sc1
  v_mov_b32 v32, 1
  s_lshl_b32 s39, s36, 8
  s_lshr_b32 s48, s38, 7
  s_add_u32 s48, s48, 32
  s_lshl_b32 s48, s48, 8
  v_mov_b32 v33, s39
  v_mov_b32 v34, s48
  v_mov_b32 v35, 0x4000000
  v_cmp_eq_u32 vcc, 1, v2
  s_nop 1
  v_cndmask_b32 v33, v33, v34, vcc
  v_cmp_gt_u32 vcc, 2, v2
  s_nop 1
  v_cndmask_b32 v33, v35, v33, vcc
  s_mov_b32 s39, 294912
  s_waitcnt vmcnt(0)
  s_barrier
  s_cmp_lg_u32 s3, 0
  s_cbranch_scc1 L_sg_13
  buffer_atomic_add v32, v33, s[32:35], s39 offen sc1
L_sg_13:
  s_load_dwordx2 s[4:5], s[0:1], 16
  s_load_dwordx2 s[6:7], s[0:1], 112
  v_lshrrev_b32 v1, 6, v0
  v_and_b32 v2, 63, v0
  s_nop 0
  v_readfirstlane_b32 s3, v1
  s_waitcnt lgkmcnt(0)
  s_mov_b32 s16, s6
  s_and_b32 s17, s7, 0xffff
  s_mov_b32 s18, 0x4000000
  s_mov_b32 s19, 0x20000
  s_mov_b32 s20, s4
  s_and_b32 s21, s5, 0xffff
  s_mov_b32 s22, 0x400000
  s_mov_b32 s23, 0x20000
  s_and_b32 s24, s2, 7
  s_lshl_b32 s24, s24, 2
  s_lshr_b32 s38, s2, 3
  s_and_b32 s38, s38, 3
  s_add_u32 s24, s24, s38
  s_lshr_b32 s25, s2, 5
  s_lshl_b32 s28, s3, 12
  v_lshlrev_b32 v3, 4, v2
  v_lshrrev_b32 v16, 4, v2
  v_and_b32 v17, 15, v2
  v_lshrrev_b32 v18, 1, v17
  v_xor_b32 v18, v18, v16
  v_lshlrev_b32 v18, 5, v18
  v_and_b32 v19, 1, v17
  v_lshl_add_u32 v18, v19, 4, v18
  v_lshl_add_u32 v18, v16, 13, v18
  v_xor_b32 v19, 128, v18
  v_add_u32 v12, 0, v18
  v_add_u32 v13, 31744, v18
  v_add_u32 v14, 63488, v19
  v_add_u32 v15, 95232, v19
  s_lshl_b32 s50, s3, 17
  s_lshl_b32 s38, s24, 8
  s_add_u32 s50, s50, s38
  s_sub_u32 s26, 15, s25
  s_lshl_b32 s38, s26, 3
  s_lshl_b32 s39, s3, 1
  s_add_u32 s38, s38, s39
  s_add_u32 s38, s38, 0
  s_lshl_b32 s38, s38, 14
  s_add_u32 s46, s38, 0x100000
  s_lshl_b32 s38, s26, 3
  s_lshl_b32 s39, s3, 1
  s_add_u32 s38, s38, s39
  s_add_u32 s38, s38, 1
  s_lshl_b32 s38, s38, 14
  s_add_u32 s47, s38, 0x100000
  s_lshl_b32 s38, s25, 3
  s_lshl_b32 s39, s3, 1
  s_add_u32 s38, s38, s39
  s_add_u32 s38, s38, 0
  s_lshl_b32 s38, s38, 14
  s_add_u32 s48, s38, 0x100000
  s_lshl_b32 s38, s25, 3
  s_lshl_b32 s39, s3, 1
  s_add_u32 s38, s38, s39
  s_add_u32 s38, s38, 1
  s_lshl_b32 s38, s38, 14
  s_add_u32 s49, s38, 0x100000
  s_mov_b32 s61, 0
  s_lshl_b32 s38, s61, 12
  s_add_u32 s46, s46, s38
  s_add_u32 s47, s47, s38
  s_add_u32 s48, s48, s38
  s_add_u32 s49, s49, s38
  s_lshl_b32 s40, s61, 1
  s_add_u32 s40, s40, 0
  s_and_b32 s40, s40, 7
  s_lshl_b32 s40, s40, 19
  s_add_u32 s40, s40, s50
  s_add_u32 m0, s28, 0
  s_nop 0
  buffer_load_dwordx4 v12, s[20:23], s40 offen offset:0 lds
  buffer_load_dwordx4 v13, s[20:23], s40 offen offset:1024 lds
  buffer_load_dwordx4 v14, s[20:23], s40 offen offset:2048 lds
  buffer_load_dwordx4 v15, s[20:23], s40 offen offset:3072 lds
  s_lshl_b32 s40, s61, 1
  s_add_u32 s40, s40, 1
  s_and_b32 s40, s40, 7
  s_lshl_b32 s40, s40, 19
  s_add_u32 s40, s40, s50
  s_add_u32 m0, s28, 16384
  s_nop 0
  buffer_load_dwordx4 v12, s[20:23], s40 offen offset:0 lds
  buffer_load_dwordx4 v13, s[20:23], s40 offen offset:1024 lds
  buffer_load_dwordx4 v14, s[20:23], s40 offen offset:2048 lds
  buffer_load_dwordx4 v15, s[20:23], s40 offen offset:3072 lds
  s_lshl_b32 s40, s61, 1
  s_add_u32 s40, s40, 2
  s_and_b32 s40, s40, 7
  s_lshl_b32 s40, s40, 19
  s_add_u32 s40, s40, s50
  s_add_u32 m0, s28, 32768
  s_nop 0
  buffer_load_dwordx4 v12, s[20:23], s40 offen offset:0 lds
  buffer_load_dwordx4 v13, s[20:23], s40 offen offset:1024 lds
  buffer_load_dwordx4 v14, s[20:23], s40 offen offset:2048 lds
  buffer_load_dwordx4 v15, s[20:23], s40 offen offset:3072 lds
  s_lshl_b32 s40, s61, 1
  s_add_u32 s40, s40, 3
  s_and_b32 s40, s40, 7
  s_lshl_b32 s40, s40, 19
  s_add_u32 s40, s40, s50
  s_add_u32 m0, s28, 49152
  s_nop 0
  buffer_load_dwordx4 v12, s[20:23], s40 offen offset:0 lds
  buffer_load_dwordx4 v13, s[20:23], s40 offen offset:1024 lds
  buffer_load_dwordx4 v14, s[20:23], s40 offen offset:2048 lds
  buffer_load_dwordx4 v15, s[20:23], s40 offen offset:3072 lds
  s_lshl_b32 s40, s61, 1
  s_add_u32 s40, s40, 4
  s_and_b32 s40, s40, 7
  s_lshl_b32 s40, s40, 19
  s_add_u32 s40, s40, s50
  s_add_u32 m0, s28, 65536
  s_nop 0
  buffer_load_dwordx4 v12, s[20:23], s40 offen offset:0 lds
  buffer_load_dwordx4 v13, s[20:23], s40 offen offset:1024 lds
  buffer_load_dwordx4 v14, s[20:23], s40 offen offset:2048 lds
  buffer_load_dwordx4 v15, s[20:23], s40 offen offset:3072 lds
  s_lshl_b32 s40, s61, 1
  s_add_u32 s40, s40, 5
  s_and_b32 s40, s40, 7
  s_lshl_b32 s40, s40, 19
  s_add_u32 s40, s40, s50
  s_add_u32 m0, s28, 81920
  s_nop 0
  buffer_load_dwordx4 v12, s[20:23], s40 offen offset:0 lds
  buffer_load_dwordx4 v13, s[20:23], s40 offen offset:1024 lds
  buffer_load_dwordx4 v14, s[20:23], s40 offen offset:2048 lds
  buffer_load_dwordx4 v15, s[20:23], s40 offen offset:3072 lds
  s_lshl_b32 s38, s24, 8
  s_add_u32 s39, s26, 32
  s_lshl_b32 s39, s39, 8
  s_add_u32 s40, s25, 32
  s_lshl_b32 s40, s40, 8
  v_mov_b32 v16, s38
  v_mov_b32 v17, s39
  v_mov_b32 v18, s40
  v_mov_b32 v19, 0x4000000
  v_cmp_eq_u32 vcc, 1, v2
  s_nop 1
  v_cndmask_b32 v16, v16, v17, vcc
  v_cmp_eq_u32 vcc, 2, v2
  s_nop 1
  v_cndmask_b32 v16, v16, v18, vcc
  v_cmp_gt_u32 vcc, 3, v2
  s_nop 1
  v_cndmask_b32 v16, v19, v16, vcc
  v_mov_b32 v17, 16
  v_mov_b32 v18, 8
  v_cmp_eq_u32 vcc, 0, v2
  s_nop 1
  v_cndmask_b32 v17, v17, v18, vcc
  s_mov_b32 s38, 294912
  s_cmp_lg_u32 s3, 0
  s_cbranch_scc1 L_aw_14
  s_mov_b32 s59, 0
L_as_15:
  buffer_load_dword v20, v16, s[16:19], s38 offen sc1
  s_waitcnt vmcnt(0)
  v_cmp_le_u32 vcc, v17, v20
  s_add_u32 s59, s59, 1
  s_nop 3
  s_and_b32 s58, vcc_lo, 7
  s_cmp_eq_u32 s58, 7
  s_cbranch_scc1 L_ao_16
  s_sleep 2
  s_cmp_lt_u32 s59, 0x80000
  s_cbranch_scc1 L_as_15
L_ao_16:
L_aw_14:
  s_barrier
  buffer_load_dwordx4 a[128:131], v3, s[16:19], s46 offen offset:0 sc1
  buffer_load_dwordx4 a[132:135], v3, s[16:19], s47 offen offset:0 sc1
  buffer_load_dwordx4 a[136:139], v3, s[16:19], s48 offen offset:0 sc1
  buffer_load_dwordx4 a[140:143], v3, s[16:19], s49 offen offset:0 sc1
  buffer_load_dwordx4 a[144:147], v3, s[16:19], s46 offen offset:1024 sc1
  buffer_load_dwordx4 a[148:151], v3, s[16:19], s47 offen offset:1024 sc1
  buffer_load_dwordx4 a[152:155], v3, s[16:19], s48 offen offset:1024 sc1
  buffer_load_dwordx4 a[156:159], v3, s[16:19], s49 offen offset:1024 sc1
  buffer_load_dwordx4 a[160:163], v3, s[16:19], s46 offen offset:2048 sc1
  buffer_load_dwordx4 a[164:167], v3, s[16:19], s47 offen offset:2048 sc1
  buffer_load_dwordx4 a[168:171], v3, s[16:19], s48 offen offset:2048 sc1
  buffer_load_dwordx4 a[172:175], v3, s[16:19], s49 offen offset:2048 sc1
  buffer_load_dwordx4 a[176:179], v3, s[16:19], s46 offen offset:3072 sc1
  buffer_load_dwordx4 a[180:183], v3, s[16:19], s47 offen offset:3072 sc1
  buffer_load_dwordx4 a[184:187], v3, s[16:19], s48 offen offset:3072 sc1
  buffer_load_dwordx4 a[188:191], v3, s[16:19], s49 offen offset:3072 sc1
  s_load_dwordx2 s[84:85], s[0:1], 40
  s_load_dwordx4 s[88:91], s[0:1], 56
  s_load_dwordx2 s[86:87], s[0:1], 72
  v_lshrrev_b32 v16, 3, v2
  v_and_b32 v17, 7, v2
  v_lshrrev_b32 v18, 1, v17
  v_lshrrev_b32 v19, 1, v16
  v_xor_b32 v18, v18, v19
  v_lshlrev_b32 v18, 5, v18
  v_and_b32 v19, 1, v17
  v_lshl_add_u32 v18, v19, 4, v18
  v_lshl_add_u32 v30, v16, 10, v18
  s_waitcnt lgkmcnt(0)
  s_mov_b32 s80, s84
  s_and_b32 s81, s85, 0xffff
  s_mov_b32 s82, 0
  s_mov_b32 s83, 0x20000
  s_mov_b32 s79, 0
  s_mov_b32 s63, 0x28000
  v_lshrrev_b32 v16, 4, v2
  v_bfe_u32 v17, v2, 2, 2
  v_and_b32 v18, 3, v2
  v_lshl_add_u32 v19, v16, 3, v17
  v_and_b32 v20, 1, v16
  v_lshl_add_u32 v20, v20, 2, v17
  v_lshlrev_b32 v20, 5, v20
  v_lshlrev_b32 v21, 8, v19
  v_lshl_add_u32 v21, v18, 3, v21
  v_xor_b32 v22, 0, v20
  v_add_u32 v4, v21, v22
  v_xor_b32 v22, 32, v20
  v_add_u32 v5, v21, v22
  v_xor_b32 v22, 64, v20
  v_add_u32 v6, v21, v22
  v_xor_b32 v22, 96, v20
  v_add_u32 v7, v21, v22
  v_xor_b32 v22, 128, v20
  v_add_u32 v8, v21, v22
  v_xor_b32 v22, 160, v20
  v_add_u32 v9, v21, v22
  v_xor_b32 v22, 192, v20
  v_add_u32 v10, v21, v22
  v_xor_b32 v22, 224, v20
  v_add_u32 v11, v21, v22
  s_lshl_b32 s33, s24, 20
  s_add_u32 s33, s33, 0x2000000
  s_add_u32 s33, s33, s28
  s_lshl_b32 s32, s26, 1
  s_add_u32 s32, s32, 2
  s_mov_b32 s77, 0x49800000
  s_waitcnt vmcnt(36)
  s_barrier
  ds_read_b64_tr_b16 v[32:33], v4 offset:0
  ds_read_b64_tr_b16 v[34:35], v4 offset:1024
  ds_read_b64_tr_b16 v[36:37], v5 offset:0
  ds_read_b64_tr_b16 v[38:39], v5 offset:1024
  ds_read_b64_tr_b16 v[40:41], v6 offset:0
  ds_read_b64_tr_b16 v[42:43], v6 offset:1024
  ds_read_b64_tr_b16 v[44:45], v7 offset:0
  ds_read_b64_tr_b16 v[46:47], v7 offset:1024
  ds_read_b64_tr_b16 v[48:49], v8 offset:0
  ds_read_b64_tr_b16 v[50:51], v8 offset:1024
  ds_read_b64_tr_b16 v[52:53], v9 offset:0
  ds_read_b64_tr_b16 v[54:55], v9 offset:1024
  ds_read_b64_tr_b16 v[56:57], v10 offset:0
  ds_read_b64_tr_b16 v[58:59], v10 offset:1024
  ds_read_b64_tr_b16 v[60:61], v11 offset:0
  ds_read_b64_tr_b16 v[62:63], v11 offset:1024
  s_waitcnt vmcnt(12)
  s_waitcnt lgkmcnt(0)
  v_mfma_f32_16x16x32_bf16 v[128:131], v[32:35], a[128:131], 0
  s_mov_b32 s62, 4096
  s_cmp_eq_u32 s61, 3
  s_cselect_b32 s62, 0xffffd000, s62
  s_add_u32 s46, s46, s62
  s_add_u32 s47, s47, s62
  s_add_u32 s48, s48, s62
  s_add_u32 s49, s49, s62
  v_mfma_f32_16x16x32_bf16 v[160:163], v[32:35], a[132:135], 0
  buffer_load_dwordx4 a[192:195], v3, s[16:19], s46 offen offset:0 sc1
  v_mfma_f32_16x16x32_bf16 v[192:195], v[32:35], a[136:139], 0
  ds_read_b64_tr_b16 v[64:65], v4 offset:8192
  v_mfma_f32_16x16x32_bf16 v[224:227], v[32:35], a[140:143], 0
  ds_read_b64_tr_b16 v[66:67], v4 offset:9216
  v_mfma_f32_16x16x32_bf16 v[132:135], v[36:39], a[128:131], 0
  ds_read_b64_tr_b16 v[68:69], v5 offset:8192
  v_mfma_f32_16x16x32_bf16 v[164:167], v[36:39], a[132:135], 0
  buffer_load_dwordx4 a[196:199], v3, s[16:19], s47 offen offset:0 sc1
  v_mfma_f32_16x16x32_bf16 v[196:199], v[36:39], a[136:139], 0
  ds_read_b64_tr_b16 v[70:71], v5 offset:9216
  v_mfma_f32_16x16x32_bf16 v[228:231], v[36:39], a[140:143], 0
  ds_read_b64_tr_b16 v[72:73], v6 offset:8192
  v_mfma_f32_16x16x32_bf16 v[136:139], v[40:43], a[128:131], 0
  ds_read_b64_tr_b16 v[74:75], v6 offset:9216
  v_mfma_f32_16x16x32_bf16 v[168:171], v[40:43], a[132:135], 0
  buffer_load_dwordx4 a[200:203], v3, s[16:19], s48 offen offset:0 sc1
  v_mfma_f32_16x16x32_bf16 v[200:203], v[40:43], a[136:139], 0
  ds_read_b64_tr_b16 v[76:77], v7 offset:8192
  v_mfma_f32_16x16x32_bf16 v[232:235], v[40:43], a[140:143], 0
  ds_read_b64_tr_b16 v[78:79], v7 offset:9216
  v_mfma_f32_16x16x32_bf16 v[140:143], v[44:47], a[128:131], 0
  ds_read_b64_tr_b16 v[80:81], v8 offset:8192
  v_mfma_f32_16x16x32_bf16 v[172:175], v[44:47], a[132:135], 0
  buffer_load_dwordx4 a[204:207], v3, s[16:19], s49 offen offset:0 sc1
  v_mfma_f32_16x16x32_bf16 v[204:207], v[44:47], a[136:139], 0
  ds_read_b64_tr_b16 v[82:83], v8 offset:9216
  v_mfma_f32_16x16x32_bf16 v[236:239], v[44:47], a[140:143], 0
  ds_read_b64_tr_b16 v[84:85], v9 offset:8192
  v_mfma_f32_16x16x32_bf16 v[144:147], v[48:51], a[128:131], 0
  ds_read_b64_tr_b16 v[86:87], v9 offset:9216
  v_mfma_f32_16x16x32_bf16 v[176:179], v[48:51], a[132:135], 0
  buffer_load_dwordx4 a[208:211], v3, s[16:19], s46 offen offset:1024 sc1
  v_mfma_f32_16x16x32_bf16 v[208:211], v[48:51], a[136:139], 0
  ds_read_b64_tr_b16 v[88:89], v10 offset:8192
  v_mfma_f32_16x16x32_bf16 v[240:243], v[48:51], a[140:143], 0
  ds_read_b64_tr_b16 v[90:91], v10 offset:9216
  v_mfma_f32_16x16x32_bf16 v[148:151], v[52:55], a[128:131], 0
  ds_read_b64_tr_b16 v[92:93], v11 offset:8192
  v_mfma_f32_16x16x32_bf16 v[180:183], v[52:55], a[132:135], 0
  buffer_load_dwordx4 a[212:215], v3, s[16:19], s47 offen offset:1024 sc1
  v_mfma_f32_16x16x32_bf16 v[212:215], v[52:55], a[136:139], 0
  ds_read_b64_tr_b16 v[94:95], v11 offset:9216
  v_mfma_f32_16x16x32_bf16 v[244:247], v[52:55], a[140:143], 0
  v_mfma_f32_16x16x32_bf16 v[152:155], v[56:59], a[128:131], 0
  v_mfma_f32_16x16x32_bf16 v[184:187], v[56:59], a[132:135], 0
  buffer_load_dwordx4 a[216:219], v3, s[16:19], s48 offen offset:1024 sc1
  v_mfma_f32_16x16x32_bf16 v[216:219], v[56:59], a[136:139], 0
  v_mfma_f32_16x16x32_bf16 v[248:251], v[56:59], a[140:143], 0
  v_mfma_f32_16x16x32_bf16 v[156:159], v[60:63], a[128:131], 0
  v_mfma_f32_16x16x32_bf16 v[188:191], v[60:63], a[132:135], 0
  buffer_load_dwordx4 a[220:223], v3, s[16:19], s49 offen offset:1024 sc1
  v_mfma_f32_16x16x32_bf16 v[220:223], v[60:63], a[136:139], 0
  v_mfma_f32_16x16x32_bf16 v[252:255], v[60:63], a[140:143], 0
  s_waitcnt lgkmcnt(0)
  s_barrier
  s_waitcnt vmcnt(16)
  v_mfma_f32_16x16x32_bf16 v[128:131], v[64:67], a[144:147], v[128:131]
  ds_read_b64_tr_b16 v[32:33], v4 offset:16384
  v_mfma_f32_16x16x32_bf16 v[160:163], v[64:67], a[148:151], v[160:163]
  buffer_load_dwordx4 a[128:131], v3, s[16:19], s46 offen offset:2048 sc1
  v_mfma_f32_16x16x32_bf16 v[192:195], v[64:67], a[152:155], v[192:195]
  ds_read_b64_tr_b16 v[34:35], v4 offset:17408
  v_mfma_f32_16x16x32_bf16 v[224:227], v[64:67], a[156:159], v[224:227]
  ds_read_b64_tr_b16 v[36:37], v5 offset:16384
  v_mfma_f32_16x16x32_bf16 v[132:135], v[68:71], a[144:147], v[132:135]
  ds_read_b64_tr_b16 v[38:39], v5 offset:17408
  v_mfma_f32_16x16x32_bf16 v[164:167], v[68:71], a[148:151], v[164:167]
  buffer_load_dwordx4 a[132:135], v3, s[16:19], s47 offen offset:2048 sc1
  v_mfma_f32_16x16x32_bf16 v[196:199], v[68:71], a[152:155], v[196:199]
  ds_read_b64_tr_b16 v[40:41], v6 offset:16384
  v_mfma_f32_16x16x32_bf16 v[228:231], v[68:71], a[156:159], v[228:231]
  ds_read_b64_tr_b16 v[42:43], v6 offset:17408
  v_mfma_f32_16x16x32_bf16 v[136:139], v[72:75], a[144:147], v[136:139]
  ds_read_b64_tr_b16 v[44:45], v7 offset:16384
  v_mfma_f32_16x16x32_bf16 v[168:171], v[72:75], a[148:151], v[168:171]
  buffer_load_dwordx4 a[136:139], v3, s[16:19], s48 offen offset:2048 sc1
  v_mfma_f32_16x16x32_bf16 v[200:203], v[72:75], a[152:155], v[200:203]
  ds_read_b64_tr_b16 v[46:47], v7 offset:17408
  v_mfma_f32_16x16x32_bf16 v[232:235], v[72:75], a[156:159], v[232:235]
  ds_read_b64_tr_b16 v[48:49], v8 offset:16384
  v_mfma_f32_16x16x32_bf16 v[140:143], v[76:79], a[144:147], v[140:143]
  ds_read_b64_tr_b16 v[50:51], v8 offset:17408
  v_mfma_f32_16x16x32_bf16 v[172:175], v[76:79], a[148:151], v[172:175]
  buffer_load_dwordx4 a[140:143], v3, s[16:19], s49 offen offset:2048 sc1
  v_mfma_f32_16x16x32_bf16 v[204:207], v[76:79], a[152:155], v[204:207]
  ds_read_b64_tr_b16 v[52:53], v9 offset:16384
  v_mfma_f32_16x16x32_bf16 v[236:239], v[76:79], a[156:159], v[236:239]
  ds_read_b64_tr_b16 v[54:55], v9 offset:17408
  v_mfma_f32_16x16x32_bf16 v[144:147], v[80:83], a[144:147], v[144:147]
  s_lshl_b32 s40, s61, 1
  s_add_u32 s40, s40, 6
  s_and_b32 s40, s40, 7
  s_lshl_b32 s40, s40, 19
  s_add_u32 s40, s40, s50
  s_add_u32 m0, s28, 98304
  v_mfma_f32_16x16x32_bf16 v[176:179], v[80:83], a[148:151], v[176:179]
  buffer_load_dwordx4 v12, s[20:23], s40 offen offset:0 lds
  v_mfma_f32_16x16x32_bf16 v[208:211], v[80:83], a[152:155], v[208:211]
  ds_read_b64_tr_b16 v[56:57], v10 offset:16384
  v_mfma_f32_16x16x32_bf16 v[240:243], v[80:83], a[156:159], v[240:243]
  ds_read_b64_tr_b16 v[58:59], v10 offset:17408
  v_mfma_f32_16x16x32_bf16 v[148:151], v[84:87], a[144:147], v[148:151]
  ds_read_b64_tr_b16 v[60:61], v11 offset:16384
  v_mfma_f32_16x16x32_bf16 v[180:183], v[84:87], a[148:151], v[180:183]
  buffer_load_dwordx4 v13, s[20:23], s40 offen offset:1024 lds
  v_mfma_f32_16x16x32_bf16 v[212:215], v[84:87], a[152:155], v[212:215]
  ds_read_b64_tr_b16 v[62:63], v11 offset:17408
  v_mfma_f32_16x16x32_bf16 v[244:247], v[84:87], a[156:159], v[244:247]
  v_mfma_f32_16x16x32_bf16 v[152:155], v[88:91], a[144:147], v[152:155]
  v_mfma_f32_16x16x32_bf16 v[184:187], v[88:91], a[148:151], v[184:187]
  buffer_load_dwordx4 v14, s[20:23], s40 offen offset:2048 lds
  v_mfma_f32_16x16x32_bf16 v[216:219], v[88:91], a[152:155], v[216:219]
  v_mfma_f32_16x16x32_bf16 v[248:251], v[88:91], a[156:159], v[248:251]
  v_mfma_f32_16x16x32_bf16 v[156:159], v[92:95], a[144:147], v[156:159]
  v_mfma_f32_16x16x32_bf16 v[188:191], v[92:95], a[148:151], v[188:191]
  buffer_load_dwordx4 v15, s[20:23], s40 offen offset:3072 lds
  v_mfma_f32_16x16x32_bf16 v[220:223], v[92:95], a[152:155], v[220:223]
  v_mfma_f32_16x16x32_bf16 v[252:255], v[92:95], a[156:159], v[252:255]
  s_waitcnt lgkmcnt(0)
  s_waitcnt vmcnt(20)
  v_mfma_f32_16x16x32_bf16 v[128:131], v[32:35], a[160:163], v[128:131]
  ds_read_b64_tr_b16 v[64:65], v4 offset:24576
  v_mfma_f32_16x16x32_bf16 v[160:163], v[32:35], a[164:167], v[160:163]
  buffer_load_dwordx4 a[144:147], v3, s[16:19], s46 offen offset:3072 sc1
  v_mfma_f32_16x16x32_bf16 v[192:195], v[32:35], a[168:171], v[192:195]
  ds_read_b64_tr_b16 v[66:67], v4 offset:25600
  v_mfma_f32_16x16x32_bf16 v[224:227], v[32:35], a[172:175], v[224:227]
  ds_read_b64_tr_b16 v[68:69], v5 offset:24576
  v_mfma_f32_16x16x32_bf16 v[132:135], v[36:39], a[160:163], v[132:135]
  ds_read_b64_tr_b16 v[70:71], v5 offset:25600
  v_mfma_f32_16x16x32_bf16 v[164:167], v[36:39], a[164:167], v[164:167]
  buffer_load_dwordx4 a[148:151], v3, s[16:19], s47 offen offset:3072 sc1
  v_mfma_f32_16x16x32_bf16 v[196:199], v[36:39], a[168:171], v[196:199]
  ds_read_b64_tr_b16 v[72:73], v6 offset:24576
  v_mfma_f32_16x16x32_bf16 v[228:231], v[36:39], a[172:175], v[228:231]
  ds_read_b64_tr_b16 v[74:75], v6 offset:25600
  v_mfma_f32_16x16x32_bf16 v[136:139], v[40:43], a[160:163], v[136:139]
  ds_read_b64_tr_b16 v[76:77], v7 offset:24576
  v_mfma_f32_16x16x32_bf16 v[168:171], v[40:43], a[164:167], v[168:171]
  buffer_load_dwordx4 a[152:155], v3, s[16:19], s48 offen offset:3072 sc1
  v_mfma_f32_16x16x32_bf16 v[200:203], v[40:43], a[168:171], v[200:203]
  ds_read_b64_tr_b16 v[78:79], v7 offset:25600
  v_mfma_f32_16x16x32_bf16 v[232:235], v[40:43], a[172:175], v[232:235]
  ds_read_b64_tr_b16 v[80:81], v8 offset:24576
  v_mfma_f32_16x16x32_bf16 v[140:143], v[44:47], a[160:163], v[140:143]
  ds_read_b64_tr_b16 v[82:83], v8 offset:25600
  v_mfma_f32_16x16x32_bf16 v[172:175], v[44:47], a[164:167], v[172:175]
  buffer_load_dwordx4 a[156:159], v3, s[16:19], s49 offen offset:3072 sc1
  v_mfma_f32_16x16x32_bf16 v[204:207], v[44:47], a[168:171], v[204:207]
  ds_read_b64_tr_b16 v[84:85], v9 offset:24576
  v_mfma_f32_16x16x32_bf16 v[236:239], v[44:47], a[172:175], v[236:239]
  ds_read_b64_tr_b16 v[86:87], v9 offset:25600
  v_mfma_f32_16x16x32_bf16 v[144:147], v[48:51], a[160:163], v[144:147]
  s_lshl_b32 s40, s61, 1
  s_add_u32 s40, s40, 7
  s_and_b32 s40, s40, 7
  s_lshl_b32 s40, s40, 19
  s_add_u32 s40, s40, s50
  s_add_u32 m0, s28, 114688
  v_mfma_f32_16x16x32_bf16 v[176:179], v[48:51], a[164:167], v[176:179]
  buffer_load_dwordx4 v12, s[20:23], s40 offen offset:0 lds
  v_mfma_f32_16x16x32_bf16 v[208:211], v[48:51], a[168:171], v[208:211]
  ds_read_b64_tr_b16 v[88:89], v10 offset:24576
  v_mfma_f32_16x16x32_bf16 v[240:243], v[48:51], a[172:175], v[240:243]
  ds_read_b64_tr_b16 v[90:91], v10 offset:25600
  v_mfma_f32_16x16x32_bf16 v[148:151], v[52:55], a[160:163], v[148:151]
  ds_read_b64_tr_b16 v[92:93], v11 offset:24576
  v_mfma_f32_16x16x32_bf16 v[180:183], v[52:55], a[164:167], v[180:183]
  buffer_load_dwordx4 v13, s[20:23], s40 offen offset:1024 lds
  v_mfma_f32_16x16x32_bf16 v[212:215], v[52:55], a[168:171], v[212:215]
  ds_read_b64_tr_b16 v[94:95], v11 offset:25600
  v_mfma_f32_16x16x32_bf16 v[244:247], v[52:55], a[172:175], v[244:247]
  v_mfma_f32_16x16x32_bf16 v[152:155], v[56:59], a[160:163], v[152:155]
  v_mfma_f32_16x16x32_bf16 v[184:187], v[56:59], a[164:167], v[184:187]
  buffer_load_dwordx4 v14, s[20:23], s40 offen offset:2048 lds
  v_mfma_f32_16x16x32_bf16 v[216:219], v[56:59], a[168:171], v[216:219]
  v_mfma_f32_16x16x32_bf16 v[248:251], v[56:59], a[172:175], v[248:251]
  v_mfma_f32_16x16x32_bf16 v[156:159], v[60:63], a[160:163], v[156:159]
  v_mfma_f32_16x16x32_bf16 v[188:191], v[60:63], a[164:167], v[188:191]
  buffer_load_dwordx4 v15, s[20:23], s40 offen offset:3072 lds
  v_mfma_f32_16x16x32_bf16 v[220:223], v[60:63], a[168:171], v[220:223]
  v_mfma_f32_16x16x32_bf16 v[252:255], v[60:63], a[172:175], v[252:255]
  s_waitcnt lgkmcnt(0)
  s_barrier
  s_waitcnt vmcnt(24)
  v_mfma_f32_16x16x32_bf16 v[128:131], v[64:67], a[176:179], v[128:131]
  s_mov_b32 s62, 4096
  s_cmp_eq_u32 s61, 2
  s_cselect_b32 s62, 0xffffd000, s62
  s_add_u32 s46, s46, s62
  s_add_u32 s47, s47, s62
  s_add_u32 s48, s48, s62
  s_add_u32 s49, s49, s62
  v_mfma_f32_16x16x32_bf16 v[160:163], v[64:67], a[180:183], v[160:163]
  buffer_load_dwordx4 a[160:163], v3, s[16:19], s46 offen offset:0 sc1
  v_mfma_f32_16x16x32_bf16 v[192:195], v[64:67], a[184:187], v[192:195]
  ds_read_b64_tr_b16 v[32:33], v4 offset:32768
  v_mfma_f32_16x16x32_bf16 v[224:227], v[64:67], a[188:191], v[224:227]
  ds_read_b64_tr_b16 v[34:35], v4 offset:33792
  v_mfma_f32_16x16x32_bf16 v[132:135], v[68:71], a[176:179], v[132:135]
  ds_read_b64_tr_b16 v[36:37], v5 offset:32768
  v_mfma_f32_16x16x32_bf16 v[164:167], v[68:71], a[180:183], v[164:167]
  buffer_load_dwordx4 a[164:167], v3, s[16:19], s47 offen offset:0 sc1
  v_mfma_f32_16x16x32_bf16 v[196:199], v[68:71], a[184:187], v[196:199]
  ds_read_b64_tr_b16 v[38:39], v5 offset:33792
  v_mfma_f32_16x16x32_bf16 v[228:231], v[68:71], a[188:191], v[228:231]
  ds_read_b64_tr_b16 v[40:41], v6 offset:32768
  v_mfma_f32_16x16x32_bf16 v[136:139], v[72:75], a[176:179], v[136:139]
  ds_read_b64_tr_b16 v[42:43], v6 offset:33792
  v_mfma_f32_16x16x32_bf16 v[168:171], v[72:75], a[180:183], v[168:171]
  buffer_load_dwordx4 a[168:171], v3, s[16:19], s48 offen offset:0 sc1
  v_mfma_f32_16x16x32_bf16 v[200:203], v[72:75], a[184:187], v[200:203]
  ds_read_b64_tr_b16 v[44:45], v7 offset:32768
  v_mfma_f32_16x16x32_bf16 v[232:235], v[72:75], a[188:191], v[232:235]
  ds_read_b64_tr_b16 v[46:47], v7 offset:33792
  v_mfma_f32_16x16x32_bf16 v[140:143], v[76:79], a[176:179], v[140:143]
  ds_read_b64_tr_b16 v[48:49], v8 offset:32768
  v_mfma_f32_16x16x32_bf16 v[172:175], v[76:79], a[180:183], v[172:175]
  buffer_load_dwordx4 a[172:175], v3, s[16:19], s49 offen offset:0 sc1
  v_mfma_f32_16x16x32_bf16 v[204:207], v[76:79], a[184:187], v[204:207]
  ds_read_b64_tr_b16 v[50:51], v8 offset:33792
  v_mfma_f32_16x16x32_bf16 v[236:239], v[76:79], a[188:191], v[236:239]
  ds_read_b64_tr_b16 v[52:53], v9 offset:32768
  v_mfma_f32_16x16x32_bf16 v[144:147], v[80:83], a[176:179], v[144:147]
  s_mov_b32 s39, 0
  s_lshl_b32 s36, s39, 15
  s_add_u32 s36, s36, s33
  s_add_u32 m0, s28, 0
  v_mfma_f32_16x16x32_bf16 v[176:179], v[80:83], a[180:183], v[176:179]
  buffer_load_dwordx4 v3, s[16:19], s36 offen offset:0 sc1 lds
  v_mfma_f32_16x16x32_bf16 v[208:211], v[80:83], a[184:187], v[208:211]
  ds_read_b64_tr_b16 v[54:55], v9 offset:33792
  v_mfma_f32_16x16x32_bf16 v[240:243], v[80:83], a[188:191], v[240:243]
  ds_read_b64_tr_b16 v[56:57], v10 offset:32768
  v_mfma_f32_16x16x32_bf16 v[148:151], v[84:87], a[176:179], v[148:151]
  ds_read_b64_tr_b16 v[58:59], v10 offset:33792
  v_mfma_f32_16x16x32_bf16 v[180:183], v[84:87], a[180:183], v[180:183]
  buffer_load_dwordx4 v3, s[16:19], s36 offen offset:1024 sc1 lds
  v_mfma_f32_16x16x32_bf16 v[212:215], v[84:87], a[184:187], v[212:215]
  ds_read_b64_tr_b16 v[60:61], v11 offset:32768
  v_mfma_f32_16x16x32_bf16 v[244:247], v[84:87], a[188:191], v[244:247]
  ds_read_b64_tr_b16 v[62:63], v11 offset:33792
  v_mfma_f32_16x16x32_bf16 v[152:155], v[88:91], a[176:179], v[152:155]
  v_mfma_f32_16x16x32_bf16 v[184:187], v[88:91], a[180:183], v[184:187]
  buffer_load_dwordx4 v3, s[16:19], s36 offen offset:2048 sc1 lds
  v_mfma_f32_16x16x32_bf16 v[216:219], v[88:91], a[184:187], v[216:219]
  v_mfma_f32_16x16x32_bf16 v[248:251], v[88:91], a[188:191], v[248:251]
  v_mfma_f32_16x16x32_bf16 v[156:159], v[92:95], a[176:179], v[156:159]
  v_mfma_f32_16x16x32_bf16 v[188:191], v[92:95], a[180:183], v[188:191]
  buffer_load_dwordx4 v3, s[16:19], s36 offen offset:3072 sc1 lds
  v_mfma_f32_16x16x32_bf16 v[220:223], v[92:95], a[184:187], v[220:223]
  v_mfma_f32_16x16x32_bf16 v[252:255], v[92:95], a[188:191], v[252:255]
  s_waitcnt lgkmcnt(0)
  s_waitcnt vmcnt(28)
  v_mfma_f32_16x16x32_bf16 v[128:131], v[32:35], a[192:195], v[128:131]
  ds_read_b64_tr_b16 v[64:65], v4 offset:40960
  v_mfma_f32_16x16x32_bf16 v[160:163], v[32:35], a[196:199], v[160:163]
  buffer_load_dwordx4 a[176:179], v3, s[16:19], s46 offen offset:1024 sc1
  v_mfma_f32_16x16x32_bf16 v[192:195], v[32:35], a[200:203], v[192:195]
  ds_read_b64_tr_b16 v[66:67], v4 offset:41984
  v_mfma_f32_16x16x32_bf16 v[224:227], v[32:35], a[204:207], v[224:227]
  ds_read_b64_tr_b16 v[68:69], v5 offset:40960
  v_mfma_f32_16x16x32_bf16 v[132:135], v[36:39], a[192:195], v[132:135]
  ds_read_b64_tr_b16 v[70:71], v5 offset:41984
  v_mfma_f32_16x16x32_bf16 v[164:167], v[36:39], a[196:199], v[164:167]
  buffer_load_dwordx4 a[180:183], v3, s[16:19], s47 offen offset:1024 sc1
  v_mfma_f32_16x16x32_bf16 v[196:199], v[36:39], a[200:203], v[196:199]
  ds_read_b64_tr_b16 v[72:73], v6 offset:40960
  v_mfma_f32_16x16x32_bf16 v[228:231], v[36:39], a[204:207], v[228:231]
  ds_read_b64_tr_b16 v[74:75], v6 offset:41984
  v_mfma_f32_16x16x32_bf16 v[136:139], v[40:43], a[192:195], v[136:139]
  ds_read_b64_tr_b16 v[76:77], v7 offset:40960
  v_mfma_f32_16x16x32_bf16 v[168:171], v[40:43], a[196:199], v[168:171]
  buffer_load_dwordx4 a[184:187], v3, s[16:19], s48 offen offset:1024 sc1
  v_mfma_f32_16x16x32_bf16 v[200:203], v[40:43], a[200:203], v[200:203]
  ds_read_b64_tr_b16 v[78:79], v7 offset:41984
  v_mfma_f32_16x16x32_bf16 v[232:235], v[40:43], a[204:207], v[232:235]
  ds_read_b64_tr_b16 v[80:81], v8 offset:40960
  v_mfma_f32_16x16x32_bf16 v[140:143], v[44:47], a[192:195], v[140:143]
  ds_read_b64_tr_b16 v[82:83], v8 offset:41984
  v_mfma_f32_16x16x32_bf16 v[172:175], v[44:47], a[196:199], v[172:175]
  buffer_load_dwordx4 a[188:191], v3, s[16:19], s49 offen offset:1024 sc1
  v_mfma_f32_16x16x32_bf16 v[204:207], v[44:47], a[200:203], v[204:207]
  ds_read_b64_tr_b16 v[84:85], v9 offset:40960
  v_mfma_f32_16x16x32_bf16 v[236:239], v[44:47], a[204:207], v[236:239]
  ds_read_b64_tr_b16 v[86:87], v9 offset:41984
  v_mfma_f32_16x16x32_bf16 v[144:147], v[48:51], a[192:195], v[144:147]
  s_mov_b32 s39, 1
  s_lshl_b32 s36, s39, 15
  s_add_u32 s36, s36, s33
  s_add_u32 m0, s28, 16384
  v_mfma_f32_16x16x32_bf16 v[176:179], v[48:51], a[196:199], v[176:179]
  buffer_load_dwordx4 v3, s[16:19], s36 offen offset:0 sc1 lds
  v_mfma_f32_16x16x32_bf16 v[208:211], v[48:51], a[200:203], v[208:211]
  ds_read_b64_tr_b16 v[88:89], v10 offset:40960
  v_mfma_f32_16x16x32_bf16 v[240:243], v[48:51], a[204:207], v[240:243]
  ds_read_b64_tr_b16 v[90:91], v10 offset:41984
  v_mfma_f32_16x16x32_bf16 v[148:151], v[52:55], a[192:195], v[148:151]
  ds_read_b64_tr_b16 v[92:93], v11 offset:40960
  v_mfma_f32_16x16x32_bf16 v[180:183], v[52:55], a[196:199], v[180:183]
  buffer_load_dwordx4 v3, s[16:19], s36 offen offset:1024 sc1 lds
  v_mfma_f32_16x16x32_bf16 v[212:215], v[52:55], a[200:203], v[212:215]
  ds_read_b64_tr_b16 v[94:95], v11 offset:41984
  v_mfma_f32_16x16x32_bf16 v[244:247], v[52:55], a[204:207], v[244:247]
  v_mfma_f32_16x16x32_bf16 v[152:155], v[56:59], a[192:195], v[152:155]
  v_mfma_f32_16x16x32_bf16 v[184:187], v[56:59], a[196:199], v[184:187]
  buffer_load_dwordx4 v3, s[16:19], s36 offen offset:2048 sc1 lds
  v_mfma_f32_16x16x32_bf16 v[216:219], v[56:59], a[200:203], v[216:219]
  v_mfma_f32_16x16x32_bf16 v[248:251], v[56:59], a[204:207], v[248:251]
  v_mfma_f32_16x16x32_bf16 v[156:159], v[60:63], a[192:195], v[156:159]
  v_mfma_f32_16x16x32_bf16 v[188:191], v[60:63], a[196:199], v[188:191]
  buffer_load_dwordx4 v3, s[16:19], s36 offen offset:3072 sc1 lds
  v_mfma_f32_16x16x32_bf16 v[220:223], v[60:63], a[200:203], v[220:223]
  v_mfma_f32_16x16x32_bf16 v[252:255], v[60:63], a[204:207], v[252:255]
  s_waitcnt lgkmcnt(0)
  s_barrier
  s_waitcnt vmcnt(32)
  v_mfma_f32_16x16x32_bf16 v[128:131], v[64:67], a[208:211], v[128:131]
  ds_read_b64_tr_b16 v[32:33], v4 offset:49152
  v_mfma_f32_16x16x32_bf16 v[160:163], v[64:67], a[212:215], v[160:163]
  buffer_load_dwordx4 a[192:195], v3, s[16:19], s46 offen offset:2048 sc1
  v_mfma_f32_16x16x32_bf16 v[192:195], v[64:67], a[216:219], v[192:195]
  ds_read_b64_tr_b16 v[34:35], v4 offset:50176
  v_mfma_f32_16x16x32_bf16 v[224:227], v[64:67], a[220:223], v[224:227]
  ds_read_b64_tr_b16 v[36:37], v5 offset:49152
  v_mfma_f32_16x16x32_bf16 v[132:135], v[68:71], a[208:211], v[132:135]
  ds_read_b64_tr_b16 v[38:39], v5 offset:50176
  v_mfma_f32_16x16x32_bf16 v[164:167], v[68:71], a[212:215], v[164:167]
  buffer_load_dwordx4 a[196:199], v3, s[16:19], s47 offen offset:2048 sc1
  v_mfma_f32_16x16x32_bf16 v[196:199], v[68:71], a[216:219], v[196:199]
  ds_read_b64_tr_b16 v[40:41], v6 offset:49152
  v_mfma_f32_16x16x32_bf16 v[228:231], v[68:71], a[220:223], v[228:231]
  ds_read_b64_tr_b16 v[42:43], v6 offset:50176
  v_mfma_f32_16x16x32_bf16 v[136:139], v[72:75], a[208:211], v[136:139]
  ds_read_b64_tr_b16 v[44:45], v7 offset:49152
  v_mfma_f32_16x16x32_bf16 v[168:171], v[72:75], a[212:215], v[168:171]
  buffer_load_dwordx4 a[200:203], v3, s[16:19], s48 offen offset:2048 sc1
  v_mfma_f32_16x16x32_bf16 v[200:203], v[72:75], a[216:219], v[200:203]
  ds_read_b64_tr_b16 v[46:47], v7 offset:50176
  v_mfma_f32_16x16x32_bf16 v[232:235], v[72:75], a[220:223], v[232:235]
  ds_read_b64_tr_b16 v[48:49], v8 offset:49152
  v_mfma_f32_16x16x32_bf16 v[140:143], v[76:79], a[208:211], v[140:143]
  ds_read_b64_tr_b16 v[50:51], v8 offset:50176
  v_mfma_f32_16x16x32_bf16 v[172:175], v[76:79], a[212:215], v[172:175]
  buffer_load_dwordx4 a[204:207], v3, s[16:19], s49 offen offset:2048 sc1
  v_mfma_f32_16x16x32_bf16 v[204:207], v[76:79], a[216:219], v[204:207]
  ds_read_b64_tr_b16 v[52:53], v9 offset:49152
  v_mfma_f32_16x16x32_bf16 v[236:239], v[76:79], a[220:223], v[236:239]
  ds_read_b64_tr_b16 v[54:55], v9 offset:50176
  v_mfma_f32_16x16x32_bf16 v[144:147], v[80:83], a[208:211], v[144:147]
  ds_read_b64_tr_b16 v[56:57], v10 offset:49152
  v_mfma_f32_16x16x32_bf16 v[176:179], v[80:83], a[212:215], v[176:179]
  ds_read_b64_tr_b16 v[58:59], v10 offset:50176
  v_mfma_f32_16x16x32_bf16 v[208:211], v[80:83], a[216:219], v[208:211]
  ds_read_b64_tr_b16 v[60:61], v11 offset:49152
  v_mfma_f32_16x16x32_bf16 v[240:243], v[80:83], a[220:223], v[240:243]
  ds_read_b64_tr_b16 v[62:63], v11 offset:50176
  v_mfma_f32_16x16x32_bf16 v[148:151], v[84:87], a[208:211], v[148:151]
  v_mfma_f32_16x16x32_bf16 v[180:183], v[84:87], a[212:215], v[180:183]
  v_mfma_f32_16x16x32_bf16 v[212:215], v[84:87], a[216:219], v[212:215]
  v_mfma_f32_16x16x32_bf16 v[244:247], v[84:87], a[220:223], v[244:247]
  v_mfma_f32_16x16x32_bf16 v[152:155], v[88:91], a[208:211], v[152:155]
  v_mfma_f32_16x16x32_bf16 v[184:187], v[88:91], a[212:215], v[184:187]
  v_mfma_f32_16x16x32_bf16 v[216:219], v[88:91], a[216:219], v[216:219]
  v_mfma_f32_16x16x32_bf16 v[248:251], v[88:91], a[220:223], v[248:251]
  v_mfma_f32_16x16x32_bf16 v[156:159], v[92:95], a[208:211], v[156:159]
  v_mfma_f32_16x16x32_bf16 v[188:191], v[92:95], a[212:215], v[188:191]
  v_mfma_f32_16x16x32_bf16 v[220:223], v[92:95], a[216:219], v[220:223]
  v_mfma_f32_16x16x32_bf16 v[252:255], v[92:95], a[220:223], v[252:255]
  s_waitcnt lgkmcnt(0)
  s_waitcnt vmcnt(32)
  v_mfma_f32_16x16x32_bf16 v[128:131], v[32:35], a[128:131], v[128:131]
  ds_read_b64_tr_b16 v[64:65], v4 offset:57344
  v_mfma_f32_16x16x32_bf16 v[160:163], v[32:35], a[132:135], v[160:163]
  buffer_load_dwordx4 a[208:211], v3, s[16:19], s46 offen offset:3072 sc1
  v_mfma_f32_16x16x32_bf16 v[192:195], v[32:35], a[136:139], v[192:195]
  ds_read_b64_tr_b16 v[66:67], v4 offset:58368
  v_mfma_f32_16x16x32_bf16 v[224:227], v[32:35], a[140:143], v[224:227]
  ds_read_b64_tr_b16 v[68:69], v5 offset:57344
  v_mfma_f32_16x16x32_bf16 v[132:135], v[36:39], a[128:131], v[132:135]
  ds_read_b64_tr_b16 v[70:71], v5 offset:58368
  v_mfma_f32_16x16x32_bf16 v[164:167], v[36:39], a[132:135], v[164:167]
  buffer_load_dwordx4 a[212:215], v3, s[16:19], s47 offen offset:3072 sc1
  v_mfma_f32_16x16x32_bf16 v[196:199], v[36:39], a[136:139], v[196:199]
  ds_read_b64_tr_b16 v[72:73], v6 offset:57344
  v_mfma_f32_16x16x32_bf16 v[228:231], v[36:39], a[140:143], v[228:231]
  ds_read_b64_tr_b16 v[74:75], v6 offset:58368
  v_mfma_f32_16x16x32_bf16 v[136:139], v[40:43], a[128:131], v[136:139]
  ds_read_b64_tr_b16 v[76:77], v7 offset:57344
  v_mfma_f32_16x16x32_bf16 v[168:171], v[40:43], a[132:135], v[168:171]
  buffer_load_dwordx4 a[216:219], v3, s[16:19], s48 offen offset:3072 sc1
  v_mfma_f32_16x16x32_bf16 v[200:203], v[40:43], a[136:139], v[200:203]
  ds_read_b64_tr_b16 v[78:79], v7 offset:58368
  v_mfma_f32_16x16x32_bf16 v[232:235], v[40:43], a[140:143], v[232:235]
  ds_read_b64_tr_b16 v[80:81], v8 offset:57344
  v_mfma_f32_16x16x32_bf16 v[140:143], v[44:47], a[128:131], v[140:143]
  ds_read_b64_tr_b16 v[82:83], v8 offset:58368
  v_mfma_f32_16x16x32_bf16 v[172:175], v[44:47], a[132:135], v[172:175]
  buffer_load_dwordx4 a[220:223], v3, s[16:19], s49 offen offset:3072 sc1
  v_mfma_f32_16x16x32_bf16 v[204:207], v[44:47], a[136:139], v[204:207]
  ds_read_b64_tr_b16 v[84:85], v9 offset:57344
  v_mfma_f32_16x16x32_bf16 v[236:239], v[44:47], a[140:143], v[236:239]
  ds_read_b64_tr_b16 v[86:87], v9 offset:58368
  v_mfma_f32_16x16x32_bf16 v[144:147], v[48:51], a[128:131], v[144:147]
  ds_read_b64_tr_b16 v[88:89], v10 offset:57344
  v_mfma_f32_16x16x32_bf16 v[176:179], v[48:51], a[132:135], v[176:179]
  ds_read_b64_tr_b16 v[90:91], v10 offset:58368
  v_mfma_f32_16x16x32_bf16 v[208:211], v[48:51], a[136:139], v[208:211]
  ds_read_b64_tr_b16 v[92:93], v11 offset:57344
  v_mfma_f32_16x16x32_bf16 v[240:243], v[48:51], a[140:143], v[240:243]
  ds_read_b64_tr_b16 v[94:95], v11 offset:58368
  v_mfma_f32_16x16x32_bf16 v[148:151], v[52:55], a[128:131], v[148:151]
  v_mfma_f32_16x16x32_bf16 v[180:183], v[52:55], a[132:135], v[180:183]
  v_mfma_f32_16x16x32_bf16 v[212:215], v[52:55], a[136:139], v[212:215]
  v_mfma_f32_16x16x32_bf16 v[244:247], v[52:55], a[140:143], v[244:247]
  v_mfma_f32_16x16x32_bf16 v[152:155], v[56:59], a[128:131], v[152:155]
  v_mfma_f32_16x16x32_bf16 v[184:187], v[56:59], a[132:135], v[184:187]
  v_mfma_f32_16x16x32_bf16 v[216:219], v[56:59], a[136:139], v[216:219]
  v_mfma_f32_16x16x32_bf16 v[248:251], v[56:59], a[140:143], v[248:251]
  v_mfma_f32_16x16x32_bf16 v[156:159], v[60:63], a[128:131], v[156:159]
  v_mfma_f32_16x16x32_bf16 v[188:191], v[60:63], a[132:135], v[188:191]
  v_mfma_f32_16x16x32_bf16 v[220:223], v[60:63], a[136:139], v[220:223]
  v_mfma_f32_16x16x32_bf16 v[252:255], v[60:63], a[140:143], v[252:255]
  s_waitcnt lgkmcnt(0)
  s_barrier
  v_add_u32 v4, 0x10000, v4
  v_add_u32 v5, 0x10000, v5
  v_add_u32 v6, 0x10000, v6
  v_add_u32 v7, 0x10000, v7
  v_add_u32 v8, 0x10000, v8
  v_add_u32 v9, 0x10000, v9
  v_add_u32 v10, 0x10000, v10
  v_add_u32 v11, 0x10000, v11
  s_waitcnt vmcnt(28)
  v_mfma_f32_16x16x32_bf16 v[128:131], v[64:67], a[144:147], v[128:131]
  s_mov_b32 s62, 4096
  s_cmp_eq_u32 s61, 1
  s_cselect_b32 s62, 0xffffd000, s62
  s_add_u32 s46, s46, s62
  s_add_u32 s47, s47, s62
  s_add_u32 s48, s48, s62
  s_add_u32 s49, s49, s62
  v_mfma_f32_16x16x32_bf16 v[160:163], v[64:67], a[148:151], v[160:163]
  buffer_load_dwordx4 a[128:131], v3, s[16:19], s46 offen offset:0 sc1
  v_mfma_f32_16x16x32_bf16 v[192:195], v[64:67], a[152:155], v[192:195]
  ds_read_b64_tr_b16 v[32:33], v4 offset:0
  v_mfma_f32_16x16x32_bf16 v[224:227], v[64:67], a[156:159], v[224:227]
  ds_read_b64_tr_b16 v[34:35], v4 offset:1024
  v_mfma_f32_16x16x32_bf16 v[132:135], v[68:71], a[144:147], v[132:135]
  ds_read_b64_tr_b16 v[36:37], v5 offset:0
  v_mfma_f32_16x16x32_bf16 v[164:167], v[68:71], a[148:151], v[164:167]
  buffer_load_dwordx4 a[132:135], v3, s[16:19], s47 offen offset:0 sc1
  v_mfma_f32_16x16x32_bf16 v[196:199], v[68:71], a[152:155], v[196:199]
  ds_read_b64_tr_b16 v[38:39], v5 offset:1024
  v_mfma_f32_16x16x32_bf16 v[228:231], v[68:71], a[156:159], v[228:231]
  ds_read_b64_tr_b16 v[40:41], v6 offset:0
  v_mfma_f32_16x16x32_bf16 v[136:139], v[72:75], a[144:147], v[136:139]
  ds_read_b64_tr_b16 v[42:43], v6 offset:1024
  v_mfma_f32_16x16x32_bf16 v[168:171], v[72:75], a[148:151], v[168:171]
  buffer_load_dwordx4 a[136:139], v3, s[16:19], s48 offen offset:0 sc1
  v_mfma_f32_16x16x32_bf16 v[200:203], v[72:75], a[152:155], v[200:203]
  ds_read_b64_tr_b16 v[44:45], v7 offset:0
  v_mfma_f32_16x16x32_bf16 v[232:235], v[72:75], a[156:159], v[232:235]
  ds_read_b64_tr_b16 v[46:47], v7 offset:1024
  v_mfma_f32_16x16x32_bf16 v[140:143], v[76:79], a[144:147], v[140:143]
  ds_read_b64_tr_b16 v[48:49], v8 offset:0
  v_mfma_f32_16x16x32_bf16 v[172:175], v[76:79], a[148:151], v[172:175]
  buffer_load_dwordx4 a[140:143], v3, s[16:19], s49 offen offset:0 sc1
  v_mfma_f32_16x16x32_bf16 v[204:207], v[76:79], a[152:155], v[204:207]
  ds_read_b64_tr_b16 v[50:51], v8 offset:1024
  v_mfma_f32_16x16x32_bf16 v[236:239], v[76:79], a[156:159], v[236:239]
  ds_read_b64_tr_b16 v[52:53], v9 offset:0
  v_mfma_f32_16x16x32_bf16 v[144:147], v[80:83], a[144:147], v[144:147]
  ds_read_b64_tr_b16 v[54:55], v9 offset:1024
  v_mfma_f32_16x16x32_bf16 v[176:179], v[80:83], a[148:151], v[176:179]
  ds_read_b64_tr_b16 v[56:57], v10 offset:0
  v_mfma_f32_16x16x32_bf16 v[208:211], v[80:83], a[152:155], v[208:211]
  ds_read_b64_tr_b16 v[58:59], v10 offset:1024
  v_mfma_f32_16x16x32_bf16 v[240:243], v[80:83], a[156:159], v[240:243]
  ds_read_b64_tr_b16 v[60:61], v11 offset:0
  v_mfma_f32_16x16x32_bf16 v[148:151], v[84:87], a[144:147], v[148:151]
  ds_read_b64_tr_b16 v[62:63], v11 offset:1024
  v_mfma_f32_16x16x32_bf16 v[180:183], v[84:87], a[148:151], v[180:183]
  v_mfma_f32_16x16x32_bf16 v[212:215], v[84:87], a[152:155], v[212:215]
  v_mfma_f32_16x16x32_bf16 v[244:247], v[84:87], a[156:159], v[244:247]
  v_mfma_f32_16x16x32_bf16 v[152:155], v[88:91], a[144:147], v[152:155]
  v_mfma_f32_16x16x32_bf16 v[184:187], v[88:91], a[148:151], v[184:187]
  v_mfma_f32_16x16x32_bf16 v[216:219], v[88:91], a[152:155], v[216:219]
  v_mfma_f32_16x16x32_bf16 v[248:251], v[88:91], a[156:159], v[248:251]
  v_mfma_f32_16x16x32_bf16 v[156:159], v[92:95], a[144:147], v[156:159]
  v_mfma_f32_16x16x32_bf16 v[188:191], v[92:95], a[148:151], v[188:191]
  v_mfma_f32_16x16x32_bf16 v[220:223], v[92:95], a[152:155], v[220:223]
  v_mfma_f32_16x16x32_bf16 v[252:255], v[92:95], a[156:159], v[252:255]
  s_waitcnt lgkmcnt(0)
  s_waitcnt vmcnt(24)
  v_mfma_f32_16x16x32_bf16 v[128:131], v[32:35], a[160:163], v[128:131]
  ds_read_b64_tr_b16 v[64:65], v4 offset:8192
  v_mfma_f32_16x16x32_bf16 v[160:163], v[32:35], a[164:167], v[160:163]
  buffer_load_dwordx4 a[144:147], v3, s[16:19], s46 offen offset:1024 sc1
  v_mfma_f32_16x16x32_bf16 v[192:195], v[32:35], a[168:171], v[192:195]
  ds_read_b64_tr_b16 v[66:67], v4 offset:9216
  v_mfma_f32_16x16x32_bf16 v[224:227], v[32:35], a[172:175], v[224:227]
  ds_read_b64_tr_b16 v[68:69], v5 offset:8192
  v_mfma_f32_16x16x32_bf16 v[132:135], v[36:39], a[160:163], v[132:135]
  ds_read_b64_tr_b16 v[70:71], v5 offset:9216
  v_mfma_f32_16x16x32_bf16 v[164:167], v[36:39], a[164:167], v[164:167]
  buffer_load_dwordx4 a[148:151], v3, s[16:19], s47 offen offset:1024 sc1
  v_mfma_f32_16x16x32_bf16 v[196:199], v[36:39], a[168:171], v[196:199]
  ds_read_b64_tr_b16 v[72:73], v6 offset:8192
  v_mfma_f32_16x16x32_bf16 v[228:231], v[36:39], a[172:175], v[228:231]
  ds_read_b64_tr_b16 v[74:75], v6 offset:9216
  v_mfma_f32_16x16x32_bf16 v[136:139], v[40:43], a[160:163], v[136:139]
  ds_read_b64_tr_b16 v[76:77], v7 offset:8192
  v_mfma_f32_16x16x32_bf16 v[168:171], v[40:43], a[164:167], v[168:171]
  buffer_load_dwordx4 a[152:155], v3, s[16:19], s48 offen offset:1024 sc1
  v_mfma_f32_16x16x32_bf16 v[200:203], v[40:43], a[168:171], v[200:203]
  ds_read_b64_tr_b16 v[78:79], v7 offset:9216
  v_mfma_f32_16x16x32_bf16 v[232:235], v[40:43], a[172:175], v[232:235]
  ds_read_b64_tr_b16 v[80:81], v8 offset:8192
  v_mfma_f32_16x16x32_bf16 v[140:143], v[44:47], a[160:163], v[140:143]
  ds_read_b64_tr_b16 v[82:83], v8 offset:9216
  v_mfma_f32_16x16x32_bf16 v[172:175], v[44:47], a[164:167], v[172:175]
  buffer_load_dwordx4 a[156:159], v3, s[16:19], s49 offen offset:1024 sc1
  v_mfma_f32_16x16x32_bf16 v[204:207], v[44:47], a[168:171], v[204:207]
  ds_read_b64_tr_b16 v[84:85], v9 offset:8192
  v_mfma_f32_16x16x32_bf16 v[236:239], v[44:47], a[172:175], v[236:239]
  ds_read_b64_tr_b16 v[86:87], v9 offset:9216
  v_mfma_f32_16x16x32_bf16 v[144:147], v[48:51], a[160:163], v[144:147]
  ds_read_b64_tr_b16 v[88:89], v10 offset:8192
  v_mfma_f32_16x16x32_bf16 v[176:179], v[48:51], a[164:167], v[176:179]
  ds_read_b64_tr_b16 v[90:91], v10 offset:9216
  v_mfma_f32_16x16x32_bf16 v[208:211], v[48:51], a[168:171], v[208:211]
  ds_read_b64_tr_b16 v[92:93], v11 offset:8192
  v_mfma_f32_16x16x32_bf16 v[240:243], v[48:51], a[172:175], v[240:243]
  ds_read_b64_tr_b16 v[94:95], v11 offset:9216
  v_mfma_f32_16x16x32_bf16 v[148:151], v[52:55], a[160:163], v[148:151]
  v_mfma_f32_16x16x32_bf16 v[180:183], v[52:55], a[164:167], v[180:183]
  v_mfma_f32_16x16x32_bf16 v[212:215], v[52:55], a[168:171], v[212:215]
  v_mfma_f32_16x16x32_bf16 v[244:247], v[52:55], a[172:175], v[244:247]
  v_mfma_f32_16x16x32_bf16 v[152:155], v[56:59], a[160:163], v[152:155]
  v_mfma_f32_16x16x32_bf16 v[184:187], v[56:59], a[164:167], v[184:187]
  v_mfma_f32_16x16x32_bf16 v[216:219], v[56:59], a[168:171], v[216:219]
  v_mfma_f32_16x16x32_bf16 v[248:251], v[56:59], a[172:175], v[248:251]
  v_mfma_f32_16x16x32_bf16 v[156:159], v[60:63], a[160:163], v[156:159]
  v_mfma_f32_16x16x32_bf16 v[188:191], v[60:63], a[164:167], v[188:191]
  v_mfma_f32_16x16x32_bf16 v[220:223], v[60:63], a[168:171], v[220:223]
  v_mfma_f32_16x16x32_bf16 v[252:255], v[60:63], a[172:175], v[252:255]
  s_waitcnt lgkmcnt(0)
  s_barrier
  s_waitcnt vmcnt(20)
  v_mfma_f32_16x16x32_bf16 v[128:131], v[64:67], a[176:179], v[128:131]
  ds_read_b64_tr_b16 v[32:33], v4 offset:16384
  v_mfma_f32_16x16x32_bf16 v[160:163], v[64:67], a[180:183], v[160:163]
  buffer_load_dwordx4 a[160:163], v3, s[16:19], s46 offen offset:2048 sc1
  v_mfma_f32_16x16x32_bf16 v[192:195], v[64:67], a[184:187], v[192:195]
  ds_read_b64_tr_b16 v[34:35], v4 offset:17408
  v_mfma_f32_16x16x32_bf16 v[224:227], v[64:67], a[188:191], v[224:227]
  ds_read_b64_tr_b16 v[36:37], v5 offset:16384
  v_mfma_f32_16x16x32_bf16 v[132:135], v[68:71], a[176:179], v[132:135]
  ds_read_b64_tr_b16 v[38:39], v5 offset:17408
  v_mfma_f32_16x16x32_bf16 v[164:167], v[68:71], a[180:183], v[164:167]
  buffer_load_dwordx4 a[164:167], v3, s[16:19], s47 offen offset:2048 sc1
  v_mfma_f32_16x16x32_bf16 v[196:199], v[68:71], a[184:187], v[196:199]
  ds_read_b64_tr_b16 v[40:41], v6 offset:16384
  v_mfma_f32_16x16x32_bf16 v[228:231], v[68:71], a[188:191], v[228:231]
  ds_read_b64_tr_b16 v[42:43], v6 offset:17408
  v_mfma_f32_16x16x32_bf16 v[136:139], v[72:75], a[176:179], v[136:139]
  ds_read_b64_tr_b16 v[44:45], v7 offset:16384
  v_mfma_f32_16x16x32_bf16 v[168:171], v[72:75], a[180:183], v[168:171]
  buffer_load_dwordx4 a[168:171], v3, s[16:19], s48 offen offset:2048 sc1
  v_mfma_f32_16x16x32_bf16 v[200:203], v[72:75], a[184:187], v[200:203]
  ds_read_b64_tr_b16 v[46:47], v7 offset:17408
  v_mfma_f32_16x16x32_bf16 v[232:235], v[72:75], a[188:191], v[232:235]
  ds_read_b64_tr_b16 v[48:49], v8 offset:16384
  v_mfma_f32_16x16x32_bf16 v[140:143], v[76:79], a[176:179], v[140:143]
  ds_read_b64_tr_b16 v[50:51], v8 offset:17408
  v_mfma_f32_16x16x32_bf16 v[172:175], v[76:79], a[180:183], v[172:175]
  buffer_load_dwordx4 a[172:175], v3, s[16:19], s49 offen offset:2048 sc1
  v_mfma_f32_16x16x32_bf16 v[204:207], v[76:79], a[184:187], v[204:207]
  ds_read_b64_tr_b16 v[52:53], v9 offset:16384
  v_mfma_f32_16x16x32_bf16 v[236:239], v[76:79], a[188:191], v[236:239]
  ds_read_b64_tr_b16 v[54:55], v9 offset:17408
  v_mfma_f32_16x16x32_bf16 v[144:147], v[80:83], a[176:179], v[144:147]
  ds_read_b64_tr_b16 v[56:57], v10 offset:16384
  v_mfma_f32_16x16x32_bf16 v[176:179], v[80:83], a[180:183], v[176:179]
  ds_read_b64_tr_b16 v[58:59], v10 offset:17408
  v_mfma_f32_16x16x32_bf16 v[208:211], v[80:83], a[184:187], v[208:211]
  ds_read_b64_tr_b16 v[60:61], v11 offset:16384
  v_mfma_f32_16x16x32_bf16 v[240:243], v[80:83], a[188:191], v[240:243]
  ds_read_b64_tr_b16 v[62:63], v11 offset:17408
  v_mfma_f32_16x16x32_bf16 v[148:151], v[84:87], a[176:179], v[148:151]
  v_mfma_f32_16x16x32_bf16 v[180:183], v[84:87], a[180:183], v[180:183]
  v_mfma_f32_16x16x32_bf16 v[212:215], v[84:87], a[184:187], v[212:215]
  v_mfma_f32_16x16x32_bf16 v[244:247], v[84:87], a[188:191], v[244:247]
  v_mfma_f32_16x16x32_bf16 v[152:155], v[88:91], a[176:179], v[152:155]
  v_mfma_f32_16x16x32_bf16 v[184:187], v[88:91], a[180:183], v[184:187]
  v_mfma_f32_16x16x32_bf16 v[216:219], v[88:91], a[184:187], v[216:219]
  v_mfma_f32_16x16x32_bf16 v[248:251], v[88:91], a[188:191], v[248:251]
  v_mfma_f32_16x16x32_bf16 v[156:159], v[92:95], a[176:179], v[156:159]
  v_mfma_f32_16x16x32_bf16 v[188:191], v[92:95], a[180:183], v[188:191]
  v_mfma_f32_16x16x32_bf16 v[220:223], v[92:95], a[184:187], v[220:223]
  v_mfma_f32_16x16x32_bf16 v[252:255], v[92:95], a[188:191], v[252:255]
  s_waitcnt lgkmcnt(0)
  s_waitcnt vmcnt(16)
  v_mfma_f32_16x16x32_bf16 v[128:131], v[32:35], a[192:195], v[128:131]
  ds_read_b64_tr_b16 v[64:65], v4 offset:24576
  v_mfma_f32_16x16x32_bf16 v[160:163], v[32:35], a[196:199], v[160:163]
  buffer_load_dwordx4 a[176:179], v3, s[16:19], s46 offen offset:3072 sc1
  v_mfma_f32_16x16x32_bf16 v[192:195], v[32:35], a[200:203], v[192:195]
  ds_read_b64_tr_b16 v[66:67], v4 offset:25600
  v_mfma_f32_16x16x32_bf16 v[224:227], v[32:35], a[204:207], v[224:227]
  ds_read_b64_tr_b16 v[68:69], v5 offset:24576
  v_mfma_f32_16x16x32_bf16 v[132:135], v[36:39], a[192:195], v[132:135]
  ds_read_b64_tr_b16 v[70:71], v5 offset:25600
  v_mfma_f32_16x16x32_bf16 v[164:167], v[36:39], a[196:199], v[164:167]
  buffer_load_dwordx4 a[180:183], v3, s[16:19], s47 offen offset:3072 sc1
  v_mfma_f32_16x16x32_bf16 v[196:199], v[36:39], a[200:203], v[196:199]
  ds_read_b64_tr_b16 v[72:73], v6 offset:24576
  v_mfma_f32_16x16x32_bf16 v[228:231], v[36:39], a[204:207], v[228:231]
  ds_read_b64_tr_b16 v[74:75], v6 offset:25600
  v_mfma_f32_16x16x32_bf16 v[136:139], v[40:43], a[192:195], v[136:139]
  ds_read_b64_tr_b16 v[76:77], v7 offset:24576
  v_mfma_f32_16x16x32_bf16 v[168:171], v[40:43], a[196:199], v[168:171]
  buffer_load_dwordx4 a[184:187], v3, s[16:19], s48 offen offset:3072 sc1
  v_mfma_f32_16x16x32_bf16 v[200:203], v[40:43], a[200:203], v[200:203]
  ds_read_b64_tr_b16 v[78:79], v7 offset:25600
  v_mfma_f32_16x16x32_bf16 v[232:235], v[40:43], a[204:207], v[232:235]
  ds_read_b64_tr_b16 v[80:81], v8 offset:24576
  v_mfma_f32_16x16x32_bf16 v[140:143], v[44:47], a[192:195], v[140:143]
  ds_read_b64_tr_b16 v[82:83], v8 offset:25600
  v_mfma_f32_16x16x32_bf16 v[172:175], v[44:47], a[196:199], v[172:175]
  buffer_load_dwordx4 a[188:191], v3, s[16:19], s49 offen offset:3072 sc1
  v_mfma_f32_16x16x32_bf16 v[204:207], v[44:47], a[200:203], v[204:207]
  ds_read_b64_tr_b16 v[84:85], v9 offset:24576
  v_mfma_f32_16x16x32_bf16 v[236:239], v[44:47], a[204:207], v[236:239]
  ds_read_b64_tr_b16 v[86:87], v9 offset:25600
  v_mfma_f32_16x16x32_bf16 v[144:147], v[48:51], a[192:195], v[144:147]
  ds_read_b64_tr_b16 v[88:89], v10 offset:24576
  v_mfma_f32_16x16x32_bf16 v[176:179], v[48:51], a[196:199], v[176:179]
  ds_read_b64_tr_b16 v[90:91], v10 offset:25600
  v_mfma_f32_16x16x32_bf16 v[208:211], v[48:51], a[200:203], v[208:211]
  ds_read_b64_tr_b16 v[92:93], v11 offset:24576
  v_mfma_f32_16x16x32_bf16 v[240:243], v[48:51], a[204:207], v[240:243]
  ds_read_b64_tr_b16 v[94:95], v11 offset:25600
  v_mfma_f32_16x16x32_bf16 v[148:151], v[52:55], a[192:195], v[148:151]
  v_mfma_f32_16x16x32_bf16 v[180:183], v[52:55], a[196:199], v[180:183]
  v_mfma_f32_16x16x32_bf16 v[212:215], v[52:55], a[200:203], v[212:215]
  v_mfma_f32_16x16x32_bf16 v[244:247], v[52:55], a[204:207], v[244:247]
  v_mfma_f32_16x16x32_bf16 v[152:155], v[56:59], a[192:195], v[152:155]
  v_mfma_f32_16x16x32_bf16 v[184:187], v[56:59], a[196:199], v[184:187]
  v_mfma_f32_16x16x32_bf16 v[216:219], v[56:59], a[200:203], v[216:219]
  v_mfma_f32_16x16x32_bf16 v[248:251], v[56:59], a[204:207], v[248:251]
  v_mfma_f32_16x16x32_bf16 v[156:159], v[60:63], a[192:195], v[156:159]
  v_mfma_f32_16x16x32_bf16 v[188:191], v[60:63], a[196:199], v[188:191]
  v_mfma_f32_16x16x32_bf16 v[220:223], v[60:63], a[200:203], v[220:223]
  v_mfma_f32_16x16x32_bf16 v[252:255], v[60:63], a[204:207], v[252:255]
  s_waitcnt lgkmcnt(0)
  s_barrier
  s_waitcnt vmcnt(16)
  v_mfma_f32_16x16x32_bf16 v[128:131], v[64:67], a[208:211], v[128:131]
  s_mov_b32 s39, 0
  s_lshl_b32 s37, s39, 15
  s_add_u32 s37, s37, s33
  s_add_u32 s37, s37, 16384
  s_add_u32 m0, s28, 65536
  v_mfma_f32_16x16x32_bf16 v[160:163], v[64:67], a[212:215], v[160:163]
  buffer_load_dwordx4 v3, s[16:19], s37 offen offset:0 sc1 lds
  v_mfma_f32_16x16x32_bf16 v[192:195], v[64:67], a[216:219], v[192:195]
  ds_read_b64_tr_b16 v[32:33], v4 offset:32768
  v_mfma_f32_16x16x32_bf16 v[224:227], v[64:67], a[220:223], v[224:227]
  ds_read_b64_tr_b16 v[34:35], v4 offset:33792
  v_mfma_f32_16x16x32_bf16 v[132:135], v[68:71], a[208:211], v[132:135]
  ds_read_b64_tr_b16 v[36:37], v5 offset:32768
  v_mfma_f32_16x16x32_bf16 v[164:167], v[68:71], a[212:215], v[164:167]
  buffer_load_dwordx4 v3, s[16:19], s37 offen offset:1024 sc1 lds
  v_mfma_f32_16x16x32_bf16 v[196:199], v[68:71], a[216:219], v[196:199]
  ds_read_b64_tr_b16 v[38:39], v5 offset:33792
  v_mfma_f32_16x16x32_bf16 v[228:231], v[68:71], a[220:223], v[228:231]
  ds_read_b64_tr_b16 v[40:41], v6 offset:32768
  v_mfma_f32_16x16x32_bf16 v[136:139], v[72:75], a[208:211], v[136:139]
  ds_read_b64_tr_b16 v[42:43], v6 offset:33792
  v_mfma_f32_16x16x32_bf16 v[168:171], v[72:75], a[212:215], v[168:171]
  buffer_load_dwordx4 v3, s[16:19], s37 offen offset:2048 sc1 lds
  v_mfma_f32_16x16x32_bf16 v[200:203], v[72:75], a[216:219], v[200:203]
  ds_read_b64_tr_b16 v[44:45], v7 offset:32768
  v_mfma_f32_16x16x32_bf16 v[232:235], v[72:75], a[220:223], v[232:235]
  ds_read_b64_tr_b16 v[46:47], v7 offset:33792
  v_mfma_f32_16x16x32_bf16 v[140:143], v[76:79], a[208:211], v[140:143]
  ds_read_b64_tr_b16 v[48:49], v8 offset:32768
  v_mfma_f32_16x16x32_bf16 v[172:175], v[76:79], a[212:215], v[172:175]
  buffer_load_dwordx4 v3, s[16:19], s37 offen offset:3072 sc1 lds
  v_mfma_f32_16x16x32_bf16 v[204:207], v[76:79], a[216:219], v[204:207]
  ds_read_b64_tr_b16 v[50:51], v8 offset:33792
  v_mfma_f32_16x16x32_bf16 v[236:239], v[76:79], a[220:223], v[236:239]
  ds_read_b64_tr_b16 v[52:53], v9 offset:32768
  v_mfma_f32_16x16x32_bf16 v[144:147], v[80:83], a[208:211], v[144:147]
  ds_read_b64_tr_b16 v[54:55], v9 offset:33792
  v_mfma_f32_16x16x32_bf16 v[176:179], v[80:83], a[212:215], v[176:179]
  s_mov_b32 m0, s63
  s_nop 0
  buffer_load_dwordx4 v30, s[80:83], s79 offen lds
  v_mfma_f32_16x16x32_bf16 v[208:211], v[80:83], a[216:219], v[208:211]
  ds_read_b64_tr_b16 v[56:57], v10 offset:32768
  v_mfma_f32_16x16x32_bf16 v[240:243], v[80:83], a[220:223], v[240:243]
  ds_read_b64_tr_b16 v[58:59], v10 offset:33792
  v_mfma_f32_16x16x32_bf16 v[148:151], v[84:87], a[208:211], v[148:151]
  s_mov_b32 s39, 2
  s_lshl_b32 s36, s39, 15
  s_add_u32 s36, s36, s33
  s_add_u32 m0, s28, 32768
  v_mfma_f32_16x16x32_bf16 v[180:183], v[84:87], a[212:215], v[180:183]
  buffer_load_dwordx4 v3, s[16:19], s36 offen offset:0 sc1 lds
  v_mfma_f32_16x16x32_bf16 v[212:215], v[84:87], a[216:219], v[212:215]
  ds_read_b64_tr_b16 v[60:61], v11 offset:32768
  v_mfma_f32_16x16x32_bf16 v[244:247], v[84:87], a[220:223], v[244:247]
  ds_read_b64_tr_b16 v[62:63], v11 offset:33792
  v_mfma_f32_16x16x32_bf16 v[152:155], v[88:91], a[208:211], v[152:155]
  v_mfma_f32_16x16x32_bf16 v[184:187], v[88:91], a[212:215], v[184:187]
  buffer_load_dwordx4 v3, s[16:19], s36 offen offset:1024 sc1 lds
  v_mfma_f32_16x16x32_bf16 v[216:219], v[88:91], a[216:219], v[216:219]
  v_mfma_f32_16x16x32_bf16 v[248:251], v[88:91], a[220:223], v[248:251]
  v_mfma_f32_16x16x32_bf16 v[156:159], v[92:95], a[208:211], v[156:159]
  v_mfma_f32_16x16x32_bf16 v[188:191], v[92:95], a[212:215], v[188:191]
  buffer_load_dwordx4 v3, s[16:19], s36 offen offset:2048 sc1 lds
  v_mfma_f32_16x16x32_bf16 v[220:223], v[92:95], a[216:219], v[220:223]
  v_mfma_f32_16x16x32_bf16 v[252:255], v[92:95], a[220:223], v[252:255]
  s_waitcnt lgkmcnt(0)
  s_waitcnt vmcnt(20)
  v_mfma_f32_16x16x32_bf16 v[128:131], v[32:35], a[128:131], v[128:131]
  ds_read_b64_tr_b16 v[64:65], v4 offset:40960
  v_mfma_f32_16x16x32_bf16 v[160:163], v[32:35], a[132:135], v[160:163]
  buffer_load_dwordx4 v3, s[16:19], s36 offen offset:3072 sc1 lds
  v_mfma_f32_16x16x32_bf16 v[192:195], v[32:35], a[136:139], v[192:195]
  ds_read_b64_tr_b16 v[66:67], v4 offset:41984
  v_mfma_f32_16x16x32_bf16 v[224:227], v[32:35], a[140:143], v[224:227]
  ds_read_b64_tr_b16 v[68:69], v5 offset:40960
  v_mfma_f32_16x16x32_bf16 v[132:135], v[36:39], a[128:131], v[132:135]
  s_mov_b32 s39, 1
  s_lshl_b32 s37, s39, 15
  s_add_u32 s37, s37, s33
  s_add_u32 s37, s37, 16384
  s_add_u32 m0, s28, 81920
  v_mfma_f32_16x16x32_bf16 v[164:167], v[36:39], a[132:135], v[164:167]
  buffer_load_dwordx4 v3, s[16:19], s37 offen offset:0 sc1 lds
  v_mfma_f32_16x16x32_bf16 v[196:199], v[36:39], a[136:139], v[196:199]
  ds_read_b64_tr_b16 v[70:71], v5 offset:41984
  v_mfma_f32_16x16x32_bf16 v[228:231], v[36:39], a[140:143], v[228:231]
  ds_read_b64_tr_b16 v[72:73], v6 offset:40960
  v_mfma_f32_16x16x32_bf16 v[136:139], v[40:43], a[128:131], v[136:139]
  ds_read_b64_tr_b16 v[74:75], v6 offset:41984
  v_mfma_f32_16x16x32_bf16 v[168:171], v[40:43], a[132:135], v[168:171]
  buffer_load_dwordx4 v3, s[16:19], s37 offen offset:1024 sc1 lds
  v_mfma_f32_16x16x32_bf16 v[200:203], v[40:43], a[136:139], v[200:203]
  ds_read_b64_tr_b16 v[76:77], v7 offset:40960
  v_mfma_f32_16x16x32_bf16 v[232:235], v[40:43], a[140:143], v[232:235]
  ds_read_b64_tr_b16 v[78:79], v7 offset:41984
  v_mfma_f32_16x16x32_bf16 v[140:143], v[44:47], a[128:131], v[140:143]
  ds_read_b64_tr_b16 v[80:81], v8 offset:40960
  v_mfma_f32_16x16x32_bf16 v[172:175], v[44:47], a[132:135], v[172:175]
  buffer_load_dwordx4 v3, s[16:19], s37 offen offset:2048 sc1 lds
  v_mfma_f32_16x16x32_bf16 v[204:207], v[44:47], a[136:139], v[204:207]
  ds_read_b64_tr_b16 v[82:83], v8 offset:41984
  v_mfma_f32_16x16x32_bf16 v[236:239], v[44:47], a[140:143], v[236:239]
  ds_read_b64_tr_b16 v[84:85], v9 offset:40960
  v_mfma_f32_16x16x32_bf16 v[144:147], v[48:51], a[128:131], v[144:147]
  ds_read_b64_tr_b16 v[86:87], v9 offset:41984
  v_mfma_f32_16x16x32_bf16 v[176:179], v[48:51], a[132:135], v[176:179]
  buffer_load_dwordx4 v3, s[16:19], s37 offen offset:3072 sc1 lds
  v_mfma_f32_16x16x32_bf16 v[208:211], v[48:51], a[136:139], v[208:211]
  ds_read_b64_tr_b16 v[88:89], v10 offset:40960
  v_mfma_f32_16x16x32_bf16 v[240:243], v[48:51], a[140:143], v[240:243]
  ds_read_b64_tr_b16 v[90:91], v10 offset:41984
  v_mfma_f32_16x16x32_bf16 v[148:151], v[52:55], a[128:131], v[148:151]
  ds_read_b64_tr_b16 v[92:93], v11 offset:40960
  v_mfma_f32_16x16x32_bf16 v[180:183], v[52:55], a[132:135], v[180:183]
  s_mov_b32 m0, s63
  s_nop 0
  buffer_load_dwordx4 v30, s[80:83], s79 offen lds
  v_mfma_f32_16x16x32_bf16 v[212:215], v[52:55], a[136:139], v[212:215]
  ds_read_b64_tr_b16 v[94:95], v11 offset:41984
  v_mfma_f32_16x16x32_bf16 v[244:247], v[52:55], a[140:143], v[244:247]
  v_mfma_f32_16x16x32_bf16 v[152:155], v[56:59], a[128:131], v[152:155]
  s_mov_b32 s39, 3
  s_lshl_b32 s36, s39, 15
  s_add_u32 s36, s36, s33
  s_add_u32 m0, s28, 49152
  v_mfma_f32_16x16x32_bf16 v[184:187], v[56:59], a[132:135], v[184:187]
  buffer_load_dwordx4 v3, s[16:19], s36 offen offset:0 sc1 lds
  v_mfma_f32_16x16x32_bf16 v[216:219], v[56:59], a[136:139], v[216:219]
  v_mfma_f32_16x16x32_bf16 v[248:251], v[56:59], a[140:143], v[248:251]
  v_mfma_f32_16x16x32_bf16 v[156:159], v[60:63], a[128:131], v[156:159]
  v_mfma_f32_16x16x32_bf16 v[188:191], v[60:63], a[132:135], v[188:191]
  buffer_load_dwordx4 v3, s[16:19], s36 offen offset:1024 sc1 lds
  v_mfma_f32_16x16x32_bf16 v[220:223], v[60:63], a[136:139], v[220:223]
  v_mfma_f32_16x16x32_bf16 v[252:255], v[60:63], a[140:143], v[252:255]
  s_waitcnt lgkmcnt(0)
  s_barrier
  s_waitcnt vmcnt(24)
  v_mfma_f32_16x16x32_bf16 v[128:131], v[64:67], a[144:147], v[128:131]
  ds_read_b64_tr_b16 v[32:33], v4 offset:49152
  v_mfma_f32_16x16x32_bf16 v[160:163], v[64:67], a[148:151], v[160:163]
  buffer_load_dwordx4 v3, s[16:19], s36 offen offset:2048 sc1 lds
  v_mfma_f32_16x16x32_bf16 v[192:195], v[64:67], a[152:155], v[192:195]
  ds_read_b64_tr_b16 v[34:35], v4 offset:50176
  v_mfma_f32_16x16x32_bf16 v[224:227], v[64:67], a[156:159], v[224:227]
  ds_read_b64_tr_b16 v[36:37], v5 offset:49152
  v_mfma_f32_16x16x32_bf16 v[132:135], v[68:71], a[144:147], v[132:135]
  ds_read_b64_tr_b16 v[38:39], v5 offset:50176
  v_mfma_f32_16x16x32_bf16 v[164:167], v[68:71], a[148:151], v[164:167]
  buffer_load_dwordx4 v3, s[16:19], s36 offen offset:3072 sc1 lds
  v_mfma_f32_16x16x32_bf16 v[196:199], v[68:71], a[152:155], v[196:199]
  ds_read_b64_tr_b16 v[40:41], v6 offset:49152
  v_mfma_f32_16x16x32_bf16 v[228:231], v[68:71], a[156:159], v[228:231]
  ds_read_b64_tr_b16 v[42:43], v6 offset:50176
  v_mfma_f32_16x16x32_bf16 v[136:139], v[72:75], a[144:147], v[136:139]
  ds_read_b64_tr_b16 v[44:45], v7 offset:49152
  v_mfma_f32_16x16x32_bf16 v[168:171], v[72:75], a[148:151], v[168:171]
  ds_read_b64_tr_b16 v[46:47], v7 offset:50176
  v_mfma_f32_16x16x32_bf16 v[200:203], v[72:75], a[152:155], v[200:203]
  ds_read_b64_tr_b16 v[48:49], v8 offset:49152
  v_mfma_f32_16x16x32_bf16 v[232:235], v[72:75], a[156:159], v[232:235]
  ds_read_b64_tr_b16 v[50:51], v8 offset:50176
  v_mfma_f32_16x16x32_bf16 v[140:143], v[76:79], a[144:147], v[140:143]
  ds_read_b64_tr_b16 v[52:53], v9 offset:49152
  v_mfma_f32_16x16x32_bf16 v[172:175], v[76:79], a[148:151], v[172:175]
  ds_read_b64_tr_b16 v[54:55], v9 offset:50176
  v_mfma_f32_16x16x32_bf16 v[204:207], v[76:79], a[152:155], v[204:207]
  ds_read_b64_tr_b16 v[56:57], v10 offset:49152
  v_mfma_f32_16x16x32_bf16 v[236:239], v[76:79], a[156:159], v[236:239]
  ds_read_b64_tr_b16 v[58:59], v10 offset:50176
  v_mfma_f32_16x16x32_bf16 v[144:147], v[80:83], a[144:147], v[144:147]
  ds_read_b64_tr_b16 v[60:61], v11 offset:49152
  v_mfma_f32_16x16x32_bf16 v[176:179], v[80:83], a[148:151], v[176:179]
  ds_read_b64_tr_b16 v[62:63], v11 offset:50176
  v_mfma_f32_16x16x32_bf16 v[208:211], v[80:83], a[152:155], v[208:211]
  v_mfma_f32_16x16x32_bf16 v[240:243], v[80:83], a[156:159], v[240:243]
  v_mfma_f32_16x16x32_bf16 v[148:151], v[84:87], a[144:147], v[148:151]
  v_mfma_f32_16x16x32_bf16 v[180:183], v[84:87], a[148:151], v[180:183]
  v_mfma_f32_16x16x32_bf16 v[212:215], v[84:87], a[152:155], v[212:215]
  v_mfma_f32_16x16x32_bf16 v[244:247], v[84:87], a[156:159], v[244:247]
  v_mfma_f32_16x16x32_bf16 v[152:155], v[88:91], a[144:147], v[152:155]
  v_mfma_f32_16x16x32_bf16 v[184:187], v[88:91], a[148:151], v[184:187]
  v_mfma_f32_16x16x32_bf16 v[216:219], v[88:91], a[152:155], v[216:219]
  v_mfma_f32_16x16x32_bf16 v[248:251], v[88:91], a[156:159], v[248:251]
  v_mfma_f32_16x16x32_bf16 v[156:159], v[92:95], a[144:147], v[156:159]
  v_mfma_f32_16x16x32_bf16 v[188:191], v[92:95], a[148:151], v[188:191]
  v_mfma_f32_16x16x32_bf16 v[220:223], v[92:95], a[152:155], v[220:223]
  v_mfma_f32_16x16x32_bf16 v[252:255], v[92:95], a[156:159], v[252:255]
  s_waitcnt lgkmcnt(0)
  s_waitcnt vmcnt(22)
  v_mfma_f32_16x16x32_bf16 v[128:131], v[32:35], a[160:163], v[128:131]
  ds_read_b64_tr_b16 v[64:65], v4 offset:57344
  v_mfma_f32_16x16x32_bf16 v[160:163], v[32:35], a[164:167], v[160:163]
  ds_read_b64_tr_b16 v[66:67], v4 offset:58368
  v_mfma_f32_16x16x32_bf16 v[192:195], v[32:35], a[168:171], v[192:195]
  ds_read_b64_tr_b16 v[68:69], v5 offset:57344
  v_mfma_f32_16x16x32_bf16 v[224:227], v[32:35], a[172:175], v[224:227]
  ds_read_b64_tr_b16 v[70:71], v5 offset:58368
  v_mfma_f32_16x16x32_bf16 v[132:135], v[36:39], a[160:163], v[132:135]
  ds_read_b64_tr_b16 v[72:73], v6 offset:57344
  v_mfma_f32_16x16x32_bf16 v[164:167], v[36:39], a[164:167], v[164:167]
  ds_read_b64_tr_b16 v[74:75], v6 offset:58368
  v_mfma_f32_16x16x32_bf16 v[196:199], v[36:39], a[168:171], v[196:199]
  ds_read_b64_tr_b16 v[76:77], v7 offset:57344
  v_mfma_f32_16x16x32_bf16 v[228:231], v[36:39], a[172:175], v[228:231]
  ds_read_b64_tr_b16 v[78:79], v7 offset:58368
  v_mfma_f32_16x16x32_bf16 v[136:139], v[40:43], a[160:163], v[136:139]
  ds_read_b64_tr_b16 v[80:81], v8 offset:57344
  v_mfma_f32_16x16x32_bf16 v[168:171], v[40:43], a[164:167], v[168:171]
  ds_read_b64_tr_b16 v[82:83], v8 offset:58368
  v_mfma_f32_16x16x32_bf16 v[200:203], v[40:43], a[168:171], v[200:203]
  ds_read_b64_tr_b16 v[84:85], v9 offset:57344
  v_mfma_f32_16x16x32_bf16 v[232:235], v[40:43], a[172:175], v[232:235]
  ds_read_b64_tr_b16 v[86:87], v9 offset:58368
  v_mfma_f32_16x16x32_bf16 v[140:143], v[44:47], a[160:163], v[140:143]
  ds_read_b64_tr_b16 v[88:89], v10 offset:57344
  v_mfma_f32_16x16x32_bf16 v[172:175], v[44:47], a[164:167], v[172:175]
  ds_read_b64_tr_b16 v[90:91], v10 offset:58368
  v_mfma_f32_16x16x32_bf16 v[204:207], v[44:47], a[168:171], v[204:207]
  ds_read_b64_tr_b16 v[92:93], v11 offset:57344
  v_mfma_f32_16x16x32_bf16 v[236:239], v[44:47], a[172:175], v[236:239]
  ds_read_b64_tr_b16 v[94:95], v11 offset:58368
  v_mfma_f32_16x16x32_bf16 v[144:147], v[48:51], a[160:163], v[144:147]
  v_mfma_f32_16x16x32_bf16 v[176:179], v[48:51], a[164:167], v[176:179]
  v_mfma_f32_16x16x32_bf16 v[208:211], v[48:51], a[168:171], v[208:211]
  v_mfma_f32_16x16x32_bf16 v[240:243], v[48:51], a[172:175], v[240:243]
  v_mfma_f32_16x16x32_bf16 v[148:151], v[52:55], a[160:163], v[148:151]
  v_mfma_f32_16x16x32_bf16 v[180:183], v[52:55], a[164:167], v[180:183]
  v_mfma_f32_16x16x32_bf16 v[212:215], v[52:55], a[168:171], v[212:215]
  v_mfma_f32_16x16x32_bf16 v[244:247], v[52:55], a[172:175], v[244:247]
  v_mfma_f32_16x16x32_bf16 v[152:155], v[56:59], a[160:163], v[152:155]
  v_mfma_f32_16x16x32_bf16 v[184:187], v[56:59], a[164:167], v[184:187]
  v_mfma_f32_16x16x32_bf16 v[216:219], v[56:59], a[168:171], v[216:219]
  v_mfma_f32_16x16x32_bf16 v[248:251], v[56:59], a[172:175], v[248:251]
  v_mfma_f32_16x16x32_bf16 v[156:159], v[60:63], a[160:163], v[156:159]
  v_mfma_f32_16x16x32_bf16 v[188:191], v[60:63], a[164:167], v[188:191]
  v_mfma_f32_16x16x32_bf16 v[220:223], v[60:63], a[168:171], v[220:223]
  v_mfma_f32_16x16x32_bf16 v[252:255], v[60:63], a[172:175], v[252:255]
  s_waitcnt lgkmcnt(0)
  s_waitcnt vmcnt(18)
  v_mfma_f32_16x16x32_bf16 v[128:131], v[64:67], a[176:179], v[128:131]
  v_mfma_f32_16x16x32_bf16 v[160:163], v[64:67], a[180:183], v[160:163]
  v_mfma_f32_16x16x32_bf16 v[192:195], v[64:67], a[184:187], v[192:195]
  v_mfma_f32_16x16x32_bf16 v[224:227], v[64:67], a[188:191], v[224:227]
  v_mfma_f32_16x16x32_bf16 v[132:135], v[68:71], a[176:179], v[132:135]
  v_mfma_f32_16x16x32_bf16 v[164:167], v[68:71], a[180:183], v[164:167]
  v_mfma_f32_16x16x32_bf16 v[196:199], v[68:71], a[184:187], v[196:199]
  v_mfma_f32_16x16x32_bf16 v[228:231], v[68:71], a[188:191], v[228:231]
  v_mfma_f32_16x16x32_bf16 v[136:139], v[72:75], a[176:179], v[136:139]
  v_mfma_f32_16x16x32_bf16 v[168:171], v[72:75], a[180:183], v[168:171]
  v_mfma_f32_16x16x32_bf16 v[200:203], v[72:75], a[184:187], v[200:203]
  v_mfma_f32_16x16x32_bf16 v[232:235], v[72:75], a[188:191], v[232:235]
  v_mfma_f32_16x16x32_bf16 v[140:143], v[76:79], a[176:179], v[140:143]
  v_mfma_f32_16x16x32_bf16 v[172:175], v[76:79], a[180:183], v[172:175]
  v_mfma_f32_16x16x32_bf16 v[204:207], v[76:79], a[184:187], v[204:207]
  v_mfma_f32_16x16x32_bf16 v[236:239], v[76:79], a[188:191], v[236:239]
  v_mfma_f32_16x16x32_bf16 v[144:147], v[80:83], a[176:179], v[144:147]
  v_mfma_f32_16x16x32_bf16 v[176:179], v[80:83], a[180:183], v[176:179]
  v_mfma_f32_16x16x32_bf16 v[208:211], v[80:83], a[184:187], v[208:211]
  v_mfma_f32_16x16x32_bf16 v[240:243], v[80:83], a[188:191], v[240:243]
  v_mfma_f32_16x16x32_bf16 v[148:151], v[84:87], a[176:179], v[148:151]
  v_mfma_f32_16x16x32_bf16 v[180:183], v[84:87], a[180:183], v[180:183]
  v_mfma_f32_16x16x32_bf16 v[212:215], v[84:87], a[184:187], v[212:215]
  v_mfma_f32_16x16x32_bf16 v[244:247], v[84:87], a[188:191], v[244:247]
  v_mfma_f32_16x16x32_bf16 v[152:155], v[88:91], a[176:179], v[152:155]
  v_mfma_f32_16x16x32_bf16 v[184:187], v[88:91], a[180:183], v[184:187]
  v_mfma_f32_16x16x32_bf16 v[216:219], v[88:91], a[184:187], v[216:219]
  v_mfma_f32_16x16x32_bf16 v[248:251], v[88:91], a[188:191], v[248:251]
  v_mfma_f32_16x16x32_bf16 v[156:159], v[92:95], a[176:179], v[156:159]
  v_mfma_f32_16x16x32_bf16 v[188:191], v[92:95], a[180:183], v[188:191]
  v_mfma_f32_16x16x32_bf16 v[220:223], v[92:95], a[184:187], v[220:223]
  v_mfma_f32_16x16x32_bf16 v[252:255], v[92:95], a[188:191], v[252:255]
  s_waitcnt lgkmcnt(0)
  s_barrier
  s_mov_b32 s39, 2
  s_lshl_b32 s37, s39, 15
  s_add_u32 s37, s37, s33
  s_add_u32 s37, s37, 16384
  s_add_u32 m0, s28, 98304
  s_nop 0
  buffer_load_dwordx4 v3, s[16:19], s37 offen offset:0 sc1 lds
  buffer_load_dwordx4 v3, s[16:19], s37 offen offset:1024 sc1 lds
  buffer_load_dwordx4 v3, s[16:19], s37 offen offset:2048 sc1 lds
  buffer_load_dwordx4 v3, s[16:19], s37 offen offset:3072 sc1 lds
  s_mov_b32 m0, s63
  s_nop 0
  buffer_load_dwordx4 v30, s[80:83], s79 offen lds
  s_nop 4
  v_cvt_pk_bf16_f32 v128, v128, v129
  v_cvt_pk_bf16_f32 v129, v130, v131
  v_cvt_pk_bf16_f32 v130, v132, v133
  v_cvt_pk_bf16_f32 v131, v134, v135
  v_cvt_pk_bf16_f32 v132, v136, v137
  v_cvt_pk_bf16_f32 v133, v138, v139
  v_cvt_pk_bf16_f32 v134, v140, v141
  v_cvt_pk_bf16_f32 v135, v142, v143
  v_cvt_pk_bf16_f32 v136, v144, v145
  v_cvt_pk_bf16_f32 v137, v146, v147
  v_cvt_pk_bf16_f32 v138, v148, v149
  v_cvt_pk_bf16_f32 v139, v150, v151
  v_cvt_pk_bf16_f32 v140, v152, v153
  v_cvt_pk_bf16_f32 v141, v154, v155
  v_cvt_pk_bf16_f32 v142, v156, v157
  v_cvt_pk_bf16_f32 v143, v158, v159
  v_cvt_pk_bf16_f32 v144, v160, v161
  v_cvt_pk_bf16_f32 v145, v162, v163
  v_cvt_pk_bf16_f32 v146, v164, v165
  v_cvt_pk_bf16_f32 v147, v166, v167
  v_cvt_pk_bf16_f32 v148, v168, v169
  v_cvt_pk_bf16_f32 v149, v170, v171
  v_cvt_pk_bf16_f32 v150, v172, v173
  v_cvt_pk_bf16_f32 v151, v174, v175
  v_cvt_pk_bf16_f32 v152, v176, v177
  v_cvt_pk_bf16_f32 v153, v178, v179
  v_cvt_pk_bf16_f32 v154, v180, v181
  v_cvt_pk_bf16_f32 v155, v182, v183
  v_cvt_pk_bf16_f32 v156, v184, v185
  v_cvt_pk_bf16_f32 v157, v186, v187
  v_cvt_pk_bf16_f32 v158, v188, v189
  v_cvt_pk_bf16_f32 v159, v190, v191
  v_cvt_pk_bf16_f32 v160, v192, v193
  v_cvt_pk_bf16_f32 v161, v194, v195
  v_cvt_pk_bf16_f32 v162, v196, v197
  v_cvt_pk_bf16_f32 v163, v198, v199
  v_cvt_pk_bf16_f32 v164, v200, v201
  v_cvt_pk_bf16_f32 v165, v202, v203
  v_cvt_pk_bf16_f32 v166, v204, v205
  v_cvt_pk_bf16_f32 v167, v206, v207
  v_cvt_pk_bf16_f32 v168, v208, v209
  v_cvt_pk_bf16_f32 v169, v210, v211
  v_cvt_pk_bf16_f32 v170, v212, v213
  v_cvt_pk_bf16_f32 v171, v214, v215
  v_cvt_pk_bf16_f32 v172, v216, v217
  v_cvt_pk_bf16_f32 v173, v218, v219
  v_cvt_pk_bf16_f32 v174, v220, v221
  v_cvt_pk_bf16_f32 v175, v222, v223
  v_cvt_pk_bf16_f32 v176, v224, v225
  v_cvt_pk_bf16_f32 v177, v226, v227
  v_cvt_pk_bf16_f32 v178, v228, v229
  v_cvt_pk_bf16_f32 v179, v230, v231
  v_cvt_pk_bf16_f32 v180, v232, v233
  v_cvt_pk_bf16_f32 v181, v234, v235
  v_cvt_pk_bf16_f32 v182, v236, v237
  v_cvt_pk_bf16_f32 v183, v238, v239
  v_cvt_pk_bf16_f32 v184, v240, v241
  v_cvt_pk_bf16_f32 v185, v242, v243
  v_cvt_pk_bf16_f32 v186, v244, v245
  v_cvt_pk_bf16_f32 v187, v246, v247
  v_cvt_pk_bf16_f32 v188, v248, v249
  v_cvt_pk_bf16_f32 v189, v250, v251
  v_cvt_pk_bf16_f32 v190, v252, v253
  v_cvt_pk_bf16_f32 v191, v254, v255
  s_mov_b32 s46, 0x28000
  s_mov_b32 s47, 0
  s_mov_b32 s48, 0
  v_mov_b32 v116, 0x3f803f80
  v_mov_b32 v117, 0x3f803f80
  v_mov_b32 v118, 0x3f803f80
  v_mov_b32 v119, 0x3f803f80
  v_mov_b32 v28, 0xff800000
  v_lshrrev_b32 v16, 4, v2
  v_lshlrev_b32 v16, 2, v16
  v_and_b32 v17, 15, v2
  v_sub_u32 v24, v16, v17
  v_add_u32 v25, 1, v24
  v_add_u32 v26, 2, v24
  v_add_u32 v27, 3, v24
  s_mov_b32 s31, 4
  s_add_u32 s36, s33, 98304
  s_mov_b32 s29, 49152
  s_mov_b32 s30, 0
  s_mov_b32 s51, 16384
  s_add_u32 s78, s28, 65536
  s_mov_b32 s41, 0
  s_waitcnt vmcnt(27)
  s_barrier
  v_mov_b32 v124, v3
  ds_read_b128 a[128:131], v124 offset:0
  ds_read_b128 a[132:135], v124 offset:1024
  ds_read_b128 a[136:139], v124 offset:2048
  ds_read_b128 a[140:143], v124 offset:3072
  ds_read_b128 a[144:147], v124 offset:4096
  ds_read_b128 a[148:151], v124 offset:5120
  ds_read_b128 a[152:155], v124 offset:6144
  ds_read_b128 a[156:159], v124 offset:7168
  ds_read_b128 a[160:163], v124 offset:8192
  ds_read_b128 a[164:167], v124 offset:9216
  ds_read_b128 a[168:171], v124 offset:10240
  ds_read_b128 a[172:175], v124 offset:11264
  ds_read_b128 a[176:179], v124 offset:12288
  ds_read_b128 a[180:183], v124 offset:13312
  ds_read_b128 a[184:187], v124 offset:14336
  ds_read_b128 a[188:191], v124 offset:15360
  s_waitcnt lgkmcnt(0)
  v_add_u32 v127, 65536, v3
  v_mov_b32 v125, v127
  s_mov_b32 s38, -16
  v_cmp_lt_i32 s[52:53], s38, v24
  v_cmp_lt_i32 s[54:55], s38, v25
  v_cmp_lt_i32 s[56:57], s38, v26
  v_cmp_lt_i32 s[58:59], s38, v27
  s_mov_b32 s38, 0
  v_cmp_lt_i32 s[60:61], s38, v24
  v_cmp_lt_i32 s[62:63], s38, v25
  v_cmp_lt_i32 s[64:65], s38, v26
  v_cmp_lt_i32 s[66:67], s38, v27
  s_mov_b32 s38, 16
  v_cmp_lt_i32 s[68:69], s38, v24
  v_cmp_lt_i32 s[70:71], s38, v25
  v_cmp_lt_i32 s[72:73], s38, v26
  v_cmp_lt_i32 s[74:75], s38, v27
  s_lshl_b32 s27, s26, 1
  s_add_u32 s27, s27, 2
  s_lshl_b32 s43, s26, 2
  s_add_u32 s43, s43, s3
  s_lshl_b32 s43, s43, 5
  s_cmp_ge_i32 s43, 32
  s_cbranch_scc1 L_q0u_17
  v_cndmask_b32 v80, 0, v28, s[60:61]
  v_cndmask_b32 v81, 0, v28, s[62:63]
  v_cndmask_b32 v82, 0, v28, s[64:65]
  v_cndmask_b32 v83, 0, v28, s[66:67]
  v_cndmask_b32 v84, 0, v28, s[68:69]
  v_cndmask_b32 v85, 0, v28, s[70:71]
  v_cndmask_b32 v86, 0, v28, s[72:73]
  v_cndmask_b32 v87, 0, v28, s[74:75]
  v_cndmask_b32 v88, 0, v28, s[52:53]
  v_cndmask_b32 v89, 0, v28, s[54:55]
  v_cndmask_b32 v90, 0, v28, s[56:57]
  v_cndmask_b32 v91, 0, v28, s[58:59]
  v_cndmask_b32 v92, 0, v28, s[60:61]
  v_cndmask_b32 v93, 0, v28, s[62:63]
  v_cndmask_b32 v94, 0, v28, s[64:65]
  v_cndmask_b32 v95, 0, v28, s[66:67]
  s_branch L_q0d_18
L_q0u_17:
  v_mov_b32 v80, 0
  v_mov_b32 v81, 0
  v_mov_b32 v82, 0
  v_mov_b32 v83, 0
  v_mov_b32 v84, 0
  v_mov_b32 v85, 0
  v_mov_b32 v86, 0
  v_mov_b32 v87, 0
  v_mov_b32 v88, 0
  v_mov_b32 v89, 0
  v_mov_b32 v90, 0
  v_mov_b32 v91, 0
  v_mov_b32 v92, 0
  v_mov_b32 v93, 0
  v_mov_b32 v94, 0
  v_mov_b32 v95, 0
L_q0d_18:
  s_nop 1
  v_mfma_f32_16x16x32_bf16 v[32:35], a[128:131], v[128:131], v[80:83]
  v_mfma_f32_16x16x32_bf16 v[36:39], a[128:131], v[144:147], v[84:87]
  v_mfma_f32_16x16x32_bf16 v[32:35], a[132:135], v[132:135], v[32:35]
  v_mfma_f32_16x16x32_bf16 v[36:39], a[132:135], v[148:151], v[36:39]
  v_mfma_f32_16x16x32_bf16 v[32:35], a[136:139], v[136:139], v[32:35]
  v_mfma_f32_16x16x32_bf16 v[36:39], a[136:139], v[152:155], v[36:39]
  v_mfma_f32_16x16x32_bf16 v[32:35], a[140:143], v[140:143], v[32:35]
  v_mfma_f32_16x16x32_bf16 v[36:39], a[140:143], v[156:159], v[36:39]
  v_mfma_f32_16x16x32_bf16 v[40:43], a[144:147], v[128:131], v[88:91]
  v_mfma_f32_16x16x32_bf16 v[44:47], a[144:147], v[144:147], v[92:95]
  v_mfma_f32_16x16x32_bf16 v[40:43], a[148:151], v[132:135], v[40:43]
  v_mfma_f32_16x16x32_bf16 v[44:47], a[148:151], v[148:151], v[44:47]
  v_mfma_f32_16x16x32_bf16 v[40:43], a[152:155], v[136:139], v[40:43]
  v_mfma_f32_16x16x32_bf16 v[44:47], a[152:155], v[152:155], v[44:47]
  v_mfma_f32_16x16x32_bf16 v[40:43], a[156:159], v[140:143], v[40:43]
  v_mfma_f32_16x16x32_bf16 v[44:47], a[156:159], v[156:159], v[44:47]
  s_sub_u32 s43, s43, 32
L_attn_kernel_pass:
  s_nop 7
  v_max3_f32 v4, v32, v33, v34
  v_max3_f32 v5, v36, v37, v38
  v_max3_f32 v4, v4, v35, v40
  v_max3_f32 v5, v5, v39, v44
  v_max3_f32 v4, v4, v41, v42
  v_max3_f32 v5, v5, v45, v46
  v_max_f32 v4, v4, v43
  v_max_f32 v5, v5, v47
  v_mov_b32 v12, v4
  v_mov_b32 v13, v5
  s_nop 0
  v_permlane16_swap_b32 v4, v12
  v_permlane16_swap_b32 v5, v13
  s_nop 0
  v_max_f32 v4, v4, v12
  v_max_f32 v5, v5, v13
  v_mov_b32 v12, v4
  v_mov_b32 v13, v5
  s_nop 0
  v_permlane32_swap_b32 v4, v12
  v_permlane32_swap_b32 v5, v13
  s_nop 0
  v_max_f32 v4, v4, v12
  v_max_f32 v5, v5, v13
  v_sub_f32 v96, 0, v4
  v_add_f32 v32, v32, v96
  v_add_f32 v33, v33, v96
  v_add_f32 v34, v34, v96
  v_add_f32 v35, v35, v96
  v_add_f32 v40, v40, v96
  v_add_f32 v41, v41, v96
  v_add_f32 v42, v42, v96
  v_add_f32 v43, v43, v96
  v_mov_b32 v80, v96
  v_mov_b32 v81, v96
  v_mov_b32 v82, v96
  v_mov_b32 v83, v96
  v_mov_b32 v88, v96
  v_mov_b32 v89, v96
  v_mov_b32 v90, v96
  v_mov_b32 v91, v96
  v_sub_f32 v97, 0, v5
  v_add_f32 v36, v36, v97
  v_add_f32 v37, v37, v97
  v_add_f32 v38, v38, v97
  v_add_f32 v39, v39, v97
  v_add_f32 v44, v44, v97
  v_add_f32 v45, v45, v97
  v_add_f32 v46, v46, v97
  v_add_f32 v47, v47, v97
  v_mov_b32 v84, v97
  v_mov_b32 v85, v97
  v_mov_b32 v86, v97
  v_mov_b32 v87, v97
  v_mov_b32 v92, v97
  v_mov_b32 v93, v97
  v_mov_b32 v94, v97
  v_mov_b32 v95, v97
  s_cmp_eq_u32 s27, 2
  s_cbranch_scc1 L_attn_kernel_fm
  s_waitcnt vmcnt(19)
  s_barrier
  s_cmp_lg_u32 s41, 1
  s_cbranch_scc1 L_rlsig_19
  s_cmp_lg_u32 s3, 0
  s_cbranch_scc1 L_rlsig_19
  v_mov_b32 v12, 1
  v_lshlrev_b32 v13, 8, v2
  v_mov_b32 v14, 0x4000000
  v_cmp_gt_u32 vcc, 8, v2
  s_nop 1
  v_cndmask_b32 v13, v14, v13, vcc
  s_mov_b32 s38, 315392
  buffer_atomic_add v12, v13, s[16:19], s38 offen sc1
L_rlsig_19:
  s_add_u32 s37, s36, 16384
  s_add_u32 s36, s36, 32768
  s_cmp_eq_u32 s31, s32
  s_cselect_b32 s36, s33, s36
  s_add_u32 m0, s28, s30
  v_add_u32 v124, s51, v3
  s_waitcnt lgkmcnt(0)
  v_mfma_f32_16x16x32_bf16 v[48:51], a[160:163], v[128:131], v[80:83]
  v_exp_f32 v120, v32
  v_exp_f32 v121, v33
  ds_read_b128 a[192:195], v125 offset:0
  v_cvt_pk_bf16_f32 v64, v120, v121
  v_mfma_f32_16x16x32_bf16 v[52:55], a[160:163], v[144:147], v[84:87]
  v_exp_f32 v122, v34
  v_exp_f32 v123, v35
  ds_read_b128 a[196:199], v125 offset:1024
  v_cvt_pk_bf16_f32 v65, v122, v123
  buffer_load_dwordx4 v3, s[16:19], s36 offen offset:0 sc1 lds
  v_mfma_f32_16x16x32_bf16 v[48:51], a[164:167], v[132:135], v[48:51]
  v_exp_f32 v120, v36
  v_exp_f32 v121, v37
  ds_read_b128 a[200:203], v125 offset:2048
  v_cvt_pk_bf16_f32 v68, v120, v121
  v_mfma_f32_16x16x32_bf16 v[52:55], a[164:167], v[148:151], v[52:55]
  v_exp_f32 v122, v38
  v_exp_f32 v123, v39
  ds_read_b128 a[204:207], v125 offset:3072
  v_cvt_pk_bf16_f32 v69, v122, v123
  buffer_load_dwordx4 v3, s[16:19], s36 offen offset:1024 sc1 lds
  v_mfma_f32_16x16x32_bf16 v[48:51], a[168:171], v[136:139], v[48:51]
  v_exp_f32 v120, v40
  v_exp_f32 v121, v41
  ds_read_b128 a[208:211], v125 offset:4096
  v_cvt_pk_bf16_f32 v66, v120, v121
  v_mfma_f32_16x16x32_bf16 v[52:55], a[168:171], v[152:155], v[52:55]
  v_exp_f32 v122, v42
  v_exp_f32 v123, v43
  ds_read_b128 a[212:215], v125 offset:5120
  v_cvt_pk_bf16_f32 v67, v122, v123
  buffer_load_dwordx4 v3, s[16:19], s36 offen offset:2048 sc1 lds
  v_mfma_f32_16x16x32_bf16 v[48:51], a[172:175], v[140:143], v[48:51]
  v_exp_f32 v120, v44
  v_exp_f32 v121, v45
  ds_read_b128 a[216:219], v125 offset:6144
  v_cvt_pk_bf16_f32 v70, v120, v121
  v_mfma_f32_16x16x32_bf16 v[52:55], a[172:175], v[156:159], v[52:55]
  v_exp_f32 v122, v46
  v_exp_f32 v123, v47
  ds_read_b128 a[220:223], v125 offset:7168
  v_cvt_pk_bf16_f32 v71, v122, v123
  buffer_load_dwordx4 v3, s[16:19], s36 offen offset:3072 sc1 lds
  v_mfma_f32_16x16x32_bf16 v[56:59], a[176:179], v[128:131], v[80:83]
  ds_read_b128 a[128:131], v124 offset:0
  v_mfma_f32_16x16x32_bf16 v[60:63], a[176:179], v[144:147], v[84:87]
  ds_read_b128 a[132:135], v124 offset:1024
  v_mfma_f32_16x16x32_bf16 v[100:103], v[116:119], v[64:67], 0
  v_mfma_f32_16x16x32_bf16 v[104:107], v[116:119], v[68:71], 0
  v_mfma_f32_16x16x32_bf16 v[56:59], a[180:183], v[132:135], v[56:59]
  ds_read_b128 a[136:139], v124 offset:2048
  v_mfma_f32_16x16x32_bf16 v[60:63], a[180:183], v[148:151], v[60:63]
  ds_read_b128 a[140:143], v124 offset:3072
  v_mfma_f32_16x16x32_bf16 v[56:59], a[184:187], v[136:139], v[56:59]
  ds_read_b128 a[144:147], v124 offset:4096
  v_mfma_f32_16x16x32_bf16 v[60:63], a[184:187], v[152:155], v[60:63]
  ds_read_b128 a[148:151], v124 offset:5120
  v_mfma_f32_16x16x32_bf16 v[56:59], a[188:191], v[140:143], v[56:59]
  ds_read_b128 a[152:155], v124 offset:6144
  v_mfma_f32_16x16x32_bf16 v[60:63], a[188:191], v[156:159], v[60:63]
  ds_read_b128 a[156:159], v124 offset:7168
  v_max_f32 v120, v100, v104
  v_cmp_lt_f32 vcc, s77, v120
  s_cbranch_vccnz L_rs0_20
L_rb0_21:
  s_waitcnt lgkmcnt(8)
  v_mfma_f32_16x16x32_bf16 v[192:195], a[192:195], v[64:67], 0
  s_add_u32 m0, s78, s29
  v_exp_f32 v120, v48
  v_mfma_f32_16x16x32_bf16 v[200:203], a[192:195], v[68:71], 0
  s_add_u32 s31, s31, 1
  v_exp_f32 v121, v49
  v_mfma_f32_16x16x32_bf16 v[196:199], a[196:199], v[64:67], 0
  ds_read_b128 a[224:227], v125 offset:8192
  v_cvt_pk_bf16_f32 v72, v120, v121
  v_mfma_f32_16x16x32_bf16 v[204:207], a[196:199], v[68:71], 0
  s_mov_b32 s29, s30
  v_exp_f32 v122, v50
  v_mfma_f32_16x16x32_bf16 v[208:211], a[200:203], v[64:67], 0
  s_mov_b32 s30, s51
  v_exp_f32 v123, v51
  v_mfma_f32_16x16x32_bf16 v[216:219], a[200:203], v[68:71], 0
  ds_read_b128 a[228:231], v125 offset:9216
  v_cvt_pk_bf16_f32 v73, v122, v123
  v_mfma_f32_16x16x32_bf16 v[212:215], a[204:207], v[64:67], 0
  s_add_u32 s51, s51, 0x4000
  v_exp_f32 v120, v52
  v_mfma_f32_16x16x32_bf16 v[220:223], a[204:207], v[68:71], 0
  s_and_b32 s51, s51, 0xffff
  v_exp_f32 v121, v53
  v_mfma_f32_16x16x32_bf16 v[224:227], a[208:211], v[64:67], 0
  ds_read_b128 a[232:235], v125 offset:10240
  v_cvt_pk_bf16_f32 v76, v120, v121
  v_mfma_f32_16x16x32_bf16 v[232:235], a[208:211], v[68:71], 0
  v_exp_f32 v122, v54
  v_mfma_f32_16x16x32_bf16 v[228:231], a[212:215], v[64:67], 0
  v_exp_f32 v123, v55
  v_mfma_f32_16x16x32_bf16 v[236:239], a[212:215], v[68:71], 0
  ds_read_b128 a[236:239], v125 offset:11264
  v_cvt_pk_bf16_f32 v77, v122, v123
  v_mfma_f32_16x16x32_bf16 v[240:243], a[216:219], v[64:67], 0
  v_exp_f32 v120, v56
  v_mfma_f32_16x16x32_bf16 v[248:251], a[216:219], v[68:71], 0
  v_exp_f32 v121, v57
  v_mfma_f32_16x16x32_bf16 v[244:247], a[220:223], v[64:67], 0
  ds_read_b128 a[240:243], v125 offset:12288
  v_cvt_pk_bf16_f32 v74, v120, v121
  v_mfma_f32_16x16x32_bf16 v[252:255], a[220:223], v[68:71], 0
  s_waitcnt lgkmcnt(5)
  v_exp_f32 v122, v58
  v_mfma_f32_16x16x32_bf16 v[32:35], a[128:131], v[128:131], v[80:83]
  v_exp_f32 v123, v59
  v_mfma_f32_16x16x32_bf16 v[36:39], a[128:131], v[144:147], v[84:87]
  ds_read_b128 a[244:247], v125 offset:13312
  v_cvt_pk_bf16_f32 v75, v122, v123
  v_mfma_f32_16x16x32_bf16 v[32:35], a[132:135], v[132:135], v[32:35]
  v_exp_f32 v120, v60
  v_mfma_f32_16x16x32_bf16 v[36:39], a[132:135], v[148:151], v[36:39]
  v_exp_f32 v121, v61
  v_mfma_f32_16x16x32_bf16 v[32:35], a[136:139], v[136:139], v[32:35]
  ds_read_b128 a[248:251], v125 offset:14336
  v_cvt_pk_bf16_f32 v78, v120, v121
  v_mfma_f32_16x16x32_bf16 v[36:39], a[136:139], v[152:155], v[36:39]
  v_exp_f32 v122, v62
  v_mfma_f32_16x16x32_bf16 v[32:35], a[140:143], v[140:143], v[32:35]
  v_exp_f32 v123, v63
  v_mfma_f32_16x16x32_bf16 v[36:39], a[140:143], v[156:159], v[36:39]
  ds_read_b128 a[252:255], v125 offset:15360
  v_cvt_pk_bf16_f32 v79, v122, v123
  v_mfma_f32_16x16x32_bf16 v[40:43], a[144:147], v[128:131], v[80:83]
  ds_read_b128 a[160:163], v124 offset:8192
  v_add_u32 v125, s30, v127
  v_mfma_f32_16x16x32_bf16 v[44:47], a[144:147], v[144:147], v[84:87]
  buffer_load_dwordx4 v3, s[16:19], s37 offen offset:0 sc1 lds
  v_mfma_f32_16x16x32_bf16 v[108:111], v[116:119], v[72:75], v[100:103]
  ds_read_b128 a[164:167], v124 offset:9216
  ds_read_b128 a[168:171], v124 offset:10240
  v_mfma_f32_16x16x32_bf16 v[112:115], v[116:119], v[76:79], v[104:107]
  buffer_load_dwordx4 v3, s[16:19], s37 offen offset:1024 sc1 lds
  v_mfma_f32_16x16x32_bf16 v[40:43], a[148:151], v[132:135], v[40:43]
  ds_read_b128 a[172:175], v124 offset:11264
  ds_read_b128 a[176:179], v124 offset:12288
  v_mfma_f32_16x16x32_bf16 v[44:47], a[148:151], v[148:151], v[44:47]
  buffer_load_dwordx4 v3, s[16:19], s37 offen offset:2048 sc1 lds
  v_mfma_f32_16x16x32_bf16 v[40:43], a[152:155], v[136:139], v[40:43]
  ds_read_b128 a[180:183], v124 offset:13312
  ds_read_b128 a[184:187], v124 offset:14336
  v_mfma_f32_16x16x32_bf16 v[44:47], a[152:155], v[152:155], v[44:47]
  buffer_load_dwordx4 v3, s[16:19], s37 offen offset:3072 sc1 lds
  s_mov_b32 m0, s46
  v_max_f32 v120, v108, v112
  v_mfma_f32_16x16x32_bf16 v[40:43], a[156:159], v[140:143], v[40:43]
  buffer_load_dwordx4 v30, s[80:83], s79 offen lds
  ds_read_b128 a[188:191], v124 offset:15360
  v_cmp_lt_f32 vcc, s77, v120
  v_mfma_f32_16x16x32_bf16 v[44:47], a[156:159], v[156:159], v[44:47]
  s_cbranch_vccnz L_rs1_22
L_rb1_23:
  s_sub_u32 s49, s27, 4
L_attn_kernel_disp:
  s_cmp_eq_u32 s48, 1
  s_cbranch_scc1 L_seg_25
  s_cmp_eq_u32 s48, 2
  s_cbranch_scc1 L_seg_26
  s_cmp_eq_u32 s48, 3
  s_cbranch_scc1 L_seg3a_28
  s_cmp_ge_u32 s48, 3
  s_cbranch_scc1 L_seg_27
  s_lshl_b32 s38, s2, 2
  s_add_u32 s38, s38, s3
  s_cmp_ge_u32 s38, 512
  s_cselect_b32 s80, s90, s88
  s_cselect_b32 s81, s91, s89
  s_and_b32 s81, s81, 0xffff
  s_mov_b32 s82, 1835008
  s_and_b32 s38, s38, 511
  s_lshr_b32 s79, s38, 1
  s_lshl_b32 s79, s79, 13
  s_and_b32 s38, s38, 1
  s_lshl_b32 s38, s38, 9
  s_add_u32 s79, s79, s38
  s_sub_u32 s79, s79, 128
  s_mov_b32 s47, 128
  s_lshl_b32 s46, s3, 13
  s_add_u32 s46, s46, 130048
  s_branch L_seg_24
L_seg_25:
  s_lshl_b32 s38, s2, 2
  s_add_u32 s38, s38, s3
  s_mov_b32 s80, s84
  s_and_b32 s81, s85, 0xffff
  s_mov_b32 s82, 4194304
  s_lshr_b32 s79, s38, 3
  s_lshl_b32 s79, s79, 15
  s_and_b32 s38, s38, 7
  s_lshl_b32 s38, s38, 7
  s_add_u32 s79, s79, s38
  s_sub_u32 s79, s79, 8192
  s_mov_b32 s47, 8192
  s_lshl_b32 s46, s3, 13
  s_add_u32 s46, s46, 130048
  s_branch L_seg_24
L_seg_26:
  s_lshl_b32 s38, s2, 2
  s_add_u32 s38, s38, s3
  s_mov_b32 s80, s86
  s_and_b32 s81, s87, 0xffff
  s_mov_b32 s82, 1835008
  s_lshr_b32 s79, s38, 3
  s_lshl_b32 s79, s79, 15
  s_and_b32 s38, s38, 7
  s_lshl_b32 s38, s38, 7
  s_add_u32 s79, s79, s38
  s_sub_u32 s79, s79, 8192
  s_mov_b32 s47, 8192
  s_lshl_b32 s46, s3, 13
  s_add_u32 s46, s46, 134144
L_seg_24:
  s_add_u32 s48, s48, 1
  s_mov_b32 s35, 4
  s_sub_u32 s49, s49, 4
  s_branch L_attn_kernel_fast
L_seg3a_28:
  s_mov_b32 s82, 0
  s_mov_b32 s46, 0x28000
  s_mov_b32 s47, 0
  s_mov_b32 s48, 4
  s_mov_b32 s35, 2
  s_sub_u32 s49, s49, 2
  s_branch L_attn_kernel_fast
L_seg_27:
  s_cmp_lg_u32 s41, 0
  s_cbranch_scc1 L_nr_29
  s_waitcnt vmcnt(18)
  v_lshrrev_b32 v12, 4, v2
  v_bfe_u32 v13, v2, 2, 2
  v_and_b32 v14, 3, v2
  v_lshl_add_u32 v15, v12, 2, v13
  v_bfe_u32 v16, v15, 1, 2
  v_lshlrev_b32 v16, 5, v16
  v_lshlrev_b32 v15, 7, v15
  v_lshl_add_u32 v15, v14, 3, v15
  s_lshl_b32 s40, s3, 13
  s_add_u32 s40, s40, 131072
  v_add_u32 v15, s40, v15
  v_xor_b32 v12, 0, v16
  v_add_u32 v17, v15, v12
  v_xor_b32 v12, 32, v16
  v_add_u32 v18, v15, v12
  v_xor_b32 v12, 64, v16
  v_add_u32 v19, v15, v12
  v_xor_b32 v12, 96, v16
  v_add_u32 v20, v15, v12
  ds_read_b64_tr_b16 a[0:1], v17 offset:0
  ds_read_b64_tr_b16 a[2:3], v17 offset:2048
  ds_read_b64_tr_b16 a[4:5], v18 offset:0
  ds_read_b64_tr_b16 a[6:7], v18 offset:2048
  ds_read_b64_tr_b16 a[8:9], v19 offset:0
  ds_read_b64_tr_b16 a[10:11], v19 offset:2048
  ds_read_b64_tr_b16 a[12:13], v20 offset:0
  ds_read_b64_tr_b16 a[14:15], v20 offset:2048
  ds_read_b64_tr_b16 a[16:17], v17 offset:4096
  ds_read_b64_tr_b16 a[18:19], v17 offset:6144
  ds_read_b64_tr_b16 a[20:21], v18 offset:4096
  ds_read_b64_tr_b16 a[22:23], v18 offset:6144
  ds_read_b64_tr_b16 a[24:25], v19 offset:4096
  ds_read_b64_tr_b16 a[26:27], v19 offset:6144
  ds_read_b64_tr_b16 a[28:29], v20 offset:4096
  ds_read_b64_tr_b16 a[30:31], v20 offset:6144
  s_lshl_b32 s40, s2, 2
  s_add_u32 s40, s40, s3
  s_and_b32 s86, s40, 7
  s_lshr_b32 s87, s40, 3
  s_lshl_b32 s84, s86, 7
  s_add_u32 s84, s84, s87
  s_lshl_b32 s84, s84, 12
  s_add_u32 s84, s84, 0x400000
  s_mul_i32 s85, s86, 56
  s_add_u32 s85, s85, s87
  s_lshl_b32 s85, s85, 12
  s_add_u32 s85, s85, 0x800000
  s_cmp_ge_u32 s40, 448
  s_cselect_b32 s85, 0x4000000, s85
  s_waitcnt lgkmcnt(0)
  buffer_store_dwordx4 a[0:3], v3, s[16:19], s84 offen offset:0 sc1
  buffer_store_dwordx4 a[4:7], v3, s[16:19], s84 offen offset:1024 sc1
  buffer_store_dwordx4 a[8:11], v3, s[16:19], s84 offen offset:2048 sc1
  buffer_store_dwordx4 a[12:15], v3, s[16:19], s84 offen offset:3072 sc1
  buffer_store_dwordx4 a[16:19], v3, s[16:19], s85 offen offset:0 sc1
  buffer_store_dwordx4 a[20:23], v3, s[16:19], s85 offen offset:1024 sc1
  buffer_store_dwordx4 a[24:27], v3, s[16:19], s85 offen offset:2048 sc1
  buffer_store_dwordx4 a[28:31], v3, s[16:19], s85 offen offset:3072 sc1
L_nr_29:
  s_mov_b32 s82, 0
  s_mov_b32 s46, 0x28000
  s_mov_b32 s47, 0
  s_cmp_eq_u32 s49, 0
  s_cbranch_scc1 L_attn_kernel_m_pre
  s_mov_b32 s35, s49
  s_mov_b32 s49, 0
.p2align 6
L_attn_kernel_fast:
  s_waitcnt lgkmcnt(8)
  v_mfma_f32_16x16x32_bf16 v[192:195], a[224:227], v[72:75], v[192:195]
  s_waitcnt vmcnt(19)
  s_barrier
  v_exp_f32 v120, v32
  v_mfma_f32_16x16x32_bf16 v[200:203], a[224:227], v[76:79], v[200:203]
  s_add_u32 s37, s36, 16384
  v_exp_f32 v121, v33
  v_mfma_f32_16x16x32_bf16 v[196:199], a[228:231], v[72:75], v[196:199]
  ds_read_b128 a[192:195], v125 offset:0
  v_cvt_pk_bf16_f32 v64, v120, v121
  v_mfma_f32_16x16x32_bf16 v[204:207], a[228:231], v[76:79], v[204:207]
  s_add_u32 s36, s36, 32768
  v_exp_f32 v122, v34
  v_mfma_f32_16x16x32_bf16 v[208:211], a[232:235], v[72:75], v[208:211]
  s_cmp_eq_u32 s31, s32
  v_exp_f32 v123, v35
  v_mfma_f32_16x16x32_bf16 v[216:219], a[232:235], v[76:79], v[216:219]
  ds_read_b128 a[196:199], v125 offset:1024
  v_cvt_pk_bf16_f32 v65, v122, v123
  v_mfma_f32_16x16x32_bf16 v[212:215], a[236:239], v[72:75], v[212:215]
  s_cselect_b32 s36, s33, s36
  v_exp_f32 v120, v36
  v_mfma_f32_16x16x32_bf16 v[220:223], a[236:239], v[76:79], v[220:223]
  s_add_u32 m0, s28, s30
  v_exp_f32 v121, v37
  v_mfma_f32_16x16x32_bf16 v[224:227], a[240:243], v[72:75], v[224:227]
  ds_read_b128 a[200:203], v125 offset:2048
  v_cvt_pk_bf16_f32 v68, v120, v121
  v_mfma_f32_16x16x32_bf16 v[232:235], a[240:243], v[76:79], v[232:235]
  s_add_u32 s79, s79, s47
  v_exp_f32 v122, v38
  v_mfma_f32_16x16x32_bf16 v[228:231], a[244:247], v[72:75], v[228:231]
  s_add_u32 s46, s46, 1024
  v_exp_f32 v123, v39
  v_mfma_f32_16x16x32_bf16 v[236:239], a[244:247], v[76:79], v[236:239]
  ds_read_b128 a[204:207], v125 offset:3072
  v_cvt_pk_bf16_f32 v69, v122, v123
  v_mfma_f32_16x16x32_bf16 v[240:243], a[248:251], v[72:75], v[240:243]
  v_exp_f32 v120, v40
  v_mfma_f32_16x16x32_bf16 v[248:251], a[248:251], v[76:79], v[248:251]
  v_exp_f32 v121, v41
  v_mfma_f32_16x16x32_bf16 v[244:247], a[252:255], v[72:75], v[244:247]
  ds_read_b128 a[208:211], v125 offset:4096
  v_cvt_pk_bf16_f32 v66, v120, v121
  v_mfma_f32_16x16x32_bf16 v[252:255], a[252:255], v[76:79], v[252:255]
  s_waitcnt lgkmcnt(5)
  v_exp_f32 v122, v42
  v_mfma_f32_16x16x32_bf16 v[48:51], a[160:163], v[128:131], v[80:83]
  v_exp_f32 v123, v43
  v_mfma_f32_16x16x32_bf16 v[52:55], a[160:163], v[144:147], v[84:87]
  ds_read_b128 a[212:215], v125 offset:5120
  v_cvt_pk_bf16_f32 v67, v122, v123
  v_mfma_f32_16x16x32_bf16 v[48:51], a[164:167], v[132:135], v[48:51]
  v_exp_f32 v120, v44
  v_mfma_f32_16x16x32_bf16 v[52:55], a[164:167], v[148:151], v[52:55]
  v_exp_f32 v121, v45
  v_mfma_f32_16x16x32_bf16 v[48:51], a[168:171], v[136:139], v[48:51]
  ds_read_b128 a[216:219], v125 offset:6144
  v_cvt_pk_bf16_f32 v70, v120, v121
  v_mfma_f32_16x16x32_bf16 v[52:55], a[168:171], v[152:155], v[52:55]
  v_exp_f32 v122, v46
  v_mfma_f32_16x16x32_bf16 v[48:51], a[172:175], v[140:143], v[48:51]
  v_exp_f32 v123, v47
  v_mfma_f32_16x16x32_bf16 v[52:55], a[172:175], v[156:159], v[52:55]
  ds_read_b128 a[220:223], v125 offset:7168
  v_cvt_pk_bf16_f32 v71, v122, v123
  v_add_u32 v124, s51, v3
  v_mfma_f32_16x16x32_bf16 v[56:59], a[176:179], v[128:131], v[80:83]
  ds_read_b128 a[128:131], v124 offset:0
  v_mfma_f32_16x16x32_bf16 v[60:63], a[176:179], v[144:147], v[84:87]
  buffer_load_dwordx4 v3, s[16:19], s36 offen offset:0 sc1 lds
  v_mfma_f32_16x16x32_bf16 v[100:103], v[116:119], v[64:67], v[108:111]
  ds_read_b128 a[132:135], v124 offset:1024
  ds_read_b128 a[136:139], v124 offset:2048
  v_mfma_f32_16x16x32_bf16 v[104:107], v[116:119], v[68:71], v[112:115]
  buffer_load_dwordx4 v3, s[16:19], s36 offen offset:1024 sc1 lds
  v_mfma_f32_16x16x32_bf16 v[56:59], a[180:183], v[132:135], v[56:59]
  ds_read_b128 a[140:143], v124 offset:3072
  ds_read_b128 a[144:147], v124 offset:4096
  v_mfma_f32_16x16x32_bf16 v[60:63], a[180:183], v[148:151], v[60:63]
  buffer_load_dwordx4 v3, s[16:19], s36 offen offset:2048 sc1 lds
  v_mfma_f32_16x16x32_bf16 v[56:59], a[184:187], v[136:139], v[56:59]
  ds_read_b128 a[148:151], v124 offset:5120
  v_mfma_f32_16x16x32_bf16 v[60:63], a[184:187], v[152:155], v[60:63]
  ds_read_b128 a[152:155], v124 offset:6144
  v_max_f32 v120, v100, v104
  v_mfma_f32_16x16x32_bf16 v[56:59], a[188:191], v[140:143], v[56:59]
  ds_read_b128 a[156:159], v124 offset:7168
  v_cmp_lt_f32 vcc, s77, v120
  v_mfma_f32_16x16x32_bf16 v[60:63], a[188:191], v[156:159], v[60:63]
  s_cbranch_vccnz L_rs0_30
L_rb0_31:
  buffer_load_dwordx4 v3, s[16:19], s36 offen offset:3072 sc1 lds
  s_waitcnt lgkmcnt(8)
  v_mfma_f32_16x16x32_bf16 v[192:195], a[192:195], v[64:67], v[192:195]
  s_add_u32 m0, s78, s29
  v_exp_f32 v120, v48
  v_mfma_f32_16x16x32_bf16 v[200:203], a[192:195], v[68:71], v[200:203]
  s_add_u32 s31, s31, 1
  v_exp_f32 v121, v49
  v_mfma_f32_16x16x32_bf16 v[196:199], a[196:199], v[64:67], v[196:199]
  ds_read_b128 a[224:227], v125 offset:8192
  v_cvt_pk_bf16_f32 v72, v120, v121
  v_mfma_f32_16x16x32_bf16 v[204:207], a[196:199], v[68:71], v[204:207]
  s_mov_b32 s29, s30
  v_exp_f32 v122, v50
  v_mfma_f32_16x16x32_bf16 v[208:211], a[200:203], v[64:67], v[208:211]
  s_mov_b32 s30, s51
  v_exp_f32 v123, v51
  v_mfma_f32_16x16x32_bf16 v[216:219], a[200:203], v[68:71], v[216:219]
  ds_read_b128 a[228:231], v125 offset:9216
  v_cvt_pk_bf16_f32 v73, v122, v123
  v_mfma_f32_16x16x32_bf16 v[212:215], a[204:207], v[64:67], v[212:215]
  s_add_u32 s51, s51, 0x4000
  v_exp_f32 v120, v52
  v_mfma_f32_16x16x32_bf16 v[220:223], a[204:207], v[68:71], v[220:223]
  s_and_b32 s51, s51, 0xffff
  v_exp_f32 v121, v53
  v_mfma_f32_16x16x32_bf16 v[224:227], a[208:211], v[64:67], v[224:227]
  ds_read_b128 a[232:235], v125 offset:10240
  v_cvt_pk_bf16_f32 v76, v120, v121
  v_mfma_f32_16x16x32_bf16 v[232:235], a[208:211], v[68:71], v[232:235]
  v_exp_f32 v122, v54
  v_mfma_f32_16x16x32_bf16 v[228:231], a[212:215], v[64:67], v[228:231]
  v_exp_f32 v123, v55
  v_mfma_f32_16x16x32_bf16 v[236:239], a[212:215], v[68:71], v[236:239]
  ds_read_b128 a[236:239], v125 offset:11264
  v_cvt_pk_bf16_f32 v77, v122, v123
  v_mfma_f32_16x16x32_bf16 v[240:243], a[216:219], v[64:67], v[240:243]
  v_exp_f32 v120, v56
  v_mfma_f32_16x16x32_bf16 v[248:251], a[216:219], v[68:71], v[248:251]
  v_exp_f32 v121, v57
  v_mfma_f32_16x16x32_bf16 v[244:247], a[220:223], v[64:67], v[244:247]
  ds_read_b128 a[240:243], v125 offset:12288
  v_cvt_pk_bf16_f32 v74, v120, v121
  v_mfma_f32_16x16x32_bf16 v[252:255], a[220:223], v[68:71], v[252:255]
  s_waitcnt lgkmcnt(5)
  v_exp_f32 v122, v58
  v_mfma_f32_16x16x32_bf16 v[32:35], a[128:131], v[128:131], v[80:83]
  v_exp_f32 v123, v59
  v_mfma_f32_16x16x32_bf16 v[36:39], a[128:131], v[144:147], v[84:87]
  ds_read_b128 a[244:247], v125 offset:13312
  v_cvt_pk_bf16_f32 v75, v122, v123
  v_mfma_f32_16x16x32_bf16 v[32:35], a[132:135], v[132:135], v[32:35]
  s_sub_u32 s35, s35, 1
  v_exp_f32 v120, v60
  v_mfma_f32_16x16x32_bf16 v[36:39], a[132:135], v[148:151], v[36:39]
  s_cmp_lg_u32 s35, 0
  v_exp_f32 v121, v61
  v_mfma_f32_16x16x32_bf16 v[32:35], a[136:139], v[136:139], v[32:35]
  ds_read_b128 a[248:251], v125 offset:14336
  v_cvt_pk_bf16_f32 v78, v120, v121
  v_mfma_f32_16x16x32_bf16 v[36:39], a[136:139], v[152:155], v[36:39]
  v_exp_f32 v122, v62
  v_mfma_f32_16x16x32_bf16 v[32:35], a[140:143], v[140:143], v[32:35]
  v_exp_f32 v123, v63
  v_mfma_f32_16x16x32_bf16 v[36:39], a[140:143], v[156:159], v[36:39]
  ds_read_b128 a[252:255], v125 offset:15360
  v_cvt_pk_bf16_f32 v79, v122, v123
  v_mfma_f32_16x16x32_bf16 v[40:43], a[144:147], v[128:131], v[80:83]
  ds_read_b128 a[160:163], v124 offset:8192
  v_add_u32 v125, s30, v127
  v_mfma_f32_16x16x32_bf16 v[44:47], a[144:147], v[144:147], v[84:87]
  buffer_load_dwordx4 v3, s[16:19], s37 offen offset:0 sc1 lds
  v_mfma_f32_16x16x32_bf16 v[108:111], v[116:119], v[72:75], v[100:103]
  ds_read_b128 a[164:167], v124 offset:9216
  ds_read_b128 a[168:171], v124 offset:10240
  v_mfma_f32_16x16x32_bf16 v[112:115], v[116:119], v[76:79], v[104:107]
  buffer_load_dwordx4 v3, s[16:19], s37 offen offset:1024 sc1 lds
  v_mfma_f32_16x16x32_bf16 v[40:43], a[148:151], v[132:135], v[40:43]
  ds_read_b128 a[172:175], v124 offset:11264
  ds_read_b128 a[176:179], v124 offset:12288
  v_mfma_f32_16x16x32_bf16 v[44:47], a[148:151], v[148:151], v[44:47]
  buffer_load_dwordx4 v3, s[16:19], s37 offen offset:2048 sc1 lds
  v_mfma_f32_16x16x32_bf16 v[40:43], a[152:155], v[136:139], v[40:43]
  ds_read_b128 a[180:183], v124 offset:13312
  ds_read_b128 a[184:187], v124 offset:14336
  v_mfma_f32_16x16x32_bf16 v[44:47], a[152:155], v[152:155], v[44:47]
  buffer_load_dwordx4 v3, s[16:19], s37 offen offset:3072 sc1 lds
  s_mov_b32 m0, s46
  v_max_f32 v120, v108, v112
  v_mfma_f32_16x16x32_bf16 v[40:43], a[156:159], v[140:143], v[40:43]
  buffer_load_dwordx4 v30, s[80:83], s79 offen lds
  ds_read_b128 a[188:191], v124 offset:15360
  v_cmp_lt_f32 vcc, s77, v120
  v_mfma_f32_16x16x32_bf16 v[44:47], a[156:159], v[156:159], v[44:47]
  s_cbranch_vccnz L_rs1_32
L_rb1_33:
  s_cbranch_scc1 L_attn_kernel_fast
  s_branch L_attn_kernel_disp
L_attn_kernel_m_pre:
  s_mov_b32 s35, 2
  s_lshl_b32 s43, s3, 5
  s_add_u32 s43, s43, 32
.p2align 6
L_attn_kernel_m:
  s_waitcnt lgkmcnt(8)
  s_cmp_ge_i32 s43, 32
  s_cbranch_scc1 L_mk_34
  s_cmp_lt_i32 s43, 0
  s_cbranch_scc1 L_mf_35
  v_cndmask_b32 v80, v96, v28, s[60:61]
  v_cndmask_b32 v81, v96, v28, s[62:63]
  v_cndmask_b32 v82, v96, v28, s[64:65]
  v_cndmask_b32 v83, v96, v28, s[66:67]
  v_cndmask_b32 v92, v97, v28, s[60:61]
  v_cndmask_b32 v93, v97, v28, s[62:63]
  v_cndmask_b32 v94, v97, v28, s[64:65]
  v_cndmask_b32 v95, v97, v28, s[66:67]
  v_mov_b32 v88, v28
  v_mov_b32 v89, v28
  v_mov_b32 v90, v28
  v_mov_b32 v91, v28
  s_branch L_mk_34
L_mf_35:
  v_mov_b32 v80, v28
  v_mov_b32 v81, v28
  v_mov_b32 v82, v28
  v_mov_b32 v83, v28
  v_mov_b32 v84, v28
  v_mov_b32 v85, v28
  v_mov_b32 v86, v28
  v_mov_b32 v87, v28
  v_mov_b32 v88, v28
  v_mov_b32 v89, v28
  v_mov_b32 v90, v28
  v_mov_b32 v91, v28
  v_mov_b32 v92, v28
  v_mov_b32 v93, v28
  v_mov_b32 v94, v28
  v_mov_b32 v95, v28
L_mk_34:
  s_sub_u32 s43, s43, 32
  v_mfma_f32_16x16x32_bf16 v[192:195], a[224:227], v[72:75], v[192:195]
  s_waitcnt vmcnt(19)
  s_barrier
  v_exp_f32 v120, v32
  v_mfma_f32_16x16x32_bf16 v[200:203], a[224:227], v[76:79], v[200:203]
  s_add_u32 s37, s36, 16384
  v_exp_f32 v121, v33
  v_mfma_f32_16x16x32_bf16 v[196:199], a[228:231], v[72:75], v[196:199]
  ds_read_b128 a[192:195], v125 offset:0
  v_cvt_pk_bf16_f32 v64, v120, v121
  v_mfma_f32_16x16x32_bf16 v[204:207], a[228:231], v[76:79], v[204:207]
  s_add_u32 s36, s36, 32768
  v_exp_f32 v122, v34
  v_mfma_f32_16x16x32_bf16 v[208:211], a[232:235], v[72:75], v[208:211]
  s_cmp_eq_u32 s31, s32
  v_exp_f32 v123, v35
  v_mfma_f32_16x16x32_bf16 v[216:219], a[232:235], v[76:79], v[216:219]
  ds_read_b128 a[196:199], v125 offset:1024
  v_cvt_pk_bf16_f32 v65, v122, v123
  v_mfma_f32_16x16x32_bf16 v[212:215], a[236:239], v[72:75], v[212:215]
  s_cselect_b32 s36, s33, s36
  v_exp_f32 v120, v36
  v_mfma_f32_16x16x32_bf16 v[220:223], a[236:239], v[76:79], v[220:223]
  s_add_u32 m0, s28, s30
  v_exp_f32 v121, v37
  v_mfma_f32_16x16x32_bf16 v[224:227], a[240:243], v[72:75], v[224:227]
  ds_read_b128 a[200:203], v125 offset:2048
  v_cvt_pk_bf16_f32 v68, v120, v121
  v_mfma_f32_16x16x32_bf16 v[232:235], a[240:243], v[76:79], v[232:235]
  s_add_u32 s79, s79, s47
  v_exp_f32 v122, v38
  v_mfma_f32_16x16x32_bf16 v[228:231], a[244:247], v[72:75], v[228:231]
  s_add_u32 s46, s46, 1024
  v_exp_f32 v123, v39
  v_mfma_f32_16x16x32_bf16 v[236:239], a[244:247], v[76:79], v[236:239]
  ds_read_b128 a[204:207], v125 offset:3072
  v_cvt_pk_bf16_f32 v69, v122, v123
  v_mfma_f32_16x16x32_bf16 v[240:243], a[248:251], v[72:75], v[240:243]
  v_exp_f32 v120, v40
  v_mfma_f32_16x16x32_bf16 v[248:251], a[248:251], v[76:79], v[248:251]
  v_exp_f32 v121, v41
  v_mfma_f32_16x16x32_bf16 v[244:247], a[252:255], v[72:75], v[244:247]
  ds_read_b128 a[208:211], v125 offset:4096
  v_cvt_pk_bf16_f32 v66, v120, v121
  v_mfma_f32_16x16x32_bf16 v[252:255], a[252:255], v[76:79], v[252:255]
  s_waitcnt lgkmcnt(5)
  v_exp_f32 v122, v42
  v_mfma_f32_16x16x32_bf16 v[48:51], a[160:163], v[128:131], v[80:83]
  v_exp_f32 v123, v43
  v_mfma_f32_16x16x32_bf16 v[52:55], a[160:163], v[144:147], v[84:87]
  ds_read_b128 a[212:215], v125 offset:5120
  v_cvt_pk_bf16_f32 v67, v122, v123
  v_mfma_f32_16x16x32_bf16 v[48:51], a[164:167], v[132:135], v[48:51]
  v_exp_f32 v120, v44
  v_mfma_f32_16x16x32_bf16 v[52:55], a[164:167], v[148:151], v[52:55]
  v_exp_f32 v121, v45
  v_mfma_f32_16x16x32_bf16 v[48:51], a[168:171], v[136:139], v[48:51]
  ds_read_b128 a[216:219], v125 offset:6144
  v_cvt_pk_bf16_f32 v70, v120, v121
  v_mfma_f32_16x16x32_bf16 v[52:55], a[168:171], v[152:155], v[52:55]
  v_exp_f32 v122, v46
  v_mfma_f32_16x16x32_bf16 v[48:51], a[172:175], v[140:143], v[48:51]
  v_exp_f32 v123, v47
  v_mfma_f32_16x16x32_bf16 v[52:55], a[172:175], v[156:159], v[52:55]
  ds_read_b128 a[220:223], v125 offset:7168
  v_cvt_pk_bf16_f32 v71, v122, v123
  v_add_u32 v124, s51, v3
  v_mfma_f32_16x16x32_bf16 v[56:59], a[176:179], v[128:131], v[88:91]
  ds_read_b128 a[128:131], v124 offset:0
  v_mfma_f32_16x16x32_bf16 v[60:63], a[176:179], v[144:147], v[92:95]
  buffer_load_dwordx4 v3, s[16:19], s36 offen offset:0 sc1 lds
  v_mfma_f32_16x16x32_bf16 v[100:103], v[116:119], v[64:67], v[108:111]
  ds_read_b128 a[132:135], v124 offset:1024
  ds_read_b128 a[136:139], v124 offset:2048
  v_mfma_f32_16x16x32_bf16 v[104:107], v[116:119], v[68:71], v[112:115]
  buffer_load_dwordx4 v3, s[16:19], s36 offen offset:1024 sc1 lds
  v_mfma_f32_16x16x32_bf16 v[56:59], a[180:183], v[132:135], v[56:59]
  ds_read_b128 a[140:143], v124 offset:3072
  ds_read_b128 a[144:147], v124 offset:4096
  v_mfma_f32_16x16x32_bf16 v[60:63], a[180:183], v[148:151], v[60:63]
  buffer_load_dwordx4 v3, s[16:19], s36 offen offset:2048 sc1 lds
  v_mfma_f32_16x16x32_bf16 v[56:59], a[184:187], v[136:139], v[56:59]
  ds_read_b128 a[148:151], v124 offset:5120
  v_mfma_f32_16x16x32_bf16 v[60:63], a[184:187], v[152:155], v[60:63]
  ds_read_b128 a[152:155], v124 offset:6144
  v_max_f32 v120, v100, v104
  v_mfma_f32_16x16x32_bf16 v[56:59], a[188:191], v[140:143], v[56:59]
  ds_read_b128 a[156:159], v124 offset:7168
  v_cmp_lt_f32 vcc, s77, v120
  v_mfma_f32_16x16x32_bf16 v[60:63], a[188:191], v[156:159], v[60:63]
  s_cbranch_vccnz L_rs0_36
L_rb0_37:
  buffer_load_dwordx4 v3, s[16:19], s36 offen offset:3072 sc1 lds
  s_waitcnt lgkmcnt(8)
  s_cmp_ge_i32 s43, 32
  s_cbranch_scc1 L_mk_38
  s_cmp_lt_i32 s43, 0
  s_cbranch_scc1 L_mf_39
  v_cndmask_b32 v80, v96, v28, s[60:61]
  v_cndmask_b32 v81, v96, v28, s[62:63]
  v_cndmask_b32 v82, v96, v28, s[64:65]
  v_cndmask_b32 v83, v96, v28, s[66:67]
  v_cndmask_b32 v92, v97, v28, s[60:61]
  v_cndmask_b32 v93, v97, v28, s[62:63]
  v_cndmask_b32 v94, v97, v28, s[64:65]
  v_cndmask_b32 v95, v97, v28, s[66:67]
  v_mov_b32 v88, v28
  v_mov_b32 v89, v28
  v_mov_b32 v90, v28
  v_mov_b32 v91, v28
  s_branch L_mk_38
L_mf_39:
  v_mov_b32 v80, v28
  v_mov_b32 v81, v28
  v_mov_b32 v82, v28
  v_mov_b32 v83, v28
  v_mov_b32 v84, v28
  v_mov_b32 v85, v28
  v_mov_b32 v86, v28
  v_mov_b32 v87, v28
  v_mov_b32 v88, v28
  v_mov_b32 v89, v28
  v_mov_b32 v90, v28
  v_mov_b32 v91, v28
  v_mov_b32 v92, v28
  v_mov_b32 v93, v28
  v_mov_b32 v94, v28
  v_mov_b32 v95, v28
L_mk_38:
  s_sub_u32 s43, s43, 32
  v_mfma_f32_16x16x32_bf16 v[192:195], a[192:195], v[64:67], v[192:195]
  s_add_u32 m0, s78, s29
  v_exp_f32 v120, v48
  v_mfma_f32_16x16x32_bf16 v[200:203], a[192:195], v[68:71], v[200:203]
  s_add_u32 s31, s31, 1
  v_exp_f32 v121, v49
  v_mfma_f32_16x16x32_bf16 v[196:199], a[196:199], v[64:67], v[196:199]
  ds_read_b128 a[224:227], v125 offset:8192
  v_cvt_pk_bf16_f32 v72, v120, v121
  v_mfma_f32_16x16x32_bf16 v[204:207], a[196:199], v[68:71], v[204:207]
  s_mov_b32 s29, s30
  v_exp_f32 v122, v50
  v_mfma_f32_16x16x32_bf16 v[208:211], a[200:203], v[64:67], v[208:211]
  s_mov_b32 s30, s51
  v_exp_f32 v123, v51
  v_mfma_f32_16x16x32_bf16 v[216:219], a[200:203], v[68:71], v[216:219]
  ds_read_b128 a[228:231], v125 offset:9216
  v_cvt_pk_bf16_f32 v73, v122, v123
  v_mfma_f32_16x16x32_bf16 v[212:215], a[204:207], v[64:67], v[212:215]
  s_add_u32 s51, s51, 0x4000
  v_exp_f32 v120, v52
  v_mfma_f32_16x16x32_bf16 v[220:223], a[204:207], v[68:71], v[220:223]
  s_and_b32 s51, s51, 0xffff
  v_exp_f32 v121, v53
  v_mfma_f32_16x16x32_bf16 v[224:227], a[208:211], v[64:67], v[224:227]
  ds_read_b128 a[232:235], v125 offset:10240
  v_cvt_pk_bf16_f32 v76, v120, v121
  v_mfma_f32_16x16x32_bf16 v[232:235], a[208:211], v[68:71], v[232:235]
  v_exp_f32 v122, v54
  v_mfma_f32_16x16x32_bf16 v[228:231], a[212:215], v[64:67], v[228:231]
  v_exp_f32 v123, v55
  v_mfma_f32_16x16x32_bf16 v[236:239], a[212:215], v[68:71], v[236:239]
  ds_read_b128 a[236:239], v125 offset:11264
  v_cvt_pk_bf16_f32 v77, v122, v123
  v_mfma_f32_16x16x32_bf16 v[240:243], a[216:219], v[64:67], v[240:243]
  v_exp_f32 v120, v56
  v_mfma_f32_16x16x32_bf16 v[248:251], a[216:219], v[68:71], v[248:251]
  v_exp_f32 v121, v57
  v_mfma_f32_16x16x32_bf16 v[244:247], a[220:223], v[64:67], v[244:247]
  ds_read_b128 a[240:243], v125 offset:12288
  v_cvt_pk_bf16_f32 v74, v120, v121
  v_mfma_f32_16x16x32_bf16 v[252:255], a[220:223], v[68:71], v[252:255]
  s_waitcnt lgkmcnt(5)
  v_exp_f32 v122, v58
  v_mfma_f32_16x16x32_bf16 v[32:35], a[128:131], v[128:131], v[80:83]
  v_exp_f32 v123, v59
  v_mfma_f32_16x16x32_bf16 v[36:39], a[128:131], v[144:147], v[84:87]
  ds_read_b128 a[244:247], v125 offset:13312
  v_cvt_pk_bf16_f32 v75, v122, v123
  v_mfma_f32_16x16x32_bf16 v[32:35], a[132:135], v[132:135], v[32:35]
  s_sub_u32 s35, s35, 1
  v_exp_f32 v120, v60
  v_mfma_f32_16x16x32_bf16 v[36:39], a[132:135], v[148:151], v[36:39]
  s_cmp_lg_u32 s35, 0
  v_exp_f32 v121, v61
  v_mfma_f32_16x16x32_bf16 v[32:35], a[136:139], v[136:139], v[32:35]
  ds_read_b128 a[248:251], v125 offset:14336
  v_cvt_pk_bf16_f32 v78, v120, v121
  v_mfma_f32_16x16x32_bf16 v[36:39], a[136:139], v[152:155], v[36:39]
  v_exp_f32 v122, v62
  v_mfma_f32_16x16x32_bf16 v[32:35], a[140:143], v[140:143], v[32:35]
  v_exp_f32 v123, v63
  v_mfma_f32_16x16x32_bf16 v[36:39], a[140:143], v[156:159], v[36:39]
  ds_read_b128 a[252:255], v125 offset:15360
  v_cvt_pk_bf16_f32 v79, v122, v123
  v_mfma_f32_16x16x32_bf16 v[40:43], a[144:147], v[128:131], v[88:91]
  ds_read_b128 a[160:163], v124 offset:8192
  v_add_u32 v125, s30, v127
  v_mfma_f32_16x16x32_bf16 v[44:47], a[144:147], v[144:147], v[92:95]
  buffer_load_dwordx4 v3, s[16:19], s37 offen offset:0 sc1 lds
  v_mfma_f32_16x16x32_bf16 v[108:111], v[116:119], v[72:75], v[100:103]
  ds_read_b128 a[164:167], v124 offset:9216
  ds_read_b128 a[168:171], v124 offset:10240
  v_mfma_f32_16x16x32_bf16 v[112:115], v[116:119], v[76:79], v[104:107]
  buffer_load_dwordx4 v3, s[16:19], s37 offen offset:1024 sc1 lds
  v_mfma_f32_16x16x32_bf16 v[40:43], a[148:151], v[132:135], v[40:43]
  ds_read_b128 a[172:175], v124 offset:11264
  ds_read_b128 a[176:179], v124 offset:12288
  v_mfma_f32_16x16x32_bf16 v[44:47], a[148:151], v[148:151], v[44:47]
  buffer_load_dwordx4 v3, s[16:19], s37 offen offset:2048 sc1 lds
  v_mfma_f32_16x16x32_bf16 v[40:43], a[152:155], v[136:139], v[40:43]
  ds_read_b128 a[180:183], v124 offset:13312
  ds_read_b128 a[184:187], v124 offset:14336
  v_mfma_f32_16x16x32_bf16 v[44:47], a[152:155], v[152:155], v[44:47]
  buffer_load_dwordx4 v3, s[16:19], s37 offen offset:3072 sc1 lds
  s_mov_b32 m0, s46
  v_max_f32 v120, v108, v112
  v_mfma_f32_16x16x32_bf16 v[40:43], a[156:159], v[140:143], v[40:43]
  buffer_load_dwordx4 v30, s[80:83], s79 offen lds
  ds_read_b128 a[188:191], v124 offset:15360
  v_cmp_lt_f32 vcc, s77, v120
  v_mfma_f32_16x16x32_bf16 v[44:47], a[156:159], v[156:159], v[44:47]
  s_cbranch_vccnz L_rs1_40
L_rb1_41:
  s_cbranch_scc1 L_attn_kernel_m
  s_branch L_attn_kernel_m_last
L_attn_kernel_fm:
  s_waitcnt vmcnt(19)
  s_barrier
  s_cmp_lg_u32 s41, 1
  s_cbranch_scc1 L_rlsig_42
  s_cmp_lg_u32 s3, 0
  s_cbranch_scc1 L_rlsig_42
  v_mov_b32 v12, 1
  v_lshlrev_b32 v13, 8, v2
  v_mov_b32 v14, 0x4000000
  v_cmp_gt_u32 vcc, 8, v2
  s_nop 1
  v_cndmask_b32 v13, v14, v13, vcc
  s_mov_b32 s38, 315392
  buffer_atomic_add v12, v13, s[16:19], s38 offen sc1
L_rlsig_42:
  s_cmp_ge_i32 s43, 32
  s_cbranch_scc1 L_mk_43
  s_cmp_lt_i32 s43, 0
  s_cbranch_scc1 L_mf_44
  v_cndmask_b32 v80, v96, v28, s[60:61]
  v_cndmask_b32 v81, v96, v28, s[62:63]
  v_cndmask_b32 v82, v96, v28, s[64:65]
  v_cndmask_b32 v83, v96, v28, s[66:67]
  v_cndmask_b32 v92, v97, v28, s[60:61]
  v_cndmask_b32 v93, v97, v28, s[62:63]
  v_cndmask_b32 v94, v97, v28, s[64:65]
  v_cndmask_b32 v95, v97, v28, s[66:67]
  v_mov_b32 v88, v28
  v_mov_b32 v89, v28
  v_mov_b32 v90, v28
  v_mov_b32 v91, v28
  s_branch L_mk_43
L_mf_44:
  v_mov_b32 v80, v28
  v_mov_b32 v81, v28
  v_mov_b32 v82, v28
  v_mov_b32 v83, v28
  v_mov_b32 v84, v28
  v_mov_b32 v85, v28
  v_mov_b32 v86, v28
  v_mov_b32 v87, v28
  v_mov_b32 v88, v28
  v_mov_b32 v89, v28
  v_mov_b32 v90, v28
  v_mov_b32 v91, v28
  v_mov_b32 v92, v28
  v_mov_b32 v93, v28
  v_mov_b32 v94, v28
  v_mov_b32 v95, v28
L_mk_43:
  s_sub_u32 s43, s43, 32
  s_add_u32 s37, s36, 16384
  s_add_u32 s36, s36, 32768
  s_cmp_eq_u32 s31, s32
  s_cselect_b32 s36, s33, s36
  s_add_u32 m0, s28, s30
  v_add_u32 v124, s51, v3
  s_waitcnt lgkmcnt(0)
  v_mfma_f32_16x16x32_bf16 v[48:51], a[160:163], v[128:131], v[80:83]
  v_exp_f32 v120, v32
  v_exp_f32 v121, v33
  ds_read_b128 a[192:195], v125 offset:0
  v_cvt_pk_bf16_f32 v64, v120, v121
  v_mfma_f32_16x16x32_bf16 v[52:55], a[160:163], v[144:147], v[84:87]
  v_exp_f32 v122, v34
  v_exp_f32 v123, v35
  ds_read_b128 a[196:199], v125 offset:1024
  v_cvt_pk_bf16_f32 v65, v122, v123
  buffer_load_dwordx4 v3, s[16:19], s36 offen offset:0 sc1 lds
  v_mfma_f32_16x16x32_bf16 v[48:51], a[164:167], v[132:135], v[48:51]
  v_exp_f32 v120, v36
  v_exp_f32 v121, v37
  ds_read_b128 a[200:203], v125 offset:2048
  v_cvt_pk_bf16_f32 v68, v120, v121
  v_mfma_f32_16x16x32_bf16 v[52:55], a[164:167], v[148:151], v[52:55]
  v_exp_f32 v122, v38
  v_exp_f32 v123, v39
  ds_read_b128 a[204:207], v125 offset:3072
  v_cvt_pk_bf16_f32 v69, v122, v123
  buffer_load_dwordx4 v3, s[16:19], s36 offen offset:1024 sc1 lds
  v_mfma_f32_16x16x32_bf16 v[48:51], a[168:171], v[136:139], v[48:51]
  v_exp_f32 v120, v40
  v_exp_f32 v121, v41
  ds_read_b128 a[208:211], v125 offset:4096
  v_cvt_pk_bf16_f32 v66, v120, v121
  v_mfma_f32_16x16x32_bf16 v[52:55], a[168:171], v[152:155], v[52:55]
  v_exp_f32 v122, v42
  v_exp_f32 v123, v43
  ds_read_b128 a[212:215], v125 offset:5120
  v_cvt_pk_bf16_f32 v67, v122, v123
  buffer_load_dwordx4 v3, s[16:19], s36 offen offset:2048 sc1 lds
  v_mfma_f32_16x16x32_bf16 v[48:51], a[172:175], v[140:143], v[48:51]
  v_exp_f32 v120, v44
  v_exp_f32 v121, v45
  ds_read_b128 a[216:219], v125 offset:6144
  v_cvt_pk_bf16_f32 v70, v120, v121
  v_mfma_f32_16x16x32_bf16 v[52:55], a[172:175], v[156:159], v[52:55]
  v_exp_f32 v122, v46
  v_exp_f32 v123, v47
  ds_read_b128 a[220:223], v125 offset:7168
  v_cvt_pk_bf16_f32 v71, v122, v123
  buffer_load_dwordx4 v3, s[16:19], s36 offen offset:3072 sc1 lds
  v_mfma_f32_16x16x32_bf16 v[56:59], a[176:179], v[128:131], v[88:91]
  ds_read_b128 a[128:131], v124 offset:0
  v_mfma_f32_16x16x32_bf16 v[60:63], a[176:179], v[144:147], v[92:95]
  ds_read_b128 a[132:135], v124 offset:1024
  v_mfma_f32_16x16x32_bf16 v[100:103], v[116:119], v[64:67], 0
  v_mfma_f32_16x16x32_bf16 v[104:107], v[116:119], v[68:71], 0
  v_mfma_f32_16x16x32_bf16 v[56:59], a[180:183], v[132:135], v[56:59]
  ds_read_b128 a[136:139], v124 offset:2048
  v_mfma_f32_16x16x32_bf16 v[60:63], a[180:183], v[148:151], v[60:63]
  ds_read_b128 a[140:143], v124 offset:3072
  v_mfma_f32_16x16x32_bf16 v[56:59], a[184:187], v[136:139], v[56:59]
  ds_read_b128 a[144:147], v124 offset:4096
  v_mfma_f32_16x16x32_bf16 v[60:63], a[184:187], v[152:155], v[60:63]
  ds_read_b128 a[148:151], v124 offset:5120
  v_mfma_f32_16x16x32_bf16 v[56:59], a[188:191], v[140:143], v[56:59]
  ds_read_b128 a[152:155], v124 offset:6144
  v_mfma_f32_16x16x32_bf16 v[60:63], a[188:191], v[156:159], v[60:63]
  ds_read_b128 a[156:159], v124 offset:7168
  v_max_f32 v120, v100, v104
  v_cmp_lt_f32 vcc, s77, v120
  s_cbranch_vccnz L_rs0_45
L_rb0_46:
  s_waitcnt lgkmcnt(8)
  s_cmp_ge_i32 s43, 32
  s_cbranch_scc1 L_mk_47
  s_cmp_lt_i32 s43, 0
  s_cbranch_scc1 L_mf_48
  v_cndmask_b32 v80, v96, v28, s[60:61]
  v_cndmask_b32 v81, v96, v28, s[62:63]
  v_cndmask_b32 v82, v96, v28, s[64:65]
  v_cndmask_b32 v83, v96, v28, s[66:67]
  v_cndmask_b32 v92, v97, v28, s[60:61]
  v_cndmask_b32 v93, v97, v28, s[62:63]
  v_cndmask_b32 v94, v97, v28, s[64:65]
  v_cndmask_b32 v95, v97, v28, s[66:67]
  v_mov_b32 v88, v28
  v_mov_b32 v89, v28
  v_mov_b32 v90, v28
  v_mov_b32 v91, v28
  s_branch L_mk_47
L_mf_48:
  v_mov_b32 v80, v28
  v_mov_b32 v81, v28
  v_mov_b32 v82, v28
  v_mov_b32 v83, v28
  v_mov_b32 v84, v28
  v_mov_b32 v85, v28
  v_mov_b32 v86, v28
  v_mov_b32 v87, v28
  v_mov_b32 v88, v28
  v_mov_b32 v89, v28
  v_mov_b32 v90, v28
  v_mov_b32 v91, v28
  v_mov_b32 v92, v28
  v_mov_b32 v93, v28
  v_mov_b32 v94, v28
  v_mov_b32 v95, v28
L_mk_47:
  s_sub_u32 s43, s43, 32
  v_mfma_f32_16x16x32_bf16 v[192:195], a[192:195], v[64:67], 0
  s_add_u32 m0, s78, s29
  v_exp_f32 v120, v48
  v_mfma_f32_16x16x32_bf16 v[200:203], a[192:195], v[68:71], 0
  s_add_u32 s31, s31, 1
  v_exp_f32 v121, v49
  v_mfma_f32_16x16x32_bf16 v[196:199], a[196:199], v[64:67], 0
  ds_read_b128 a[224:227], v125 offset:8192
  v_cvt_pk_bf16_f32 v72, v120, v121
  v_mfma_f32_16x16x32_bf16 v[204:207], a[196:199], v[68:71], 0
  s_mov_b32 s29, s30
  v_exp_f32 v122, v50
  v_mfma_f32_16x16x32_bf16 v[208:211], a[200:203], v[64:67], 0
  s_mov_b32 s30, s51
  v_exp_f32 v123, v51
  v_mfma_f32_16x16x32_bf16 v[216:219], a[200:203], v[68:71], 0
  ds_read_b128 a[228:231], v125 offset:9216
  v_cvt_pk_bf16_f32 v73, v122, v123
  v_mfma_f32_16x16x32_bf16 v[212:215], a[204:207], v[64:67], 0
  s_add_u32 s51, s51, 0x4000
  v_exp_f32 v120, v52
  v_mfma_f32_16x16x32_bf16 v[220:223], a[204:207], v[68:71], 0
  s_and_b32 s51, s51, 0xffff
  v_exp_f32 v121, v53
  v_mfma_f32_16x16x32_bf16 v[224:227], a[208:211], v[64:67], 0
  ds_read_b128 a[232:235], v125 offset:10240
  v_cvt_pk_bf16_f32 v76, v120, v121
  v_mfma_f32_16x16x32_bf16 v[232:235], a[208:211], v[68:71], 0
  v_exp_f32 v122, v54
  v_mfma_f32_16x16x32_bf16 v[228:231], a[212:215], v[64:67], 0
  v_exp_f32 v123, v55
  v_mfma_f32_16x16x32_bf16 v[236:239], a[212:215], v[68:71], 0
  ds_read_b128 a[236:239], v125 offset:11264
  v_cvt_pk_bf16_f32 v77, v122, v123
  v_mfma_f32_16x16x32_bf16 v[240:243], a[216:219], v[64:67], 0
  v_exp_f32 v120, v56
  v_mfma_f32_16x16x32_bf16 v[248:251], a[216:219], v[68:71], 0
  v_exp_f32 v121, v57
  v_mfma_f32_16x16x32_bf16 v[244:247], a[220:223], v[64:67], 0
  ds_read_b128 a[240:243], v125 offset:12288
  v_cvt_pk_bf16_f32 v74, v120, v121
  v_mfma_f32_16x16x32_bf16 v[252:255], a[220:223], v[68:71], 0
  s_waitcnt lgkmcnt(5)
  v_exp_f32 v122, v58
  v_mfma_f32_16x16x32_bf16 v[32:35], a[128:131], v[128:131], v[80:83]
  v_exp_f32 v123, v59
  v_mfma_f32_16x16x32_bf16 v[36:39], a[128:131], v[144:147], v[84:87]
  ds_read_b128 a[244:247], v125 offset:13312
  v_cvt_pk_bf16_f32 v75, v122, v123
  v_mfma_f32_16x16x32_bf16 v[32:35], a[132:135], v[132:135], v[32:35]
  v_exp_f32 v120, v60
  v_mfma_f32_16x16x32_bf16 v[36:39], a[132:135], v[148:151], v[36:39]
  v_exp_f32 v121, v61
  v_mfma_f32_16x16x32_bf16 v[32:35], a[136:139], v[136:139], v[32:35]
  ds_read_b128 a[248:251], v125 offset:14336
  v_cvt_pk_bf16_f32 v78, v120, v121
  v_mfma_f32_16x16x32_bf16 v[36:39], a[136:139], v[152:155], v[36:39]
  v_exp_f32 v122, v62
  v_mfma_f32_16x16x32_bf16 v[32:35], a[140:143], v[140:143], v[32:35]
  v_exp_f32 v123, v63
  v_mfma_f32_16x16x32_bf16 v[36:39], a[140:143], v[156:159], v[36:39]
  ds_read_b128 a[252:255], v125 offset:15360
  v_cvt_pk_bf16_f32 v79, v122, v123
  v_mfma_f32_16x16x32_bf16 v[40:43], a[144:147], v[128:131], v[88:91]
  ds_read_b128 a[160:163], v124 offset:8192
  v_add_u32 v125, s30, v127
  v_mfma_f32_16x16x32_bf16 v[44:47], a[144:147], v[144:147], v[92:95]
  buffer_load_dwordx4 v3, s[16:19], s37 offen offset:0 sc1 lds
  v_mfma_f32_16x16x32_bf16 v[108:111], v[116:119], v[72:75], v[100:103]
  ds_read_b128 a[164:167], v124 offset:9216
  ds_read_b128 a[168:171], v124 offset:10240
  v_mfma_f32_16x16x32_bf16 v[112:115], v[116:119], v[76:79], v[104:107]
  buffer_load_dwordx4 v3, s[16:19], s37 offen offset:1024 sc1 lds
  v_mfma_f32_16x16x32_bf16 v[40:43], a[148:151], v[132:135], v[40:43]
  ds_read_b128 a[172:175], v124 offset:11264
  ds_read_b128 a[176:179], v124 offset:12288
  v_mfma_f32_16x16x32_bf16 v[44:47], a[148:151], v[148:151], v[44:47]
  buffer_load_dwordx4 v3, s[16:19], s37 offen offset:2048 sc1 lds
  v_mfma_f32_16x16x32_bf16 v[40:43], a[152:155], v[136:139], v[40:43]
  ds_read_b128 a[180:183], v124 offset:13312
  ds_read_b128 a[184:187], v124 offset:14336
  v_mfma_f32_16x16x32_bf16 v[44:47], a[152:155], v[152:155], v[44:47]
  buffer_load_dwordx4 v3, s[16:19], s37 offen offset:3072 sc1 lds
  s_mov_b32 m0, s46
  v_max_f32 v120, v108, v112
  v_mfma_f32_16x16x32_bf16 v[40:43], a[156:159], v[140:143], v[40:43]
  buffer_load_dwordx4 v30, s[80:83], s79 offen lds
  ds_read_b128 a[188:191], v124 offset:15360
  v_cmp_lt_f32 vcc, s77, v120
  v_mfma_f32_16x16x32_bf16 v[44:47], a[156:159], v[156:159], v[44:47]
  s_cbranch_vccnz L_rs1_49
L_rb1_50:
L_attn_kernel_m_last:
  s_waitcnt lgkmcnt(8)
  s_cmp_ge_i32 s43, 32
  s_cbranch_scc1 L_mk_51
  s_cmp_lt_i32 s43, 0
  s_cbranch_scc1 L_mf_52
  v_cndmask_b32 v80, v96, v28, s[60:61]
  v_cndmask_b32 v81, v96, v28, s[62:63]
  v_cndmask_b32 v82, v96, v28, s[64:65]
  v_cndmask_b32 v83, v96, v28, s[66:67]
  v_cndmask_b32 v92, v97, v28, s[60:61]
  v_cndmask_b32 v93, v97, v28, s[62:63]
  v_cndmask_b32 v94, v97, v28, s[64:65]
  v_cndmask_b32 v95, v97, v28, s[66:67]
  v_mov_b32 v88, v28
  v_mov_b32 v89, v28
  v_mov_b32 v90, v28
  v_mov_b32 v91, v28
  s_branch L_mk_51
L_mf_52:
  v_mov_b32 v80, v28
  v_mov_b32 v81, v28
  v_mov_b32 v82, v28
  v_mov_b32 v83, v28
  v_mov_b32 v84, v28
  v_mov_b32 v85, v28
  v_mov_b32 v86, v28
  v_mov_b32 v87, v28
  v_mov_b32 v88, v28
  v_mov_b32 v89, v28
  v_mov_b32 v90, v28
  v_mov_b32 v91, v28
  v_mov_b32 v92, v28
  v_mov_b32 v93, v28
  v_mov_b32 v94, v28
  v_mov_b32 v95, v28
L_mk_51:
  s_sub_u32 s43, s43, 32
  v_mfma_f32_16x16x32_bf16 v[192:195], a[224:227], v[72:75], v[192:195]
  s_waitcnt vmcnt(19)
  s_barrier
  v_exp_f32 v120, v32
  v_mfma_f32_16x16x32_bf16 v[200:203], a[224:227], v[76:79], v[200:203]
  s_add_u32 s37, s36, 16384
  v_exp_f32 v121, v33
  v_mfma_f32_16x16x32_bf16 v[196:199], a[228:231], v[72:75], v[196:199]
  ds_read_b128 a[192:195], v125 offset:0
  v_cvt_pk_bf16_f32 v64, v120, v121
  v_mfma_f32_16x16x32_bf16 v[204:207], a[228:231], v[76:79], v[204:207]
  s_add_u32 s36, s36, 32768
  v_exp_f32 v122, v34
  v_mfma_f32_16x16x32_bf16 v[208:211], a[232:235], v[72:75], v[208:211]
  s_cmp_eq_u32 s31, s32
  v_exp_f32 v123, v35
  v_mfma_f32_16x16x32_bf16 v[216:219], a[232:235], v[76:79], v[216:219]
  ds_read_b128 a[196:199], v125 offset:1024
  v_cvt_pk_bf16_f32 v65, v122, v123
  v_mfma_f32_16x16x32_bf16 v[212:215], a[236:239], v[72:75], v[212:215]
  s_cselect_b32 s36, s33, s36
  v_exp_f32 v120, v36
  v_mfma_f32_16x16x32_bf16 v[220:223], a[236:239], v[76:79], v[220:223]
  s_add_u32 m0, s28, s30
  v_exp_f32 v121, v37
  v_mfma_f32_16x16x32_bf16 v[224:227], a[240:243], v[72:75], v[224:227]
  ds_read_b128 a[200:203], v125 offset:2048
  v_cvt_pk_bf16_f32 v68, v120, v121
  v_mfma_f32_16x16x32_bf16 v[232:235], a[240:243], v[76:79], v[232:235]
  s_add_u32 s79, s79, s47
  v_exp_f32 v122, v38
  v_mfma_f32_16x16x32_bf16 v[228:231], a[244:247], v[72:75], v[228:231]
  s_add_u32 s46, s46, 1024
  v_exp_f32 v123, v39
  v_mfma_f32_16x16x32_bf16 v[236:239], a[244:247], v[76:79], v[236:239]
  ds_read_b128 a[204:207], v125 offset:3072
  v_cvt_pk_bf16_f32 v69, v122, v123
  v_mfma_f32_16x16x32_bf16 v[240:243], a[248:251], v[72:75], v[240:243]
  v_exp_f32 v120, v40
  v_mfma_f32_16x16x32_bf16 v[248:251], a[248:251], v[76:79], v[248:251]
  v_exp_f32 v121, v41
  v_mfma_f32_16x16x32_bf16 v[244:247], a[252:255], v[72:75], v[244:247]
  ds_read_b128 a[208:211], v125 offset:4096
  v_cvt_pk_bf16_f32 v66, v120, v121
  v_mfma_f32_16x16x32_bf16 v[252:255], a[252:255], v[76:79], v[252:255]
  s_waitcnt lgkmcnt(5)
  v_exp_f32 v122, v42
  v_mfma_f32_16x16x32_bf16 v[48:51], a[160:163], v[128:131], v[80:83]
  v_exp_f32 v123, v43
  v_mfma_f32_16x16x32_bf16 v[52:55], a[160:163], v[144:147], v[84:87]
  ds_read_b128 a[212:215], v125 offset:5120
  v_cvt_pk_bf16_f32 v67, v122, v123
  v_mfma_f32_16x16x32_bf16 v[48:51], a[164:167], v[132:135], v[48:51]
  v_exp_f32 v120, v44
  v_mfma_f32_16x16x32_bf16 v[52:55], a[164:167], v[148:151], v[52:55]
  v_exp_f32 v121, v45
  v_mfma_f32_16x16x32_bf16 v[48:51], a[168:171], v[136:139], v[48:51]
  ds_read_b128 a[216:219], v125 offset:6144
  v_cvt_pk_bf16_f32 v70, v120, v121
  v_mfma_f32_16x16x32_bf16 v[52:55], a[168:171], v[152:155], v[52:55]
  v_exp_f32 v122, v46
  v_mfma_f32_16x16x32_bf16 v[48:51], a[172:175], v[140:143], v[48:51]
  v_exp_f32 v123, v47
  v_mfma_f32_16x16x32_bf16 v[52:55], a[172:175], v[156:159], v[52:55]
  ds_read_b128 a[220:223], v125 offset:7168
  v_cvt_pk_bf16_f32 v71, v122, v123
  v_add_u32 v124, s51, v3
  v_mfma_f32_16x16x32_bf16 v[56:59], a[176:179], v[128:131], v[88:91]
  ds_read_b128 a[128:131], v124 offset:0
  v_mfma_f32_16x16x32_bf16 v[60:63], a[176:179], v[144:147], v[92:95]
  buffer_load_dwordx4 v3, s[16:19], s36 offen offset:0 sc1 lds
  v_mfma_f32_16x16x32_bf16 v[100:103], v[116:119], v[64:67], v[108:111]
  ds_read_b128 a[132:135], v124 offset:1024
  ds_read_b128 a[136:139], v124 offset:2048
  v_mfma_f32_16x16x32_bf16 v[104:107], v[116:119], v[68:71], v[112:115]
  buffer_load_dwordx4 v3, s[16:19], s36 offen offset:1024 sc1 lds
  v_mfma_f32_16x16x32_bf16 v[56:59], a[180:183], v[132:135], v[56:59]
  ds_read_b128 a[140:143], v124 offset:3072
  ds_read_b128 a[144:147], v124 offset:4096
  v_mfma_f32_16x16x32_bf16 v[60:63], a[180:183], v[148:151], v[60:63]
  buffer_load_dwordx4 v3, s[16:19], s36 offen offset:2048 sc1 lds
  v_mfma_f32_16x16x32_bf16 v[56:59], a[184:187], v[136:139], v[56:59]
  ds_read_b128 a[148:151], v124 offset:5120
  v_mfma_f32_16x16x32_bf16 v[60:63], a[184:187], v[152:155], v[60:63]
  ds_read_b128 a[152:155], v124 offset:6144
  v_max_f32 v120, v100, v104
  v_mfma_f32_16x16x32_bf16 v[56:59], a[188:191], v[140:143], v[56:59]
  ds_read_b128 a[156:159], v124 offset:7168
  v_cmp_lt_f32 vcc, s77, v120
  v_mfma_f32_16x16x32_bf16 v[60:63], a[188:191], v[156:159], v[60:63]
  s_cbranch_vccnz L_rs0_53
L_rb0_54:
  buffer_load_dwordx4 v3, s[16:19], s36 offen offset:3072 sc1 lds
  s_waitcnt lgkmcnt(8)
  s_add_u32 m0, s78, s29
  s_add_u32 s31, s31, 1
  s_mov_b32 s29, s30
  s_mov_b32 s30, s51
  s_add_u32 s51, s51, 0x4000
  s_and_b32 s51, s51, 0xffff
  v_mfma_f32_16x16x32_bf16 v[192:195], a[192:195], v[64:67], v[192:195]
  v_exp_f32 v120, v48
  v_mfma_f32_16x16x32_bf16 v[200:203], a[192:195], v[68:71], v[200:203]
  v_exp_f32 v121, v49
  ds_read_b128 a[224:227], v125 offset:8192
  v_cvt_pk_bf16_f32 v72, v120, v121
  v_mfma_f32_16x16x32_bf16 v[196:199], a[196:199], v[64:67], v[196:199]
  v_exp_f32 v122, v50
  v_mfma_f32_16x16x32_bf16 v[204:207], a[196:199], v[68:71], v[204:207]
  v_exp_f32 v123, v51
  ds_read_b128 a[228:231], v125 offset:9216
  v_cvt_pk_bf16_f32 v73, v122, v123
  v_mfma_f32_16x16x32_bf16 v[208:211], a[200:203], v[64:67], v[208:211]
  v_exp_f32 v120, v52
  v_mfma_f32_16x16x32_bf16 v[216:219], a[200:203], v[68:71], v[216:219]
  v_exp_f32 v121, v53
  ds_read_b128 a[232:235], v125 offset:10240
  v_cvt_pk_bf16_f32 v76, v120, v121
  v_mfma_f32_16x16x32_bf16 v[212:215], a[204:207], v[64:67], v[212:215]
  v_exp_f32 v122, v54
  v_mfma_f32_16x16x32_bf16 v[220:223], a[204:207], v[68:71], v[220:223]
  v_exp_f32 v123, v55
  ds_read_b128 a[236:239], v125 offset:11264
  v_cvt_pk_bf16_f32 v77, v122, v123
  v_mfma_f32_16x16x32_bf16 v[224:227], a[208:211], v[64:67], v[224:227]
  v_exp_f32 v120, v56
  v_mfma_f32_16x16x32_bf16 v[232:235], a[208:211], v[68:71], v[232:235]
  v_exp_f32 v121, v57
  ds_read_b128 a[240:243], v125 offset:12288
  v_cvt_pk_bf16_f32 v74, v120, v121
  v_mfma_f32_16x16x32_bf16 v[228:231], a[212:215], v[64:67], v[228:231]
  v_exp_f32 v122, v58
  v_mfma_f32_16x16x32_bf16 v[236:239], a[212:215], v[68:71], v[236:239]
  v_exp_f32 v123, v59
  ds_read_b128 a[244:247], v125 offset:13312
  v_cvt_pk_bf16_f32 v75, v122, v123
  v_mfma_f32_16x16x32_bf16 v[240:243], a[216:219], v[64:67], v[240:243]
  v_exp_f32 v120, v60
  v_mfma_f32_16x16x32_bf16 v[248:251], a[216:219], v[68:71], v[248:251]
  v_exp_f32 v121, v61
  ds_read_b128 a[248:251], v125 offset:14336
  v_cvt_pk_bf16_f32 v78, v120, v121
  v_mfma_f32_16x16x32_bf16 v[244:247], a[220:223], v[64:67], v[244:247]
  v_exp_f32 v122, v62
  v_mfma_f32_16x16x32_bf16 v[252:255], a[220:223], v[68:71], v[252:255]
  v_exp_f32 v123, v63
  ds_read_b128 a[252:255], v125 offset:15360
  v_cvt_pk_bf16_f32 v79, v122, v123
  v_add_u32 v125, s30, v127
  ds_read_b128 a[160:163], v124 offset:8192
  ds_read_b128 a[164:167], v124 offset:9216
  v_mfma_f32_16x16x32_bf16 v[108:111], v[116:119], v[72:75], v[100:103]
  v_mfma_f32_16x16x32_bf16 v[112:115], v[116:119], v[76:79], v[104:107]
  buffer_load_dwordx4 v3, s[16:19], s37 offen offset:0 sc1 lds
  ds_read_b128 a[168:171], v124 offset:10240
  buffer_load_dwordx4 v3, s[16:19], s37 offen offset:1024 sc1 lds
  ds_read_b128 a[172:175], v124 offset:11264
  buffer_load_dwordx4 v3, s[16:19], s37 offen offset:2048 sc1 lds
  ds_read_b128 a[176:179], v124 offset:12288
  buffer_load_dwordx4 v3, s[16:19], s37 offen offset:3072 sc1 lds
  ds_read_b128 a[180:183], v124 offset:13312
  s_mov_b32 m0, s46
  ds_read_b128 a[184:187], v124 offset:14336
  buffer_load_dwordx4 v30, s[80:83], s79 offen lds
  ds_read_b128 a[188:191], v124 offset:15360
  v_max_f32 v120, v108, v112
  v_cmp_lt_f32 vcc, s77, v120
  s_cbranch_vccnz L_rs1_55
L_rb1_56:
  s_waitcnt lgkmcnt(8)
  v_mfma_f32_16x16x32_bf16 v[192:195], a[224:227], v[72:75], v[192:195]
  v_mov_b32 v128, v160
  v_mov_b32 v129, v161
  v_mfma_f32_16x16x32_bf16 v[200:203], a[224:227], v[76:79], v[200:203]
  v_mov_b32 v130, v162
  v_mov_b32 v131, v163
  v_mfma_f32_16x16x32_bf16 v[196:199], a[228:231], v[72:75], v[196:199]
  v_mov_b32 v132, v164
  v_mov_b32 v133, v165
  v_mfma_f32_16x16x32_bf16 v[204:207], a[228:231], v[76:79], v[204:207]
  v_mov_b32 v134, v166
  v_mov_b32 v135, v167
  v_mfma_f32_16x16x32_bf16 v[208:211], a[232:235], v[72:75], v[208:211]
  v_mov_b32 v136, v168
  v_mov_b32 v137, v169
  v_mfma_f32_16x16x32_bf16 v[216:219], a[232:235], v[76:79], v[216:219]
  v_mov_b32 v138, v170
  v_mov_b32 v139, v171
  v_mfma_f32_16x16x32_bf16 v[212:215], a[236:239], v[72:75], v[212:215]
  v_mov_b32 v140, v172
  v_mov_b32 v141, v173
  v_mfma_f32_16x16x32_bf16 v[220:223], a[236:239], v[76:79], v[220:223]
  v_mov_b32 v142, v174
  v_mov_b32 v143, v175
  v_mfma_f32_16x16x32_bf16 v[224:227], a[240:243], v[72:75], v[224:227]
  v_mov_b32 v144, v176
  v_mov_b32 v145, v177
  v_mfma_f32_16x16x32_bf16 v[232:235], a[240:243], v[76:79], v[232:235]
  v_mov_b32 v146, v178
  v_mov_b32 v147, v179
  v_mfma_f32_16x16x32_bf16 v[228:231], a[244:247], v[72:75], v[228:231]
  v_mov_b32 v148, v180
  v_mov_b32 v149, v181
  v_mfma_f32_16x16x32_bf16 v[236:239], a[244:247], v[76:79], v[236:239]
  v_mov_b32 v150, v182
  v_mov_b32 v151, v183
  v_mfma_f32_16x16x32_bf16 v[240:243], a[248:251], v[72:75], v[240:243]
  v_mov_b32 v152, v184
  v_mov_b32 v153, v185
  v_mfma_f32_16x16x32_bf16 v[248:251], a[248:251], v[76:79], v[248:251]
  v_mov_b32 v154, v186
  v_mov_b32 v155, v187
  v_mfma_f32_16x16x32_bf16 v[244:247], a[252:255], v[72:75], v[244:247]
  v_mov_b32 v156, v188
  v_mov_b32 v157, v189
  v_mfma_f32_16x16x32_bf16 v[252:255], a[252:255], v[76:79], v[252:255]
  v_mov_b32 v158, v190
  v_mov_b32 v159, v191
  v_rcp_f32 v4, v108
  v_rcp_f32 v6, v112
  s_lshl_b32 s38, s26, 1
  s_lshr_b32 s39, s3, 1
  s_add_u32 s38, s38, s39
  s_lshl_b32 s38, s38, 5
  s_add_u32 s38, s38, s24
  s_lshl_b32 s38, s38, 14
  s_and_b32 s39, s3, 1
  s_lshl_b32 s39, s39, 11
  s_add_u32 s38, s38, s39
  s_add_u32 s76, s38, 0x1000000
  s_mov_b32 s26, s25
  s_lshl_b32 s27, s26, 1
  s_add_u32 s27, s27, 2
  s_lshl_b32 s43, s26, 2
  s_add_u32 s43, s43, s3
  s_lshl_b32 s43, s43, 5
  s_waitcnt lgkmcnt(0)
  s_cmp_ge_i32 s43, 32
  s_cbranch_scc1 L_q0u_57
  v_cndmask_b32 v80, 0, v28, s[60:61]
  v_cndmask_b32 v81, 0, v28, s[62:63]
  v_cndmask_b32 v82, 0, v28, s[64:65]
  v_cndmask_b32 v83, 0, v28, s[66:67]
  v_cndmask_b32 v84, 0, v28, s[68:69]
  v_cndmask_b32 v85, 0, v28, s[70:71]
  v_cndmask_b32 v86, 0, v28, s[72:73]
  v_cndmask_b32 v87, 0, v28, s[74:75]
  v_cndmask_b32 v88, 0, v28, s[52:53]
  v_cndmask_b32 v89, 0, v28, s[54:55]
  v_cndmask_b32 v90, 0, v28, s[56:57]
  v_cndmask_b32 v91, 0, v28, s[58:59]
  v_cndmask_b32 v92, 0, v28, s[60:61]
  v_cndmask_b32 v93, 0, v28, s[62:63]
  v_cndmask_b32 v94, 0, v28, s[64:65]
  v_cndmask_b32 v95, 0, v28, s[66:67]
  s_branch L_q0d_58
L_q0u_57:
  v_mov_b32 v80, 0
  v_mov_b32 v81, 0
  v_mov_b32 v82, 0
  v_mov_b32 v83, 0
  v_mov_b32 v84, 0
  v_mov_b32 v85, 0
  v_mov_b32 v86, 0
  v_mov_b32 v87, 0
  v_mov_b32 v88, 0
  v_mov_b32 v89, 0
  v_mov_b32 v90, 0
  v_mov_b32 v91, 0
  v_mov_b32 v92, 0
  v_mov_b32 v93, 0
  v_mov_b32 v94, 0
  v_mov_b32 v95, 0
L_q0d_58:
  s_nop 1
  v_mfma_f32_16x16x32_bf16 v[32:35], a[128:131], v[128:131], v[80:83]
  v_mul_f32 v192, v4, v192
  v_mul_f32 v193, v4, v193
  v_mul_f32 v194, v4, v194
  v_mul_f32 v195, v4, v195
  v_mul_f32 v196, v4, v196
  v_mul_f32 v197, v4, v197
  v_mul_f32 v198, v4, v198
  v_mfma_f32_16x16x32_bf16 v[36:39], a[128:131], v[144:147], v[84:87]
  v_mul_f32 v199, v4, v199
  v_cvt_pk_bf16_f32 v192, v192, v193
  v_cvt_pk_bf16_f32 v193, v194, v195
  v_cvt_pk_bf16_f32 v194, v196, v197
  v_cvt_pk_bf16_f32 v195, v198, v199
  buffer_store_dwordx4 v[192:195], v3, s[16:19], s76 offen offset:0 sc1
  v_mul_f32 v200, v6, v200
  v_mfma_f32_16x16x32_bf16 v[32:35], a[132:135], v[132:135], v[32:35]
  v_mul_f32 v201, v6, v201
  v_mul_f32 v202, v6, v202
  v_mul_f32 v203, v6, v203
  v_mul_f32 v204, v6, v204
  v_mul_f32 v205, v6, v205
  v_mul_f32 v206, v6, v206
  v_mul_f32 v207, v6, v207
  v_mfma_f32_16x16x32_bf16 v[36:39], a[132:135], v[148:151], v[36:39]
  v_cvt_pk_bf16_f32 v200, v200, v201
  v_cvt_pk_bf16_f32 v201, v202, v203
  v_cvt_pk_bf16_f32 v202, v204, v205
  v_cvt_pk_bf16_f32 v203, v206, v207
  buffer_store_dwordx4 v[200:203], v3, s[16:19], s76 offen offset:1024 sc1
  s_add_u32 s76, s76, 4096
  v_mul_f32 v208, v4, v208
  v_mfma_f32_16x16x32_bf16 v[32:35], a[136:139], v[136:139], v[32:35]
  v_mul_f32 v209, v4, v209
  v_mul_f32 v210, v4, v210
  v_mul_f32 v211, v4, v211
  v_mul_f32 v212, v4, v212
  v_mul_f32 v213, v4, v213
  v_mul_f32 v214, v4, v214
  v_mul_f32 v215, v4, v215
  v_mfma_f32_16x16x32_bf16 v[36:39], a[136:139], v[152:155], v[36:39]
  v_cvt_pk_bf16_f32 v208, v208, v209
  v_cvt_pk_bf16_f32 v209, v210, v211
  v_cvt_pk_bf16_f32 v210, v212, v213
  v_cvt_pk_bf16_f32 v211, v214, v215
  buffer_store_dwordx4 v[208:211], v3, s[16:19], s76 offen offset:0 sc1
  v_mul_f32 v216, v6, v216
  v_mul_f32 v217, v6, v217
  v_mfma_f32_16x16x32_bf16 v[32:35], a[140:143], v[140:143], v[32:35]
  v_mul_f32 v218, v6, v218
  v_mul_f32 v219, v6, v219
  v_mul_f32 v220, v6, v220
  v_mul_f32 v221, v6, v221
  v_mul_f32 v222, v6, v222
  v_mul_f32 v223, v6, v223
  v_cvt_pk_bf16_f32 v216, v216, v217
  v_mfma_f32_16x16x32_bf16 v[36:39], a[140:143], v[156:159], v[36:39]
  v_cvt_pk_bf16_f32 v217, v218, v219
  v_cvt_pk_bf16_f32 v218, v220, v221
  v_cvt_pk_bf16_f32 v219, v222, v223
  buffer_store_dwordx4 v[216:219], v3, s[16:19], s76 offen offset:1024 sc1
  s_add_u32 s76, s76, 4096
  v_mul_f32 v224, v4, v224
  v_mul_f32 v225, v4, v225
  v_mfma_f32_16x16x32_bf16 v[40:43], a[144:147], v[128:131], v[88:91]
  v_mul_f32 v226, v4, v226
  v_mul_f32 v227, v4, v227
  v_mul_f32 v228, v4, v228
  v_mul_f32 v229, v4, v229
  v_mul_f32 v230, v4, v230
  v_mul_f32 v231, v4, v231
  v_cvt_pk_bf16_f32 v224, v224, v225
  v_mfma_f32_16x16x32_bf16 v[44:47], a[144:147], v[144:147], v[92:95]
  v_cvt_pk_bf16_f32 v225, v226, v227
  v_cvt_pk_bf16_f32 v226, v228, v229
  v_cvt_pk_bf16_f32 v227, v230, v231
  buffer_store_dwordx4 v[224:227], v3, s[16:19], s76 offen offset:0 sc1
  v_mul_f32 v232, v6, v232
  v_mul_f32 v233, v6, v233
  v_mul_f32 v234, v6, v234
  v_mfma_f32_16x16x32_bf16 v[40:43], a[148:151], v[132:135], v[40:43]
  v_mul_f32 v235, v6, v235
  v_mul_f32 v236, v6, v236
  v_mul_f32 v237, v6, v237
  v_mul_f32 v238, v6, v238
  v_mul_f32 v239, v6, v239
  v_cvt_pk_bf16_f32 v232, v232, v233
  v_cvt_pk_bf16_f32 v233, v234, v235
  v_mfma_f32_16x16x32_bf16 v[44:47], a[148:151], v[148:151], v[44:47]
  v_cvt_pk_bf16_f32 v234, v236, v237
  v_cvt_pk_bf16_f32 v235, v238, v239
  buffer_store_dwordx4 v[232:235], v3, s[16:19], s76 offen offset:1024 sc1
  s_add_u32 s76, s76, 4096
  v_mul_f32 v240, v4, v240
  v_mul_f32 v241, v4, v241
  v_mul_f32 v242, v4, v242
  v_mfma_f32_16x16x32_bf16 v[40:43], a[152:155], v[136:139], v[40:43]
  v_mul_f32 v243, v4, v243
  v_mul_f32 v244, v4, v244
  v_mul_f32 v245, v4, v245
  v_mul_f32 v246, v4, v246
  v_mul_f32 v247, v4, v247
  v_cvt_pk_bf16_f32 v240, v240, v241
  v_cvt_pk_bf16_f32 v241, v242, v243
  v_mfma_f32_16x16x32_bf16 v[44:47], a[152:155], v[152:155], v[44:47]
  v_cvt_pk_bf16_f32 v242, v244, v245
  v_cvt_pk_bf16_f32 v243, v246, v247
  buffer_store_dwordx4 v[240:243], v3, s[16:19], s76 offen offset:0 sc1
  v_mul_f32 v248, v6, v248
  v_mul_f32 v249, v6, v249
  v_mul_f32 v250, v6, v250
  v_mul_f32 v251, v6, v251
  v_mfma_f32_16x16x32_bf16 v[40:43], a[156:159], v[140:143], v[40:43]
  v_mul_f32 v252, v6, v252
  v_mul_f32 v253, v6, v253
  v_mul_f32 v254, v6, v254
  v_mul_f32 v255, v6, v255
  v_cvt_pk_bf16_f32 v248, v248, v249
  v_cvt_pk_bf16_f32 v249, v250, v251
  v_cvt_pk_bf16_f32 v250, v252, v253
  v_mfma_f32_16x16x32_bf16 v[44:47], a[156:159], v[156:159], v[44:47]
  v_cvt_pk_bf16_f32 v251, v254, v255
  buffer_store_dwordx4 v[248:251], v3, s[16:19], s76 offen offset:1024 sc1
  s_add_u32 s76, s76, 4096
  s_sub_u32 s43, s43, 32
  s_cmp_eq_u32 s41, 1
  s_cbranch_scc1 L_attn_kernel_fin
  s_mov_b32 s41, 1
  s_mov_b32 s48, 5
  s_branch L_attn_kernel_pass
L_rs0_20:
  s_mov_b32 s42, 16
  s_branch L_attn_kernel_rare0
L_rs0_30:
  s_mov_b32 s42, 1
  s_branch L_attn_kernel_rare0
L_rs0_36:
  s_mov_b32 s42, 2
  s_branch L_attn_kernel_rare0
L_rs0_45:
  s_mov_b32 s42, 19
  s_branch L_attn_kernel_rare0
L_rs0_53:
  s_mov_b32 s42, 4
  s_branch L_attn_kernel_rare0
L_attn_kernel_rare0:
  s_nop 7
  s_nop 7
  s_waitcnt lgkmcnt(0)
  s_cmp_lt_u32 s42, 16
  s_cbranch_scc1 L_rz_59
  v_mov_b32 v108, 0
  v_mov_b32 v109, 0
  v_mov_b32 v110, 0
  v_mov_b32 v111, 0
  v_mov_b32 v112, 0
  v_mov_b32 v113, 0
  v_mov_b32 v114, 0
  v_mov_b32 v115, 0
  s_sub_u32 s42, s42, 16
L_rz_59:
  v_max3_f32 v4, v32, v33, v34
  v_max3_f32 v5, v36, v37, v38
  v_max3_f32 v4, v4, v35, v40
  v_max3_f32 v5, v5, v39, v44
  v_max3_f32 v4, v4, v41, v42
  v_max3_f32 v5, v5, v45, v46
  v_max_f32 v4, v4, v43
  v_max_f32 v5, v5, v47
  v_mov_b32 v12, v4
  v_mov_b32 v13, v5
  s_nop 0
  v_permlane16_swap_b32 v4, v12
  v_permlane16_swap_b32 v5, v13
  s_nop 0
  v_max_f32 v4, v4, v12
  v_max_f32 v5, v5, v13
  v_mov_b32 v12, v4
  v_mov_b32 v13, v5
  s_nop 0
  v_permlane32_swap_b32 v4, v12
  v_permlane32_swap_b32 v5, v13
  s_nop 0
  v_max_f32 v4, v4, v12
  v_max_f32 v5, v5, v13
  v_max_f32 v12, 1.0, v108
  v_log_f32 v12, v12
  s_nop 0
  v_add_f32 v12, 0xc1200000, v12
  v_max3_f32 v7, 0, v4, v12
  v_sub_f32 v9, 0, v7
  v_exp_f32 v9, v9
  v_sub_f32 v96, v96, v7
  v_mul_f32 v108, v108, v9
  v_mul_f32 v109, v109, v9
  v_mul_f32 v110, v110, v9
  v_mul_f32 v111, v111, v9
  v_mov_b32 v80, v96
  v_mov_b32 v81, v96
  v_mov_b32 v82, v96
  v_mov_b32 v83, v96
  v_mov_b32 v88, v96
  v_mov_b32 v89, v96
  v_mov_b32 v90, v96
  v_mov_b32 v91, v96
  v_sub_f32 v32, v32, v7
  v_sub_f32 v48, v48, v7
  v_sub_f32 v33, v33, v7
  v_sub_f32 v49, v49, v7
  v_sub_f32 v34, v34, v7
  v_sub_f32 v50, v50, v7
  v_sub_f32 v35, v35, v7
  v_sub_f32 v51, v51, v7
  v_sub_f32 v40, v40, v7
  v_sub_f32 v56, v56, v7
  v_sub_f32 v41, v41, v7
  v_sub_f32 v57, v57, v7
  v_sub_f32 v42, v42, v7
  v_sub_f32 v58, v58, v7
  v_sub_f32 v43, v43, v7
  v_sub_f32 v59, v59, v7
  v_mul_f32 v192, v192, v9
  v_mul_f32 v193, v193, v9
  v_mul_f32 v194, v194, v9
  v_mul_f32 v195, v195, v9
  v_mul_f32 v196, v196, v9
  v_mul_f32 v197, v197, v9
  v_mul_f32 v198, v198, v9
  v_mul_f32 v199, v199, v9
  v_mul_f32 v208, v208, v9
  v_mul_f32 v209, v209, v9
  v_mul_f32 v210, v210, v9
  v_mul_f32 v211, v211, v9
  v_mul_f32 v212, v212, v9
  v_mul_f32 v213, v213, v9
  v_mul_f32 v214, v214, v9
  v_mul_f32 v215, v215, v9
  v_mul_f32 v224, v224, v9
  v_mul_f32 v225, v225, v9
  v_mul_f32 v226, v226, v9
  v_mul_f32 v227, v227, v9
  v_mul_f32 v228, v228, v9
  v_mul_f32 v229, v229, v9
  v_mul_f32 v230, v230, v9
  v_mul_f32 v231, v231, v9
  v_mul_f32 v240, v240, v9
  v_mul_f32 v241, v241, v9
  v_mul_f32 v242, v242, v9
  v_mul_f32 v243, v243, v9
  v_mul_f32 v244, v244, v9
  v_mul_f32 v245, v245, v9
  v_mul_f32 v246, v246, v9
  v_mul_f32 v247, v247, v9
  v_exp_f32 v12, v32
  v_exp_f32 v13, v33
  s_nop 0
  v_cvt_pk_bf16_f32 v64, v12, v13
  v_exp_f32 v12, v34
  v_exp_f32 v13, v35
  s_nop 0
  v_cvt_pk_bf16_f32 v65, v12, v13
  v_exp_f32 v12, v40
  v_exp_f32 v13, v41
  s_nop 0
  v_cvt_pk_bf16_f32 v66, v12, v13
  v_exp_f32 v12, v42
  v_exp_f32 v13, v43
  s_nop 0
  v_cvt_pk_bf16_f32 v67, v12, v13
  v_max_f32 v12, 1.0, v112
  v_log_f32 v12, v12
  s_nop 0
  v_add_f32 v12, 0xc1200000, v12
  v_max3_f32 v8, 0, v5, v12
  v_sub_f32 v10, 0, v8
  v_exp_f32 v10, v10
  v_sub_f32 v97, v97, v8
  v_mul_f32 v112, v112, v10
  v_mul_f32 v113, v113, v10
  v_mul_f32 v114, v114, v10
  v_mul_f32 v115, v115, v10
  v_mov_b32 v84, v97
  v_mov_b32 v85, v97
  v_mov_b32 v86, v97
  v_mov_b32 v87, v97
  v_mov_b32 v92, v97
  v_mov_b32 v93, v97
  v_mov_b32 v94, v97
  v_mov_b32 v95, v97
  v_sub_f32 v36, v36, v8
  v_sub_f32 v52, v52, v8
  v_sub_f32 v37, v37, v8
  v_sub_f32 v53, v53, v8
  v_sub_f32 v38, v38, v8
  v_sub_f32 v54, v54, v8
  v_sub_f32 v39, v39, v8
  v_sub_f32 v55, v55, v8
  v_sub_f32 v44, v44, v8
  v_sub_f32 v60, v60, v8
  v_sub_f32 v45, v45, v8
  v_sub_f32 v61, v61, v8
  v_sub_f32 v46, v46, v8
  v_sub_f32 v62, v62, v8
  v_sub_f32 v47, v47, v8
  v_sub_f32 v63, v63, v8
  v_mul_f32 v200, v200, v10
  v_mul_f32 v201, v201, v10
  v_mul_f32 v202, v202, v10
  v_mul_f32 v203, v203, v10
  v_mul_f32 v204, v204, v10
  v_mul_f32 v205, v205, v10
  v_mul_f32 v206, v206, v10
  v_mul_f32 v207, v207, v10
  v_mul_f32 v216, v216, v10
  v_mul_f32 v217, v217, v10
  v_mul_f32 v218, v218, v10
  v_mul_f32 v219, v219, v10
  v_mul_f32 v220, v220, v10
  v_mul_f32 v221, v221, v10
  v_mul_f32 v222, v222, v10
  v_mul_f32 v223, v223, v10
  v_mul_f32 v232, v232, v10
  v_mul_f32 v233, v233, v10
  v_mul_f32 v234, v234, v10
  v_mul_f32 v235, v235, v10
  v_mul_f32 v236, v236, v10
  v_mul_f32 v237, v237, v10
  v_mul_f32 v238, v238, v10
  v_mul_f32 v239, v239, v10
  v_mul_f32 v248, v248, v10
  v_mul_f32 v249, v249, v10
  v_mul_f32 v250, v250, v10
  v_mul_f32 v251, v251, v10
  v_mul_f32 v252, v252, v10
  v_mul_f32 v253, v253, v10
  v_mul_f32 v254, v254, v10
  v_mul_f32 v255, v255, v10
  v_exp_f32 v12, v36
  v_exp_f32 v13, v37
  s_nop 0
  v_cvt_pk_bf16_f32 v68, v12, v13
  v_exp_f32 v12, v38
  v_exp_f32 v13, v39
  s_nop 0
  v_cvt_pk_bf16_f32 v69, v12, v13
  v_exp_f32 v12, v44
  v_exp_f32 v13, v45
  s_nop 0
  v_cvt_pk_bf16_f32 v70, v12, v13
  v_exp_f32 v12, v46
  v_exp_f32 v13, v47
  s_nop 0
  v_cvt_pk_bf16_f32 v71, v12, v13
  s_nop 1
  v_mfma_f32_16x16x32_bf16 v[100:103], v[116:119], v[64:67], v[108:111]
  v_mfma_f32_16x16x32_bf16 v[104:107], v[116:119], v[68:71], v[112:115]
  s_nop 7
  s_nop 3
  s_cmp_eq_u32 s42, 0
  s_cbranch_scc1 L_rb0_21_t
  s_cmp_eq_u32 s42, 1
  s_cbranch_scc1 L_rb0_31_t
  s_cmp_eq_u32 s42, 2
  s_cbranch_scc1 L_rb0_37_t
  s_cmp_eq_u32 s42, 3
  s_cbranch_scc1 L_rb0_46_t
  s_cmp_eq_u32 s42, 4
  s_cbranch_scc1 L_rb0_54_t
L_rb0_54_t:
  s_cmp_lg_u32 s35, 0
  s_branch L_rb0_54
L_rb0_46_t:
  s_cmp_lg_u32 s35, 0
  s_branch L_rb0_46
L_rb0_37_t:
  s_cmp_lg_u32 s35, 0
  s_branch L_rb0_37
L_rb0_31_t:
  s_cmp_lg_u32 s35, 0
  s_branch L_rb0_31
L_rb0_21_t:
  s_cmp_lg_u32 s35, 0
  s_branch L_rb0_21
L_rs1_22:
  s_mov_b32 s42, 0
  s_branch L_attn_kernel_rare1
L_rs1_32:
  s_mov_b32 s42, 1
  s_branch L_attn_kernel_rare1
L_rs1_40:
  s_mov_b32 s42, 2
  s_branch L_attn_kernel_rare1
L_rs1_49:
  s_mov_b32 s42, 3
  s_branch L_attn_kernel_rare1
L_rs1_55:
  s_mov_b32 s42, 4
  s_branch L_attn_kernel_rare1
L_attn_kernel_rare1:
  s_nop 7
  s_nop 7
  s_waitcnt lgkmcnt(0)
  s_cmp_lt_u32 s42, 16
  s_cbranch_scc1 L_rz_60
  v_mov_b32 v100, 0
  v_mov_b32 v101, 0
  v_mov_b32 v102, 0
  v_mov_b32 v103, 0
  v_mov_b32 v104, 0
  v_mov_b32 v105, 0
  v_mov_b32 v106, 0
  v_mov_b32 v107, 0
  s_sub_u32 s42, s42, 16
L_rz_60:
  v_max3_f32 v4, v48, v49, v50
  v_max3_f32 v5, v52, v53, v54
  v_max3_f32 v4, v4, v51, v56
  v_max3_f32 v5, v5, v55, v60
  v_max3_f32 v4, v4, v57, v58
  v_max3_f32 v5, v5, v61, v62
  v_max_f32 v4, v4, v59
  v_max_f32 v5, v5, v63
  v_mov_b32 v12, v4
  v_mov_b32 v13, v5
  s_nop 0
  v_permlane16_swap_b32 v4, v12
  v_permlane16_swap_b32 v5, v13
  s_nop 0
  v_max_f32 v4, v4, v12
  v_max_f32 v5, v5, v13
  v_mov_b32 v12, v4
  v_mov_b32 v13, v5
  s_nop 0
  v_permlane32_swap_b32 v4, v12
  v_permlane32_swap_b32 v5, v13
  s_nop 0
  v_max_f32 v4, v4, v12
  v_max_f32 v5, v5, v13
  v_max_f32 v12, 1.0, v100
  v_log_f32 v12, v12
  s_nop 0
  v_add_f32 v12, 0xc1200000, v12
  v_max3_f32 v7, 0, v4, v12
  v_sub_f32 v9, 0, v7
  v_exp_f32 v9, v9
  v_sub_f32 v96, v96, v7
  v_mul_f32 v100, v100, v9
  v_mul_f32 v101, v101, v9
  v_mul_f32 v102, v102, v9
  v_mul_f32 v103, v103, v9
  v_mov_b32 v80, v96
  v_mov_b32 v81, v96
  v_mov_b32 v82, v96
  v_mov_b32 v83, v96
  v_mov_b32 v88, v96
  v_mov_b32 v89, v96
  v_mov_b32 v90, v96
  v_mov_b32 v91, v96
  v_sub_f32 v48, v48, v7
  v_sub_f32 v32, v32, v7
  v_sub_f32 v49, v49, v7
  v_sub_f32 v33, v33, v7
  v_sub_f32 v50, v50, v7
  v_sub_f32 v34, v34, v7
  v_sub_f32 v51, v51, v7
  v_sub_f32 v35, v35, v7
  v_sub_f32 v56, v56, v7
  v_sub_f32 v40, v40, v7
  v_sub_f32 v57, v57, v7
  v_sub_f32 v41, v41, v7
  v_sub_f32 v58, v58, v7
  v_sub_f32 v42, v42, v7
  v_sub_f32 v59, v59, v7
  v_sub_f32 v43, v43, v7
  v_mul_f32 v192, v192, v9
  v_mul_f32 v193, v193, v9
  v_mul_f32 v194, v194, v9
  v_mul_f32 v195, v195, v9
  v_mul_f32 v196, v196, v9
  v_mul_f32 v197, v197, v9
  v_mul_f32 v198, v198, v9
  v_mul_f32 v199, v199, v9
  v_mul_f32 v208, v208, v9
  v_mul_f32 v209, v209, v9
  v_mul_f32 v210, v210, v9
  v_mul_f32 v211, v211, v9
  v_mul_f32 v212, v212, v9
  v_mul_f32 v213, v213, v9
  v_mul_f32 v214, v214, v9
  v_mul_f32 v215, v215, v9
  v_mul_f32 v224, v224, v9
  v_mul_f32 v225, v225, v9
  v_mul_f32 v226, v226, v9
  v_mul_f32 v227, v227, v9
  v_mul_f32 v228, v228, v9
  v_mul_f32 v229, v229, v9
  v_mul_f32 v230, v230, v9
  v_mul_f32 v231, v231, v9
  v_mul_f32 v240, v240, v9
  v_mul_f32 v241, v241, v9
  v_mul_f32 v242, v242, v9
  v_mul_f32 v243, v243, v9
  v_mul_f32 v244, v244, v9
  v_mul_f32 v245, v245, v9
  v_mul_f32 v246, v246, v9
  v_mul_f32 v247, v247, v9
  v_exp_f32 v12, v48
  v_exp_f32 v13, v49
  s_nop 0
  v_cvt_pk_bf16_f32 v72, v12, v13
  v_exp_f32 v12, v50
  v_exp_f32 v13, v51
  s_nop 0
  v_cvt_pk_bf16_f32 v73, v12, v13
  v_exp_f32 v12, v56
  v_exp_f32 v13, v57
  s_nop 0
  v_cvt_pk_bf16_f32 v74, v12, v13
  v_exp_f32 v12, v58
  v_exp_f32 v13, v59
  s_nop 0
  v_cvt_pk_bf16_f32 v75, v12, v13
  v_max_f32 v12, 1.0, v104
  v_log_f32 v12, v12
  s_nop 0
  v_add_f32 v12, 0xc1200000, v12
  v_max3_f32 v8, 0, v5, v12
  v_sub_f32 v10, 0, v8
  v_exp_f32 v10, v10
  v_sub_f32 v97, v97, v8
  v_mul_f32 v104, v104, v10
  v_mul_f32 v105, v105, v10
  v_mul_f32 v106, v106, v10
  v_mul_f32 v107, v107, v10
  v_mov_b32 v84, v97
  v_mov_b32 v85, v97
  v_mov_b32 v86, v97
  v_mov_b32 v87, v97
  v_mov_b32 v92, v97
  v_mov_b32 v93, v97
  v_mov_b32 v94, v97
  v_mov_b32 v95, v97
  v_sub_f32 v52, v52, v8
  v_sub_f32 v36, v36, v8
  v_sub_f32 v53, v53, v8
  v_sub_f32 v37, v37, v8
  v_sub_f32 v54, v54, v8
  v_sub_f32 v38, v38, v8
  v_sub_f32 v55, v55, v8
  v_sub_f32 v39, v39, v8
  v_sub_f32 v60, v60, v8
  v_sub_f32 v44, v44, v8
  v_sub_f32 v61, v61, v8
  v_sub_f32 v45, v45, v8
  v_sub_f32 v62, v62, v8
  v_sub_f32 v46, v46, v8
  v_sub_f32 v63, v63, v8
  v_sub_f32 v47, v47, v8
  v_mul_f32 v200, v200, v10
  v_mul_f32 v201, v201, v10
  v_mul_f32 v202, v202, v10
  v_mul_f32 v203, v203, v10
  v_mul_f32 v204, v204, v10
  v_mul_f32 v205, v205, v10
  v_mul_f32 v206, v206, v10
  v_mul_f32 v207, v207, v10
  v_mul_f32 v216, v216, v10
  v_mul_f32 v217, v217, v10
  v_mul_f32 v218, v218, v10
  v_mul_f32 v219, v219, v10
  v_mul_f32 v220, v220, v10
  v_mul_f32 v221, v221, v10
  v_mul_f32 v222, v222, v10
  v_mul_f32 v223, v223, v10
  v_mul_f32 v232, v232, v10
  v_mul_f32 v233, v233, v10
  v_mul_f32 v234, v234, v10
  v_mul_f32 v235, v235, v10
  v_mul_f32 v236, v236, v10
  v_mul_f32 v237, v237, v10
  v_mul_f32 v238, v238, v10
  v_mul_f32 v239, v239, v10
  v_mul_f32 v248, v248, v10
  v_mul_f32 v249, v249, v10
  v_mul_f32 v250, v250, v10
  v_mul_f32 v251, v251, v10
  v_mul_f32 v252, v252, v10
  v_mul_f32 v253, v253, v10
  v_mul_f32 v254, v254, v10
  v_mul_f32 v255, v255, v10
  v_exp_f32 v12, v52
  v_exp_f32 v13, v53
  s_nop 0
  v_cvt_pk_bf16_f32 v76, v12, v13
  v_exp_f32 v12, v54
  v_exp_f32 v13, v55
  s_nop 0
  v_cvt_pk_bf16_f32 v77, v12, v13
  v_exp_f32 v12, v60
  v_exp_f32 v13, v61
  s_nop 0
  v_cvt_pk_bf16_f32 v78, v12, v13
  v_exp_f32 v12, v62
  v_exp_f32 v13, v63
  s_nop 0
  v_cvt_pk_bf16_f32 v79, v12, v13
  s_nop 1
  v_mfma_f32_16x16x32_bf16 v[108:111], v[116:119], v[72:75], v[100:103]
  v_mfma_f32_16x16x32_bf16 v[112:115], v[116:119], v[76:79], v[104:107]
  s_nop 7
  s_nop 3
  s_cmp_eq_u32 s42, 0
  s_cbranch_scc1 L_rb1_23_t
  s_cmp_eq_u32 s42, 1
  s_cbranch_scc1 L_rb1_33_t
  s_cmp_eq_u32 s42, 2
  s_cbranch_scc1 L_rb1_41_t
  s_cmp_eq_u32 s42, 3
  s_cbranch_scc1 L_rb1_50_t
  s_cmp_eq_u32 s42, 4
  s_cbranch_scc1 L_rb1_56_t
L_rb1_56_t:
  s_cmp_lg_u32 s35, 0
  s_branch L_rb1_56
L_rb1_50_t:
  s_cmp_lg_u32 s35, 0
  s_branch L_rb1_50
L_rb1_41_t:
  s_cmp_lg_u32 s35, 0
  s_branch L_rb1_41
L_rb1_33_t:
  s_cmp_lg_u32 s35, 0
  s_branch L_rb1_33
L_rb1_23_t:
  s_cmp_lg_u32 s35, 0
  s_branch L_rb1_23
L_attn_kernel_fin:
L_attn_kernel_tail:
  s_load_dwordx2 s[64:65], s[0:1], 112
  s_load_dwordx2 s[66:67], s[0:1], 0
  s_load_dwordx2 s[68:69], s[0:1], 96
  s_load_dwordx4 s[72:75], s[0:1], 56
  v_mov_b32 v28, 1
  s_sub_u32 s78, 15, s25
  s_lshl_b32 s78, s78, 8
  s_lshl_b32 s79, s25, 8
  v_mov_b32 v29, s78
  v_mov_b32 v30, s79
  v_mov_b32 v31, 0x4000000
  v_cmp_eq_u32 vcc, 1, v2
  s_nop 1
  v_cndmask_b32 v29, v29, v30, vcc
  v_cmp_gt_u32 vcc, 2, v2
  s_nop 1
  v_cndmask_b32 v29, v31, v29, vcc
  s_mov_b32 s78, 311296
  s_waitcnt vmcnt(0)
  s_barrier
  s_cmp_lg_u32 s3, 0
  s_cbranch_scc1 L_sg_61
  buffer_atomic_add v28, v29, s[16:19], s78 offen sc1
L_sg_61:
  s_waitcnt lgkmcnt(0)
  s_mov_b32 s24, s66
  s_and_b32 s25, s67, 0xffff
  s_mov_b32 s26, 0x200000
  s_mov_b32 s27, 0x20000
  s_mov_b32 s28, s68
  s_and_b32 s29, s69, 0xffff
  s_mov_b32 s30, 0x200000
  s_mov_b32 s31, 0x20000
  s_and_b32 s32, s2, 7
  s_lshl_b32 s32, s32, 2
  s_lshr_b32 s37, s2, 3
  s_and_b32 s37, s37, 3
  s_add_u32 s32, s32, s37
  s_lshr_b32 s33, s2, 5
  v_lshlrev_b32 v3, 4, v2
  s_mul_i32 s34, s32, 128
  s_mul_i32 s37, s3, 32
  s_add_u32 s34, s34, s37
  s_lshl_b32 s34, s34, 12
  s_add_u32 s34, s34, 0x1000000
  s_mul_i32 s35, s33, 128
  s_add_u32 s35, s35, s37
  s_lshl_b32 s35, s35, 12
  s_add_u32 s35, s35, 0x400000
  v_mov_b32 v18, 0
  s_and_b32 s78, s2, 7
  s_lshl_b32 s78, s78, 8
  s_add_u32 s78, s78, 315392
  s_cmp_lg_u32 s3, 0
  s_cbranch_scc1 L_aw_62
  s_mov_b32 s81, 0
L_as_63:
  buffer_load_dword v19, v18, s[16:19], s78 offen sc1
  s_waitcnt vmcnt(0)
  v_readfirstlane_b32 s80, v19
  s_add_u32 s81, s81, 1
  s_nop 2
  s_cmp_ge_u32 s80, 256
  s_cbranch_scc1 L_ao_64
  s_sleep 4
  s_cmp_lt_u32 s81, 0x80000
  s_cbranch_scc1 L_as_63
L_ao_64:
L_aw_62:
  s_barrier
  buffer_load_dwordx4 a[128:131], v3, s[16:19], s35 offen offset:0 sc1
  buffer_load_dwordx4 a[132:135], v3, s[16:19], s35 offen offset:1024 sc1
  buffer_load_dwordx4 a[136:139], v3, s[16:19], s35 offen offset:2048 sc1
  buffer_load_dwordx4 a[140:143], v3, s[16:19], s35 offen offset:3072 sc1
  s_add_u32 s35, s35, 4096
  buffer_load_dwordx4 a[144:147], v3, s[16:19], s35 offen offset:0 sc1
  buffer_load_dwordx4 a[148:151], v3, s[16:19], s35 offen offset:1024 sc1
  buffer_load_dwordx4 a[152:155], v3, s[16:19], s35 offen offset:2048 sc1
  buffer_load_dwordx4 a[156:159], v3, s[16:19], s35 offen offset:3072 sc1
  s_add_u32 s35, s35, 4096
  buffer_load_dwordx4 a[160:163], v3, s[16:19], s35 offen offset:0 sc1
  buffer_load_dwordx4 a[164:167], v3, s[16:19], s35 offen offset:1024 sc1
  buffer_load_dwordx4 a[168:171], v3, s[16:19], s35 offen offset:2048 sc1
  buffer_load_dwordx4 a[172:175], v3, s[16:19], s35 offen offset:3072 sc1
  s_add_u32 s35, s35, 4096
  buffer_load_dwordx4 a[176:179], v3, s[16:19], s35 offen offset:0 sc1
  buffer_load_dwordx4 a[180:183], v3, s[16:19], s35 offen offset:1024 sc1
  buffer_load_dwordx4 a[184:187], v3, s[16:19], s35 offen offset:2048 sc1
  buffer_load_dwordx4 a[188:191], v3, s[16:19], s35 offen offset:3072 sc1
  s_add_u32 s35, s35, 4096
  buffer_load_dwordx4 a[192:195], v3, s[16:19], s35 offen offset:0 sc1
  buffer_load_dwordx4 a[196:199], v3, s[16:19], s35 offen offset:1024 sc1
  buffer_load_dwordx4 a[200:203], v3, s[16:19], s35 offen offset:2048 sc1
  buffer_load_dwordx4 a[204:207], v3, s[16:19], s35 offen offset:3072 sc1
  s_add_u32 s35, s35, 4096
  buffer_load_dwordx4 a[208:211], v3, s[16:19], s35 offen offset:0 sc1
  buffer_load_dwordx4 a[212:215], v3, s[16:19], s35 offen offset:1024 sc1
  buffer_load_dwordx4 a[216:219], v3, s[16:19], s35 offen offset:2048 sc1
  buffer_load_dwordx4 a[220:223], v3, s[16:19], s35 offen offset:3072 sc1
  s_add_u32 s35, s35, 4096
  v_mov_b32 v21, 0
  s_lshr_b32 s78, s32, 1
  s_lshl_b32 s78, s78, 8
  s_add_u32 s78, s78, 311296
  s_cmp_lg_u32 s3, 0
  s_cbranch_scc1 L_aw_65
  s_mov_b32 s81, 0
L_as_66:
  buffer_load_dword v22, v21, s[16:19], s78 offen sc1
  s_waitcnt vmcnt(0)
  v_readfirstlane_b32 s80, v22
  s_add_u32 s81, s81, 1
  s_nop 2
  s_cmp_ge_u32 s80, 32
  s_cbranch_scc1 L_ao_67
  s_sleep 4
  s_cmp_lt_u32 s81, 0x80000
  s_cbranch_scc1 L_as_66
L_ao_67:
L_aw_65:
  s_barrier
  buffer_load_dwordx4 a[0:3], v3, s[16:19], s34 offen offset:0 sc1
  buffer_load_dwordx4 a[4:7], v3, s[16:19], s34 offen offset:1024 sc1
  buffer_load_dwordx4 a[8:11], v3, s[16:19], s34 offen offset:2048 sc1
  buffer_load_dwordx4 a[12:15], v3, s[16:19], s34 offen offset:3072 sc1
  s_add_u32 s34, s34, 4096
  buffer_load_dwordx4 a[16:19], v3, s[16:19], s34 offen offset:0 sc1
  buffer_load_dwordx4 a[20:23], v3, s[16:19], s34 offen offset:1024 sc1
  buffer_load_dwordx4 a[24:27], v3, s[16:19], s34 offen offset:2048 sc1
  buffer_load_dwordx4 a[28:31], v3, s[16:19], s34 offen offset:3072 sc1
  s_add_u32 s34, s34, 4096
  buffer_load_dwordx4 a[32:35], v3, s[16:19], s34 offen offset:0 sc1
  buffer_load_dwordx4 a[36:39], v3, s[16:19], s34 offen offset:1024 sc1
  buffer_load_dwordx4 a[40:43], v3, s[16:19], s34 offen offset:2048 sc1
  buffer_load_dwordx4 a[44:47], v3, s[16:19], s34 offen offset:3072 sc1
  s_add_u32 s34, s34, 4096
  buffer_load_dwordx4 a[48:51], v3, s[16:19], s34 offen offset:0 sc1
  buffer_load_dwordx4 a[52:55], v3, s[16:19], s34 offen offset:1024 sc1
  buffer_load_dwordx4 a[56:59], v3, s[16:19], s34 offen offset:2048 sc1
  buffer_load_dwordx4 a[60:63], v3, s[16:19], s34 offen offset:3072 sc1
  s_add_u32 s34, s34, 4096
  s_waitcnt vmcnt(12)
  v_mfma_f32_16x16x32_bf16 v[64:67], a[128:131], a[0:3], 0
  v_mfma_f32_16x16x32_bf16 v[80:83], a[128:131], a[4:7], 0
  buffer_load_dwordx4 a[64:67], v3, s[16:19], s34 offen offset:0 sc1
  v_mfma_f32_16x16x32_bf16 v[96:99], a[128:131], a[8:11], 0
  v_mfma_f32_16x16x32_bf16 v[112:115], a[128:131], a[12:15], 0
  buffer_load_dwordx4 a[68:71], v3, s[16:19], s34 offen offset:1024 sc1
  v_mfma_f32_16x16x32_bf16 v[68:71], a[132:135], a[0:3], 0
  v_mfma_f32_16x16x32_bf16 v[84:87], a[132:135], a[4:7], 0
  buffer_load_dwordx4 a[72:75], v3, s[16:19], s34 offen offset:2048 sc1
  v_mfma_f32_16x16x32_bf16 v[100:103], a[132:135], a[8:11], 0
  v_mfma_f32_16x16x32_bf16 v[116:119], a[132:135], a[12:15], 0
  buffer_load_dwordx4 a[76:79], v3, s[16:19], s34 offen offset:3072 sc1
  v_mfma_f32_16x16x32_bf16 v[72:75], a[136:139], a[0:3], 0
  s_add_u32 s34, s34, 4096
  v_mfma_f32_16x16x32_bf16 v[88:91], a[136:139], a[4:7], 0
  buffer_load_dwordx4 a[80:83], v3, s[16:19], s34 offen offset:0 sc1
  v_mfma_f32_16x16x32_bf16 v[104:107], a[136:139], a[8:11], 0
  v_mfma_f32_16x16x32_bf16 v[120:123], a[136:139], a[12:15], 0
  buffer_load_dwordx4 a[84:87], v3, s[16:19], s34 offen offset:1024 sc1
  v_mfma_f32_16x16x32_bf16 v[76:79], a[140:143], a[0:3], 0
  v_mfma_f32_16x16x32_bf16 v[92:95], a[140:143], a[4:7], 0
  buffer_load_dwordx4 a[88:91], v3, s[16:19], s34 offen offset:2048 sc1
  v_mfma_f32_16x16x32_bf16 v[108:111], a[140:143], a[8:11], 0
  v_mfma_f32_16x16x32_bf16 v[124:127], a[140:143], a[12:15], 0
  buffer_load_dwordx4 a[92:95], v3, s[16:19], s34 offen offset:3072 sc1
  s_add_u32 s34, s34, 4096
  s_waitcnt vmcnt(16)
  v_mfma_f32_16x16x32_bf16 v[64:67], a[144:147], a[16:19], v[64:67]
  buffer_load_dwordx4 a[224:227], v3, s[16:19], s35 offen offset:0 sc1
  v_mfma_f32_16x16x32_bf16 v[80:83], a[144:147], a[20:23], v[80:83]
  buffer_load_dwordx4 a[228:231], v3, s[16:19], s35 offen offset:1024 sc1
  v_mfma_f32_16x16x32_bf16 v[96:99], a[144:147], a[24:27], v[96:99]
  buffer_load_dwordx4 a[232:235], v3, s[16:19], s35 offen offset:2048 sc1
  v_mfma_f32_16x16x32_bf16 v[112:115], a[144:147], a[28:31], v[112:115]
  buffer_load_dwordx4 a[236:239], v3, s[16:19], s35 offen offset:3072 sc1
  s_add_u32 s35, s35, 4096
  v_mfma_f32_16x16x32_bf16 v[68:71], a[148:151], a[16:19], v[68:71]
  buffer_load_dwordx4 a[96:99], v3, s[16:19], s34 offen offset:0 sc1
  v_mfma_f32_16x16x32_bf16 v[84:87], a[148:151], a[20:23], v[84:87]
  buffer_load_dwordx4 a[100:103], v3, s[16:19], s34 offen offset:1024 sc1
  v_mfma_f32_16x16x32_bf16 v[100:103], a[148:151], a[24:27], v[100:103]
  buffer_load_dwordx4 a[104:107], v3, s[16:19], s34 offen offset:2048 sc1
  v_mfma_f32_16x16x32_bf16 v[116:119], a[148:151], a[28:31], v[116:119]
  buffer_load_dwordx4 a[108:111], v3, s[16:19], s34 offen offset:3072 sc1
  s_add_u32 s34, s34, 4096
  v_mfma_f32_16x16x32_bf16 v[72:75], a[152:155], a[16:19], v[72:75]
  buffer_load_dwordx4 a[240:243], v3, s[16:19], s35 offen offset:0 sc1
  v_mfma_f32_16x16x32_bf16 v[88:91], a[152:155], a[20:23], v[88:91]
  buffer_load_dwordx4 a[244:247], v3, s[16:19], s35 offen offset:1024 sc1
  v_mfma_f32_16x16x32_bf16 v[104:107], a[152:155], a[24:27], v[104:107]
  buffer_load_dwordx4 a[248:251], v3, s[16:19], s35 offen offset:2048 sc1
  v_mfma_f32_16x16x32_bf16 v[120:123], a[152:155], a[28:31], v[120:123]
  buffer_load_dwordx4 a[252:255], v3, s[16:19], s35 offen offset:3072 sc1
  s_add_u32 s35, s35, 4096
  v_mfma_f32_16x16x32_bf16 v[76:79], a[156:159], a[16:19], v[76:79]
  buffer_load_dwordx4 a[112:115], v3, s[16:19], s34 offen offset:0 sc1
  v_mfma_f32_16x16x32_bf16 v[92:95], a[156:159], a[20:23], v[92:95]
  buffer_load_dwordx4 a[116:119], v3, s[16:19], s34 offen offset:1024 sc1
  v_mfma_f32_16x16x32_bf16 v[108:111], a[156:159], a[24:27], v[108:111]
  buffer_load_dwordx4 a[120:123], v3, s[16:19], s34 offen offset:2048 sc1
  v_mfma_f32_16x16x32_bf16 v[124:127], a[156:159], a[28:31], v[124:127]
  buffer_load_dwordx4 a[124:127], v3, s[16:19], s34 offen offset:3072 sc1
  s_add_u32 s34, s34, 4096
  s_waitcnt vmcnt(28)
  v_mfma_f32_16x16x32_bf16 v[64:67], a[160:163], a[32:35], v[64:67]
  buffer_load_dwordx4 a[128:131], v3, s[16:19], s35 offen offset:0 sc1
  v_mfma_f32_16x16x32_bf16 v[80:83], a[160:163], a[36:39], v[80:83]
  buffer_load_dwordx4 a[132:135], v3, s[16:19], s35 offen offset:1024 sc1
  v_mfma_f32_16x16x32_bf16 v[96:99], a[160:163], a[40:43], v[96:99]
  buffer_load_dwordx4 a[136:139], v3, s[16:19], s35 offen offset:2048 sc1
  v_mfma_f32_16x16x32_bf16 v[112:115], a[160:163], a[44:47], v[112:115]
  buffer_load_dwordx4 a[140:143], v3, s[16:19], s35 offen offset:3072 sc1
  s_add_u32 s35, s35, 4096
  v_mfma_f32_16x16x32_bf16 v[68:71], a[164:167], a[32:35], v[68:71]
  buffer_load_dwordx4 a[0:3], v3, s[16:19], s34 offen offset:0 sc1
  v_mfma_f32_16x16x32_bf16 v[84:87], a[164:167], a[36:39], v[84:87]
  buffer_load_dwordx4 a[4:7], v3, s[16:19], s34 offen offset:1024 sc1
  v_mfma_f32_16x16x32_bf16 v[100:103], a[164:167], a[40:43], v[100:103]
  buffer_load_dwordx4 a[8:11], v3, s[16:19], s34 offen offset:2048 sc1
  v_mfma_f32_16x16x32_bf16 v[116:119], a[164:167], a[44:47], v[116:119]
  buffer_load_dwordx4 a[12:15], v3, s[16:19], s34 offen offset:3072 sc1
  s_add_u32 s34, s34, 4096
  v_mfma_f32_16x16x32_bf16 v[72:75], a[168:171], a[32:35], v[72:75]
  buffer_load_dwordx4 a[144:147], v3, s[16:19], s35 offen offset:0 sc1
  v_mfma_f32_16x16x32_bf16 v[88:91], a[168:171], a[36:39], v[88:91]
  buffer_load_dwordx4 a[148:151], v3, s[16:19], s35 offen offset:1024 sc1
  v_mfma_f32_16x16x32_bf16 v[104:107], a[168:171], a[40:43], v[104:107]
  buffer_load_dwordx4 a[152:155], v3, s[16:19], s35 offen offset:2048 sc1
  v_mfma_f32_16x16x32_bf16 v[120:123], a[168:171], a[44:47], v[120:123]
  buffer_load_dwordx4 a[156:159], v3, s[16:19], s35 offen offset:3072 sc1
  s_add_u32 s35, s35, 4096
  v_mfma_f32_16x16x32_bf16 v[76:79], a[172:175], a[32:35], v[76:79]
  buffer_load_dwordx4 a[16:19], v3, s[16:19], s34 offen offset:0 sc1
  v_mfma_f32_16x16x32_bf16 v[92:95], a[172:175], a[36:39], v[92:95]
  buffer_load_dwordx4 a[20:23], v3, s[16:19], s34 offen offset:1024 sc1
  v_mfma_f32_16x16x32_bf16 v[108:111], a[172:175], a[40:43], v[108:111]
  buffer_load_dwordx4 a[24:27], v3, s[16:19], s34 offen offset:2048 sc1
  v_mfma_f32_16x16x32_bf16 v[124:127], a[172:175], a[44:47], v[124:127]
  buffer_load_dwordx4 a[28:31], v3, s[16:19], s34 offen offset:3072 sc1
  s_add_u32 s34, s34, 4096
  s_waitcnt vmcnt(40)
  v_mfma_f32_16x16x32_bf16 v[64:67], a[176:179], a[48:51], v[64:67]
  v_mfma_f32_16x16x32_bf16 v[80:83], a[176:179], a[52:55], v[80:83]
  buffer_load_dwordx4 a[160:163], v3, s[16:19], s35 offen offset:0 sc1
  v_mfma_f32_16x16x32_bf16 v[96:99], a[176:179], a[56:59], v[96:99]
  v_mfma_f32_16x16x32_bf16 v[112:115], a[176:179], a[60:63], v[112:115]
  buffer_load_dwordx4 a[164:167], v3, s[16:19], s35 offen offset:1024 sc1
  v_mfma_f32_16x16x32_bf16 v[68:71], a[180:183], a[48:51], v[68:71]
  v_mfma_f32_16x16x32_bf16 v[84:87], a[180:183], a[52:55], v[84:87]
  buffer_load_dwordx4 a[168:171], v3, s[16:19], s35 offen offset:2048 sc1
  v_mfma_f32_16x16x32_bf16 v[100:103], a[180:183], a[56:59], v[100:103]
  v_mfma_f32_16x16x32_bf16 v[116:119], a[180:183], a[60:63], v[116:119]
  buffer_load_dwordx4 a[172:175], v3, s[16:19], s35 offen offset:3072 sc1
  v_mfma_f32_16x16x32_bf16 v[72:75], a[184:187], a[48:51], v[72:75]
  s_add_u32 s35, s35, 4096
  v_mfma_f32_16x16x32_bf16 v[88:91], a[184:187], a[52:55], v[88:91]
  buffer_load_dwordx4 a[32:35], v3, s[16:19], s34 offen offset:0 sc1
  v_mfma_f32_16x16x32_bf16 v[104:107], a[184:187], a[56:59], v[104:107]
  v_mfma_f32_16x16x32_bf16 v[120:123], a[184:187], a[60:63], v[120:123]
  buffer_load_dwordx4 a[36:39], v3, s[16:19], s34 offen offset:1024 sc1
  v_mfma_f32_16x16x32_bf16 v[76:79], a[188:191], a[48:51], v[76:79]
  v_mfma_f32_16x16x32_bf16 v[92:95], a[188:191], a[52:55], v[92:95]
  buffer_load_dwordx4 a[40:43], v3, s[16:19], s34 offen offset:2048 sc1
  v_mfma_f32_16x16x32_bf16 v[108:111], a[188:191], a[56:59], v[108:111]
  v_mfma_f32_16x16x32_bf16 v[124:127], a[188:191], a[60:63], v[124:127]
  buffer_load_dwordx4 a[44:47], v3, s[16:19], s34 offen offset:3072 sc1
  s_add_u32 s34, s34, 4096
  s_waitcnt vmcnt(44)
  v_mfma_f32_16x16x32_bf16 v[64:67], a[192:195], a[64:67], v[64:67]
  v_mfma_f32_16x16x32_bf16 v[80:83], a[192:195], a[68:71], v[80:83]
  buffer_load_dwordx4 a[176:179], v3, s[16:19], s35 offen offset:0 sc1
  v_mfma_f32_16x16x32_bf16 v[96:99], a[192:195], a[72:75], v[96:99]
  v_mfma_f32_16x16x32_bf16 v[112:115], a[192:195], a[76:79], v[112:115]
  buffer_load_dwordx4 a[180:183], v3, s[16:19], s35 offen offset:1024 sc1
  v_mfma_f32_16x16x32_bf16 v[68:71], a[196:199], a[64:67], v[68:71]
  v_mfma_f32_16x16x32_bf16 v[84:87], a[196:199], a[68:71], v[84:87]
  buffer_load_dwordx4 a[184:187], v3, s[16:19], s35 offen offset:2048 sc1
  v_mfma_f32_16x16x32_bf16 v[100:103], a[196:199], a[72:75], v[100:103]
  v_mfma_f32_16x16x32_bf16 v[116:119], a[196:199], a[76:79], v[116:119]
  buffer_load_dwordx4 a[188:191], v3, s[16:19], s35 offen offset:3072 sc1
  v_mfma_f32_16x16x32_bf16 v[72:75], a[200:203], a[64:67], v[72:75]
  s_add_u32 s35, s35, 4096
  v_mfma_f32_16x16x32_bf16 v[88:91], a[200:203], a[68:71], v[88:91]
  buffer_load_dwordx4 a[48:51], v3, s[16:19], s34 offen offset:0 sc1
  v_mfma_f32_16x16x32_bf16 v[104:107], a[200:203], a[72:75], v[104:107]
  v_mfma_f32_16x16x32_bf16 v[120:123], a[200:203], a[76:79], v[120:123]
  buffer_load_dwordx4 a[52:55], v3, s[16:19], s34 offen offset:1024 sc1
  v_mfma_f32_16x16x32_bf16 v[76:79], a[204:207], a[64:67], v[76:79]
  v_mfma_f32_16x16x32_bf16 v[92:95], a[204:207], a[68:71], v[92:95]
  buffer_load_dwordx4 a[56:59], v3, s[16:19], s34 offen offset:2048 sc1
  v_mfma_f32_16x16x32_bf16 v[108:111], a[204:207], a[72:75], v[108:111]
  v_mfma_f32_16x16x32_bf16 v[124:127], a[204:207], a[76:79], v[124:127]
  buffer_load_dwordx4 a[60:63], v3, s[16:19], s34 offen offset:3072 sc1
  s_add_u32 s34, s34, 4096
  s_waitcnt vmcnt(48)
  v_mfma_f32_16x16x32_bf16 v[64:67], a[208:211], a[80:83], v[64:67]
  v_mfma_f32_16x16x32_bf16 v[80:83], a[208:211], a[84:87], v[80:83]
  buffer_load_dwordx4 a[192:195], v3, s[16:19], s35 offen offset:0 sc1
  v_mfma_f32_16x16x32_bf16 v[96:99], a[208:211], a[88:91], v[96:99]
  v_mfma_f32_16x16x32_bf16 v[112:115], a[208:211], a[92:95], v[112:115]
  buffer_load_dwordx4 a[196:199], v3, s[16:19], s35 offen offset:1024 sc1
  v_mfma_f32_16x16x32_bf16 v[68:71], a[212:215], a[80:83], v[68:71]
  v_mfma_f32_16x16x32_bf16 v[84:87], a[212:215], a[84:87], v[84:87]
  buffer_load_dwordx4 a[200:203], v3, s[16:19], s35 offen offset:2048 sc1
  v_mfma_f32_16x16x32_bf16 v[100:103], a[212:215], a[88:91], v[100:103]
  v_mfma_f32_16x16x32_bf16 v[116:119], a[212:215], a[92:95], v[116:119]
  buffer_load_dwordx4 a[204:207], v3, s[16:19], s35 offen offset:3072 sc1
  v_mfma_f32_16x16x32_bf16 v[72:75], a[216:219], a[80:83], v[72:75]
  s_add_u32 s35, s35, 4096
  v_mfma_f32_16x16x32_bf16 v[88:91], a[216:219], a[84:87], v[88:91]
  buffer_load_dwordx4 a[64:67], v3, s[16:19], s34 offen offset:0 sc1
  v_mfma_f32_16x16x32_bf16 v[104:107], a[216:219], a[88:91], v[104:107]
  v_mfma_f32_16x16x32_bf16 v[120:123], a[216:219], a[92:95], v[120:123]
  buffer_load_dwordx4 a[68:71], v3, s[16:19], s34 offen offset:1024 sc1
  v_mfma_f32_16x16x32_bf16 v[76:79], a[220:223], a[80:83], v[76:79]
  v_mfma_f32_16x16x32_bf16 v[92:95], a[220:223], a[84:87], v[92:95]
  buffer_load_dwordx4 a[72:75], v3, s[16:19], s34 offen offset:2048 sc1
  v_mfma_f32_16x16x32_bf16 v[108:111], a[220:223], a[88:91], v[108:111]
  v_mfma_f32_16x16x32_bf16 v[124:127], a[220:223], a[92:95], v[124:127]
  buffer_load_dwordx4 a[76:79], v3, s[16:19], s34 offen offset:3072 sc1
  s_add_u32 s34, s34, 4096
  s_waitcnt vmcnt(48)
  v_mfma_f32_16x16x32_bf16 v[64:67], a[224:227], a[96:99], v[64:67]
  v_mfma_f32_16x16x32_bf16 v[80:83], a[224:227], a[100:103], v[80:83]
  buffer_load_dwordx4 a[208:211], v3, s[16:19], s35 offen offset:0 sc1
  v_mfma_f32_16x16x32_bf16 v[96:99], a[224:227], a[104:107], v[96:99]
  v_mfma_f32_16x16x32_bf16 v[112:115], a[224:227], a[108:111], v[112:115]
  buffer_load_dwordx4 a[212:215], v3, s[16:19], s35 offen offset:1024 sc1
  v_mfma_f32_16x16x32_bf16 v[68:71], a[228:231], a[96:99], v[68:71]
  v_mfma_f32_16x16x32_bf16 v[84:87], a[228:231], a[100:103], v[84:87]
  buffer_load_dwordx4 a[216:219], v3, s[16:19], s35 offen offset:2048 sc1
  v_mfma_f32_16x16x32_bf16 v[100:103], a[228:231], a[104:107], v[100:103]
  v_mfma_f32_16x16x32_bf16 v[116:119], a[228:231], a[108:111], v[116:119]
  buffer_load_dwordx4 a[220:223], v3, s[16:19], s35 offen offset:3072 sc1
  v_mfma_f32_16x16x32_bf16 v[72:75], a[232:235], a[96:99], v[72:75]
  s_add_u32 s35, s35, 4096
  v_mfma_f32_16x16x32_bf16 v[88:91], a[232:235], a[100:103], v[88:91]
  buffer_load_dwordx4 a[80:83], v3, s[16:19], s34 offen offset:0 sc1
  v_mfma_f32_16x16x32_bf16 v[104:107], a[232:235], a[104:107], v[104:107]
  v_mfma_f32_16x16x32_bf16 v[120:123], a[232:235], a[108:111], v[120:123]
  buffer_load_dwordx4 a[84:87], v3, s[16:19], s34 offen offset:1024 sc1
  v_mfma_f32_16x16x32_bf16 v[76:79], a[236:239], a[96:99], v[76:79]
  v_mfma_f32_16x16x32_bf16 v[92:95], a[236:239], a[100:103], v[92:95]
  buffer_load_dwordx4 a[88:91], v3, s[16:19], s34 offen offset:2048 sc1
  v_mfma_f32_16x16x32_bf16 v[108:111], a[236:239], a[104:107], v[108:111]
  v_mfma_f32_16x16x32_bf16 v[124:127], a[236:239], a[108:111], v[124:127]
  buffer_load_dwordx4 a[92:95], v3, s[16:19], s34 offen offset:3072 sc1
  s_add_u32 s34, s34, 4096
  s_waitcnt vmcnt(48)
  v_mfma_f32_16x16x32_bf16 v[64:67], a[240:243], a[112:115], v[64:67]
  v_mfma_f32_16x16x32_bf16 v[80:83], a[240:243], a[116:119], v[80:83]
  buffer_load_dwordx4 a[224:227], v3, s[16:19], s35 offen offset:0 sc1
  v_mfma_f32_16x16x32_bf16 v[96:99], a[240:243], a[120:123], v[96:99]
  v_mfma_f32_16x16x32_bf16 v[112:115], a[240:243], a[124:127], v[112:115]
  buffer_load_dwordx4 a[228:231], v3, s[16:19], s35 offen offset:1024 sc1
  v_mfma_f32_16x16x32_bf16 v[68:71], a[244:247], a[112:115], v[68:71]
  v_mfma_f32_16x16x32_bf16 v[84:87], a[244:247], a[116:119], v[84:87]
  buffer_load_dwordx4 a[232:235], v3, s[16:19], s35 offen offset:2048 sc1
  v_mfma_f32_16x16x32_bf16 v[100:103], a[244:247], a[120:123], v[100:103]
  v_mfma_f32_16x16x32_bf16 v[116:119], a[244:247], a[124:127], v[116:119]
  buffer_load_dwordx4 a[236:239], v3, s[16:19], s35 offen offset:3072 sc1
  v_mfma_f32_16x16x32_bf16 v[72:75], a[248:251], a[112:115], v[72:75]
  s_add_u32 s35, s35, 4096
  v_mfma_f32_16x16x32_bf16 v[88:91], a[248:251], a[116:119], v[88:91]
  buffer_load_dwordx4 a[96:99], v3, s[16:19], s34 offen offset:0 sc1
  v_mfma_f32_16x16x32_bf16 v[104:107], a[248:251], a[120:123], v[104:107]
  v_mfma_f32_16x16x32_bf16 v[120:123], a[248:251], a[124:127], v[120:123]
  buffer_load_dwordx4 a[100:103], v3, s[16:19], s34 offen offset:1024 sc1
  v_mfma_f32_16x16x32_bf16 v[76:79], a[252:255], a[112:115], v[76:79]
  v_mfma_f32_16x16x32_bf16 v[92:95], a[252:255], a[116:119], v[92:95]
  buffer_load_dwordx4 a[104:107], v3, s[16:19], s34 offen offset:2048 sc1
  v_mfma_f32_16x16x32_bf16 v[108:111], a[252:255], a[120:123], v[108:111]
  v_mfma_f32_16x16x32_bf16 v[124:127], a[252:255], a[124:127], v[124:127]
  buffer_load_dwordx4 a[108:111], v3, s[16:19], s34 offen offset:3072 sc1
  s_add_u32 s34, s34, 4096
  s_waitcnt vmcnt(48)
  v_mfma_f32_16x16x32_bf16 v[64:67], a[128:131], a[0:3], v[64:67]
  v_mfma_f32_16x16x32_bf16 v[80:83], a[128:131], a[4:7], v[80:83]
  buffer_load_dwordx4 a[240:243], v3, s[16:19], s35 offen offset:0 sc1
  v_mfma_f32_16x16x32_bf16 v[96:99], a[128:131], a[8:11], v[96:99]
  v_mfma_f32_16x16x32_bf16 v[112:115], a[128:131], a[12:15], v[112:115]
  buffer_load_dwordx4 a[244:247], v3, s[16:19], s35 offen offset:1024 sc1
  v_mfma_f32_16x16x32_bf16 v[68:71], a[132:135], a[0:3], v[68:71]
  v_mfma_f32_16x16x32_bf16 v[84:87], a[132:135], a[4:7], v[84:87]
  buffer_load_dwordx4 a[248:251], v3, s[16:19], s35 offen offset:2048 sc1
  v_mfma_f32_16x16x32_bf16 v[100:103], a[132:135], a[8:11], v[100:103]
  v_mfma_f32_16x16x32_bf16 v[116:119], a[132:135], a[12:15], v[116:119]
  buffer_load_dwordx4 a[252:255], v3, s[16:19], s35 offen offset:3072 sc1
  v_mfma_f32_16x16x32_bf16 v[72:75], a[136:139], a[0:3], v[72:75]
  s_add_u32 s35, s35, 4096
  v_mfma_f32_16x16x32_bf16 v[88:91], a[136:139], a[4:7], v[88:91]
  buffer_load_dwordx4 a[112:115], v3, s[16:19], s34 offen offset:0 sc1
  v_mfma_f32_16x16x32_bf16 v[104:107], a[136:139], a[8:11], v[104:107]
  v_mfma_f32_16x16x32_bf16 v[120:123], a[136:139], a[12:15], v[120:123]
  buffer_load_dwordx4 a[116:119], v3, s[16:19], s34 offen offset:1024 sc1
  v_mfma_f32_16x16x32_bf16 v[76:79], a[140:143], a[0:3], v[76:79]
  v_mfma_f32_16x16x32_bf16 v[92:95], a[140:143], a[4:7], v[92:95]
  buffer_load_dwordx4 a[120:123], v3, s[16:19], s34 offen offset:2048 sc1
  v_mfma_f32_16x16x32_bf16 v[108:111], a[140:143], a[8:11], v[108:111]
  v_mfma_f32_16x16x32_bf16 v[124:127], a[140:143], a[12:15], v[124:127]
  buffer_load_dwordx4 a[124:127], v3, s[16:19], s34 offen offset:3072 sc1
  s_add_u32 s34, s34, 4096
  s_waitcnt vmcnt(48)
  v_mfma_f32_16x16x32_bf16 v[64:67], a[144:147], a[16:19], v[64:67]
  v_mfma_f32_16x16x32_bf16 v[80:83], a[144:147], a[20:23], v[80:83]
  buffer_load_dwordx4 a[128:131], v3, s[16:19], s35 offen offset:0 sc1
  v_mfma_f32_16x16x32_bf16 v[96:99], a[144:147], a[24:27], v[96:99]
  v_mfma_f32_16x16x32_bf16 v[112:115], a[144:147], a[28:31], v[112:115]
  buffer_load_dwordx4 a[132:135], v3, s[16:19], s35 offen offset:1024 sc1
  v_mfma_f32_16x16x32_bf16 v[68:71], a[148:151], a[16:19], v[68:71]
  v_mfma_f32_16x16x32_bf16 v[84:87], a[148:151], a[20:23], v[84:87]
  buffer_load_dwordx4 a[136:139], v3, s[16:19], s35 offen offset:2048 sc1
  v_mfma_f32_16x16x32_bf16 v[100:103], a[148:151], a[24:27], v[100:103]
  v_mfma_f32_16x16x32_bf16 v[116:119], a[148:151], a[28:31], v[116:119]
  buffer_load_dwordx4 a[140:143], v3, s[16:19], s35 offen offset:3072 sc1
  v_mfma_f32_16x16x32_bf16 v[72:75], a[152:155], a[16:19], v[72:75]
  s_add_u32 s35, s35, 4096
  v_mfma_f32_16x16x32_bf16 v[88:91], a[152:155], a[20:23], v[88:91]
  buffer_load_dwordx4 a[0:3], v3, s[16:19], s34 offen offset:0 sc1
  v_mfma_f32_16x16x32_bf16 v[104:107], a[152:155], a[24:27], v[104:107]
  v_mfma_f32_16x16x32_bf16 v[120:123], a[152:155], a[28:31], v[120:123]
  buffer_load_dwordx4 a[4:7], v3, s[16:19], s34 offen offset:1024 sc1
  v_mfma_f32_16x16x32_bf16 v[76:79], a[156:159], a[16:19], v[76:79]
  v_mfma_f32_16x16x32_bf16 v[92:95], a[156:159], a[20:23], v[92:95]
  buffer_load_dwordx4 a[8:11], v3, s[16:19], s34 offen offset:2048 sc1
  v_mfma_f32_16x16x32_bf16 v[108:111], a[156:159], a[24:27], v[108:111]
  v_mfma_f32_16x16x32_bf16 v[124:127], a[156:159], a[28:31], v[124:127]
  buffer_load_dwordx4 a[12:15], v3, s[16:19], s34 offen offset:3072 sc1
  s_add_u32 s34, s34, 4096
  s_waitcnt vmcnt(48)
  v_mfma_f32_16x16x32_bf16 v[64:67], a[160:163], a[32:35], v[64:67]
  v_mfma_f32_16x16x32_bf16 v[80:83], a[160:163], a[36:39], v[80:83]
  buffer_load_dwordx4 a[144:147], v3, s[16:19], s35 offen offset:0 sc1
  v_mfma_f32_16x16x32_bf16 v[96:99], a[160:163], a[40:43], v[96:99]
  v_mfma_f32_16x16x32_bf16 v[112:115], a[160:163], a[44:47], v[112:115]
  buffer_load_dwordx4 a[148:151], v3, s[16:19], s35 offen offset:1024 sc1
  v_mfma_f32_16x16x32_bf16 v[68:71], a[164:167], a[32:35], v[68:71]
  v_mfma_f32_16x16x32_bf16 v[84:87], a[164:167], a[36:39], v[84:87]
  buffer_load_dwordx4 a[152:155], v3, s[16:19], s35 offen offset:2048 sc1
  v_mfma_f32_16x16x32_bf16 v[100:103], a[164:167], a[40:43], v[100:103]
  v_mfma_f32_16x16x32_bf16 v[116:119], a[164:167], a[44:47], v[116:119]
  buffer_load_dwordx4 a[156:159], v3, s[16:19], s35 offen offset:3072 sc1
  v_mfma_f32_16x16x32_bf16 v[72:75], a[168:171], a[32:35], v[72:75]
  s_add_u32 s35, s35, 4096
  v_mfma_f32_16x16x32_bf16 v[88:91], a[168:171], a[36:39], v[88:91]
  buffer_load_dwordx4 a[16:19], v3, s[16:19], s34 offen offset:0 sc1
  v_mfma_f32_16x16x32_bf16 v[104:107], a[168:171], a[40:43], v[104:107]
  v_mfma_f32_16x16x32_bf16 v[120:123], a[168:171], a[44:47], v[120:123]
  buffer_load_dwordx4 a[20:23], v3, s[16:19], s34 offen offset:1024 sc1
  v_mfma_f32_16x16x32_bf16 v[76:79], a[172:175], a[32:35], v[76:79]
  v_mfma_f32_16x16x32_bf16 v[92:95], a[172:175], a[36:39], v[92:95]
  buffer_load_dwordx4 a[24:27], v3, s[16:19], s34 offen offset:2048 sc1
  v_mfma_f32_16x16x32_bf16 v[108:111], a[172:175], a[40:43], v[108:111]
  v_mfma_f32_16x16x32_bf16 v[124:127], a[172:175], a[44:47], v[124:127]
  buffer_load_dwordx4 a[28:31], v3, s[16:19], s34 offen offset:3072 sc1
  s_add_u32 s34, s34, 4096
  s_waitcnt vmcnt(48)
  v_mfma_f32_16x16x32_bf16 v[64:67], a[176:179], a[48:51], v[64:67]
  v_mfma_f32_16x16x32_bf16 v[80:83], a[176:179], a[52:55], v[80:83]
  buffer_load_dwordx4 a[160:163], v3, s[16:19], s35 offen offset:0 sc1
  v_mfma_f32_16x16x32_bf16 v[96:99], a[176:179], a[56:59], v[96:99]
  v_mfma_f32_16x16x32_bf16 v[112:115], a[176:179], a[60:63], v[112:115]
  buffer_load_dwordx4 a[164:167], v3, s[16:19], s35 offen offset:1024 sc1
  v_mfma_f32_16x16x32_bf16 v[68:71], a[180:183], a[48:51], v[68:71]
  v_mfma_f32_16x16x32_bf16 v[84:87], a[180:183], a[52:55], v[84:87]
  buffer_load_dwordx4 a[168:171], v3, s[16:19], s35 offen offset:2048 sc1
  v_mfma_f32_16x16x32_bf16 v[100:103], a[180:183], a[56:59], v[100:103]
  v_mfma_f32_16x16x32_bf16 v[116:119], a[180:183], a[60:63], v[116:119]
  buffer_load_dwordx4 a[172:175], v3, s[16:19], s35 offen offset:3072 sc1
  v_mfma_f32_16x16x32_bf16 v[72:75], a[184:187], a[48:51], v[72:75]
  s_add_u32 s35, s35, 4096
  v_mfma_f32_16x16x32_bf16 v[88:91], a[184:187], a[52:55], v[88:91]
  buffer_load_dwordx4 a[32:35], v3, s[16:19], s34 offen offset:0 sc1
  v_mfma_f32_16x16x32_bf16 v[104:107], a[184:187], a[56:59], v[104:107]
  v_mfma_f32_16x16x32_bf16 v[120:123], a[184:187], a[60:63], v[120:123]
  buffer_load_dwordx4 a[36:39], v3, s[16:19], s34 offen offset:1024 sc1
  v_mfma_f32_16x16x32_bf16 v[76:79], a[188:191], a[48:51], v[76:79]
  v_mfma_f32_16x16x32_bf16 v[92:95], a[188:191], a[52:55], v[92:95]
  buffer_load_dwordx4 a[40:43], v3, s[16:19], s34 offen offset:2048 sc1
  v_mfma_f32_16x16x32_bf16 v[108:111], a[188:191], a[56:59], v[108:111]
  v_mfma_f32_16x16x32_bf16 v[124:127], a[188:191], a[60:63], v[124:127]
  buffer_load_dwordx4 a[44:47], v3, s[16:19], s34 offen offset:3072 sc1
  s_add_u32 s34, s34, 4096
  s_waitcnt vmcnt(48)
  v_mfma_f32_16x16x32_bf16 v[64:67], a[192:195], a[64:67], v[64:67]
  v_mfma_f32_16x16x32_bf16 v[80:83], a[192:195], a[68:71], v[80:83]
  buffer_load_dwordx4 a[176:179], v3, s[16:19], s35 offen offset:0 sc1
  v_mfma_f32_16x16x32_bf16 v[96:99], a[192:195], a[72:75], v[96:99]
  v_mfma_f32_16x16x32_bf16 v[112:115], a[192:195], a[76:79], v[112:115]
  buffer_load_dwordx4 a[180:183], v3, s[16:19], s35 offen offset:1024 sc1
  v_mfma_f32_16x16x32_bf16 v[68:71], a[196:199], a[64:67], v[68:71]
  v_mfma_f32_16x16x32_bf16 v[84:87], a[196:199], a[68:71], v[84:87]
  buffer_load_dwordx4 a[184:187], v3, s[16:19], s35 offen offset:2048 sc1
  v_mfma_f32_16x16x32_bf16 v[100:103], a[196:199], a[72:75], v[100:103]
  v_mfma_f32_16x16x32_bf16 v[116:119], a[196:199], a[76:79], v[116:119]
  buffer_load_dwordx4 a[188:191], v3, s[16:19], s35 offen offset:3072 sc1
  v_mfma_f32_16x16x32_bf16 v[72:75], a[200:203], a[64:67], v[72:75]
  s_add_u32 s35, s35, 4096
  v_mfma_f32_16x16x32_bf16 v[88:91], a[200:203], a[68:71], v[88:91]
  buffer_load_dwordx4 a[48:51], v3, s[16:19], s34 offen offset:0 sc1
  v_mfma_f32_16x16x32_bf16 v[104:107], a[200:203], a[72:75], v[104:107]
  v_mfma_f32_16x16x32_bf16 v[120:123], a[200:203], a[76:79], v[120:123]
  buffer_load_dwordx4 a[52:55], v3, s[16:19], s34 offen offset:1024 sc1
  v_mfma_f32_16x16x32_bf16 v[76:79], a[204:207], a[64:67], v[76:79]
  v_mfma_f32_16x16x32_bf16 v[92:95], a[204:207], a[68:71], v[92:95]
  buffer_load_dwordx4 a[56:59], v3, s[16:19], s34 offen offset:2048 sc1
  v_mfma_f32_16x16x32_bf16 v[108:111], a[204:207], a[72:75], v[108:111]
  v_mfma_f32_16x16x32_bf16 v[124:127], a[204:207], a[76:79], v[124:127]
  buffer_load_dwordx4 a[60:63], v3, s[16:19], s34 offen offset:3072 sc1
  s_add_u32 s34, s34, 4096
  s_waitcnt vmcnt(48)
  v_mfma_f32_16x16x32_bf16 v[64:67], a[208:211], a[80:83], v[64:67]
  v_mfma_f32_16x16x32_bf16 v[80:83], a[208:211], a[84:87], v[80:83]
  buffer_load_dwordx4 a[192:195], v3, s[16:19], s35 offen offset:0 sc1
  v_mfma_f32_16x16x32_bf16 v[96:99], a[208:211], a[88:91], v[96:99]
  v_mfma_f32_16x16x32_bf16 v[112:115], a[208:211], a[92:95], v[112:115]
  buffer_load_dwordx4 a[196:199], v3, s[16:19], s35 offen offset:1024 sc1
  v_mfma_f32_16x16x32_bf16 v[68:71], a[212:215], a[80:83], v[68:71]
  v_mfma_f32_16x16x32_bf16 v[84:87], a[212:215], a[84:87], v[84:87]
  buffer_load_dwordx4 a[200:203], v3, s[16:19], s35 offen offset:2048 sc1
  v_mfma_f32_16x16x32_bf16 v[100:103], a[212:215], a[88:91], v[100:103]
  v_mfma_f32_16x16x32_bf16 v[116:119], a[212:215], a[92:95], v[116:119]
  buffer_load_dwordx4 a[204:207], v3, s[16:19], s35 offen offset:3072 sc1
  v_mfma_f32_16x16x32_bf16 v[72:75], a[216:219], a[80:83], v[72:75]
  s_add_u32 s35, s35, 4096
  v_mfma_f32_16x16x32_bf16 v[88:91], a[216:219], a[84:87], v[88:91]
  buffer_load_dwordx4 a[64:67], v3, s[16:19], s34 offen offset:0 sc1
  v_mfma_f32_16x16x32_bf16 v[104:107], a[216:219], a[88:91], v[104:107]
  v_mfma_f32_16x16x32_bf16 v[120:123], a[216:219], a[92:95], v[120:123]
  buffer_load_dwordx4 a[68:71], v3, s[16:19], s34 offen offset:1024 sc1
  v_mfma_f32_16x16x32_bf16 v[76:79], a[220:223], a[80:83], v[76:79]
  v_mfma_f32_16x16x32_bf16 v[92:95], a[220:223], a[84:87], v[92:95]
  buffer_load_dwordx4 a[72:75], v3, s[16:19], s34 offen offset:2048 sc1
  v_mfma_f32_16x16x32_bf16 v[108:111], a[220:223], a[88:91], v[108:111]
  v_mfma_f32_16x16x32_bf16 v[124:127], a[220:223], a[92:95], v[124:127]
  buffer_load_dwordx4 a[76:79], v3, s[16:19], s34 offen offset:3072 sc1
  s_add_u32 s34, s34, 4096
  s_waitcnt vmcnt(48)
  v_mfma_f32_16x16x32_bf16 v[64:67], a[224:227], a[96:99], v[64:67]
  v_mfma_f32_16x16x32_bf16 v[80:83], a[224:227], a[100:103], v[80:83]
  buffer_load_dwordx4 a[208:211], v3, s[16:19], s35 offen offset:0 sc1
  v_mfma_f32_16x16x32_bf16 v[96:99], a[224:227], a[104:107], v[96:99]
  v_mfma_f32_16x16x32_bf16 v[112:115], a[224:227], a[108:111], v[112:115]
  buffer_load_dwordx4 a[212:215], v3, s[16:19], s35 offen offset:1024 sc1
  v_mfma_f32_16x16x32_bf16 v[68:71], a[228:231], a[96:99], v[68:71]
  v_mfma_f32_16x16x32_bf16 v[84:87], a[228:231], a[100:103], v[84:87]
  buffer_load_dwordx4 a[216:219], v3, s[16:19], s35 offen offset:2048 sc1
  v_mfma_f32_16x16x32_bf16 v[100:103], a[228:231], a[104:107], v[100:103]
  v_mfma_f32_16x16x32_bf16 v[116:119], a[228:231], a[108:111], v[116:119]
  buffer_load_dwordx4 a[220:223], v3, s[16:19], s35 offen offset:3072 sc1
  v_mfma_f32_16x16x32_bf16 v[72:75], a[232:235], a[96:99], v[72:75]
  s_add_u32 s35, s35, 4096
  v_mfma_f32_16x16x32_bf16 v[88:91], a[232:235], a[100:103], v[88:91]
  buffer_load_dwordx4 a[80:83], v3, s[16:19], s34 offen offset:0 sc1
  v_mfma_f32_16x16x32_bf16 v[104:107], a[232:235], a[104:107], v[104:107]
  v_mfma_f32_16x16x32_bf16 v[120:123], a[232:235], a[108:111], v[120:123]
  buffer_load_dwordx4 a[84:87], v3, s[16:19], s34 offen offset:1024 sc1
  v_mfma_f32_16x16x32_bf16 v[76:79], a[236:239], a[96:99], v[76:79]
  v_mfma_f32_16x16x32_bf16 v[92:95], a[236:239], a[100:103], v[92:95]
  buffer_load_dwordx4 a[88:91], v3, s[16:19], s34 offen offset:2048 sc1
  v_mfma_f32_16x16x32_bf16 v[108:111], a[236:239], a[104:107], v[108:111]
  v_mfma_f32_16x16x32_bf16 v[124:127], a[236:239], a[108:111], v[124:127]
  buffer_load_dwordx4 a[92:95], v3, s[16:19], s34 offen offset:3072 sc1
  s_add_u32 s34, s34, 4096
  s_waitcnt vmcnt(48)
  v_mfma_f32_16x16x32_bf16 v[64:67], a[240:243], a[112:115], v[64:67]
  v_mfma_f32_16x16x32_bf16 v[80:83], a[240:243], a[116:119], v[80:83]
  buffer_load_dwordx4 a[224:227], v3, s[16:19], s35 offen offset:0 sc1
  v_mfma_f32_16x16x32_bf16 v[96:99], a[240:243], a[120:123], v[96:99]
  v_mfma_f32_16x16x32_bf16 v[112:115], a[240:243], a[124:127], v[112:115]
  buffer_load_dwordx4 a[228:231], v3, s[16:19], s35 offen offset:1024 sc1
  v_mfma_f32_16x16x32_bf16 v[68:71], a[244:247], a[112:115], v[68:71]
  v_mfma_f32_16x16x32_bf16 v[84:87], a[244:247], a[116:119], v[84:87]
  buffer_load_dwordx4 a[232:235], v3, s[16:19], s35 offen offset:2048 sc1
  v_mfma_f32_16x16x32_bf16 v[100:103], a[244:247], a[120:123], v[100:103]
  v_mfma_f32_16x16x32_bf16 v[116:119], a[244:247], a[124:127], v[116:119]
  buffer_load_dwordx4 a[236:239], v3, s[16:19], s35 offen offset:3072 sc1
  v_mfma_f32_16x16x32_bf16 v[72:75], a[248:251], a[112:115], v[72:75]
  s_add_u32 s35, s35, 4096
  v_mfma_f32_16x16x32_bf16 v[88:91], a[248:251], a[116:119], v[88:91]
  buffer_load_dwordx4 a[96:99], v3, s[16:19], s34 offen offset:0 sc1
  v_mfma_f32_16x16x32_bf16 v[104:107], a[248:251], a[120:123], v[104:107]
  v_mfma_f32_16x16x32_bf16 v[120:123], a[248:251], a[124:127], v[120:123]
  buffer_load_dwordx4 a[100:103], v3, s[16:19], s34 offen offset:1024 sc1
  v_mfma_f32_16x16x32_bf16 v[76:79], a[252:255], a[112:115], v[76:79]
  v_mfma_f32_16x16x32_bf16 v[92:95], a[252:255], a[116:119], v[92:95]
  buffer_load_dwordx4 a[104:107], v3, s[16:19], s34 offen offset:2048 sc1
  v_mfma_f32_16x16x32_bf16 v[108:111], a[252:255], a[120:123], v[108:111]
  v_mfma_f32_16x16x32_bf16 v[124:127], a[252:255], a[124:127], v[124:127]
  buffer_load_dwordx4 a[108:111], v3, s[16:19], s34 offen offset:3072 sc1
  s_add_u32 s34, s34, 4096
  s_waitcnt vmcnt(48)
  v_mfma_f32_16x16x32_bf16 v[64:67], a[128:131], a[0:3], v[64:67]
  v_mfma_f32_16x16x32_bf16 v[80:83], a[128:131], a[4:7], v[80:83]
  buffer_load_dwordx4 a[240:243], v3, s[16:19], s35 offen offset:0 sc1
  v_mfma_f32_16x16x32_bf16 v[96:99], a[128:131], a[8:11], v[96:99]
  v_mfma_f32_16x16x32_bf16 v[112:115], a[128:131], a[12:15], v[112:115]
  buffer_load_dwordx4 a[244:247], v3, s[16:19], s35 offen offset:1024 sc1
  v_mfma_f32_16x16x32_bf16 v[68:71], a[132:135], a[0:3], v[68:71]
  v_mfma_f32_16x16x32_bf16 v[84:87], a[132:135], a[4:7], v[84:87]
  buffer_load_dwordx4 a[248:251], v3, s[16:19], s35 offen offset:2048 sc1
  v_mfma_f32_16x16x32_bf16 v[100:103], a[132:135], a[8:11], v[100:103]
  v_mfma_f32_16x16x32_bf16 v[116:119], a[132:135], a[12:15], v[116:119]
  buffer_load_dwordx4 a[252:255], v3, s[16:19], s35 offen offset:3072 sc1
  v_mfma_f32_16x16x32_bf16 v[72:75], a[136:139], a[0:3], v[72:75]
  s_add_u32 s35, s35, 4096
  v_mfma_f32_16x16x32_bf16 v[88:91], a[136:139], a[4:7], v[88:91]
  buffer_load_dwordx4 a[112:115], v3, s[16:19], s34 offen offset:0 sc1
  v_mfma_f32_16x16x32_bf16 v[104:107], a[136:139], a[8:11], v[104:107]
  v_mfma_f32_16x16x32_bf16 v[120:123], a[136:139], a[12:15], v[120:123]
  buffer_load_dwordx4 a[116:119], v3, s[16:19], s34 offen offset:1024 sc1
  v_mfma_f32_16x16x32_bf16 v[76:79], a[140:143], a[0:3], v[76:79]
  v_mfma_f32_16x16x32_bf16 v[92:95], a[140:143], a[4:7], v[92:95]
  buffer_load_dwordx4 a[120:123], v3, s[16:19], s34 offen offset:2048 sc1
  v_mfma_f32_16x16x32_bf16 v[108:111], a[140:143], a[8:11], v[108:111]
  v_mfma_f32_16x16x32_bf16 v[124:127], a[140:143], a[12:15], v[124:127]
  buffer_load_dwordx4 a[124:127], v3, s[16:19], s34 offen offset:3072 sc1
  s_add_u32 s34, s34, 4096
  s_waitcnt vmcnt(48)
  v_mfma_f32_16x16x32_bf16 v[64:67], a[144:147], a[16:19], v[64:67]
  v_mfma_f32_16x16x32_bf16 v[80:83], a[144:147], a[20:23], v[80:83]
  buffer_load_dwordx4 a[128:131], v3, s[16:19], s35 offen offset:0 sc1
  v_mfma_f32_16x16x32_bf16 v[96:99], a[144:147], a[24:27], v[96:99]
  v_mfma_f32_16x16x32_bf16 v[112:115], a[144:147], a[28:31], v[112:115]
  buffer_load_dwordx4 a[132:135], v3, s[16:19], s35 offen offset:1024 sc1
  v_mfma_f32_16x16x32_bf16 v[68:71], a[148:151], a[16:19], v[68:71]
  v_mfma_f32_16x16x32_bf16 v[84:87], a[148:151], a[20:23], v[84:87]
  buffer_load_dwordx4 a[136:139], v3, s[16:19], s35 offen offset:2048 sc1
  v_mfma_f32_16x16x32_bf16 v[100:103], a[148:151], a[24:27], v[100:103]
  v_mfma_f32_16x16x32_bf16 v[116:119], a[148:151], a[28:31], v[116:119]
  buffer_load_dwordx4 a[140:143], v3, s[16:19], s35 offen offset:3072 sc1
  v_mfma_f32_16x16x32_bf16 v[72:75], a[152:155], a[16:19], v[72:75]
  s_add_u32 s35, s35, 4096
  v_mfma_f32_16x16x32_bf16 v[88:91], a[152:155], a[20:23], v[88:91]
  buffer_load_dwordx4 a[0:3], v3, s[16:19], s34 offen offset:0 sc1
  v_mfma_f32_16x16x32_bf16 v[104:107], a[152:155], a[24:27], v[104:107]
  v_mfma_f32_16x16x32_bf16 v[120:123], a[152:155], a[28:31], v[120:123]
  buffer_load_dwordx4 a[4:7], v3, s[16:19], s34 offen offset:1024 sc1
  v_mfma_f32_16x16x32_bf16 v[76:79], a[156:159], a[16:19], v[76:79]
  v_mfma_f32_16x16x32_bf16 v[92:95], a[156:159], a[20:23], v[92:95]
  buffer_load_dwordx4 a[8:11], v3, s[16:19], s34 offen offset:2048 sc1
  v_mfma_f32_16x16x32_bf16 v[108:111], a[156:159], a[24:27], v[108:111]
  v_mfma_f32_16x16x32_bf16 v[124:127], a[156:159], a[28:31], v[124:127]
  buffer_load_dwordx4 a[12:15], v3, s[16:19], s34 offen offset:3072 sc1
  s_add_u32 s34, s34, 4096
  s_waitcnt vmcnt(48)
  v_mfma_f32_16x16x32_bf16 v[64:67], a[160:163], a[32:35], v[64:67]
  v_mfma_f32_16x16x32_bf16 v[80:83], a[160:163], a[36:39], v[80:83]
  buffer_load_dwordx4 a[144:147], v3, s[16:19], s35 offen offset:0 sc1
  v_mfma_f32_16x16x32_bf16 v[96:99], a[160:163], a[40:43], v[96:99]
  v_mfma_f32_16x16x32_bf16 v[112:115], a[160:163], a[44:47], v[112:115]
  buffer_load_dwordx4 a[148:151], v3, s[16:19], s35 offen offset:1024 sc1
  v_mfma_f32_16x16x32_bf16 v[68:71], a[164:167], a[32:35], v[68:71]
  v_mfma_f32_16x16x32_bf16 v[84:87], a[164:167], a[36:39], v[84:87]
  buffer_load_dwordx4 a[152:155], v3, s[16:19], s35 offen offset:2048 sc1
  v_mfma_f32_16x16x32_bf16 v[100:103], a[164:167], a[40:43], v[100:103]
  v_mfma_f32_16x16x32_bf16 v[116:119], a[164:167], a[44:47], v[116:119]
  buffer_load_dwordx4 a[156:159], v3, s[16:19], s35 offen offset:3072 sc1
  v_mfma_f32_16x16x32_bf16 v[72:75], a[168:171], a[32:35], v[72:75]
  s_add_u32 s35, s35, 4096
  v_mfma_f32_16x16x32_bf16 v[88:91], a[168:171], a[36:39], v[88:91]
  buffer_load_dwordx4 a[16:19], v3, s[16:19], s34 offen offset:0 sc1
  v_mfma_f32_16x16x32_bf16 v[104:107], a[168:171], a[40:43], v[104:107]
  v_mfma_f32_16x16x32_bf16 v[120:123], a[168:171], a[44:47], v[120:123]
  buffer_load_dwordx4 a[20:23], v3, s[16:19], s34 offen offset:1024 sc1
  v_mfma_f32_16x16x32_bf16 v[76:79], a[172:175], a[32:35], v[76:79]
  v_mfma_f32_16x16x32_bf16 v[92:95], a[172:175], a[36:39], v[92:95]
  buffer_load_dwordx4 a[24:27], v3, s[16:19], s34 offen offset:2048 sc1
  v_mfma_f32_16x16x32_bf16 v[108:111], a[172:175], a[40:43], v[108:111]
  v_mfma_f32_16x16x32_bf16 v[124:127], a[172:175], a[44:47], v[124:127]
  buffer_load_dwordx4 a[28:31], v3, s[16:19], s34 offen offset:3072 sc1
  s_add_u32 s34, s34, 4096
  s_waitcnt vmcnt(48)
  v_mfma_f32_16x16x32_bf16 v[64:67], a[176:179], a[48:51], v[64:67]
  v_mfma_f32_16x16x32_bf16 v[80:83], a[176:179], a[52:55], v[80:83]
  buffer_load_dwordx4 a[160:163], v3, s[16:19], s35 offen offset:0 sc1
  v_mfma_f32_16x16x32_bf16 v[96:99], a[176:179], a[56:59], v[96:99]
  v_mfma_f32_16x16x32_bf16 v[112:115], a[176:179], a[60:63], v[112:115]
  buffer_load_dwordx4 a[164:167], v3, s[16:19], s35 offen offset:1024 sc1
  v_mfma_f32_16x16x32_bf16 v[68:71], a[180:183], a[48:51], v[68:71]
  v_mfma_f32_16x16x32_bf16 v[84:87], a[180:183], a[52:55], v[84:87]
  buffer_load_dwordx4 a[168:171], v3, s[16:19], s35 offen offset:2048 sc1
  v_mfma_f32_16x16x32_bf16 v[100:103], a[180:183], a[56:59], v[100:103]
  v_mfma_f32_16x16x32_bf16 v[116:119], a[180:183], a[60:63], v[116:119]
  buffer_load_dwordx4 a[172:175], v3, s[16:19], s35 offen offset:3072 sc1
  v_mfma_f32_16x16x32_bf16 v[72:75], a[184:187], a[48:51], v[72:75]
  s_add_u32 s35, s35, 4096
  v_mfma_f32_16x16x32_bf16 v[88:91], a[184:187], a[52:55], v[88:91]
  buffer_load_dwordx4 a[32:35], v3, s[16:19], s34 offen offset:0 sc1
  v_mfma_f32_16x16x32_bf16 v[104:107], a[184:187], a[56:59], v[104:107]
  v_mfma_f32_16x16x32_bf16 v[120:123], a[184:187], a[60:63], v[120:123]
  buffer_load_dwordx4 a[36:39], v3, s[16:19], s34 offen offset:1024 sc1
  v_mfma_f32_16x16x32_bf16 v[76:79], a[188:191], a[48:51], v[76:79]
  v_mfma_f32_16x16x32_bf16 v[92:95], a[188:191], a[52:55], v[92:95]
  buffer_load_dwordx4 a[40:43], v3, s[16:19], s34 offen offset:2048 sc1
  v_mfma_f32_16x16x32_bf16 v[108:111], a[188:191], a[56:59], v[108:111]
  v_mfma_f32_16x16x32_bf16 v[124:127], a[188:191], a[60:63], v[124:127]
  buffer_load_dwordx4 a[44:47], v3, s[16:19], s34 offen offset:3072 sc1
  s_add_u32 s34, s34, 4096
  s_waitcnt vmcnt(48)
  v_mfma_f32_16x16x32_bf16 v[64:67], a[192:195], a[64:67], v[64:67]
  v_mfma_f32_16x16x32_bf16 v[80:83], a[192:195], a[68:71], v[80:83]
  buffer_load_dwordx4 a[176:179], v3, s[16:19], s35 offen offset:0 sc1
  v_mfma_f32_16x16x32_bf16 v[96:99], a[192:195], a[72:75], v[96:99]
  v_mfma_f32_16x16x32_bf16 v[112:115], a[192:195], a[76:79], v[112:115]
  buffer_load_dwordx4 a[180:183], v3, s[16:19], s35 offen offset:1024 sc1
  v_mfma_f32_16x16x32_bf16 v[68:71], a[196:199], a[64:67], v[68:71]
  v_mfma_f32_16x16x32_bf16 v[84:87], a[196:199], a[68:71], v[84:87]
  buffer_load_dwordx4 a[184:187], v3, s[16:19], s35 offen offset:2048 sc1
  v_mfma_f32_16x16x32_bf16 v[100:103], a[196:199], a[72:75], v[100:103]
  v_mfma_f32_16x16x32_bf16 v[116:119], a[196:199], a[76:79], v[116:119]
  buffer_load_dwordx4 a[188:191], v3, s[16:19], s35 offen offset:3072 sc1
  v_mfma_f32_16x16x32_bf16 v[72:75], a[200:203], a[64:67], v[72:75]
  s_add_u32 s35, s35, 4096
  v_mfma_f32_16x16x32_bf16 v[88:91], a[200:203], a[68:71], v[88:91]
  buffer_load_dwordx4 a[48:51], v3, s[16:19], s34 offen offset:0 sc1
  v_mfma_f32_16x16x32_bf16 v[104:107], a[200:203], a[72:75], v[104:107]
  v_mfma_f32_16x16x32_bf16 v[120:123], a[200:203], a[76:79], v[120:123]
  buffer_load_dwordx4 a[52:55], v3, s[16:19], s34 offen offset:1024 sc1
  v_mfma_f32_16x16x32_bf16 v[76:79], a[204:207], a[64:67], v[76:79]
  v_mfma_f32_16x16x32_bf16 v[92:95], a[204:207], a[68:71], v[92:95]
  buffer_load_dwordx4 a[56:59], v3, s[16:19], s34 offen offset:2048 sc1
  v_mfma_f32_16x16x32_bf16 v[108:111], a[204:207], a[72:75], v[108:111]
  v_mfma_f32_16x16x32_bf16 v[124:127], a[204:207], a[76:79], v[124:127]
  buffer_load_dwordx4 a[60:63], v3, s[16:19], s34 offen offset:3072 sc1
  s_add_u32 s34, s34, 4096
  s_waitcnt vmcnt(48)
  v_mfma_f32_16x16x32_bf16 v[64:67], a[208:211], a[80:83], v[64:67]
  v_mfma_f32_16x16x32_bf16 v[80:83], a[208:211], a[84:87], v[80:83]
  buffer_load_dwordx4 a[192:195], v3, s[16:19], s35 offen offset:0 sc1
  v_mfma_f32_16x16x32_bf16 v[96:99], a[208:211], a[88:91], v[96:99]
  v_mfma_f32_16x16x32_bf16 v[112:115], a[208:211], a[92:95], v[112:115]
  buffer_load_dwordx4 a[196:199], v3, s[16:19], s35 offen offset:1024 sc1
  v_mfma_f32_16x16x32_bf16 v[68:71], a[212:215], a[80:83], v[68:71]
  v_mfma_f32_16x16x32_bf16 v[84:87], a[212:215], a[84:87], v[84:87]
  buffer_load_dwordx4 a[200:203], v3, s[16:19], s35 offen offset:2048 sc1
  v_mfma_f32_16x16x32_bf16 v[100:103], a[212:215], a[88:91], v[100:103]
  v_mfma_f32_16x16x32_bf16 v[116:119], a[212:215], a[92:95], v[116:119]
  buffer_load_dwordx4 a[204:207], v3, s[16:19], s35 offen offset:3072 sc1
  v_mfma_f32_16x16x32_bf16 v[72:75], a[216:219], a[80:83], v[72:75]
  s_add_u32 s35, s35, 4096
  v_mfma_f32_16x16x32_bf16 v[88:91], a[216:219], a[84:87], v[88:91]
  buffer_load_dwordx4 a[64:67], v3, s[16:19], s34 offen offset:0 sc1
  v_mfma_f32_16x16x32_bf16 v[104:107], a[216:219], a[88:91], v[104:107]
  v_mfma_f32_16x16x32_bf16 v[120:123], a[216:219], a[92:95], v[120:123]
  buffer_load_dwordx4 a[68:71], v3, s[16:19], s34 offen offset:1024 sc1
  v_mfma_f32_16x16x32_bf16 v[76:79], a[220:223], a[80:83], v[76:79]
  v_mfma_f32_16x16x32_bf16 v[92:95], a[220:223], a[84:87], v[92:95]
  buffer_load_dwordx4 a[72:75], v3, s[16:19], s34 offen offset:2048 sc1
  v_mfma_f32_16x16x32_bf16 v[108:111], a[220:223], a[88:91], v[108:111]
  v_mfma_f32_16x16x32_bf16 v[124:127], a[220:223], a[92:95], v[124:127]
  buffer_load_dwordx4 a[76:79], v3, s[16:19], s34 offen offset:3072 sc1
  s_add_u32 s34, s34, 4096
  s_waitcnt vmcnt(48)
  v_mfma_f32_16x16x32_bf16 v[64:67], a[224:227], a[96:99], v[64:67]
  v_mfma_f32_16x16x32_bf16 v[80:83], a[224:227], a[100:103], v[80:83]
  buffer_load_dwordx4 a[208:211], v3, s[16:19], s35 offen offset:0 sc1
  v_mfma_f32_16x16x32_bf16 v[96:99], a[224:227], a[104:107], v[96:99]
  v_mfma_f32_16x16x32_bf16 v[112:115], a[224:227], a[108:111], v[112:115]
  buffer_load_dwordx4 a[212:215], v3, s[16:19], s35 offen offset:1024 sc1
  v_mfma_f32_16x16x32_bf16 v[68:71], a[228:231], a[96:99], v[68:71]
  v_mfma_f32_16x16x32_bf16 v[84:87], a[228:231], a[100:103], v[84:87]
  buffer_load_dwordx4 a[216:219], v3, s[16:19], s35 offen offset:2048 sc1
  v_mfma_f32_16x16x32_bf16 v[100:103], a[228:231], a[104:107], v[100:103]
  v_mfma_f32_16x16x32_bf16 v[116:119], a[228:231], a[108:111], v[116:119]
  buffer_load_dwordx4 a[220:223], v3, s[16:19], s35 offen offset:3072 sc1
  v_mfma_f32_16x16x32_bf16 v[72:75], a[232:235], a[96:99], v[72:75]
  s_add_u32 s35, s35, 4096
  v_mfma_f32_16x16x32_bf16 v[88:91], a[232:235], a[100:103], v[88:91]
  buffer_load_dwordx4 a[80:83], v3, s[16:19], s34 offen offset:0 sc1
  v_mfma_f32_16x16x32_bf16 v[104:107], a[232:235], a[104:107], v[104:107]
  v_mfma_f32_16x16x32_bf16 v[120:123], a[232:235], a[108:111], v[120:123]
  buffer_load_dwordx4 a[84:87], v3, s[16:19], s34 offen offset:1024 sc1
  v_mfma_f32_16x16x32_bf16 v[76:79], a[236:239], a[96:99], v[76:79]
  v_mfma_f32_16x16x32_bf16 v[92:95], a[236:239], a[100:103], v[92:95]
  buffer_load_dwordx4 a[88:91], v3, s[16:19], s34 offen offset:2048 sc1
  v_mfma_f32_16x16x32_bf16 v[108:111], a[236:239], a[104:107], v[108:111]
  v_mfma_f32_16x16x32_bf16 v[124:127], a[236:239], a[108:111], v[124:127]
  buffer_load_dwordx4 a[92:95], v3, s[16:19], s34 offen offset:3072 sc1
  s_add_u32 s34, s34, 4096
  s_waitcnt vmcnt(48)
  v_mfma_f32_16x16x32_bf16 v[64:67], a[240:243], a[112:115], v[64:67]
  v_mfma_f32_16x16x32_bf16 v[80:83], a[240:243], a[116:119], v[80:83]
  buffer_load_dwordx4 a[224:227], v3, s[16:19], s35 offen offset:0 sc1
  v_mfma_f32_16x16x32_bf16 v[96:99], a[240:243], a[120:123], v[96:99]
  v_mfma_f32_16x16x32_bf16 v[112:115], a[240:243], a[124:127], v[112:115]
  buffer_load_dwordx4 a[228:231], v3, s[16:19], s35 offen offset:1024 sc1
  v_mfma_f32_16x16x32_bf16 v[68:71], a[244:247], a[112:115], v[68:71]
  v_mfma_f32_16x16x32_bf16 v[84:87], a[244:247], a[116:119], v[84:87]
  buffer_load_dwordx4 a[232:235], v3, s[16:19], s35 offen offset:2048 sc1
  v_mfma_f32_16x16x32_bf16 v[100:103], a[244:247], a[120:123], v[100:103]
  v_mfma_f32_16x16x32_bf16 v[116:119], a[244:247], a[124:127], v[116:119]
  buffer_load_dwordx4 a[236:239], v3, s[16:19], s35 offen offset:3072 sc1
  v_mfma_f32_16x16x32_bf16 v[72:75], a[248:251], a[112:115], v[72:75]
  s_add_u32 s35, s35, 4096
  v_mfma_f32_16x16x32_bf16 v[88:91], a[248:251], a[116:119], v[88:91]
  buffer_load_dwordx4 a[96:99], v3, s[16:19], s34 offen offset:0 sc1
  v_mfma_f32_16x16x32_bf16 v[104:107], a[248:251], a[120:123], v[104:107]
  v_mfma_f32_16x16x32_bf16 v[120:123], a[248:251], a[124:127], v[120:123]
  buffer_load_dwordx4 a[100:103], v3, s[16:19], s34 offen offset:1024 sc1
  v_mfma_f32_16x16x32_bf16 v[76:79], a[252:255], a[112:115], v[76:79]
  v_mfma_f32_16x16x32_bf16 v[92:95], a[252:255], a[116:119], v[92:95]
  buffer_load_dwordx4 a[104:107], v3, s[16:19], s34 offen offset:2048 sc1
  v_mfma_f32_16x16x32_bf16 v[108:111], a[252:255], a[120:123], v[108:111]
  v_mfma_f32_16x16x32_bf16 v[124:127], a[252:255], a[124:127], v[124:127]
  buffer_load_dwordx4 a[108:111], v3, s[16:19], s34 offen offset:3072 sc1
  s_add_u32 s34, s34, 4096
  s_waitcnt vmcnt(48)
  v_mfma_f32_16x16x32_bf16 v[64:67], a[128:131], a[0:3], v[64:67]
  v_mfma_f32_16x16x32_bf16 v[80:83], a[128:131], a[4:7], v[80:83]
  buffer_load_dwordx4 a[240:243], v3, s[16:19], s35 offen offset:0 sc1
  v_mfma_f32_16x16x32_bf16 v[96:99], a[128:131], a[8:11], v[96:99]
  v_mfma_f32_16x16x32_bf16 v[112:115], a[128:131], a[12:15], v[112:115]
  buffer_load_dwordx4 a[244:247], v3, s[16:19], s35 offen offset:1024 sc1
  v_mfma_f32_16x16x32_bf16 v[68:71], a[132:135], a[0:3], v[68:71]
  v_mfma_f32_16x16x32_bf16 v[84:87], a[132:135], a[4:7], v[84:87]
  buffer_load_dwordx4 a[248:251], v3, s[16:19], s35 offen offset:2048 sc1
  v_mfma_f32_16x16x32_bf16 v[100:103], a[132:135], a[8:11], v[100:103]
  v_mfma_f32_16x16x32_bf16 v[116:119], a[132:135], a[12:15], v[116:119]
  buffer_load_dwordx4 a[252:255], v3, s[16:19], s35 offen offset:3072 sc1
  v_mfma_f32_16x16x32_bf16 v[72:75], a[136:139], a[0:3], v[72:75]
  s_add_u32 s35, s35, 4096
  v_mfma_f32_16x16x32_bf16 v[88:91], a[136:139], a[4:7], v[88:91]
  buffer_load_dwordx4 a[112:115], v3, s[16:19], s34 offen offset:0 sc1
  v_mfma_f32_16x16x32_bf16 v[104:107], a[136:139], a[8:11], v[104:107]
  v_mfma_f32_16x16x32_bf16 v[120:123], a[136:139], a[12:15], v[120:123]
  buffer_load_dwordx4 a[116:119], v3, s[16:19], s34 offen offset:1024 sc1
  v_mfma_f32_16x16x32_bf16 v[76:79], a[140:143], a[0:3], v[76:79]
  v_mfma_f32_16x16x32_bf16 v[92:95], a[140:143], a[4:7], v[92:95]
  buffer_load_dwordx4 a[120:123], v3, s[16:19], s34 offen offset:2048 sc1
  v_mfma_f32_16x16x32_bf16 v[108:111], a[140:143], a[8:11], v[108:111]
  v_mfma_f32_16x16x32_bf16 v[124:127], a[140:143], a[12:15], v[124:127]
  buffer_load_dwordx4 a[124:127], v3, s[16:19], s34 offen offset:3072 sc1
  s_add_u32 s34, s34, 4096
  v_and_b32 v17, 15, v2
  v_lshrrev_b32 v18, 4, v2
  v_lshlrev_b32 v19, 10, v17
  v_lshl_add_u32 v19, v18, 4, v19
  s_lshl_b32 s40, s32, 6
  s_lshl_b32 s37, s3, 4
  s_add_u32 s40, s40, s37
  s_lshl_b32 s41, s40, 10
  s_lshl_b32 s37, s33, 7
  s_add_u32 s41, s41, s37
  buffer_load_dwordx4 v[200:203], v19, s[24:27], s41 offen offset:0
  buffer_load_dwordx4 v[204:207], v19, s[24:27], s41 offen offset:64
  v_lshlrev_b32 v20, 5, v18
  s_lshl_b32 s42, s33, 8
  s_add_u32 s43, s42, 4096
  buffer_load_dwordx4 v[208:211], v20, s[16:19], s43 offen offset:0 sc1
  buffer_load_dwordx4 v[212:215], v20, s[16:19], s43 offen offset:16 sc1
  buffer_load_dwordx4 v[216:219], v20, s[16:19], s43 offen offset:128 sc1
  buffer_load_dwordx4 v[220:223], v20, s[16:19], s43 offen offset:144 sc1
  s_add_u32 s43, s42, 8192
  buffer_load_dwordx4 v[224:227], v20, s[16:19], s43 offen offset:0 sc1
  buffer_load_dwordx4 v[228:231], v20, s[16:19], s43 offen offset:16 sc1
  buffer_load_dwordx4 v[232:235], v20, s[16:19], s43 offen offset:128 sc1
  buffer_load_dwordx4 v[236:239], v20, s[16:19], s43 offen offset:144 sc1
  s_waitcnt vmcnt(58)
  v_mfma_f32_16x16x32_bf16 v[64:67], a[144:147], a[16:19], v[64:67]
  v_mfma_f32_16x16x32_bf16 v[80:83], a[144:147], a[20:23], v[80:83]
  v_mfma_f32_16x16x32_bf16 v[96:99], a[144:147], a[24:27], v[96:99]
  v_mfma_f32_16x16x32_bf16 v[112:115], a[144:147], a[28:31], v[112:115]
  v_mfma_f32_16x16x32_bf16 v[68:71], a[148:151], a[16:19], v[68:71]
  v_mfma_f32_16x16x32_bf16 v[84:87], a[148:151], a[20:23], v[84:87]
  v_mfma_f32_16x16x32_bf16 v[100:103], a[148:151], a[24:27], v[100:103]
  v_mfma_f32_16x16x32_bf16 v[116:119], a[148:151], a[28:31], v[116:119]
  v_mfma_f32_16x16x32_bf16 v[72:75], a[152:155], a[16:19], v[72:75]
  v_mfma_f32_16x16x32_bf16 v[88:91], a[152:155], a[20:23], v[88:91]
  v_mfma_f32_16x16x32_bf16 v[104:107], a[152:155], a[24:27], v[104:107]
  v_mfma_f32_16x16x32_bf16 v[120:123], a[152:155], a[28:31], v[120:123]
  v_mfma_f32_16x16x32_bf16 v[76:79], a[156:159], a[16:19], v[76:79]
  v_mfma_f32_16x16x32_bf16 v[92:95], a[156:159], a[20:23], v[92:95]
  v_mfma_f32_16x16x32_bf16 v[108:111], a[156:159], a[24:27], v[108:111]
  v_mfma_f32_16x16x32_bf16 v[124:127], a[156:159], a[28:31], v[124:127]
  s_waitcnt vmcnt(50)
  v_mfma_f32_16x16x32_bf16 v[64:67], a[160:163], a[32:35], v[64:67]
  v_mfma_f32_16x16x32_bf16 v[80:83], a[160:163], a[36:39], v[80:83]
  v_mfma_f32_16x16x32_bf16 v[96:99], a[160:163], a[40:43], v[96:99]
  v_mfma_f32_16x16x32_bf16 v[112:115], a[160:163], a[44:47], v[112:115]
  v_mfma_f32_16x16x32_bf16 v[68:71], a[164:167], a[32:35], v[68:71]
  v_mfma_f32_16x16x32_bf16 v[84:87], a[164:167], a[36:39], v[84:87]
  v_mfma_f32_16x16x32_bf16 v[100:103], a[164:167], a[40:43], v[100:103]
  v_mfma_f32_16x16x32_bf16 v[116:119], a[164:167], a[44:47], v[116:119]
  v_mfma_f32_16x16x32_bf16 v[72:75], a[168:171], a[32:35], v[72:75]
  v_mfma_f32_16x16x32_bf16 v[88:91], a[168:171], a[36:39], v[88:91]
  v_mfma_f32_16x16x32_bf16 v[104:107], a[168:171], a[40:43], v[104:107]
  v_mfma_f32_16x16x32_bf16 v[120:123], a[168:171], a[44:47], v[120:123]
  v_mfma_f32_16x16x32_bf16 v[76:79], a[172:175], a[32:35], v[76:79]
  v_mfma_f32_16x16x32_bf16 v[92:95], a[172:175], a[36:39], v[92:95]
  v_mfma_f32_16x16x32_bf16 v[108:111], a[172:175], a[40:43], v[108:111]
  v_mfma_f32_16x16x32_bf16 v[124:127], a[172:175], a[44:47], v[124:127]
  s_waitcnt vmcnt(42)
  v_mfma_f32_16x16x32_bf16 v[64:67], a[176:179], a[48:51], v[64:67]
  v_mfma_f32_16x16x32_bf16 v[80:83], a[176:179], a[52:55], v[80:83]
  v_mfma_f32_16x16x32_bf16 v[96:99], a[176:179], a[56:59], v[96:99]
  v_mfma_f32_16x16x32_bf16 v[112:115], a[176:179], a[60:63], v[112:115]
  v_mfma_f32_16x16x32_bf16 v[68:71], a[180:183], a[48:51], v[68:71]
  v_mfma_f32_16x16x32_bf16 v[84:87], a[180:183], a[52:55], v[84:87]
  v_mfma_f32_16x16x32_bf16 v[100:103], a[180:183], a[56:59], v[100:103]
  v_mfma_f32_16x16x32_bf16 v[116:119], a[180:183], a[60:63], v[116:119]
  v_mfma_f32_16x16x32_bf16 v[72:75], a[184:187], a[48:51], v[72:75]
  v_mfma_f32_16x16x32_bf16 v[88:91], a[184:187], a[52:55], v[88:91]
  v_mfma_f32_16x16x32_bf16 v[104:107], a[184:187], a[56:59], v[104:107]
  v_mfma_f32_16x16x32_bf16 v[120:123], a[184:187], a[60:63], v[120:123]
  v_mfma_f32_16x16x32_bf16 v[76:79], a[188:191], a[48:51], v[76:79]
  v_mfma_f32_16x16x32_bf16 v[92:95], a[188:191], a[52:55], v[92:95]
  v_mfma_f32_16x16x32_bf16 v[108:111], a[188:191], a[56:59], v[108:111]
  v_mfma_f32_16x16x32_bf16 v[124:127], a[188:191], a[60:63], v[124:127]
  s_waitcnt vmcnt(34)
  v_mfma_f32_16x16x32_bf16 v[64:67], a[192:195], a[64:67], v[64:67]
  v_mfma_f32_16x16x32_bf16 v[80:83], a[192:195], a[68:71], v[80:83]
  v_mfma_f32_16x16x32_bf16 v[96:99], a[192:195], a[72:75], v[96:99]
  v_mfma_f32_16x16x32_bf16 v[112:115], a[192:195], a[76:79], v[112:115]
  v_mfma_f32_16x16x32_bf16 v[68:71], a[196:199], a[64:67], v[68:71]
  v_mfma_f32_16x16x32_bf16 v[84:87], a[196:199], a[68:71], v[84:87]
  v_mfma_f32_16x16x32_bf16 v[100:103], a[196:199], a[72:75], v[100:103]
  v_mfma_f32_16x16x32_bf16 v[116:119], a[196:199], a[76:79], v[116:119]
  v_mfma_f32_16x16x32_bf16 v[72:75], a[200:203], a[64:67], v[72:75]
  v_mfma_f32_16x16x32_bf16 v[88:91], a[200:203], a[68:71], v[88:91]
  v_mfma_f32_16x16x32_bf16 v[104:107], a[200:203], a[72:75], v[104:107]
  v_mfma_f32_16x16x32_bf16 v[120:123], a[200:203], a[76:79], v[120:123]
  v_mfma_f32_16x16x32_bf16 v[76:79], a[204:207], a[64:67], v[76:79]
  v_mfma_f32_16x16x32_bf16 v[92:95], a[204:207], a[68:71], v[92:95]
  v_mfma_f32_16x16x32_bf16 v[108:111], a[204:207], a[72:75], v[108:111]
  v_mfma_f32_16x16x32_bf16 v[124:127], a[204:207], a[76:79], v[124:127]
  s_waitcnt vmcnt(26)
  v_mfma_f32_16x16x32_bf16 v[64:67], a[208:211], a[80:83], v[64:67]
  v_mfma_f32_16x16x32_bf16 v[80:83], a[208:211], a[84:87], v[80:83]
  v_mfma_f32_16x16x32_bf16 v[96:99], a[208:211], a[88:91], v[96:99]
  v_mfma_f32_16x16x32_bf16 v[112:115], a[208:211], a[92:95], v[112:115]
  v_mfma_f32_16x16x32_bf16 v[68:71], a[212:215], a[80:83], v[68:71]
  v_mfma_f32_16x16x32_bf16 v[84:87], a[212:215], a[84:87], v[84:87]
  v_mfma_f32_16x16x32_bf16 v[100:103], a[212:215], a[88:91], v[100:103]
  v_mfma_f32_16x16x32_bf16 v[116:119], a[212:215], a[92:95], v[116:119]
  v_mfma_f32_16x16x32_bf16 v[72:75], a[216:219], a[80:83], v[72:75]
  v_mfma_f32_16x16x32_bf16 v[88:91], a[216:219], a[84:87], v[88:91]
  v_mfma_f32_16x16x32_bf16 v[104:107], a[216:219], a[88:91], v[104:107]
  v_mfma_f32_16x16x32_bf16 v[120:123], a[216:219], a[92:95], v[120:123]
  v_mfma_f32_16x16x32_bf16 v[76:79], a[220:223], a[80:83], v[76:79]
  v_mfma_f32_16x16x32_bf16 v[92:95], a[220:223], a[84:87], v[92:95]
  v_mfma_f32_16x16x32_bf16 v[108:111], a[220:223], a[88:91], v[108:111]
  v_mfma_f32_16x16x32_bf16 v[124:127], a[220:223], a[92:95], v[124:127]
  s_waitcnt vmcnt(18)
  v_mfma_f32_16x16x32_bf16 v[64:67], a[224:227], a[96:99], v[64:67]
  v_mfma_f32_16x16x32_bf16 v[80:83], a[224:227], a[100:103], v[80:83]
  v_mfma_f32_16x16x32_bf16 v[96:99], a[224:227], a[104:107], v[96:99]
  v_mfma_f32_16x16x32_bf16 v[112:115], a[224:227], a[108:111], v[112:115]
  v_mfma_f32_16x16x32_bf16 v[68:71], a[228:231], a[96:99], v[68:71]
  v_mfma_f32_16x16x32_bf16 v[84:87], a[228:231], a[100:103], v[84:87]
  v_mfma_f32_16x16x32_bf16 v[100:103], a[228:231], a[104:107], v[100:103]
  v_mfma_f32_16x16x32_bf16 v[116:119], a[228:231], a[108:111], v[116:119]
  v_mfma_f32_16x16x32_bf16 v[72:75], a[232:235], a[96:99], v[72:75]
  v_mfma_f32_16x16x32_bf16 v[88:91], a[232:235], a[100:103], v[88:91]
  v_mfma_f32_16x16x32_bf16 v[104:107], a[232:235], a[104:107], v[104:107]
  v_mfma_f32_16x16x32_bf16 v[120:123], a[232:235], a[108:111], v[120:123]
  v_mfma_f32_16x16x32_bf16 v[76:79], a[236:239], a[96:99], v[76:79]
  v_mfma_f32_16x16x32_bf16 v[92:95], a[236:239], a[100:103], v[92:95]
  v_mfma_f32_16x16x32_bf16 v[108:111], a[236:239], a[104:107], v[108:111]
  v_mfma_f32_16x16x32_bf16 v[124:127], a[236:239], a[108:111], v[124:127]
  s_waitcnt vmcnt(10)
  v_mfma_f32_16x16x32_bf16 v[64:67], a[240:243], a[112:115], v[64:67]
  v_mfma_f32_16x16x32_bf16 v[80:83], a[240:243], a[116:119], v[80:83]
  v_mfma_f32_16x16x32_bf16 v[96:99], a[240:243], a[120:123], v[96:99]
  v_mfma_f32_16x16x32_bf16 v[112:115], a[240:243], a[124:127], v[112:115]
  v_mfma_f32_16x16x32_bf16 v[68:71], a[244:247], a[112:115], v[68:71]
  v_mfma_f32_16x16x32_bf16 v[84:87], a[244:247], a[116:119], v[84:87]
  v_mfma_f32_16x16x32_bf16 v[100:103], a[244:247], a[120:123], v[100:103]
  v_mfma_f32_16x16x32_bf16 v[116:119], a[244:247], a[124:127], v[116:119]
  v_mfma_f32_16x16x32_bf16 v[72:75], a[248:251], a[112:115], v[72:75]
  v_mfma_f32_16x16x32_bf16 v[88:91], a[248:251], a[116:119], v[88:91]
  v_mfma_f32_16x16x32_bf16 v[104:107], a[248:251], a[120:123], v[104:107]
  v_mfma_f32_16x16x32_bf16 v[120:123], a[248:251], a[124:127], v[120:123]
  v_mfma_f32_16x16x32_bf16 v[76:79], a[252:255], a[112:115], v[76:79]
  v_mfma_f32_16x16x32_bf16 v[92:95], a[252:255], a[116:119], v[92:95]
  v_mfma_f32_16x16x32_bf16 v[108:111], a[252:255], a[120:123], v[108:111]
  v_mfma_f32_16x16x32_bf16 v[124:127], a[252:255], a[124:127], v[124:127]
  s_barrier
  s_nop 4
  v_and_b32 v12, 15, v2
  v_lshrrev_b32 v13, 4, v2
  v_mul_u32_u24 v14, 272, v12
  v_lshl_add_u32 v14, v13, 4, v14
  s_mul_i32 s37, s3, 17408
  v_add_u32 v15, s37, v14
  ds_write_b128 v15, v[64:67] offset:0
  ds_write_b128 v15, v[68:71] offset:64
  ds_write_b128 v15, v[72:75] offset:128
  ds_write_b128 v15, v[76:79] offset:192
  ds_write_b128 v15, v[80:83] offset:4352
  ds_write_b128 v15, v[84:87] offset:4416
  ds_write_b128 v15, v[88:91] offset:4480
  ds_write_b128 v15, v[92:95] offset:4544
  ds_write_b128 v15, v[96:99] offset:8704
  ds_write_b128 v15, v[100:103] offset:8768
  ds_write_b128 v15, v[104:107] offset:8832
  ds_write_b128 v15, v[108:111] offset:8896
  ds_write_b128 v15, v[112:115] offset:13056
  ds_write_b128 v15, v[116:119] offset:13120
  ds_write_b128 v15, v[120:123] offset:13184
  ds_write_b128 v15, v[124:127] offset:13248
  s_waitcnt lgkmcnt(0)
  s_barrier
  v_mul_u32_u24 v14, 272, v12
  v_lshl_add_u32 v14, v13, 5, v14
  s_mul_i32 s37, s3, 4352
  v_add_u32 v14, s37, v14
  ds_read_b128 v[128:131], v14 offset:0
  ds_read_b128 v[132:135], v14 offset:16
  ds_read_b128 v[136:139], v14 offset:128
  ds_read_b128 v[140:143], v14 offset:144
  ds_read_b128 v[144:147], v14 offset:17408
  ds_read_b128 v[148:151], v14 offset:17424
  ds_read_b128 v[152:155], v14 offset:17536
  ds_read_b128 v[156:159], v14 offset:17552
  ds_read_b128 v[160:163], v14 offset:34816
  ds_read_b128 v[164:167], v14 offset:34832
  ds_read_b128 v[168:171], v14 offset:34944
  ds_read_b128 v[172:175], v14 offset:34960
  ds_read_b128 v[176:179], v14 offset:52224
  ds_read_b128 v[180:183], v14 offset:52240
  ds_read_b128 v[184:187], v14 offset:52352
  ds_read_b128 v[188:191], v14 offset:52368
  s_waitcnt lgkmcnt(0)
  v_pk_add_f32 v[128:129], v[128:129], v[144:145]
  v_pk_add_f32 v[160:161], v[160:161], v[176:177]
  v_pk_add_f32 v[130:131], v[130:131], v[146:147]
  v_pk_add_f32 v[162:163], v[162:163], v[178:179]
  v_pk_add_f32 v[132:133], v[132:133], v[148:149]
  v_pk_add_f32 v[164:165], v[164:165], v[180:181]
  v_pk_add_f32 v[134:135], v[134:135], v[150:151]
  v_pk_add_f32 v[166:167], v[166:167], v[182:183]
  v_pk_add_f32 v[136:137], v[136:137], v[152:153]
  v_pk_add_f32 v[168:169], v[168:169], v[184:185]
  v_pk_add_f32 v[138:139], v[138:139], v[154:155]
  v_pk_add_f32 v[170:171], v[170:171], v[186:187]
  v_pk_add_f32 v[140:141], v[140:141], v[156:157]
  v_pk_add_f32 v[172:173], v[172:173], v[188:189]
  v_pk_add_f32 v[142:143], v[142:143], v[158:159]
  v_pk_add_f32 v[174:175], v[174:175], v[190:191]
  v_pk_add_f32 v[128:129], v[128:129], v[160:161]
  v_pk_add_f32 v[130:131], v[130:131], v[162:163]
  v_pk_add_f32 v[132:133], v[132:133], v[164:165]
  v_pk_add_f32 v[134:135], v[134:135], v[166:167]
  v_pk_add_f32 v[136:137], v[136:137], v[168:169]
  v_pk_add_f32 v[138:139], v[138:139], v[170:171]
  v_pk_add_f32 v[140:141], v[140:141], v[172:173]
  v_pk_add_f32 v[142:143], v[142:143], v[174:175]
  s_waitcnt vmcnt(0)
  v_cvt_pk_bf16_f32 v48, v128, v129
  v_cvt_pk_bf16_f32 v49, v130, v131
  v_cvt_pk_bf16_f32 v50, v132, v133
  v_cvt_pk_bf16_f32 v51, v134, v135
  v_lshlrev_b32 v128, 16, v48
  v_and_b32 v129, 0xffff0000, v48
  v_lshlrev_b32 v130, 16, v49
  v_and_b32 v131, 0xffff0000, v49
  v_lshlrev_b32 v132, 16, v50
  v_and_b32 v133, 0xffff0000, v50
  v_lshlrev_b32 v134, 16, v51
  v_and_b32 v135, 0xffff0000, v51
  v_pk_mul_f32 v[128:129], v[128:129], v[208:209]
  v_pk_mul_f32 v[130:131], v[130:131], v[210:211]
  v_pk_mul_f32 v[132:133], v[132:133], v[212:213]
  v_pk_mul_f32 v[134:135], v[134:135], v[214:215]
  v_cvt_pk_bf16_f32 v48, v128, v129
  v_cvt_pk_bf16_f32 v49, v130, v131
  v_cvt_pk_bf16_f32 v50, v132, v133
  v_cvt_pk_bf16_f32 v51, v134, v135
  v_lshlrev_b32 v128, 16, v48
  v_and_b32 v129, 0xffff0000, v48
  v_lshlrev_b32 v130, 16, v49
  v_and_b32 v131, 0xffff0000, v49
  v_lshlrev_b32 v132, 16, v50
  v_and_b32 v133, 0xffff0000, v50
  v_lshlrev_b32 v134, 16, v51
  v_and_b32 v135, 0xffff0000, v51
  v_lshlrev_b32 v32, 16, v200
  v_and_b32 v33, 0xffff0000, v200
  v_lshlrev_b32 v34, 16, v201
  v_and_b32 v35, 0xffff0000, v201
  v_lshlrev_b32 v36, 16, v202
  v_and_b32 v37, 0xffff0000, v202
  v_lshlrev_b32 v38, 16, v203
  v_and_b32 v39, 0xffff0000, v203
  v_pk_add_f32 v[128:129], v[128:129], v[32:33]
  v_pk_add_f32 v[130:131], v[130:131], v[34:35]
  v_pk_add_f32 v[132:133], v[132:133], v[36:37]
  v_pk_add_f32 v[134:135], v[134:135], v[38:39]
  v_cvt_pk_bf16_f32 v40, v128, v129
  v_cvt_pk_bf16_f32 v41, v130, v131
  v_cvt_pk_bf16_f32 v42, v132, v133
  v_cvt_pk_bf16_f32 v43, v134, v135
  v_lshlrev_b32 v128, 16, v40
  v_and_b32 v129, 0xffff0000, v40
  v_lshlrev_b32 v130, 16, v41
  v_and_b32 v131, 0xffff0000, v41
  v_lshlrev_b32 v132, 16, v42
  v_and_b32 v133, 0xffff0000, v42
  v_lshlrev_b32 v134, 16, v43
  v_and_b32 v135, 0xffff0000, v43
  v_mov_b32 v56, v128
  v_mul_f32 v57, v128, v128
  v_add_f32 v56, v56, v129
  v_fmac_f32 v57, v129, v129
  v_add_f32 v56, v56, v130
  v_fmac_f32 v57, v130, v130
  v_add_f32 v56, v56, v131
  v_fmac_f32 v57, v131, v131
  v_add_f32 v56, v56, v132
  v_fmac_f32 v57, v132, v132
  v_add_f32 v56, v56, v133
  v_fmac_f32 v57, v133, v133
  v_add_f32 v56, v56, v134
  v_fmac_f32 v57, v134, v134
  v_add_f32 v56, v56, v135
  v_fmac_f32 v57, v135, v135
  v_add_f32 v224, 1.0, v224
  v_add_f32 v225, 1.0, v225
  v_add_f32 v226, 1.0, v226
  v_add_f32 v227, 1.0, v227
  v_add_f32 v228, 1.0, v228
  v_add_f32 v229, 1.0, v229
  v_add_f32 v230, 1.0, v230
  v_add_f32 v231, 1.0, v231
  v_cvt_pk_bf16_f32 v48, v224, v225
  v_cvt_pk_bf16_f32 v49, v226, v227
  v_cvt_pk_bf16_f32 v50, v228, v229
  v_cvt_pk_bf16_f32 v51, v230, v231
  v_lshlrev_b32 v224, 16, v48
  v_and_b32 v225, 0xffff0000, v48
  v_lshlrev_b32 v226, 16, v49
  v_and_b32 v227, 0xffff0000, v49
  v_lshlrev_b32 v228, 16, v50
  v_and_b32 v229, 0xffff0000, v50
  v_lshlrev_b32 v230, 16, v51
  v_and_b32 v231, 0xffff0000, v51
  v_pk_mul_f32 v[128:129], v[128:129], v[224:225]
  v_pk_mul_f32 v[130:131], v[130:131], v[226:227]
  v_pk_mul_f32 v[132:133], v[132:133], v[228:229]
  v_pk_mul_f32 v[134:135], v[134:135], v[230:231]
  v_cvt_pk_bf16_f32 v24, v128, v129
  v_cvt_pk_bf16_f32 v25, v130, v131
  v_cvt_pk_bf16_f32 v26, v132, v133
  v_cvt_pk_bf16_f32 v27, v134, v135
  v_cvt_pk_bf16_f32 v48, v136, v137
  v_cvt_pk_bf16_f32 v49, v138, v139
  v_cvt_pk_bf16_f32 v50, v140, v141
  v_cvt_pk_bf16_f32 v51, v142, v143
  v_lshlrev_b32 v136, 16, v48
  v_and_b32 v137, 0xffff0000, v48
  v_lshlrev_b32 v138, 16, v49
  v_and_b32 v139, 0xffff0000, v49
  v_lshlrev_b32 v140, 16, v50
  v_and_b32 v141, 0xffff0000, v50
  v_lshlrev_b32 v142, 16, v51
  v_and_b32 v143, 0xffff0000, v51
  v_pk_mul_f32 v[136:137], v[136:137], v[216:217]
  v_pk_mul_f32 v[138:139], v[138:139], v[218:219]
  v_pk_mul_f32 v[140:141], v[140:141], v[220:221]
  v_pk_mul_f32 v[142:143], v[142:143], v[222:223]
  v_cvt_pk_bf16_f32 v48, v136, v137
  v_cvt_pk_bf16_f32 v49, v138, v139
  v_cvt_pk_bf16_f32 v50, v140, v141
  v_cvt_pk_bf16_f32 v51, v142, v143
  v_lshlrev_b32 v136, 16, v48
  v_and_b32 v137, 0xffff0000, v48
  v_lshlrev_b32 v138, 16, v49
  v_and_b32 v139, 0xffff0000, v49
  v_lshlrev_b32 v140, 16, v50
  v_and_b32 v141, 0xffff0000, v50
  v_lshlrev_b32 v142, 16, v51
  v_and_b32 v143, 0xffff0000, v51
  v_lshlrev_b32 v32, 16, v204
  v_and_b32 v33, 0xffff0000, v204
  v_lshlrev_b32 v34, 16, v205
  v_and_b32 v35, 0xffff0000, v205
  v_lshlrev_b32 v36, 16, v206
  v_and_b32 v37, 0xffff0000, v206
  v_lshlrev_b32 v38, 16, v207
  v_and_b32 v39, 0xffff0000, v207
  v_pk_add_f32 v[136:137], v[136:137], v[32:33]
  v_pk_add_f32 v[138:139], v[138:139], v[34:35]
  v_pk_add_f32 v[140:141], v[140:141], v[36:37]
  v_pk_add_f32 v[142:143], v[142:143], v[38:39]
  v_cvt_pk_bf16_f32 v44, v136, v137
  v_cvt_pk_bf16_f32 v45, v138, v139
  v_cvt_pk_bf16_f32 v46, v140, v141
  v_cvt_pk_bf16_f32 v47, v142, v143
  v_lshlrev_b32 v136, 16, v44
  v_and_b32 v137, 0xffff0000, v44
  v_lshlrev_b32 v138, 16, v45
  v_and_b32 v139, 0xffff0000, v45
  v_lshlrev_b32 v140, 16, v46
  v_and_b32 v141, 0xffff0000, v46
  v_lshlrev_b32 v142, 16, v47
  v_and_b32 v143, 0xffff0000, v47
  v_add_f32 v56, v56, v136
  v_fmac_f32 v57, v136, v136
  v_add_f32 v56, v56, v137
  v_fmac_f32 v57, v137, v137
  v_add_f32 v56, v56, v138
  v_fmac_f32 v57, v138, v138
  v_add_f32 v56, v56, v139
  v_fmac_f32 v57, v139, v139
  v_add_f32 v56, v56, v140
  v_fmac_f32 v57, v140, v140
  v_add_f32 v56, v56, v141
  v_fmac_f32 v57, v141, v141
  v_add_f32 v56, v56, v142
  v_fmac_f32 v57, v142, v142
  v_add_f32 v56, v56, v143
  v_fmac_f32 v57, v143, v143
  v_add_f32 v232, 1.0, v232
  v_add_f32 v233, 1.0, v233
  v_add_f32 v234, 1.0, v234
  v_add_f32 v235, 1.0, v235
  v_add_f32 v236, 1.0, v236
  v_add_f32 v237, 1.0, v237
  v_add_f32 v238, 1.0, v238
  v_add_f32 v239, 1.0, v239
  v_cvt_pk_bf16_f32 v48, v232, v233
  v_cvt_pk_bf16_f32 v49, v234, v235
  v_cvt_pk_bf16_f32 v50, v236, v237
  v_cvt_pk_bf16_f32 v51, v238, v239
  v_lshlrev_b32 v232, 16, v48
  v_and_b32 v233, 0xffff0000, v48
  v_lshlrev_b32 v234, 16, v49
  v_and_b32 v235, 0xffff0000, v49
  v_lshlrev_b32 v236, 16, v50
  v_and_b32 v237, 0xffff0000, v50
  v_lshlrev_b32 v238, 16, v51
  v_and_b32 v239, 0xffff0000, v51
  v_pk_mul_f32 v[136:137], v[136:137], v[232:233]
  v_pk_mul_f32 v[138:139], v[138:139], v[234:235]
  v_pk_mul_f32 v[140:141], v[140:141], v[236:237]
  v_pk_mul_f32 v[142:143], v[142:143], v[238:239]
  v_cvt_pk_bf16_f32 v28, v136, v137
  v_cvt_pk_bf16_f32 v29, v138, v139
  v_cvt_pk_bf16_f32 v30, v140, v141
  v_cvt_pk_bf16_f32 v31, v142, v143
  s_lshl_b32 s44, s32, 2
  s_add_u32 s44, s44, s3
  s_lshl_b32 s44, s44, 4
  s_lshl_b32 s37, s33, 1
  s_add_u32 s44, s44, s37
  s_lshl_b32 s44, s44, 10
  s_add_u32 s45, s44, 0x2800000
  s_add_u32 s46, s44, 0x2a00000
  buffer_store_dwordx4 v[24:27], v3, s[16:19], s46 offen offset:0 sc1
  buffer_store_dwordx4 v[28:31], v3, s[16:19], s46 offen offset:1024 sc1
  v_accvgpr_write_b32 a64, v40
  v_accvgpr_write_b32 a65, v41
  v_accvgpr_write_b32 a66, v42
  v_accvgpr_write_b32 a67, v43
  v_accvgpr_write_b32 a68, v44
  v_accvgpr_write_b32 a69, v45
  v_accvgpr_write_b32 a70, v46
  v_accvgpr_write_b32 a71, v47
  v_mov_b32 v58, v56
  v_mov_b32 v59, v57
  s_nop 0
  v_permlane16_swap_b32 v56, v58
  v_permlane16_swap_b32 v57, v59
  s_nop 0
  v_add_f32 v56, v56, v58
  v_add_f32 v57, v57, v59
  v_mov_b32 v58, v56
  v_mov_b32 v59, v57
  s_nop 0
  v_permlane32_swap_b32 v56, v58
  v_permlane32_swap_b32 v57, v59
  s_nop 0
  v_add_f32 v56, v56, v58
  v_add_f32 v57, v57, v59
  v_and_b32 v17, 15, v2
  v_lshlrev_b32 v17, 3, v17
  s_lshl_b32 s47, s33, 11
  s_add_u32 s47, s47, s40
  s_lshl_b32 s47, s47, 3
  s_add_u32 s47, s47, 0x10000
  v_cmp_gt_u32 vcc, 16, v2
  s_and_saveexec_b64 s[48:49], vcc
  s_cbranch_execz L_st_68
  buffer_store_dwordx2 v[56:57], v17, s[16:19], s47 offen sc1
L_st_68:
  s_mov_b64 exec, s[48:49]
  v_mov_b32 v28, 1
  v_mov_b32 v30, 0
  v_mov_b32 v29, 0x4000000
  v_cmp_eq_u32 vcc, 0, v2
  s_nop 1
  v_cndmask_b32 v29, v29, v30, vcc
  s_lshr_b32 s76, s32, 2
  s_lshl_b32 s76, s76, 8
  s_add_u32 s76, s76, 307200
  s_add_u32 s77, s76, 2048
  s_waitcnt vmcnt(0)
  s_barrier
  s_cmp_lg_u32 s3, 0
  s_cbranch_scc1 L_sg_69
  buffer_atomic_add v28, v29, s[16:19], s76 offen sc1
L_sg_69:
  s_cmp_ge_u32 s2, 224
  s_cbranch_scc1 L_nog_70
  s_cmp_lt_u32 s3, 2
  s_cselect_b32 s10, s72, s74
  s_cselect_b32 s11, s73, s75
  s_mov_b32 s20, s10
  s_and_b32 s21, s11, 0xffff
  s_mov_b32 s22, 0x1c0000
  s_mov_b32 s23, 0x20000
  s_and_b32 s32, s2, 7
  s_lshr_b32 s33, s2, 3
  s_and_b32 s24, s32, 1
  s_lshl_b32 s24, s24, 2
  s_and_b32 s34, s33, 3
  s_add_u32 s24, s24, s34
  s_lshr_b32 s25, s32, 1
  s_mul_i32 s25, s25, 7
  s_lshr_b32 s34, s33, 2
  s_add_u32 s25, s25, s34
  s_lshl_b32 s24, s24, 2
  s_add_u32 s24, s24, s3
  v_lshlrev_b32 v3, 4, v2
  s_lshl_b32 s32, s24, 2
  s_add_u32 s32, s32, 0
  s_lshl_b32 s32, s32, 14
  s_add_u32 s26, s32, 0x2a00000
  s_lshl_b32 s32, s24, 2
  s_add_u32 s32, s32, 1
  s_lshl_b32 s32, s32, 14
  s_add_u32 s27, s32, 0x2a00000
  s_lshl_b32 s32, s24, 2
  s_add_u32 s32, s32, 2
  s_lshl_b32 s32, s32, 14
  s_add_u32 s28, s32, 0x2a00000
  s_lshl_b32 s32, s24, 2
  s_add_u32 s32, s32, 3
  s_lshl_b32 s32, s32, 14
  s_add_u32 s29, s32, 0x2a00000
  v_lshrrev_b32 v12, 3, v2
  v_and_b32 v13, 7, v2
  v_lshrrev_b32 v14, 1, v13
  v_bfe_u32 v15, v12, 1, 1
  v_xor_b32 v14, v14, v15
  v_lshlrev_b32 v14, 5, v14
  v_and_b32 v15, 1, v13
  v_lshl_add_u32 v14, v15, 4, v14
  v_mul_u32_u24 v12, 3584, v12
  v_add_u32 v14, v14, v12
  v_xor_b32 v15, 64, v14
  v_add_u32 v4, 0, v14
  v_add_u32 v5, 27648, v15
  v_add_u32 v6, 55296, v14
  v_add_u32 v7, 82944, v15
  s_and_b32 s32, s3, 1
  s_mul_i32 s30, s32, 114688
  s_lshl_b32 s33, s25, 7
  s_add_u32 s30, s30, s33
  s_lshl_b32 s31, s3, 12
  s_mov_b32 s42, 0
  s_lshl_b32 s32, s42, 12
  s_add_u32 s26, s26, s32
  s_add_u32 s27, s27, s32
  s_add_u32 s28, s28, s32
  s_add_u32 s29, s29, s32
  v_and_b32 v12, 15, v2
  v_mov_b32 v13, 0x4000000
  v_cmp_gt_u32 vcc, 2, v12
  s_nop 1
  v_cndmask_b32 v31, v13, v3, vcc
  s_lshl_b32 s34, s42, 1
  s_add_u32 s34, s34, 0
  s_and_b32 s34, s34, 7
  s_mul_i32 s34, s34, 229376
  s_add_u32 s34, s34, s30
  s_add_u32 m0, s31, 0
  s_nop 0
  buffer_load_dwordx4 v4, s[20:23], s34 offen offset:0 lds
  buffer_load_dwordx4 v5, s[20:23], s34 offen offset:1024 lds
  buffer_load_dwordx4 v6, s[20:23], s34 offen offset:2048 lds
  buffer_load_dwordx4 v7, s[20:23], s34 offen offset:3072 lds
  s_add_u32 s32, s42, 0
  s_and_b32 s32, s32, 3
  s_lshl_b32 s32, s32, 12
  s_add_u32 s32, s32, 49152
  buffer_load_dwordx4 a[0:3], v31, s[16:19], s32 offen offset:0 sc1
  buffer_load_dwordx4 a[4:7], v31, s[16:19], s32 offen offset:1024 sc1
  buffer_load_dwordx4 a[8:11], v31, s[16:19], s32 offen offset:2048 sc1
  buffer_load_dwordx4 a[12:15], v31, s[16:19], s32 offen offset:3072 sc1
  s_lshl_b32 s34, s42, 1
  s_add_u32 s34, s34, 1
  s_and_b32 s34, s34, 7
  s_mul_i32 s34, s34, 229376
  s_add_u32 s34, s34, s30
  s_add_u32 m0, s31, 16384
  s_nop 0
  buffer_load_dwordx4 v4, s[20:23], s34 offen offset:0 lds
  buffer_load_dwordx4 v5, s[20:23], s34 offen offset:1024 lds
  buffer_load_dwordx4 v6, s[20:23], s34 offen offset:2048 lds
  buffer_load_dwordx4 v7, s[20:23], s34 offen offset:3072 lds
  s_lshl_b32 s34, s42, 1
  s_add_u32 s34, s34, 2
  s_and_b32 s34, s34, 7
  s_mul_i32 s34, s34, 229376
  s_add_u32 s34, s34, s30
  s_add_u32 m0, s31, 32768
  s_nop 0
  buffer_load_dwordx4 v4, s[20:23], s34 offen offset:0 lds
  buffer_load_dwordx4 v5, s[20:23], s34 offen offset:1024 lds
  buffer_load_dwordx4 v6, s[20:23], s34 offen offset:2048 lds
  buffer_load_dwordx4 v7, s[20:23], s34 offen offset:3072 lds
  s_lshl_b32 s34, s42, 1
  s_add_u32 s34, s34, 3
  s_and_b32 s34, s34, 7
  s_mul_i32 s34, s34, 229376
  s_add_u32 s34, s34, s30
  s_add_u32 m0, s31, 49152
  s_nop 0
  buffer_load_dwordx4 v4, s[20:23], s34 offen offset:0 lds
  buffer_load_dwordx4 v5, s[20:23], s34 offen offset:1024 lds
  buffer_load_dwordx4 v6, s[20:23], s34 offen offset:2048 lds
  buffer_load_dwordx4 v7, s[20:23], s34 offen offset:3072 lds
  s_lshr_b32 s78, s24, 2
  s_lshl_b32 s78, s78, 8
  s_add_u32 s78, s78, 307200
  v_mov_b32 v18, 0
  s_cmp_lg_u32 s3, 0
  s_cbranch_scc1 L_aw_71
  s_mov_b32 s81, 0
L_as_72:
  buffer_load_dword v19, v18, s[16:19], s78 offen sc1
  s_waitcnt vmcnt(0)
  v_readfirstlane_b32 s80, v19
  s_add_u32 s81, s81, 1
  s_nop 2
  s_cmp_ge_u32 s80, 32
  s_cbranch_scc1 L_ao_73
  s_sleep 4
  s_cmp_lt_u32 s81, 0x80000
  s_cbranch_scc1 L_as_72
L_ao_73:
L_aw_71:
  s_barrier
  buffer_load_dwordx4 a[128:131], v3, s[16:19], s26 offen offset:0 sc1
  buffer_load_dwordx4 a[132:135], v3, s[16:19], s27 offen offset:0 sc1
  buffer_load_dwordx4 a[136:139], v3, s[16:19], s28 offen offset:0 sc1
  buffer_load_dwordx4 a[140:143], v3, s[16:19], s29 offen offset:0 sc1
  buffer_load_dwordx4 a[144:147], v3, s[16:19], s26 offen offset:1024 sc1
  buffer_load_dwordx4 a[148:151], v3, s[16:19], s27 offen offset:1024 sc1
  buffer_load_dwordx4 a[152:155], v3, s[16:19], s28 offen offset:1024 sc1
  buffer_load_dwordx4 a[156:159], v3, s[16:19], s29 offen offset:1024 sc1
  buffer_load_dwordx4 a[160:163], v3, s[16:19], s26 offen offset:2048 sc1
  buffer_load_dwordx4 a[164:167], v3, s[16:19], s27 offen offset:2048 sc1
  buffer_load_dwordx4 a[168:171], v3, s[16:19], s28 offen offset:2048 sc1
  buffer_load_dwordx4 a[172:175], v3, s[16:19], s29 offen offset:2048 sc1
  buffer_load_dwordx4 a[176:179], v3, s[16:19], s26 offen offset:3072 sc1
  buffer_load_dwordx4 a[180:183], v3, s[16:19], s27 offen offset:3072 sc1
  buffer_load_dwordx4 a[184:187], v3, s[16:19], s28 offen offset:3072 sc1
  buffer_load_dwordx4 a[188:191], v3, s[16:19], s29 offen offset:3072 sc1
  s_mov_b32 s43, 4096
  s_cmp_eq_u32 s42, 3
  s_cselect_b32 s43, 0xffffd000, s43
  s_add_u32 s26, s26, s43
  s_add_u32 s27, s27, s43
  s_add_u32 s28, s28, s43
  s_add_u32 s29, s29, s43
  v_lshrrev_b32 v12, 4, v2
  v_bfe_u32 v13, v2, 2, 2
  v_and_b32 v14, 3, v2
  v_lshl_add_u32 v15, v12, 3, v13
  v_lshrrev_b32 v16, 1, v13
  v_and_b32 v17, 1, v12
  v_lshl_add_u32 v16, v17, 1, v16
  v_lshlrev_b32 v16, 5, v16
  v_lshlrev_b32 v17, 7, v15
  v_lshl_add_u32 v17, v14, 3, v17
  v_xor_b32 v18, 0, v16
  v_add_u32 v8, v17, v18
  v_xor_b32 v18, 32, v16
  v_add_u32 v9, v17, v18
  v_xor_b32 v18, 64, v16
  v_add_u32 v10, v17, v18
  v_xor_b32 v18, 96, v16
  v_add_u32 v11, v17, v18
  s_waitcnt vmcnt(32)
  s_barrier
  ds_read_b64_tr_b16 v[32:33], v8 offset:0
  ds_read_b64_tr_b16 v[34:35], v8 offset:512
  ds_read_b64_tr_b16 v[36:37], v9 offset:0
  ds_read_b64_tr_b16 v[38:39], v9 offset:512
  ds_read_b64_tr_b16 v[40:41], v10 offset:0
  ds_read_b64_tr_b16 v[42:43], v10 offset:512
  ds_read_b64_tr_b16 v[44:45], v11 offset:0
  ds_read_b64_tr_b16 v[46:47], v11 offset:512
  ds_read_b64_tr_b16 v[48:49], v8 offset:8192
  ds_read_b64_tr_b16 v[50:51], v8 offset:8704
  ds_read_b64_tr_b16 v[52:53], v9 offset:8192
  ds_read_b64_tr_b16 v[54:55], v9 offset:8704
  ds_read_b64_tr_b16 v[56:57], v10 offset:8192
  ds_read_b64_tr_b16 v[58:59], v10 offset:8704
  ds_read_b64_tr_b16 v[60:61], v11 offset:8192
  ds_read_b64_tr_b16 v[62:63], v11 offset:8704
  s_waitcnt vmcnt(31)
  s_waitcnt lgkmcnt(0)
  s_lshl_b32 s36, s3, 1
  s_add_u32 s37, s36, 0
  s_and_b32 s37, s37, 3
  s_lshl_b32 s37, s37, 5
  v_xor_b32 v18, s37, v16
  v_add_u32 v28, v17, v18
  s_lshr_b32 s37, s3, 1
  s_lshl_b32 s37, s37, 13
  v_add_u32 v28, s37, v28
  s_add_u32 s37, s36, 1
  s_and_b32 s37, s37, 3
  s_lshl_b32 s37, s37, 5
  v_xor_b32 v18, s37, v16
  v_add_u32 v29, v17, v18
  s_lshr_b32 s37, s3, 1
  s_lshl_b32 s37, s37, 13
  v_add_u32 v29, s37, v29
  ds_read_b64_tr_b16 v[96:97], v28 offset:0
  ds_read_b64_tr_b16 v[98:99], v28 offset:512
  ds_read_b64_tr_b16 v[100:101], v29 offset:0
  ds_read_b64_tr_b16 v[102:103], v29 offset:512
  s_waitcnt lgkmcnt(0)
  v_and_b32 v12, 15, v2
  v_lshrrev_b32 v13, 4, v2
  v_lshlrev_b32 v30, 3, v12
  v_lshl_add_u32 v30, v13, 15, v30
  s_lshl_b32 s40, s24, 9
  s_add_u32 s40, s40, 0x10000
  s_add_u32 s41, s40, 16384
  s_waitcnt vmcnt(12)
  v_mfma_f32_16x16x32_bf16 v[128:131], v[32:35], a[128:131], 0
  ds_read_b64_tr_b16 v[64:65], v8 offset:4096
  v_mfma_f32_16x16x32_bf16 v[160:163], v[32:35], a[132:135], 0
  buffer_load_dwordx4 a[192:195], v3, s[16:19], s26 offen offset:0 sc1
  v_mfma_f32_16x16x32_bf16 v[192:195], v[32:35], a[136:139], 0
  ds_read_b64_tr_b16 v[66:67], v8 offset:4608
  v_mfma_f32_16x16x32_bf16 v[224:227], v[32:35], a[140:143], 0
  ds_read_b64_tr_b16 v[68:69], v9 offset:4096
  v_mfma_f32_16x16x32_bf16 v[132:135], v[36:39], a[128:131], 0
  buffer_load_dwordx4 a[196:199], v3, s[16:19], s27 offen offset:0 sc1
  v_mfma_f32_16x16x32_bf16 v[164:167], v[36:39], a[132:135], 0
  ds_read_b64_tr_b16 v[70:71], v9 offset:4608
  v_mfma_f32_16x16x32_bf16 v[196:199], v[36:39], a[136:139], 0
  ds_read_b64_tr_b16 v[72:73], v10 offset:4096
  v_mfma_f32_16x16x32_bf16 v[228:231], v[36:39], a[140:143], 0
  buffer_load_dwordx4 a[200:203], v3, s[16:19], s28 offen offset:0 sc1
  v_mfma_f32_16x16x32_bf16 v[136:139], v[40:43], a[128:131], 0
  ds_read_b64_tr_b16 v[74:75], v10 offset:4608
  v_mfma_f32_16x16x32_bf16 v[168:171], v[40:43], a[132:135], 0
  ds_read_b64_tr_b16 v[76:77], v11 offset:4096
  v_mfma_f32_16x16x32_bf16 v[200:203], v[40:43], a[136:139], 0
  buffer_load_dwordx4 a[204:207], v3, s[16:19], s29 offen offset:0 sc1
  v_mfma_f32_16x16x32_bf16 v[232:235], v[40:43], a[140:143], 0
  ds_read_b64_tr_b16 v[78:79], v11 offset:4608
  v_mfma_f32_16x16x32_bf16 v[140:143], v[44:47], a[128:131], 0
  ds_read_b64_tr_b16 v[80:81], v8 offset:12288
  v_mfma_f32_16x16x32_bf16 v[172:175], v[44:47], a[132:135], 0
  buffer_load_dwordx4 a[208:211], v3, s[16:19], s26 offen offset:1024 sc1
  v_mfma_f32_16x16x32_bf16 v[204:207], v[44:47], a[136:139], 0
  ds_read_b64_tr_b16 v[82:83], v8 offset:12800
  v_mfma_f32_16x16x32_bf16 v[236:239], v[44:47], a[140:143], 0
  ds_read_b64_tr_b16 v[84:85], v9 offset:12288
  v_mfma_f32_16x16x32_bf16 v[144:147], v[48:51], a[128:131], 0
  buffer_load_dwordx4 a[212:215], v3, s[16:19], s27 offen offset:1024 sc1
  v_mfma_f32_16x16x32_bf16 v[176:179], v[48:51], a[132:135], 0
  ds_read_b64_tr_b16 v[86:87], v9 offset:12800
  v_mfma_f32_16x16x32_bf16 v[208:211], v[48:51], a[136:139], 0
  ds_read_b64_tr_b16 v[88:89], v10 offset:12288
  v_mfma_f32_16x16x32_bf16 v[240:243], v[48:51], a[140:143], 0
  buffer_load_dwordx4 a[216:219], v3, s[16:19], s28 offen offset:1024 sc1
  v_mfma_f32_16x16x32_bf16 v[148:151], v[52:55], a[128:131], 0
  ds_read_b64_tr_b16 v[90:91], v10 offset:12800
  v_mfma_f32_16x16x32_bf16 v[180:183], v[52:55], a[132:135], 0
  ds_read_b64_tr_b16 v[92:93], v11 offset:12288
  v_mfma_f32_16x16x32_bf16 v[212:215], v[52:55], a[136:139], 0
  buffer_load_dwordx4 a[220:223], v3, s[16:19], s29 offen offset:1024 sc1
  v_mfma_f32_16x16x32_bf16 v[244:247], v[52:55], a[140:143], 0
  ds_read_b64_tr_b16 v[94:95], v11 offset:12800
  v_mfma_f32_16x16x32_bf16 v[152:155], v[56:59], a[128:131], 0
  s_add_u32 s35, s42, 1
  s_and_b32 s35, s35, 3
  s_lshl_b32 s35, s35, 12
  s_add_u32 s35, s35, 49152
  v_mfma_f32_16x16x32_bf16 v[184:187], v[56:59], a[132:135], 0
  buffer_load_dwordx4 a[16:19], v31, s[16:19], s35 offen offset:0 sc1
  v_mfma_f32_16x16x32_bf16 v[216:219], v[56:59], a[136:139], 0
  ds_read_b64_tr_b16 v[104:105], v28 offset:4096
  v_mfma_f32_16x16x32_bf16 v[248:251], v[56:59], a[140:143], 0
  ds_read_b64_tr_b16 v[106:107], v28 offset:4608
  v_mfma_f32_16x16x32_bf16 v[156:159], v[60:63], a[128:131], 0
  buffer_load_dwordx4 a[20:23], v31, s[16:19], s35 offen offset:1024 sc1
  v_mfma_f32_16x16x32_bf16 v[188:191], v[60:63], a[132:135], 0
  ds_read_b64_tr_b16 v[108:109], v29 offset:4096
  v_mfma_f32_16x16x32_bf16 v[220:223], v[60:63], a[136:139], 0
  ds_read_b64_tr_b16 v[110:111], v29 offset:4608
  v_mfma_f32_16x16x32_bf16 v[252:255], v[60:63], a[140:143], 0
  buffer_load_dwordx4 a[24:27], v31, s[16:19], s35 offen offset:2048 sc1
  v_mfma_f32_16x16x32_bf16 v[20:23], v[96:99], a[0:3], 0
  v_mfma_f32_16x16x32_bf16 v[24:27], v[100:103], a[0:3], 0
  s_waitcnt lgkmcnt(0)
  s_barrier
  s_waitcnt vmcnt(19)
  v_mfma_f32_16x16x32_bf16 v[128:131], v[64:67], a[144:147], v[128:131]
  ds_read_b64_tr_b16 v[32:33], v8 offset:16384
  v_mfma_f32_16x16x32_bf16 v[160:163], v[64:67], a[148:151], v[160:163]
  buffer_load_dwordx4 a[128:131], v3, s[16:19], s26 offen offset:2048 sc1
  v_mfma_f32_16x16x32_bf16 v[192:195], v[64:67], a[152:155], v[192:195]
  ds_read_b64_tr_b16 v[34:35], v8 offset:16896
  v_mfma_f32_16x16x32_bf16 v[224:227], v[64:67], a[156:159], v[224:227]
  ds_read_b64_tr_b16 v[36:37], v9 offset:16384
  v_mfma_f32_16x16x32_bf16 v[132:135], v[68:71], a[144:147], v[132:135]
  buffer_load_dwordx4 a[132:135], v3, s[16:19], s27 offen offset:2048 sc1
  v_mfma_f32_16x16x32_bf16 v[164:167], v[68:71], a[148:151], v[164:167]
  ds_read_b64_tr_b16 v[38:39], v9 offset:16896
  v_mfma_f32_16x16x32_bf16 v[196:199], v[68:71], a[152:155], v[196:199]
  ds_read_b64_tr_b16 v[40:41], v10 offset:16384
  v_mfma_f32_16x16x32_bf16 v[228:231], v[68:71], a[156:159], v[228:231]
  buffer_load_dwordx4 a[136:139], v3, s[16:19], s28 offen offset:2048 sc1
  v_mfma_f32_16x16x32_bf16 v[136:139], v[72:75], a[144:147], v[136:139]
  ds_read_b64_tr_b16 v[42:43], v10 offset:16896
  v_mfma_f32_16x16x32_bf16 v[168:171], v[72:75], a[148:151], v[168:171]
  ds_read_b64_tr_b16 v[44:45], v11 offset:16384
  v_mfma_f32_16x16x32_bf16 v[200:203], v[72:75], a[152:155], v[200:203]
  buffer_load_dwordx4 a[140:143], v3, s[16:19], s29 offen offset:2048 sc1
  v_mfma_f32_16x16x32_bf16 v[232:235], v[72:75], a[156:159], v[232:235]
  ds_read_b64_tr_b16 v[46:47], v11 offset:16896
  v_mfma_f32_16x16x32_bf16 v[140:143], v[76:79], a[144:147], v[140:143]
  ds_read_b64_tr_b16 v[48:49], v8 offset:24576
  v_mfma_f32_16x16x32_bf16 v[172:175], v[76:79], a[148:151], v[172:175]
  buffer_load_dwordx4 a[28:31], v31, s[16:19], s35 offen offset:3072 sc1
  v_mfma_f32_16x16x32_bf16 v[204:207], v[76:79], a[152:155], v[204:207]
  ds_read_b64_tr_b16 v[50:51], v8 offset:25088
  v_mfma_f32_16x16x32_bf16 v[236:239], v[76:79], a[156:159], v[236:239]
  s_lshl_b32 s34, s42, 1
  s_add_u32 s34, s34, 4
  s_and_b32 s34, s34, 7
  s_mul_i32 s34, s34, 229376
  s_add_u32 s34, s34, s30
  s_add_u32 m0, s31, 65536
  v_mfma_f32_16x16x32_bf16 v[144:147], v[80:83], a[144:147], v[144:147]
  buffer_load_dwordx4 v4, s[20:23], s34 offen offset:0 lds
  v_mfma_f32_16x16x32_bf16 v[176:179], v[80:83], a[148:151], v[176:179]
  ds_read_b64_tr_b16 v[52:53], v9 offset:24576
  v_mfma_f32_16x16x32_bf16 v[208:211], v[80:83], a[152:155], v[208:211]
  ds_read_b64_tr_b16 v[54:55], v9 offset:25088
  v_mfma_f32_16x16x32_bf16 v[240:243], v[80:83], a[156:159], v[240:243]
  buffer_load_dwordx4 v5, s[20:23], s34 offen offset:1024 lds
  v_mfma_f32_16x16x32_bf16 v[148:151], v[84:87], a[144:147], v[148:151]
  ds_read_b64_tr_b16 v[56:57], v10 offset:24576
  v_mfma_f32_16x16x32_bf16 v[180:183], v[84:87], a[148:151], v[180:183]
  ds_read_b64_tr_b16 v[58:59], v10 offset:25088
  v_mfma_f32_16x16x32_bf16 v[212:215], v[84:87], a[152:155], v[212:215]
  buffer_load_dwordx4 v6, s[20:23], s34 offen offset:2048 lds
  v_mfma_f32_16x16x32_bf16 v[244:247], v[84:87], a[156:159], v[244:247]
  ds_read_b64_tr_b16 v[60:61], v11 offset:24576
  v_mfma_f32_16x16x32_bf16 v[152:155], v[88:91], a[144:147], v[152:155]
  ds_read_b64_tr_b16 v[62:63], v11 offset:25088
  v_mfma_f32_16x16x32_bf16 v[184:187], v[88:91], a[148:151], v[184:187]
  buffer_load_dwordx4 v7, s[20:23], s34 offen offset:3072 lds
  v_mfma_f32_16x16x32_bf16 v[216:219], v[88:91], a[152:155], v[216:219]
  ds_read_b64_tr_b16 v[96:97], v28 offset:16384
  v_mfma_f32_16x16x32_bf16 v[248:251], v[88:91], a[156:159], v[248:251]
  s_add_u32 s35, s42, 2
  s_and_b32 s35, s35, 3
  s_lshl_b32 s35, s35, 12
  s_add_u32 s35, s35, 49152
  v_mfma_f32_16x16x32_bf16 v[156:159], v[92:95], a[144:147], v[156:159]
  buffer_load_dwordx4 a[32:35], v31, s[16:19], s35 offen offset:0 sc1
  v_mfma_f32_16x16x32_bf16 v[188:191], v[92:95], a[148:151], v[188:191]
  ds_read_b64_tr_b16 v[98:99], v28 offset:16896
  v_mfma_f32_16x16x32_bf16 v[220:223], v[92:95], a[152:155], v[220:223]
  ds_read_b64_tr_b16 v[100:101], v29 offset:16384
  v_mfma_f32_16x16x32_bf16 v[252:255], v[92:95], a[156:159], v[252:255]
  buffer_load_dwordx4 a[36:39], v31, s[16:19], s35 offen offset:1024 sc1
  v_mfma_f32_16x16x32_bf16 v[20:23], v[104:107], a[4:7], v[20:23]
  ds_read_b64_tr_b16 v[102:103], v29 offset:16896
  v_mfma_f32_16x16x32_bf16 v[24:27], v[108:111], a[4:7], v[24:27]
  s_waitcnt lgkmcnt(0)
  s_waitcnt vmcnt(26)
  v_mfma_f32_16x16x32_bf16 v[128:131], v[32:35], a[160:163], v[128:131]
  ds_read_b64_tr_b16 v[64:65], v8 offset:20480
  v_mfma_f32_16x16x32_bf16 v[160:163], v[32:35], a[164:167], v[160:163]
  buffer_load_dwordx4 a[144:147], v3, s[16:19], s26 offen offset:3072 sc1
  v_mfma_f32_16x16x32_bf16 v[192:195], v[32:35], a[168:171], v[192:195]
  ds_read_b64_tr_b16 v[66:67], v8 offset:20992
  v_mfma_f32_16x16x32_bf16 v[224:227], v[32:35], a[172:175], v[224:227]
  ds_read_b64_tr_b16 v[68:69], v9 offset:20480
  v_mfma_f32_16x16x32_bf16 v[132:135], v[36:39], a[160:163], v[132:135]
  buffer_load_dwordx4 a[148:151], v3, s[16:19], s27 offen offset:3072 sc1
  v_mfma_f32_16x16x32_bf16 v[164:167], v[36:39], a[164:167], v[164:167]
  ds_read_b64_tr_b16 v[70:71], v9 offset:20992
  v_mfma_f32_16x16x32_bf16 v[196:199], v[36:39], a[168:171], v[196:199]
  ds_read_b64_tr_b16 v[72:73], v10 offset:20480
  v_mfma_f32_16x16x32_bf16 v[228:231], v[36:39], a[172:175], v[228:231]
  buffer_load_dwordx4 a[152:155], v3, s[16:19], s28 offen offset:3072 sc1
  v_mfma_f32_16x16x32_bf16 v[136:139], v[40:43], a[160:163], v[136:139]
  ds_read_b64_tr_b16 v[74:75], v10 offset:20992
  v_mfma_f32_16x16x32_bf16 v[168:171], v[40:43], a[164:167], v[168:171]
  ds_read_b64_tr_b16 v[76:77], v11 offset:20480
  v_mfma_f32_16x16x32_bf16 v[200:203], v[40:43], a[168:171], v[200:203]
  buffer_load_dwordx4 a[156:159], v3, s[16:19], s29 offen offset:3072 sc1
  v_mfma_f32_16x16x32_bf16 v[232:235], v[40:43], a[172:175], v[232:235]
  ds_read_b64_tr_b16 v[78:79], v11 offset:20992
  v_mfma_f32_16x16x32_bf16 v[140:143], v[44:47], a[160:163], v[140:143]
  ds_read_b64_tr_b16 v[80:81], v8 offset:28672
  v_mfma_f32_16x16x32_bf16 v[172:175], v[44:47], a[164:167], v[172:175]
  buffer_load_dwordx4 a[40:43], v31, s[16:19], s35 offen offset:2048 sc1
  v_mfma_f32_16x16x32_bf16 v[204:207], v[44:47], a[168:171], v[204:207]
  ds_read_b64_tr_b16 v[82:83], v8 offset:29184
  v_mfma_f32_16x16x32_bf16 v[236:239], v[44:47], a[172:175], v[236:239]
  ds_read_b64_tr_b16 v[84:85], v9 offset:28672
  v_mfma_f32_16x16x32_bf16 v[144:147], v[48:51], a[160:163], v[144:147]
  buffer_load_dwordx4 a[44:47], v31, s[16:19], s35 offen offset:3072 sc1
  v_mfma_f32_16x16x32_bf16 v[176:179], v[48:51], a[164:167], v[176:179]
  ds_read_b64_tr_b16 v[86:87], v9 offset:29184
  v_mfma_f32_16x16x32_bf16 v[208:211], v[48:51], a[168:171], v[208:211]
  s_lshl_b32 s34, s42, 1
  s_add_u32 s34, s34, 5
  s_and_b32 s34, s34, 7
  s_mul_i32 s34, s34, 229376
  s_add_u32 s34, s34, s30
  s_add_u32 m0, s31, 81920
  v_mfma_f32_16x16x32_bf16 v[240:243], v[48:51], a[172:175], v[240:243]
  buffer_load_dwordx4 v4, s[20:23], s34 offen offset:0 lds
  v_mfma_f32_16x16x32_bf16 v[148:151], v[52:55], a[160:163], v[148:151]
  ds_read_b64_tr_b16 v[88:89], v10 offset:28672
  v_mfma_f32_16x16x32_bf16 v[180:183], v[52:55], a[164:167], v[180:183]
  ds_read_b64_tr_b16 v[90:91], v10 offset:29184
  v_mfma_f32_16x16x32_bf16 v[212:215], v[52:55], a[168:171], v[212:215]
  buffer_load_dwordx4 v5, s[20:23], s34 offen offset:1024 lds
  v_mfma_f32_16x16x32_bf16 v[244:247], v[52:55], a[172:175], v[244:247]
  ds_read_b64_tr_b16 v[92:93], v11 offset:28672
  v_mfma_f32_16x16x32_bf16 v[152:155], v[56:59], a[160:163], v[152:155]
  ds_read_b64_tr_b16 v[94:95], v11 offset:29184
  v_mfma_f32_16x16x32_bf16 v[184:187], v[56:59], a[164:167], v[184:187]
  buffer_load_dwordx4 v6, s[20:23], s34 offen offset:2048 lds
  v_mfma_f32_16x16x32_bf16 v[216:219], v[56:59], a[168:171], v[216:219]
  ds_read_b64_tr_b16 v[104:105], v28 offset:20480
  v_mfma_f32_16x16x32_bf16 v[248:251], v[56:59], a[172:175], v[248:251]
  ds_read_b64_tr_b16 v[106:107], v28 offset:20992
  v_mfma_f32_16x16x32_bf16 v[156:159], v[60:63], a[160:163], v[156:159]
  buffer_load_dwordx4 v7, s[20:23], s34 offen offset:3072 lds
  v_mfma_f32_16x16x32_bf16 v[188:191], v[60:63], a[164:167], v[188:191]
  ds_read_b64_tr_b16 v[108:109], v29 offset:20480
  v_mfma_f32_16x16x32_bf16 v[220:223], v[60:63], a[168:171], v[220:223]
  s_add_u32 s35, s42, 3
  s_and_b32 s35, s35, 3
  s_lshl_b32 s35, s35, 12
  s_add_u32 s35, s35, 49152
  v_mfma_f32_16x16x32_bf16 v[252:255], v[60:63], a[172:175], v[252:255]
  buffer_load_dwordx4 a[48:51], v31, s[16:19], s35 offen offset:0 sc1
  v_mfma_f32_16x16x32_bf16 v[20:23], v[96:99], a[8:11], v[20:23]
  ds_read_b64_tr_b16 v[110:111], v29 offset:20992
  v_mfma_f32_16x16x32_bf16 v[24:27], v[100:103], a[8:11], v[24:27]
  s_waitcnt lgkmcnt(0)
  s_barrier
  s_waitcnt vmcnt(33)
  v_mfma_f32_16x16x32_bf16 v[128:131], v[64:67], a[176:179], v[128:131]
  s_mov_b32 s43, 4096
  s_cmp_eq_u32 s42, 2
  s_cselect_b32 s43, 0xffffd000, s43
  s_add_u32 s26, s26, s43
  s_add_u32 s27, s27, s43
  s_add_u32 s28, s28, s43
  s_add_u32 s29, s29, s43
  v_mfma_f32_16x16x32_bf16 v[160:163], v[64:67], a[180:183], v[160:163]
  buffer_load_dwordx4 a[160:163], v3, s[16:19], s26 offen offset:0 sc1
  v_mfma_f32_16x16x32_bf16 v[192:195], v[64:67], a[184:187], v[192:195]
  ds_read_b64_tr_b16 v[32:33], v8 offset:32768
  v_mfma_f32_16x16x32_bf16 v[224:227], v[64:67], a[188:191], v[224:227]
  ds_read_b64_tr_b16 v[34:35], v8 offset:33280
  v_mfma_f32_16x16x32_bf16 v[132:135], v[68:71], a[176:179], v[132:135]
  buffer_load_dwordx4 a[164:167], v3, s[16:19], s27 offen offset:0 sc1
  v_mfma_f32_16x16x32_bf16 v[164:167], v[68:71], a[180:183], v[164:167]
  ds_read_b64_tr_b16 v[36:37], v9 offset:32768
  v_mfma_f32_16x16x32_bf16 v[196:199], v[68:71], a[184:187], v[196:199]
  ds_read_b64_tr_b16 v[38:39], v9 offset:33280
  v_mfma_f32_16x16x32_bf16 v[228:231], v[68:71], a[188:191], v[228:231]
  buffer_load_dwordx4 a[168:171], v3, s[16:19], s28 offen offset:0 sc1
  v_mfma_f32_16x16x32_bf16 v[136:139], v[72:75], a[176:179], v[136:139]
  ds_read_b64_tr_b16 v[40:41], v10 offset:32768
  v_mfma_f32_16x16x32_bf16 v[168:171], v[72:75], a[180:183], v[168:171]
  ds_read_b64_tr_b16 v[42:43], v10 offset:33280
  v_mfma_f32_16x16x32_bf16 v[200:203], v[72:75], a[184:187], v[200:203]
  buffer_load_dwordx4 a[172:175], v3, s[16:19], s29 offen offset:0 sc1
  v_mfma_f32_16x16x32_bf16 v[232:235], v[72:75], a[188:191], v[232:235]
  ds_read_b64_tr_b16 v[44:45], v11 offset:32768
  v_mfma_f32_16x16x32_bf16 v[140:143], v[76:79], a[176:179], v[140:143]
  ds_read_b64_tr_b16 v[46:47], v11 offset:33280
  v_mfma_f32_16x16x32_bf16 v[172:175], v[76:79], a[180:183], v[172:175]
  buffer_load_dwordx4 a[52:55], v31, s[16:19], s35 offen offset:1024 sc1
  v_mfma_f32_16x16x32_bf16 v[204:207], v[76:79], a[184:187], v[204:207]
  ds_read_b64_tr_b16 v[48:49], v8 offset:40960
  v_mfma_f32_16x16x32_bf16 v[236:239], v[76:79], a[188:191], v[236:239]
  ds_read_b64_tr_b16 v[50:51], v8 offset:41472
  v_mfma_f32_16x16x32_bf16 v[144:147], v[80:83], a[176:179], v[144:147]
  buffer_load_dwordx4 a[56:59], v31, s[16:19], s35 offen offset:2048 sc1
  v_mfma_f32_16x16x32_bf16 v[176:179], v[80:83], a[180:183], v[176:179]
  ds_read_b64_tr_b16 v[52:53], v9 offset:40960
  v_mfma_f32_16x16x32_bf16 v[208:211], v[80:83], a[184:187], v[208:211]
  ds_read_b64_tr_b16 v[54:55], v9 offset:41472
  v_mfma_f32_16x16x32_bf16 v[240:243], v[80:83], a[188:191], v[240:243]
  buffer_load_dwordx4 a[60:63], v31, s[16:19], s35 offen offset:3072 sc1
  v_mfma_f32_16x16x32_bf16 v[148:151], v[84:87], a[176:179], v[148:151]
  ds_read_b64_tr_b16 v[56:57], v10 offset:40960
  v_mfma_f32_16x16x32_bf16 v[180:183], v[84:87], a[180:183], v[180:183]
  s_lshl_b32 s34, s42, 1
  s_add_u32 s34, s34, 6
  s_and_b32 s34, s34, 7
  s_mul_i32 s34, s34, 229376
  s_add_u32 s34, s34, s30
  s_add_u32 m0, s31, 98304
  v_mfma_f32_16x16x32_bf16 v[212:215], v[84:87], a[184:187], v[212:215]
  buffer_load_dwordx4 v4, s[20:23], s34 offen offset:0 lds
  v_mfma_f32_16x16x32_bf16 v[244:247], v[84:87], a[188:191], v[244:247]
  ds_read_b64_tr_b16 v[58:59], v10 offset:41472
  v_mfma_f32_16x16x32_bf16 v[152:155], v[88:91], a[176:179], v[152:155]
  ds_read_b64_tr_b16 v[60:61], v11 offset:40960
  v_mfma_f32_16x16x32_bf16 v[184:187], v[88:91], a[180:183], v[184:187]
  buffer_load_dwordx4 v5, s[20:23], s34 offen offset:1024 lds
  v_mfma_f32_16x16x32_bf16 v[216:219], v[88:91], a[184:187], v[216:219]
  ds_read_b64_tr_b16 v[62:63], v11 offset:41472
  v_mfma_f32_16x16x32_bf16 v[248:251], v[88:91], a[188:191], v[248:251]
  ds_read_b64_tr_b16 v[96:97], v28 offset:32768
  v_mfma_f32_16x16x32_bf16 v[156:159], v[92:95], a[176:179], v[156:159]
  buffer_load_dwordx4 v6, s[20:23], s34 offen offset:2048 lds
  v_mfma_f32_16x16x32_bf16 v[188:191], v[92:95], a[180:183], v[188:191]
  ds_read_b64_tr_b16 v[98:99], v28 offset:33280
  v_mfma_f32_16x16x32_bf16 v[220:223], v[92:95], a[184:187], v[220:223]
  ds_read_b64_tr_b16 v[100:101], v29 offset:32768
  v_mfma_f32_16x16x32_bf16 v[252:255], v[92:95], a[188:191], v[252:255]
  buffer_load_dwordx4 v7, s[20:23], s34 offen offset:3072 lds
  v_mfma_f32_16x16x32_bf16 v[20:23], v[104:107], a[12:15], v[20:23]
  ds_read_b64_tr_b16 v[102:103], v29 offset:33280
  v_mfma_f32_16x16x32_bf16 v[24:27], v[108:111], a[12:15], v[24:27]
  s_waitcnt lgkmcnt(0)
  s_waitcnt vmcnt(40)
  s_waitcnt vmcnt(35)
  v_mfma_f32_16x16x32_bf16 v[128:131], v[32:35], a[192:195], v[128:131]
  ds_read_b64_tr_b16 v[64:65], v8 offset:36864
  v_mfma_f32_16x16x32_bf16 v[160:163], v[32:35], a[196:199], v[160:163]
  buffer_load_dwordx4 a[176:179], v3, s[16:19], s26 offen offset:1024 sc1
  v_mfma_f32_16x16x32_bf16 v[192:195], v[32:35], a[200:203], v[192:195]
  ds_read_b64_tr_b16 v[66:67], v8 offset:37376
  v_mfma_f32_16x16x32_bf16 v[224:227], v[32:35], a[204:207], v[224:227]
  ds_read_b64_tr_b16 v[68:69], v9 offset:36864
  v_mfma_f32_16x16x32_bf16 v[132:135], v[36:39], a[192:195], v[132:135]
  buffer_load_dwordx4 a[180:183], v3, s[16:19], s27 offen offset:1024 sc1
  v_mfma_f32_16x16x32_bf16 v[164:167], v[36:39], a[196:199], v[164:167]
  ds_read_b64_tr_b16 v[70:71], v9 offset:37376
  v_mfma_f32_16x16x32_bf16 v[196:199], v[36:39], a[200:203], v[196:199]
  ds_read_b64_tr_b16 v[72:73], v10 offset:36864
  v_mfma_f32_16x16x32_bf16 v[228:231], v[36:39], a[204:207], v[228:231]
  buffer_load_dwordx4 a[184:187], v3, s[16:19], s28 offen offset:1024 sc1
  v_mfma_f32_16x16x32_bf16 v[136:139], v[40:43], a[192:195], v[136:139]
  ds_read_b64_tr_b16 v[74:75], v10 offset:37376
  v_mfma_f32_16x16x32_bf16 v[168:171], v[40:43], a[196:199], v[168:171]
  ds_read_b64_tr_b16 v[76:77], v11 offset:36864
  v_mfma_f32_16x16x32_bf16 v[200:203], v[40:43], a[200:203], v[200:203]
  buffer_load_dwordx4 a[188:191], v3, s[16:19], s29 offen offset:1024 sc1
  v_mfma_f32_16x16x32_bf16 v[232:235], v[40:43], a[204:207], v[232:235]
  ds_read_b64_tr_b16 v[78:79], v11 offset:37376
  v_mfma_f32_16x16x32_bf16 v[140:143], v[44:47], a[192:195], v[140:143]
  s_lshl_b32 s34, s42, 1
  s_add_u32 s34, s34, 7
  s_and_b32 s34, s34, 7
  s_mul_i32 s34, s34, 229376
  s_add_u32 s34, s34, s30
  s_add_u32 m0, s31, 114688
  v_mfma_f32_16x16x32_bf16 v[172:175], v[44:47], a[196:199], v[172:175]
  buffer_load_dwordx4 v4, s[20:23], s34 offen offset:0 lds
  v_mfma_f32_16x16x32_bf16 v[204:207], v[44:47], a[200:203], v[204:207]
  ds_read_b64_tr_b16 v[80:81], v8 offset:45056
  v_mfma_f32_16x16x32_bf16 v[236:239], v[44:47], a[204:207], v[236:239]
  ds_read_b64_tr_b16 v[82:83], v8 offset:45568
  v_mfma_f32_16x16x32_bf16 v[144:147], v[48:51], a[192:195], v[144:147]
  buffer_load_dwordx4 v5, s[20:23], s34 offen offset:1024 lds
  v_mfma_f32_16x16x32_bf16 v[176:179], v[48:51], a[196:199], v[176:179]
  ds_read_b64_tr_b16 v[84:85], v9 offset:45056
  v_mfma_f32_16x16x32_bf16 v[208:211], v[48:51], a[200:203], v[208:211]
  ds_read_b64_tr_b16 v[86:87], v9 offset:45568
  v_mfma_f32_16x16x32_bf16 v[240:243], v[48:51], a[204:207], v[240:243]
  buffer_load_dwordx4 v6, s[20:23], s34 offen offset:2048 lds
  v_mfma_f32_16x16x32_bf16 v[148:151], v[52:55], a[192:195], v[148:151]
  ds_read_b64_tr_b16 v[88:89], v10 offset:45056
  v_mfma_f32_16x16x32_bf16 v[180:183], v[52:55], a[196:199], v[180:183]
  ds_read_b64_tr_b16 v[90:91], v10 offset:45568
  v_mfma_f32_16x16x32_bf16 v[212:215], v[52:55], a[200:203], v[212:215]
  buffer_load_dwordx4 v7, s[20:23], s34 offen offset:3072 lds
  v_mfma_f32_16x16x32_bf16 v[244:247], v[52:55], a[204:207], v[244:247]
  ds_read_b64_tr_b16 v[92:93], v11 offset:45056
  v_mfma_f32_16x16x32_bf16 v[152:155], v[56:59], a[192:195], v[152:155]
  ds_read_b64_tr_b16 v[94:95], v11 offset:45568
  v_mfma_f32_16x16x32_bf16 v[184:187], v[56:59], a[196:199], v[184:187]
  ds_read_b64_tr_b16 v[104:105], v28 offset:36864
  v_mfma_f32_16x16x32_bf16 v[216:219], v[56:59], a[200:203], v[216:219]
  ds_read_b64_tr_b16 v[106:107], v28 offset:37376
  v_mfma_f32_16x16x32_bf16 v[248:251], v[56:59], a[204:207], v[248:251]
  ds_read_b64_tr_b16 v[108:109], v29 offset:36864
  v_mfma_f32_16x16x32_bf16 v[156:159], v[60:63], a[192:195], v[156:159]
  ds_read_b64_tr_b16 v[110:111], v29 offset:37376
  v_mfma_f32_16x16x32_bf16 v[188:191], v[60:63], a[196:199], v[188:191]
  v_mfma_f32_16x16x32_bf16 v[220:223], v[60:63], a[200:203], v[220:223]
  v_mfma_f32_16x16x32_bf16 v[252:255], v[60:63], a[204:207], v[252:255]
  v_mfma_f32_16x16x32_bf16 v[20:23], v[96:99], a[16:19], v[20:23]
  v_mfma_f32_16x16x32_bf16 v[24:27], v[100:103], a[16:19], v[24:27]
  s_waitcnt lgkmcnt(0)
  s_barrier
  s_waitcnt vmcnt(42)
  v_mfma_f32_16x16x32_bf16 v[128:131], v[64:67], a[208:211], v[128:131]
  ds_read_b64_tr_b16 v[32:33], v8 offset:49152
  v_mfma_f32_16x16x32_bf16 v[160:163], v[64:67], a[212:215], v[160:163]
  buffer_load_dwordx4 a[192:195], v3, s[16:19], s26 offen offset:2048 sc1
  v_mfma_f32_16x16x32_bf16 v[192:195], v[64:67], a[216:219], v[192:195]
  ds_read_b64_tr_b16 v[34:35], v8 offset:49664
  v_mfma_f32_16x16x32_bf16 v[224:227], v[64:67], a[220:223], v[224:227]
  ds_read_b64_tr_b16 v[36:37], v9 offset:49152
  v_mfma_f32_16x16x32_bf16 v[132:135], v[68:71], a[208:211], v[132:135]
  buffer_load_dwordx4 a[196:199], v3, s[16:19], s27 offen offset:2048 sc1
  v_mfma_f32_16x16x32_bf16 v[164:167], v[68:71], a[212:215], v[164:167]
  ds_read_b64_tr_b16 v[38:39], v9 offset:49664
  v_mfma_f32_16x16x32_bf16 v[196:199], v[68:71], a[216:219], v[196:199]
  ds_read_b64_tr_b16 v[40:41], v10 offset:49152
  v_mfma_f32_16x16x32_bf16 v[228:231], v[68:71], a[220:223], v[228:231]
  buffer_load_dwordx4 a[200:203], v3, s[16:19], s28 offen offset:2048 sc1
  v_mfma_f32_16x16x32_bf16 v[136:139], v[72:75], a[208:211], v[136:139]
  ds_read_b64_tr_b16 v[42:43], v10 offset:49664
  v_mfma_f32_16x16x32_bf16 v[168:171], v[72:75], a[212:215], v[168:171]
  ds_read_b64_tr_b16 v[44:45], v11 offset:49152
  v_mfma_f32_16x16x32_bf16 v[200:203], v[72:75], a[216:219], v[200:203]
  buffer_load_dwordx4 a[204:207], v3, s[16:19], s29 offen offset:2048 sc1
  v_mfma_f32_16x16x32_bf16 v[232:235], v[72:75], a[220:223], v[232:235]
  ds_read_b64_tr_b16 v[46:47], v11 offset:49664
  v_mfma_f32_16x16x32_bf16 v[140:143], v[76:79], a[208:211], v[140:143]
  ds_read_b64_tr_b16 v[48:49], v8 offset:57344
  v_mfma_f32_16x16x32_bf16 v[172:175], v[76:79], a[212:215], v[172:175]
  ds_read_b64_tr_b16 v[50:51], v8 offset:57856
  v_mfma_f32_16x16x32_bf16 v[204:207], v[76:79], a[216:219], v[204:207]
  ds_read_b64_tr_b16 v[52:53], v9 offset:57344
  v_mfma_f32_16x16x32_bf16 v[236:239], v[76:79], a[220:223], v[236:239]
  ds_read_b64_tr_b16 v[54:55], v9 offset:57856
  v_mfma_f32_16x16x32_bf16 v[144:147], v[80:83], a[208:211], v[144:147]
  ds_read_b64_tr_b16 v[56:57], v10 offset:57344
  v_mfma_f32_16x16x32_bf16 v[176:179], v[80:83], a[212:215], v[176:179]
  ds_read_b64_tr_b16 v[58:59], v10 offset:57856
  v_mfma_f32_16x16x32_bf16 v[208:211], v[80:83], a[216:219], v[208:211]
  ds_read_b64_tr_b16 v[60:61], v11 offset:57344
  v_mfma_f32_16x16x32_bf16 v[240:243], v[80:83], a[220:223], v[240:243]
  ds_read_b64_tr_b16 v[62:63], v11 offset:57856
  v_mfma_f32_16x16x32_bf16 v[148:151], v[84:87], a[208:211], v[148:151]
  ds_read_b64_tr_b16 v[96:97], v28 offset:49152
  v_mfma_f32_16x16x32_bf16 v[180:183], v[84:87], a[212:215], v[180:183]
  ds_read_b64_tr_b16 v[98:99], v28 offset:49664
  v_mfma_f32_16x16x32_bf16 v[212:215], v[84:87], a[216:219], v[212:215]
  ds_read_b64_tr_b16 v[100:101], v29 offset:49152
  v_mfma_f32_16x16x32_bf16 v[244:247], v[84:87], a[220:223], v[244:247]
  ds_read_b64_tr_b16 v[102:103], v29 offset:49664
  v_mfma_f32_16x16x32_bf16 v[152:155], v[88:91], a[208:211], v[152:155]
  v_mfma_f32_16x16x32_bf16 v[184:187], v[88:91], a[212:215], v[184:187]
  v_mfma_f32_16x16x32_bf16 v[216:219], v[88:91], a[216:219], v[216:219]
  v_mfma_f32_16x16x32_bf16 v[248:251], v[88:91], a[220:223], v[248:251]
  v_mfma_f32_16x16x32_bf16 v[156:159], v[92:95], a[208:211], v[156:159]
  v_mfma_f32_16x16x32_bf16 v[188:191], v[92:95], a[212:215], v[188:191]
  v_mfma_f32_16x16x32_bf16 v[220:223], v[92:95], a[216:219], v[220:223]
  v_mfma_f32_16x16x32_bf16 v[252:255], v[92:95], a[220:223], v[252:255]
  v_mfma_f32_16x16x32_bf16 v[20:23], v[104:107], a[20:23], v[20:23]
  v_mfma_f32_16x16x32_bf16 v[24:27], v[108:111], a[20:23], v[24:27]
  s_waitcnt lgkmcnt(0)
  s_waitcnt vmcnt(41)
  v_mfma_f32_16x16x32_bf16 v[128:131], v[32:35], a[128:131], v[128:131]
  ds_read_b64_tr_b16 v[64:65], v8 offset:53248
  v_mfma_f32_16x16x32_bf16 v[160:163], v[32:35], a[132:135], v[160:163]
  buffer_load_dwordx4 a[208:211], v3, s[16:19], s26 offen offset:3072 sc1
  v_mfma_f32_16x16x32_bf16 v[192:195], v[32:35], a[136:139], v[192:195]
  ds_read_b64_tr_b16 v[66:67], v8 offset:53760
  v_mfma_f32_16x16x32_bf16 v[224:227], v[32:35], a[140:143], v[224:227]
  ds_read_b64_tr_b16 v[68:69], v9 offset:53248
  v_mfma_f32_16x16x32_bf16 v[132:135], v[36:39], a[128:131], v[132:135]
  buffer_load_dwordx4 a[212:215], v3, s[16:19], s27 offen offset:3072 sc1
  v_mfma_f32_16x16x32_bf16 v[164:167], v[36:39], a[132:135], v[164:167]
  ds_read_b64_tr_b16 v[70:71], v9 offset:53760
  v_mfma_f32_16x16x32_bf16 v[196:199], v[36:39], a[136:139], v[196:199]
  ds_read_b64_tr_b16 v[72:73], v10 offset:53248
  v_mfma_f32_16x16x32_bf16 v[228:231], v[36:39], a[140:143], v[228:231]
  buffer_load_dwordx4 a[216:219], v3, s[16:19], s28 offen offset:3072 sc1
  v_mfma_f32_16x16x32_bf16 v[136:139], v[40:43], a[128:131], v[136:139]
  ds_read_b64_tr_b16 v[74:75], v10 offset:53760
  v_mfma_f32_16x16x32_bf16 v[168:171], v[40:43], a[132:135], v[168:171]
  ds_read_b64_tr_b16 v[76:77], v11 offset:53248
  v_mfma_f32_16x16x32_bf16 v[200:203], v[40:43], a[136:139], v[200:203]
  buffer_load_dwordx4 a[220:223], v3, s[16:19], s29 offen offset:3072 sc1
  v_mfma_f32_16x16x32_bf16 v[232:235], v[40:43], a[140:143], v[232:235]
  ds_read_b64_tr_b16 v[78:79], v11 offset:53760
  v_mfma_f32_16x16x32_bf16 v[140:143], v[44:47], a[128:131], v[140:143]
  ds_read_b64_tr_b16 v[80:81], v8 offset:61440
  v_mfma_f32_16x16x32_bf16 v[172:175], v[44:47], a[132:135], v[172:175]
  ds_read_b64_tr_b16 v[82:83], v8 offset:61952
  v_mfma_f32_16x16x32_bf16 v[204:207], v[44:47], a[136:139], v[204:207]
  ds_read_b64_tr_b16 v[84:85], v9 offset:61440
  v_mfma_f32_16x16x32_bf16 v[236:239], v[44:47], a[140:143], v[236:239]
  ds_read_b64_tr_b16 v[86:87], v9 offset:61952
  v_mfma_f32_16x16x32_bf16 v[144:147], v[48:51], a[128:131], v[144:147]
  ds_read_b64_tr_b16 v[88:89], v10 offset:61440
  v_mfma_f32_16x16x32_bf16 v[176:179], v[48:51], a[132:135], v[176:179]
  ds_read_b64_tr_b16 v[90:91], v10 offset:61952
  v_mfma_f32_16x16x32_bf16 v[208:211], v[48:51], a[136:139], v[208:211]
  ds_read_b64_tr_b16 v[92:93], v11 offset:61440
  v_mfma_f32_16x16x32_bf16 v[240:243], v[48:51], a[140:143], v[240:243]
  ds_read_b64_tr_b16 v[94:95], v11 offset:61952
  v_mfma_f32_16x16x32_bf16 v[148:151], v[52:55], a[128:131], v[148:151]
  ds_read_b64_tr_b16 v[104:105], v28 offset:53248
  v_mfma_f32_16x16x32_bf16 v[180:183], v[52:55], a[132:135], v[180:183]
  ds_read_b64_tr_b16 v[106:107], v28 offset:53760
  v_mfma_f32_16x16x32_bf16 v[212:215], v[52:55], a[136:139], v[212:215]
  ds_read_b64_tr_b16 v[108:109], v29 offset:53248
  v_mfma_f32_16x16x32_bf16 v[244:247], v[52:55], a[140:143], v[244:247]
  ds_read_b64_tr_b16 v[110:111], v29 offset:53760
  v_mfma_f32_16x16x32_bf16 v[152:155], v[56:59], a[128:131], v[152:155]
  v_mfma_f32_16x16x32_bf16 v[184:187], v[56:59], a[132:135], v[184:187]
  v_mfma_f32_16x16x32_bf16 v[216:219], v[56:59], a[136:139], v[216:219]
  v_mfma_f32_16x16x32_bf16 v[248:251], v[56:59], a[140:143], v[248:251]
  v_mfma_f32_16x16x32_bf16 v[156:159], v[60:63], a[128:131], v[156:159]
  v_mfma_f32_16x16x32_bf16 v[188:191], v[60:63], a[132:135], v[188:191]
  v_mfma_f32_16x16x32_bf16 v[220:223], v[60:63], a[136:139], v[220:223]
  v_mfma_f32_16x16x32_bf16 v[252:255], v[60:63], a[140:143], v[252:255]
  v_mfma_f32_16x16x32_bf16 v[20:23], v[96:99], a[24:27], v[20:23]
  v_mfma_f32_16x16x32_bf16 v[24:27], v[100:103], a[24:27], v[24:27]
  s_waitcnt lgkmcnt(0)
  s_waitcnt vmcnt(40)
  s_barrier
  v_add_u32 v8, 0x10000, v8
  v_add_u32 v9, 0x10000, v9
  v_add_u32 v10, 0x10000, v10
  v_add_u32 v11, 0x10000, v11
  v_add_u32 v28, 0x10000, v28
  v_add_u32 v29, 0x10000, v29
  s_waitcnt vmcnt(34)
  v_mfma_f32_16x16x32_bf16 v[128:131], v[64:67], a[144:147], v[128:131]
  s_mov_b32 s43, 4096
  s_cmp_eq_u32 s42, 1
  s_cselect_b32 s43, 0xffffd000, s43
  s_add_u32 s26, s26, s43
  s_add_u32 s27, s27, s43
  s_add_u32 s28, s28, s43
  s_add_u32 s29, s29, s43
  v_mfma_f32_16x16x32_bf16 v[160:163], v[64:67], a[148:151], v[160:163]
  buffer_load_dwordx4 a[128:131], v3, s[16:19], s26 offen offset:0 sc1
  v_mfma_f32_16x16x32_bf16 v[192:195], v[64:67], a[152:155], v[192:195]
  ds_read_b64_tr_b16 v[32:33], v8 offset:0
  v_mfma_f32_16x16x32_bf16 v[224:227], v[64:67], a[156:159], v[224:227]
  ds_read_b64_tr_b16 v[34:35], v8 offset:512
  v_mfma_f32_16x16x32_bf16 v[132:135], v[68:71], a[144:147], v[132:135]
  buffer_load_dwordx4 a[132:135], v3, s[16:19], s27 offen offset:0 sc1
  v_mfma_f32_16x16x32_bf16 v[164:167], v[68:71], a[148:151], v[164:167]
  ds_read_b64_tr_b16 v[36:37], v9 offset:0
  v_mfma_f32_16x16x32_bf16 v[196:199], v[68:71], a[152:155], v[196:199]
  ds_read_b64_tr_b16 v[38:39], v9 offset:512
  v_mfma_f32_16x16x32_bf16 v[228:231], v[68:71], a[156:159], v[228:231]
  buffer_load_dwordx4 a[136:139], v3, s[16:19], s28 offen offset:0 sc1
  v_mfma_f32_16x16x32_bf16 v[136:139], v[72:75], a[144:147], v[136:139]
  ds_read_b64_tr_b16 v[40:41], v10 offset:0
  v_mfma_f32_16x16x32_bf16 v[168:171], v[72:75], a[148:151], v[168:171]
  ds_read_b64_tr_b16 v[42:43], v10 offset:512
  v_mfma_f32_16x16x32_bf16 v[200:203], v[72:75], a[152:155], v[200:203]
  buffer_load_dwordx4 a[140:143], v3, s[16:19], s29 offen offset:0 sc1
  v_mfma_f32_16x16x32_bf16 v[232:235], v[72:75], a[156:159], v[232:235]
  ds_read_b64_tr_b16 v[44:45], v11 offset:0
  v_mfma_f32_16x16x32_bf16 v[140:143], v[76:79], a[144:147], v[140:143]
  ds_read_b64_tr_b16 v[46:47], v11 offset:512
  v_mfma_f32_16x16x32_bf16 v[172:175], v[76:79], a[148:151], v[172:175]
  ds_read_b64_tr_b16 v[48:49], v8 offset:8192
  v_mfma_f32_16x16x32_bf16 v[204:207], v[76:79], a[152:155], v[204:207]
  ds_read_b64_tr_b16 v[50:51], v8 offset:8704
  v_mfma_f32_16x16x32_bf16 v[236:239], v[76:79], a[156:159], v[236:239]
  ds_read_b64_tr_b16 v[52:53], v9 offset:8192
  v_mfma_f32_16x16x32_bf16 v[144:147], v[80:83], a[144:147], v[144:147]
  ds_read_b64_tr_b16 v[54:55], v9 offset:8704
  v_mfma_f32_16x16x32_bf16 v[176:179], v[80:83], a[148:151], v[176:179]
  ds_read_b64_tr_b16 v[56:57], v10 offset:8192
  v_mfma_f32_16x16x32_bf16 v[208:211], v[80:83], a[152:155], v[208:211]
  ds_read_b64_tr_b16 v[58:59], v10 offset:8704
  v_mfma_f32_16x16x32_bf16 v[240:243], v[80:83], a[156:159], v[240:243]
  ds_read_b64_tr_b16 v[60:61], v11 offset:8192
  v_mfma_f32_16x16x32_bf16 v[148:151], v[84:87], a[144:147], v[148:151]
  ds_read_b64_tr_b16 v[62:63], v11 offset:8704
  v_mfma_f32_16x16x32_bf16 v[180:183], v[84:87], a[148:151], v[180:183]
  ds_read_b64_tr_b16 v[96:97], v28 offset:0
  v_mfma_f32_16x16x32_bf16 v[212:215], v[84:87], a[152:155], v[212:215]
  ds_read_b64_tr_b16 v[98:99], v28 offset:512
  v_mfma_f32_16x16x32_bf16 v[244:247], v[84:87], a[156:159], v[244:247]
  ds_read_b64_tr_b16 v[100:101], v29 offset:0
  v_mfma_f32_16x16x32_bf16 v[152:155], v[88:91], a[144:147], v[152:155]
  ds_read_b64_tr_b16 v[102:103], v29 offset:512
  v_mfma_f32_16x16x32_bf16 v[184:187], v[88:91], a[148:151], v[184:187]
  v_mfma_f32_16x16x32_bf16 v[216:219], v[88:91], a[152:155], v[216:219]
  v_mfma_f32_16x16x32_bf16 v[248:251], v[88:91], a[156:159], v[248:251]
  v_mfma_f32_16x16x32_bf16 v[156:159], v[92:95], a[144:147], v[156:159]
  v_mfma_f32_16x16x32_bf16 v[188:191], v[92:95], a[148:151], v[188:191]
  v_mfma_f32_16x16x32_bf16 v[220:223], v[92:95], a[152:155], v[220:223]
  v_mfma_f32_16x16x32_bf16 v[252:255], v[92:95], a[156:159], v[252:255]
  v_mfma_f32_16x16x32_bf16 v[20:23], v[104:107], a[28:31], v[20:23]
  v_mfma_f32_16x16x32_bf16 v[24:27], v[108:111], a[28:31], v[24:27]
  s_waitcnt lgkmcnt(0)
  s_waitcnt vmcnt(27)
  v_mfma_f32_16x16x32_bf16 v[128:131], v[32:35], a[160:163], v[128:131]
  ds_read_b64_tr_b16 v[64:65], v8 offset:4096
  v_mfma_f32_16x16x32_bf16 v[160:163], v[32:35], a[164:167], v[160:163]
  buffer_load_dwordx4 a[144:147], v3, s[16:19], s26 offen offset:1024 sc1
  v_mfma_f32_16x16x32_bf16 v[192:195], v[32:35], a[168:171], v[192:195]
  ds_read_b64_tr_b16 v[66:67], v8 offset:4608
  v_mfma_f32_16x16x32_bf16 v[224:227], v[32:35], a[172:175], v[224:227]
  ds_read_b64_tr_b16 v[68:69], v9 offset:4096
  v_mfma_f32_16x16x32_bf16 v[132:135], v[36:39], a[160:163], v[132:135]
  buffer_load_dwordx4 a[148:151], v3, s[16:19], s27 offen offset:1024 sc1
  v_mfma_f32_16x16x32_bf16 v[164:167], v[36:39], a[164:167], v[164:167]
  ds_read_b64_tr_b16 v[70:71], v9 offset:4608
  v_mfma_f32_16x16x32_bf16 v[196:199], v[36:39], a[168:171], v[196:199]
  ds_read_b64_tr_b16 v[72:73], v10 offset:4096
  v_mfma_f32_16x16x32_bf16 v[228:231], v[36:39], a[172:175], v[228:231]
  buffer_load_dwordx4 a[152:155], v3, s[16:19], s28 offen offset:1024 sc1
  v_mfma_f32_16x16x32_bf16 v[136:139], v[40:43], a[160:163], v[136:139]
  ds_read_b64_tr_b16 v[74:75], v10 offset:4608
  v_mfma_f32_16x16x32_bf16 v[168:171], v[40:43], a[164:167], v[168:171]
  ds_read_b64_tr_b16 v[76:77], v11 offset:4096
  v_mfma_f32_16x16x32_bf16 v[200:203], v[40:43], a[168:171], v[200:203]
  buffer_load_dwordx4 a[156:159], v3, s[16:19], s29 offen offset:1024 sc1
  v_mfma_f32_16x16x32_bf16 v[232:235], v[40:43], a[172:175], v[232:235]
  ds_read_b64_tr_b16 v[78:79], v11 offset:4608
  v_mfma_f32_16x16x32_bf16 v[140:143], v[44:47], a[160:163], v[140:143]
  ds_read_b64_tr_b16 v[80:81], v8 offset:12288
  v_mfma_f32_16x16x32_bf16 v[172:175], v[44:47], a[164:167], v[172:175]
  ds_read_b64_tr_b16 v[82:83], v8 offset:12800
  v_mfma_f32_16x16x32_bf16 v[204:207], v[44:47], a[168:171], v[204:207]
  ds_read_b64_tr_b16 v[84:85], v9 offset:12288
  v_mfma_f32_16x16x32_bf16 v[236:239], v[44:47], a[172:175], v[236:239]
  ds_read_b64_tr_b16 v[86:87], v9 offset:12800
  v_mfma_f32_16x16x32_bf16 v[144:147], v[48:51], a[160:163], v[144:147]
  ds_read_b64_tr_b16 v[88:89], v10 offset:12288
  v_mfma_f32_16x16x32_bf16 v[176:179], v[48:51], a[164:167], v[176:179]
  ds_read_b64_tr_b16 v[90:91], v10 offset:12800
  v_mfma_f32_16x16x32_bf16 v[208:211], v[48:51], a[168:171], v[208:211]
  ds_read_b64_tr_b16 v[92:93], v11 offset:12288
  v_mfma_f32_16x16x32_bf16 v[240:243], v[48:51], a[172:175], v[240:243]
  ds_read_b64_tr_b16 v[94:95], v11 offset:12800
  v_mfma_f32_16x16x32_bf16 v[148:151], v[52:55], a[160:163], v[148:151]
  ds_read_b64_tr_b16 v[104:105], v28 offset:4096
  v_mfma_f32_16x16x32_bf16 v[180:183], v[52:55], a[164:167], v[180:183]
  ds_read_b64_tr_b16 v[106:107], v28 offset:4608
  v_mfma_f32_16x16x32_bf16 v[212:215], v[52:55], a[168:171], v[212:215]
  ds_read_b64_tr_b16 v[108:109], v29 offset:4096
  v_mfma_f32_16x16x32_bf16 v[244:247], v[52:55], a[172:175], v[244:247]
  ds_read_b64_tr_b16 v[110:111], v29 offset:4608
  v_mfma_f32_16x16x32_bf16 v[152:155], v[56:59], a[160:163], v[152:155]
  v_mfma_f32_16x16x32_bf16 v[184:187], v[56:59], a[164:167], v[184:187]
  v_mfma_f32_16x16x32_bf16 v[216:219], v[56:59], a[168:171], v[216:219]
  v_mfma_f32_16x16x32_bf16 v[248:251], v[56:59], a[172:175], v[248:251]
  v_mfma_f32_16x16x32_bf16 v[156:159], v[60:63], a[160:163], v[156:159]
  v_mfma_f32_16x16x32_bf16 v[188:191], v[60:63], a[164:167], v[188:191]
  v_mfma_f32_16x16x32_bf16 v[220:223], v[60:63], a[168:171], v[220:223]
  v_mfma_f32_16x16x32_bf16 v[252:255], v[60:63], a[172:175], v[252:255]
  v_mfma_f32_16x16x32_bf16 v[20:23], v[96:99], a[32:35], v[20:23]
  v_mfma_f32_16x16x32_bf16 v[24:27], v[100:103], a[32:35], v[24:27]
  s_waitcnt lgkmcnt(0)
  s_barrier
  s_waitcnt vmcnt(20)
  v_mfma_f32_16x16x32_bf16 v[128:131], v[64:67], a[176:179], v[128:131]
  ds_read_b64_tr_b16 v[32:33], v8 offset:16384
  v_mfma_f32_16x16x32_bf16 v[160:163], v[64:67], a[180:183], v[160:163]
  buffer_load_dwordx4 a[160:163], v3, s[16:19], s26 offen offset:2048 sc1
  v_mfma_f32_16x16x32_bf16 v[192:195], v[64:67], a[184:187], v[192:195]
  ds_read_b64_tr_b16 v[34:35], v8 offset:16896
  v_mfma_f32_16x16x32_bf16 v[224:227], v[64:67], a[188:191], v[224:227]
  ds_read_b64_tr_b16 v[36:37], v9 offset:16384
  v_mfma_f32_16x16x32_bf16 v[132:135], v[68:71], a[176:179], v[132:135]
  buffer_load_dwordx4 a[164:167], v3, s[16:19], s27 offen offset:2048 sc1
  v_mfma_f32_16x16x32_bf16 v[164:167], v[68:71], a[180:183], v[164:167]
  ds_read_b64_tr_b16 v[38:39], v9 offset:16896
  v_mfma_f32_16x16x32_bf16 v[196:199], v[68:71], a[184:187], v[196:199]
  ds_read_b64_tr_b16 v[40:41], v10 offset:16384
  v_mfma_f32_16x16x32_bf16 v[228:231], v[68:71], a[188:191], v[228:231]
  buffer_load_dwordx4 a[168:171], v3, s[16:19], s28 offen offset:2048 sc1
  v_mfma_f32_16x16x32_bf16 v[136:139], v[72:75], a[176:179], v[136:139]
  ds_read_b64_tr_b16 v[42:43], v10 offset:16896
  v_mfma_f32_16x16x32_bf16 v[168:171], v[72:75], a[180:183], v[168:171]
  ds_read_b64_tr_b16 v[44:45], v11 offset:16384
  v_mfma_f32_16x16x32_bf16 v[200:203], v[72:75], a[184:187], v[200:203]
  buffer_load_dwordx4 a[172:175], v3, s[16:19], s29 offen offset:2048 sc1
  v_mfma_f32_16x16x32_bf16 v[232:235], v[72:75], a[188:191], v[232:235]
  ds_read_b64_tr_b16 v[46:47], v11 offset:16896
  v_mfma_f32_16x16x32_bf16 v[140:143], v[76:79], a[176:179], v[140:143]
  ds_read_b64_tr_b16 v[48:49], v8 offset:24576
  v_mfma_f32_16x16x32_bf16 v[172:175], v[76:79], a[180:183], v[172:175]
  ds_read_b64_tr_b16 v[50:51], v8 offset:25088
  v_mfma_f32_16x16x32_bf16 v[204:207], v[76:79], a[184:187], v[204:207]
  ds_read_b64_tr_b16 v[52:53], v9 offset:24576
  v_mfma_f32_16x16x32_bf16 v[236:239], v[76:79], a[188:191], v[236:239]
  ds_read_b64_tr_b16 v[54:55], v9 offset:25088
  v_mfma_f32_16x16x32_bf16 v[144:147], v[80:83], a[176:179], v[144:147]
  ds_read_b64_tr_b16 v[56:57], v10 offset:24576
  v_mfma_f32_16x16x32_bf16 v[176:179], v[80:83], a[180:183], v[176:179]
  ds_read_b64_tr_b16 v[58:59], v10 offset:25088
  v_mfma_f32_16x16x32_bf16 v[208:211], v[80:83], a[184:187], v[208:211]
  ds_read_b64_tr_b16 v[60:61], v11 offset:24576
  v_mfma_f32_16x16x32_bf16 v[240:243], v[80:83], a[188:191], v[240:243]
  ds_read_b64_tr_b16 v[62:63], v11 offset:25088
  v_mfma_f32_16x16x32_bf16 v[148:151], v[84:87], a[176:179], v[148:151]
  ds_read_b64_tr_b16 v[96:97], v28 offset:16384
  v_mfma_f32_16x16x32_bf16 v[180:183], v[84:87], a[180:183], v[180:183]
  ds_read_b64_tr_b16 v[98:99], v28 offset:16896
  v_mfma_f32_16x16x32_bf16 v[212:215], v[84:87], a[184:187], v[212:215]
  ds_read_b64_tr_b16 v[100:101], v29 offset:16384
  v_mfma_f32_16x16x32_bf16 v[244:247], v[84:87], a[188:191], v[244:247]
  ds_read_b64_tr_b16 v[102:103], v29 offset:16896
  v_mfma_f32_16x16x32_bf16 v[152:155], v[88:91], a[176:179], v[152:155]
  v_mfma_f32_16x16x32_bf16 v[184:187], v[88:91], a[180:183], v[184:187]
  v_mfma_f32_16x16x32_bf16 v[216:219], v[88:91], a[184:187], v[216:219]
  v_mfma_f32_16x16x32_bf16 v[248:251], v[88:91], a[188:191], v[248:251]
  v_mfma_f32_16x16x32_bf16 v[156:159], v[92:95], a[176:179], v[156:159]
  v_mfma_f32_16x16x32_bf16 v[188:191], v[92:95], a[180:183], v[188:191]
  v_mfma_f32_16x16x32_bf16 v[220:223], v[92:95], a[184:187], v[220:223]
  v_mfma_f32_16x16x32_bf16 v[252:255], v[92:95], a[188:191], v[252:255]
  v_mfma_f32_16x16x32_bf16 v[20:23], v[104:107], a[36:39], v[20:23]
  v_mfma_f32_16x16x32_bf16 v[24:27], v[108:111], a[36:39], v[24:27]
  s_waitcnt lgkmcnt(0)
  s_waitcnt vmcnt(16)
  v_mfma_f32_16x16x32_bf16 v[128:131], v[32:35], a[192:195], v[128:131]
  ds_read_b64_tr_b16 v[64:65], v8 offset:20480
  v_mfma_f32_16x16x32_bf16 v[160:163], v[32:35], a[196:199], v[160:163]
  buffer_load_dwordx4 a[176:179], v3, s[16:19], s26 offen offset:3072 sc1
  v_mfma_f32_16x16x32_bf16 v[192:195], v[32:35], a[200:203], v[192:195]
  ds_read_b64_tr_b16 v[66:67], v8 offset:20992
  v_mfma_f32_16x16x32_bf16 v[224:227], v[32:35], a[204:207], v[224:227]
  ds_read_b64_tr_b16 v[68:69], v9 offset:20480
  v_mfma_f32_16x16x32_bf16 v[132:135], v[36:39], a[192:195], v[132:135]
  buffer_load_dwordx4 a[180:183], v3, s[16:19], s27 offen offset:3072 sc1
  v_mfma_f32_16x16x32_bf16 v[164:167], v[36:39], a[196:199], v[164:167]
  ds_read_b64_tr_b16 v[70:71], v9 offset:20992
  v_mfma_f32_16x16x32_bf16 v[196:199], v[36:39], a[200:203], v[196:199]
  ds_read_b64_tr_b16 v[72:73], v10 offset:20480
  v_mfma_f32_16x16x32_bf16 v[228:231], v[36:39], a[204:207], v[228:231]
  buffer_load_dwordx4 a[184:187], v3, s[16:19], s28 offen offset:3072 sc1
  v_mfma_f32_16x16x32_bf16 v[136:139], v[40:43], a[192:195], v[136:139]
  ds_read_b64_tr_b16 v[74:75], v10 offset:20992
  v_mfma_f32_16x16x32_bf16 v[168:171], v[40:43], a[196:199], v[168:171]
  ds_read_b64_tr_b16 v[76:77], v11 offset:20480
  v_mfma_f32_16x16x32_bf16 v[200:203], v[40:43], a[200:203], v[200:203]
  buffer_load_dwordx4 a[188:191], v3, s[16:19], s29 offen offset:3072 sc1
  v_mfma_f32_16x16x32_bf16 v[232:235], v[40:43], a[204:207], v[232:235]
  ds_read_b64_tr_b16 v[78:79], v11 offset:20992
  v_mfma_f32_16x16x32_bf16 v[140:143], v[44:47], a[192:195], v[140:143]
  ds_read_b64_tr_b16 v[80:81], v8 offset:28672
  v_mfma_f32_16x16x32_bf16 v[172:175], v[44:47], a[196:199], v[172:175]
  ds_read_b64_tr_b16 v[82:83], v8 offset:29184
  v_mfma_f32_16x16x32_bf16 v[204:207], v[44:47], a[200:203], v[204:207]
  ds_read_b64_tr_b16 v[84:85], v9 offset:28672
  v_mfma_f32_16x16x32_bf16 v[236:239], v[44:47], a[204:207], v[236:239]
  ds_read_b64_tr_b16 v[86:87], v9 offset:29184
  v_mfma_f32_16x16x32_bf16 v[144:147], v[48:51], a[192:195], v[144:147]
  ds_read_b64_tr_b16 v[88:89], v10 offset:28672
  v_mfma_f32_16x16x32_bf16 v[176:179], v[48:51], a[196:199], v[176:179]
  ds_read_b64_tr_b16 v[90:91], v10 offset:29184
  v_mfma_f32_16x16x32_bf16 v[208:211], v[48:51], a[200:203], v[208:211]
  ds_read_b64_tr_b16 v[92:93], v11 offset:28672
  v_mfma_f32_16x16x32_bf16 v[240:243], v[48:51], a[204:207], v[240:243]
  ds_read_b64_tr_b16 v[94:95], v11 offset:29184
  v_mfma_f32_16x16x32_bf16 v[148:151], v[52:55], a[192:195], v[148:151]
  ds_read_b64_tr_b16 v[104:105], v28 offset:20480
  v_mfma_f32_16x16x32_bf16 v[180:183], v[52:55], a[196:199], v[180:183]
  ds_read_b64_tr_b16 v[106:107], v28 offset:20992
  v_mfma_f32_16x16x32_bf16 v[212:215], v[52:55], a[200:203], v[212:215]
  ds_read_b64_tr_b16 v[108:109], v29 offset:20480
  v_mfma_f32_16x16x32_bf16 v[244:247], v[52:55], a[204:207], v[244:247]
  ds_read_b64_tr_b16 v[110:111], v29 offset:20992
  v_mfma_f32_16x16x32_bf16 v[152:155], v[56:59], a[192:195], v[152:155]
  v_mfma_f32_16x16x32_bf16 v[184:187], v[56:59], a[196:199], v[184:187]
  v_mfma_f32_16x16x32_bf16 v[216:219], v[56:59], a[200:203], v[216:219]
  v_mfma_f32_16x16x32_bf16 v[248:251], v[56:59], a[204:207], v[248:251]
  v_mfma_f32_16x16x32_bf16 v[156:159], v[60:63], a[192:195], v[156:159]
  v_mfma_f32_16x16x32_bf16 v[188:191], v[60:63], a[196:199], v[188:191]
  v_mfma_f32_16x16x32_bf16 v[220:223], v[60:63], a[200:203], v[220:223]
  v_mfma_f32_16x16x32_bf16 v[252:255], v[60:63], a[204:207], v[252:255]
  v_mfma_f32_16x16x32_bf16 v[20:23], v[96:99], a[40:43], v[20:23]
  v_mfma_f32_16x16x32_bf16 v[24:27], v[100:103], a[40:43], v[24:27]
  s_waitcnt lgkmcnt(0)
  s_barrier
  s_waitcnt vmcnt(16)
  v_mfma_f32_16x16x32_bf16 v[128:131], v[64:67], a[208:211], v[128:131]
  ds_read_b64_tr_b16 v[32:33], v8 offset:32768
  v_mfma_f32_16x16x32_bf16 v[160:163], v[64:67], a[212:215], v[160:163]
  buffer_load_dwordx2 v[112:113], v30, s[16:19], s40 offen offset:0 sc1
  v_mfma_f32_16x16x32_bf16 v[192:195], v[64:67], a[216:219], v[192:195]
  ds_read_b64_tr_b16 v[34:35], v8 offset:33280
  v_mfma_f32_16x16x32_bf16 v[224:227], v[64:67], a[220:223], v[224:227]
  ds_read_b64_tr_b16 v[36:37], v9 offset:32768
  v_mfma_f32_16x16x32_bf16 v[132:135], v[68:71], a[208:211], v[132:135]
  buffer_load_dwordx2 v[114:115], v30, s[16:19], s41 offen offset:0 sc1
  v_mfma_f32_16x16x32_bf16 v[164:167], v[68:71], a[212:215], v[164:167]
  ds_read_b64_tr_b16 v[38:39], v9 offset:33280
  v_mfma_f32_16x16x32_bf16 v[196:199], v[68:71], a[216:219], v[196:199]
  ds_read_b64_tr_b16 v[40:41], v10 offset:32768
  v_mfma_f32_16x16x32_bf16 v[228:231], v[68:71], a[220:223], v[228:231]
  buffer_load_dwordx2 v[116:117], v30, s[16:19], s40 offen offset:128 sc1
  v_mfma_f32_16x16x32_bf16 v[136:139], v[72:75], a[208:211], v[136:139]
  ds_read_b64_tr_b16 v[42:43], v10 offset:33280
  v_mfma_f32_16x16x32_bf16 v[168:171], v[72:75], a[212:215], v[168:171]
  ds_read_b64_tr_b16 v[44:45], v11 offset:32768
  v_mfma_f32_16x16x32_bf16 v[200:203], v[72:75], a[216:219], v[200:203]
  buffer_load_dwordx2 v[118:119], v30, s[16:19], s41 offen offset:128 sc1
  v_mfma_f32_16x16x32_bf16 v[232:235], v[72:75], a[220:223], v[232:235]
  ds_read_b64_tr_b16 v[46:47], v11 offset:33280
  v_mfma_f32_16x16x32_bf16 v[140:143], v[76:79], a[208:211], v[140:143]
  ds_read_b64_tr_b16 v[48:49], v8 offset:40960
  v_mfma_f32_16x16x32_bf16 v[172:175], v[76:79], a[212:215], v[172:175]
  buffer_load_dwordx2 v[120:121], v30, s[16:19], s40 offen offset:256 sc1
  v_mfma_f32_16x16x32_bf16 v[204:207], v[76:79], a[216:219], v[204:207]
  ds_read_b64_tr_b16 v[50:51], v8 offset:41472
  v_mfma_f32_16x16x32_bf16 v[236:239], v[76:79], a[220:223], v[236:239]
  ds_read_b64_tr_b16 v[52:53], v9 offset:40960
  v_mfma_f32_16x16x32_bf16 v[144:147], v[80:83], a[208:211], v[144:147]
  buffer_load_dwordx2 v[122:123], v30, s[16:19], s41 offen offset:256 sc1
  v_mfma_f32_16x16x32_bf16 v[176:179], v[80:83], a[212:215], v[176:179]
  ds_read_b64_tr_b16 v[54:55], v9 offset:41472
  v_mfma_f32_16x16x32_bf16 v[208:211], v[80:83], a[216:219], v[208:211]
  ds_read_b64_tr_b16 v[56:57], v10 offset:40960
  v_mfma_f32_16x16x32_bf16 v[240:243], v[80:83], a[220:223], v[240:243]
  buffer_load_dwordx2 v[124:125], v30, s[16:19], s40 offen offset:384 sc1
  v_mfma_f32_16x16x32_bf16 v[148:151], v[84:87], a[208:211], v[148:151]
  ds_read_b64_tr_b16 v[58:59], v10 offset:41472
  v_mfma_f32_16x16x32_bf16 v[180:183], v[84:87], a[212:215], v[180:183]
  ds_read_b64_tr_b16 v[60:61], v11 offset:40960
  v_mfma_f32_16x16x32_bf16 v[212:215], v[84:87], a[216:219], v[212:215]
  buffer_load_dwordx2 v[126:127], v30, s[16:19], s41 offen offset:384 sc1
  v_mfma_f32_16x16x32_bf16 v[244:247], v[84:87], a[220:223], v[244:247]
  ds_read_b64_tr_b16 v[62:63], v11 offset:41472
  v_mfma_f32_16x16x32_bf16 v[152:155], v[88:91], a[208:211], v[152:155]
  ds_read_b64_tr_b16 v[96:97], v28 offset:32768
  v_mfma_f32_16x16x32_bf16 v[184:187], v[88:91], a[212:215], v[184:187]
  ds_read_b64_tr_b16 v[98:99], v28 offset:33280
  v_mfma_f32_16x16x32_bf16 v[216:219], v[88:91], a[216:219], v[216:219]
  ds_read_b64_tr_b16 v[100:101], v29 offset:32768
  v_mfma_f32_16x16x32_bf16 v[248:251], v[88:91], a[220:223], v[248:251]
  ds_read_b64_tr_b16 v[102:103], v29 offset:33280
  v_mfma_f32_16x16x32_bf16 v[156:159], v[92:95], a[208:211], v[156:159]
  v_mfma_f32_16x16x32_bf16 v[188:191], v[92:95], a[212:215], v[188:191]
  v_mfma_f32_16x16x32_bf16 v[220:223], v[92:95], a[216:219], v[220:223]
  v_mfma_f32_16x16x32_bf16 v[252:255], v[92:95], a[220:223], v[252:255]
  v_mfma_f32_16x16x32_bf16 v[20:23], v[104:107], a[44:47], v[20:23]
  v_mfma_f32_16x16x32_bf16 v[24:27], v[108:111], a[44:47], v[24:27]
  s_waitcnt lgkmcnt(0)
  s_waitcnt vmcnt(20)
  v_mfma_f32_16x16x32_bf16 v[128:131], v[32:35], a[128:131], v[128:131]
  ds_read_b64_tr_b16 v[64:65], v8 offset:36864
  v_mfma_f32_16x16x32_bf16 v[160:163], v[32:35], a[132:135], v[160:163]
  ds_read_b64_tr_b16 v[66:67], v8 offset:37376
  v_mfma_f32_16x16x32_bf16 v[192:195], v[32:35], a[136:139], v[192:195]
  ds_read_b64_tr_b16 v[68:69], v9 offset:36864
  v_mfma_f32_16x16x32_bf16 v[224:227], v[32:35], a[140:143], v[224:227]
  ds_read_b64_tr_b16 v[70:71], v9 offset:37376
  v_mfma_f32_16x16x32_bf16 v[132:135], v[36:39], a[128:131], v[132:135]
  ds_read_b64_tr_b16 v[72:73], v10 offset:36864
  v_mfma_f32_16x16x32_bf16 v[164:167], v[36:39], a[132:135], v[164:167]
  ds_read_b64_tr_b16 v[74:75], v10 offset:37376
  v_mfma_f32_16x16x32_bf16 v[196:199], v[36:39], a[136:139], v[196:199]
  ds_read_b64_tr_b16 v[76:77], v11 offset:36864
  v_mfma_f32_16x16x32_bf16 v[228:231], v[36:39], a[140:143], v[228:231]
  ds_read_b64_tr_b16 v[78:79], v11 offset:37376
  v_mfma_f32_16x16x32_bf16 v[136:139], v[40:43], a[128:131], v[136:139]
  ds_read_b64_tr_b16 v[80:81], v8 offset:45056
  v_mfma_f32_16x16x32_bf16 v[168:171], v[40:43], a[132:135], v[168:171]
  ds_read_b64_tr_b16 v[82:83], v8 offset:45568
  v_mfma_f32_16x16x32_bf16 v[200:203], v[40:43], a[136:139], v[200:203]
  ds_read_b64_tr_b16 v[84:85], v9 offset:45056
  v_mfma_f32_16x16x32_bf16 v[232:235], v[40:43], a[140:143], v[232:235]
  ds_read_b64_tr_b16 v[86:87], v9 offset:45568
  v_mfma_f32_16x16x32_bf16 v[140:143], v[44:47], a[128:131], v[140:143]
  ds_read_b64_tr_b16 v[88:89], v10 offset:45056
  v_mfma_f32_16x16x32_bf16 v[172:175], v[44:47], a[132:135], v[172:175]
  ds_read_b64_tr_b16 v[90:91], v10 offset:45568
  v_mfma_f32_16x16x32_bf16 v[204:207], v[44:47], a[136:139], v[204:207]
  ds_read_b64_tr_b16 v[92:93], v11 offset:45056
  v_mfma_f32_16x16x32_bf16 v[236:239], v[44:47], a[140:143], v[236:239]
  ds_read_b64_tr_b16 v[94:95], v11 offset:45568
  v_mfma_f32_16x16x32_bf16 v[144:147], v[48:51], a[128:131], v[144:147]
  ds_read_b64_tr_b16 v[104:105], v28 offset:36864
  v_mfma_f32_16x16x32_bf16 v[176:179], v[48:51], a[132:135], v[176:179]
  ds_read_b64_tr_b16 v[106:107], v28 offset:37376
  v_mfma_f32_16x16x32_bf16 v[208:211], v[48:51], a[136:139], v[208:211]
  ds_read_b64_tr_b16 v[108:109], v29 offset:36864
  v_mfma_f32_16x16x32_bf16 v[240:243], v[48:51], a[140:143], v[240:243]
  ds_read_b64_tr_b16 v[110:111], v29 offset:37376
  v_mfma_f32_16x16x32_bf16 v[148:151], v[52:55], a[128:131], v[148:151]
  v_mfma_f32_16x16x32_bf16 v[180:183], v[52:55], a[132:135], v[180:183]
  v_mfma_f32_16x16x32_bf16 v[212:215], v[52:55], a[136:139], v[212:215]
  v_mfma_f32_16x16x32_bf16 v[244:247], v[52:55], a[140:143], v[244:247]
  v_mfma_f32_16x16x32_bf16 v[152:155], v[56:59], a[128:131], v[152:155]
  v_mfma_f32_16x16x32_bf16 v[184:187], v[56:59], a[132:135], v[184:187]
  v_mfma_f32_16x16x32_bf16 v[216:219], v[56:59], a[136:139], v[216:219]
  v_mfma_f32_16x16x32_bf16 v[248:251], v[56:59], a[140:143], v[248:251]
  v_mfma_f32_16x16x32_bf16 v[156:159], v[60:63], a[128:131], v[156:159]
  v_mfma_f32_16x16x32_bf16 v[188:191], v[60:63], a[132:135], v[188:191]
  v_mfma_f32_16x16x32_bf16 v[220:223], v[60:63], a[136:139], v[220:223]
  v_mfma_f32_16x16x32_bf16 v[252:255], v[60:63], a[140:143], v[252:255]
  v_mfma_f32_16x16x32_bf16 v[20:23], v[96:99], a[48:51], v[20:23]
  v_mfma_f32_16x16x32_bf16 v[24:27], v[100:103], a[48:51], v[24:27]
  s_waitcnt lgkmcnt(0)
  s_barrier
  s_waitcnt vmcnt(16)
  v_mfma_f32_16x16x32_bf16 v[128:131], v[64:67], a[144:147], v[128:131]
  ds_read_b64_tr_b16 v[32:33], v8 offset:49152
  v_mfma_f32_16x16x32_bf16 v[160:163], v[64:67], a[148:151], v[160:163]
  ds_read_b64_tr_b16 v[34:35], v8 offset:49664
  v_mfma_f32_16x16x32_bf16 v[192:195], v[64:67], a[152:155], v[192:195]
  ds_read_b64_tr_b16 v[36:37], v9 offset:49152
  v_mfma_f32_16x16x32_bf16 v[224:227], v[64:67], a[156:159], v[224:227]
  ds_read_b64_tr_b16 v[38:39], v9 offset:49664
  v_mfma_f32_16x16x32_bf16 v[132:135], v[68:71], a[144:147], v[132:135]
  ds_read_b64_tr_b16 v[40:41], v10 offset:49152
  v_mfma_f32_16x16x32_bf16 v[164:167], v[68:71], a[148:151], v[164:167]
  ds_read_b64_tr_b16 v[42:43], v10 offset:49664
  v_mfma_f32_16x16x32_bf16 v[196:199], v[68:71], a[152:155], v[196:199]
  ds_read_b64_tr_b16 v[44:45], v11 offset:49152
  v_mfma_f32_16x16x32_bf16 v[228:231], v[68:71], a[156:159], v[228:231]
  ds_read_b64_tr_b16 v[46:47], v11 offset:49664
  v_mfma_f32_16x16x32_bf16 v[136:139], v[72:75], a[144:147], v[136:139]
  ds_read_b64_tr_b16 v[48:49], v8 offset:57344
  v_mfma_f32_16x16x32_bf16 v[168:171], v[72:75], a[148:151], v[168:171]
  ds_read_b64_tr_b16 v[50:51], v8 offset:57856
  v_mfma_f32_16x16x32_bf16 v[200:203], v[72:75], a[152:155], v[200:203]
  ds_read_b64_tr_b16 v[52:53], v9 offset:57344
  v_mfma_f32_16x16x32_bf16 v[232:235], v[72:75], a[156:159], v[232:235]
  ds_read_b64_tr_b16 v[54:55], v9 offset:57856
  v_mfma_f32_16x16x32_bf16 v[140:143], v[76:79], a[144:147], v[140:143]
  ds_read_b64_tr_b16 v[56:57], v10 offset:57344
  v_mfma_f32_16x16x32_bf16 v[172:175], v[76:79], a[148:151], v[172:175]
  ds_read_b64_tr_b16 v[58:59], v10 offset:57856
  v_mfma_f32_16x16x32_bf16 v[204:207], v[76:79], a[152:155], v[204:207]
  ds_read_b64_tr_b16 v[60:61], v11 offset:57344
  v_mfma_f32_16x16x32_bf16 v[236:239], v[76:79], a[156:159], v[236:239]
  ds_read_b64_tr_b16 v[62:63], v11 offset:57856
  v_mfma_f32_16x16x32_bf16 v[144:147], v[80:83], a[144:147], v[144:147]
  ds_read_b64_tr_b16 v[96:97], v28 offset:49152
  v_mfma_f32_16x16x32_bf16 v[176:179], v[80:83], a[148:151], v[176:179]
  ds_read_b64_tr_b16 v[98:99], v28 offset:49664
  v_mfma_f32_16x16x32_bf16 v[208:211], v[80:83], a[152:155], v[208:211]
  ds_read_b64_tr_b16 v[100:101], v29 offset:49152
  v_mfma_f32_16x16x32_bf16 v[240:243], v[80:83], a[156:159], v[240:243]
  ds_read_b64_tr_b16 v[102:103], v29 offset:49664
  v_mfma_f32_16x16x32_bf16 v[148:151], v[84:87], a[144:147], v[148:151]
  v_mfma_f32_16x16x32_bf16 v[180:183], v[84:87], a[148:151], v[180:183]
  v_mfma_f32_16x16x32_bf16 v[212:215], v[84:87], a[152:155], v[212:215]
  v_mfma_f32_16x16x32_bf16 v[244:247], v[84:87], a[156:159], v[244:247]
  v_mfma_f32_16x16x32_bf16 v[152:155], v[88:91], a[144:147], v[152:155]
  v_mfma_f32_16x16x32_bf16 v[184:187], v[88:91], a[148:151], v[184:187]
  v_mfma_f32_16x16x32_bf16 v[216:219], v[88:91], a[152:155], v[216:219]
  v_mfma_f32_16x16x32_bf16 v[248:251], v[88:91], a[156:159], v[248:251]
  v_mfma_f32_16x16x32_bf16 v[156:159], v[92:95], a[144:147], v[156:159]
  v_mfma_f32_16x16x32_bf16 v[188:191], v[92:95], a[148:151], v[188:191]
  v_mfma_f32_16x16x32_bf16 v[220:223], v[92:95], a[152:155], v[220:223]
  v_mfma_f32_16x16x32_bf16 v[252:255], v[92:95], a[156:159], v[252:255]
  v_mfma_f32_16x16x32_bf16 v[20:23], v[104:107], a[52:55], v[20:23]
  v_mfma_f32_16x16x32_bf16 v[24:27], v[108:111], a[52:55], v[24:27]
  s_waitcnt lgkmcnt(0)
  s_waitcnt vmcnt(12)
  v_mfma_f32_16x16x32_bf16 v[128:131], v[32:35], a[160:163], v[128:131]
  ds_read_b64_tr_b16 v[64:65], v8 offset:53248
  v_mfma_f32_16x16x32_bf16 v[160:163], v[32:35], a[164:167], v[160:163]
  ds_read_b64_tr_b16 v[66:67], v8 offset:53760
  v_mfma_f32_16x16x32_bf16 v[192:195], v[32:35], a[168:171], v[192:195]
  ds_read_b64_tr_b16 v[68:69], v9 offset:53248
  v_mfma_f32_16x16x32_bf16 v[224:227], v[32:35], a[172:175], v[224:227]
  ds_read_b64_tr_b16 v[70:71], v9 offset:53760
  v_mfma_f32_16x16x32_bf16 v[132:135], v[36:39], a[160:163], v[132:135]
  ds_read_b64_tr_b16 v[72:73], v10 offset:53248
  v_mfma_f32_16x16x32_bf16 v[164:167], v[36:39], a[164:167], v[164:167]
  ds_read_b64_tr_b16 v[74:75], v10 offset:53760
  v_mfma_f32_16x16x32_bf16 v[196:199], v[36:39], a[168:171], v[196:199]
  ds_read_b64_tr_b16 v[76:77], v11 offset:53248
  v_mfma_f32_16x16x32_bf16 v[228:231], v[36:39], a[172:175], v[228:231]
  ds_read_b64_tr_b16 v[78:79], v11 offset:53760
  v_mfma_f32_16x16x32_bf16 v[136:139], v[40:43], a[160:163], v[136:139]
  ds_read_b64_tr_b16 v[80:81], v8 offset:61440
  v_mfma_f32_16x16x32_bf16 v[168:171], v[40:43], a[164:167], v[168:171]
  ds_read_b64_tr_b16 v[82:83], v8 offset:61952
  v_mfma_f32_16x16x32_bf16 v[200:203], v[40:43], a[168:171], v[200:203]
  ds_read_b64_tr_b16 v[84:85], v9 offset:61440
  v_mfma_f32_16x16x32_bf16 v[232:235], v[40:43], a[172:175], v[232:235]
  ds_read_b64_tr_b16 v[86:87], v9 offset:61952
  v_mfma_f32_16x16x32_bf16 v[140:143], v[44:47], a[160:163], v[140:143]
  ds_read_b64_tr_b16 v[88:89], v10 offset:61440
  v_mfma_f32_16x16x32_bf16 v[172:175], v[44:47], a[164:167], v[172:175]
  ds_read_b64_tr_b16 v[90:91], v10 offset:61952
  v_mfma_f32_16x16x32_bf16 v[204:207], v[44:47], a[168:171], v[204:207]
  ds_read_b64_tr_b16 v[92:93], v11 offset:61440
  v_mfma_f32_16x16x32_bf16 v[236:239], v[44:47], a[172:175], v[236:239]
  ds_read_b64_tr_b16 v[94:95], v11 offset:61952
  v_mfma_f32_16x16x32_bf16 v[144:147], v[48:51], a[160:163], v[144:147]
  ds_read_b64_tr_b16 v[104:105], v28 offset:53248
  v_mfma_f32_16x16x32_bf16 v[176:179], v[48:51], a[164:167], v[176:179]
  ds_read_b64_tr_b16 v[106:107], v28 offset:53760
  v_mfma_f32_16x16x32_bf16 v[208:211], v[48:51], a[168:171], v[208:211]
  ds_read_b64_tr_b16 v[108:109], v29 offset:53248
  v_mfma_f32_16x16x32_bf16 v[240:243], v[48:51], a[172:175], v[240:243]
  ds_read_b64_tr_b16 v[110:111], v29 offset:53760
  v_mfma_f32_16x16x32_bf16 v[148:151], v[52:55], a[160:163], v[148:151]
  v_mfma_f32_16x16x32_bf16 v[180:183], v[52:55], a[164:167], v[180:183]
  v_mfma_f32_16x16x32_bf16 v[212:215], v[52:55], a[168:171], v[212:215]
  v_mfma_f32_16x16x32_bf16 v[244:247], v[52:55], a[172:175], v[244:247]
  v_mfma_f32_16x16x32_bf16 v[152:155], v[56:59], a[160:163], v[152:155]
  v_mfma_f32_16x16x32_bf16 v[184:187], v[56:59], a[164:167], v[184:187]
  v_mfma_f32_16x16x32_bf16 v[216:219], v[56:59], a[168:171], v[216:219]
  v_mfma_f32_16x16x32_bf16 v[248:251], v[56:59], a[172:175], v[248:251]
  v_mfma_f32_16x16x32_bf16 v[156:159], v[60:63], a[160:163], v[156:159]
  v_mfma_f32_16x16x32_bf16 v[188:191], v[60:63], a[164:167], v[188:191]
  v_mfma_f32_16x16x32_bf16 v[220:223], v[60:63], a[168:171], v[220:223]
  v_mfma_f32_16x16x32_bf16 v[252:255], v[60:63], a[172:175], v[252:255]
  v_mfma_f32_16x16x32_bf16 v[20:23], v[96:99], a[56:59], v[20:23]
  v_mfma_f32_16x16x32_bf16 v[24:27], v[100:103], a[56:59], v[24:27]
  s_waitcnt lgkmcnt(0)
  s_waitcnt vmcnt(8)
  v_mfma_f32_16x16x32_bf16 v[128:131], v[64:67], a[176:179], v[128:131]
  v_mfma_f32_16x16x32_bf16 v[160:163], v[64:67], a[180:183], v[160:163]
  v_mfma_f32_16x16x32_bf16 v[192:195], v[64:67], a[184:187], v[192:195]
  v_mfma_f32_16x16x32_bf16 v[224:227], v[64:67], a[188:191], v[224:227]
  v_mfma_f32_16x16x32_bf16 v[132:135], v[68:71], a[176:179], v[132:135]
  v_mfma_f32_16x16x32_bf16 v[164:167], v[68:71], a[180:183], v[164:167]
  v_mfma_f32_16x16x32_bf16 v[196:199], v[68:71], a[184:187], v[196:199]
  v_mfma_f32_16x16x32_bf16 v[228:231], v[68:71], a[188:191], v[228:231]
  v_mfma_f32_16x16x32_bf16 v[136:139], v[72:75], a[176:179], v[136:139]
  v_mfma_f32_16x16x32_bf16 v[168:171], v[72:75], a[180:183], v[168:171]
  v_mfma_f32_16x16x32_bf16 v[200:203], v[72:75], a[184:187], v[200:203]
  v_mfma_f32_16x16x32_bf16 v[232:235], v[72:75], a[188:191], v[232:235]
  v_mfma_f32_16x16x32_bf16 v[140:143], v[76:79], a[176:179], v[140:143]
  v_mfma_f32_16x16x32_bf16 v[172:175], v[76:79], a[180:183], v[172:175]
  v_mfma_f32_16x16x32_bf16 v[204:207], v[76:79], a[184:187], v[204:207]
  v_mfma_f32_16x16x32_bf16 v[236:239], v[76:79], a[188:191], v[236:239]
  v_mfma_f32_16x16x32_bf16 v[144:147], v[80:83], a[176:179], v[144:147]
  v_mfma_f32_16x16x32_bf16 v[176:179], v[80:83], a[180:183], v[176:179]
  v_mfma_f32_16x16x32_bf16 v[208:211], v[80:83], a[184:187], v[208:211]
  v_mfma_f32_16x16x32_bf16 v[240:243], v[80:83], a[188:191], v[240:243]
  v_mfma_f32_16x16x32_bf16 v[148:151], v[84:87], a[176:179], v[148:151]
  v_mfma_f32_16x16x32_bf16 v[180:183], v[84:87], a[180:183], v[180:183]
  v_mfma_f32_16x16x32_bf16 v[212:215], v[84:87], a[184:187], v[212:215]
  v_mfma_f32_16x16x32_bf16 v[244:247], v[84:87], a[188:191], v[244:247]
  v_mfma_f32_16x16x32_bf16 v[152:155], v[88:91], a[176:179], v[152:155]
  v_mfma_f32_16x16x32_bf16 v[184:187], v[88:91], a[180:183], v[184:187]
  v_mfma_f32_16x16x32_bf16 v[216:219], v[88:91], a[184:187], v[216:219]
  v_mfma_f32_16x16x32_bf16 v[248:251], v[88:91], a[188:191], v[248:251]
  v_mfma_f32_16x16x32_bf16 v[156:159], v[92:95], a[176:179], v[156:159]
  v_mfma_f32_16x16x32_bf16 v[188:191], v[92:95], a[180:183], v[188:191]
  v_mfma_f32_16x16x32_bf16 v[220:223], v[92:95], a[184:187], v[220:223]
  v_mfma_f32_16x16x32_bf16 v[252:255], v[92:95], a[188:191], v[252:255]
  v_mfma_f32_16x16x32_bf16 v[20:23], v[104:107], a[60:63], v[20:23]
  v_mfma_f32_16x16x32_bf16 v[24:27], v[108:111], a[60:63], v[24:27]
  s_waitcnt lgkmcnt(0)
  v_and_b32 v12, 15, v2
  v_lshrrev_b32 v13, 4, v2
  s_nop 4
  v_lshlrev_b32 v15, 9, v12
  v_lshl_add_u32 v15, v13, 4, v15
  s_lshl_b32 s34, s3, 7
  s_add_u32 s34, s34, 131072
  v_add_u32 v15, s34, v15
  v_cmp_gt_u32 vcc, 2, v12
  s_and_saveexec_b64 s[40:41], vcc
  s_cbranch_execz L_u_74
  ds_write_b128 v15, v[20:23] offset:0
  ds_write_b128 v15, v[24:27] offset:64
L_u_74:
  s_mov_b64 exec, s[40:41]
  s_waitcnt lgkmcnt(0)
  s_barrier
  v_lshlrev_b32 v15, 4, v13
  v_add_u32 v15, 131072, v15
  ds_read_b128 v[48:51], v15 offset:0
  ds_read_b128 v[80:83], v15 offset:512
  ds_read_b128 v[52:55], v15 offset:64
  ds_read_b128 v[84:87], v15 offset:576
  ds_read_b128 v[56:59], v15 offset:128
  ds_read_b128 v[88:91], v15 offset:640
  ds_read_b128 v[60:63], v15 offset:192
  ds_read_b128 v[92:95], v15 offset:704
  ds_read_b128 v[64:67], v15 offset:256
  ds_read_b128 v[96:99], v15 offset:768
  ds_read_b128 v[68:71], v15 offset:320
  ds_read_b128 v[100:103], v15 offset:832
  ds_read_b128 v[72:75], v15 offset:384
  ds_read_b128 v[104:107], v15 offset:896
  ds_read_b128 v[76:79], v15 offset:448
  ds_read_b128 v[108:111], v15 offset:960
  s_waitcnt vmcnt(0)
  v_add_f32 v112, v112, v114
  v_add_f32 v113, v113, v115
  v_add_f32 v116, v116, v118
  v_add_f32 v117, v117, v119
  v_add_f32 v120, v120, v122
  v_add_f32 v121, v121, v123
  v_add_f32 v124, v124, v126
  v_add_f32 v125, v125, v127
  v_mov_b32 v40, v112
  v_mov_b32 v41, v113
  v_mov_b32 v42, v116
  v_mov_b32 v43, v117
  v_mov_b32 v44, v120
  v_mov_b32 v45, v121
  v_mov_b32 v46, v124
  v_mov_b32 v47, v125
  s_nop 0
  v_permlane16_swap_b32 v112, v40
  v_permlane16_swap_b32 v113, v41
  v_permlane16_swap_b32 v116, v42
  v_permlane16_swap_b32 v117, v43
  v_permlane16_swap_b32 v120, v44
  v_permlane16_swap_b32 v121, v45
  v_permlane16_swap_b32 v124, v46
  v_permlane16_swap_b32 v125, v47
  s_nop 0
  v_add_f32 v112, v112, v40
  v_add_f32 v113, v113, v41
  v_add_f32 v116, v116, v42
  v_add_f32 v117, v117, v43
  v_add_f32 v120, v120, v44
  v_add_f32 v121, v121, v45
  v_add_f32 v124, v124, v46
  v_add_f32 v125, v125, v47
  v_mov_b32 v40, v112
  v_mov_b32 v41, v113
  v_mov_b32 v42, v116
  v_mov_b32 v43, v117
  v_mov_b32 v44, v120
  v_mov_b32 v45, v121
  v_mov_b32 v46, v124
  v_mov_b32 v47, v125
  s_nop 0
  v_permlane32_swap_b32 v112, v40
  v_permlane32_swap_b32 v113, v41
  v_permlane32_swap_b32 v116, v42
  v_permlane32_swap_b32 v117, v43
  v_permlane32_swap_b32 v120, v44
  v_permlane32_swap_b32 v121, v45
  v_permlane32_swap_b32 v124, v46
  v_permlane32_swap_b32 v125, v47
  s_nop 0
  v_add_f32 v112, v112, v40
  v_add_f32 v113, v113, v41
  v_add_f32 v116, v116, v42
  v_add_f32 v117, v117, v43
  v_add_f32 v120, v120, v44
  v_add_f32 v121, v121, v45
  v_add_f32 v124, v124, v46
  v_add_f32 v125, v125, v47
  v_mul_f32 v112, 0x3b000000, v112
  v_mul_f32 v113, 0x3b000000, v113
  v_mul_f32 v116, 0x3b000000, v116
  v_mul_f32 v117, 0x3b000000, v117
  v_mul_f32 v120, 0x3b000000, v120
  v_mul_f32 v121, 0x3b000000, v121
  v_mul_f32 v124, 0x3b000000, v124
  v_mul_f32 v125, 0x3b000000, v125
  v_fma_f32 v113, -v112, v112, v113
  v_fma_f32 v117, -v116, v116, v117
  v_fma_f32 v121, -v120, v120, v121
  v_fma_f32 v125, -v124, v124, v125
  v_max_f32 v113, 0, v113
  v_max_f32 v117, 0, v117
  v_max_f32 v121, 0, v121
  v_max_f32 v125, 0, v125
  v_add_f32 v113, 0x3727c5ac, v113
  v_add_f32 v117, 0x3727c5ac, v117
  v_add_f32 v121, 0x3727c5ac, v121
  v_add_f32 v125, 0x3727c5ac, v125
  v_rsq_f32 v32, v113
  v_rsq_f32 v34, v117
  v_rsq_f32 v36, v121
  v_rsq_f32 v38, v125
  v_mul_f32 v33, v112, v32
  v_mul_f32 v35, v116, v34
  v_mul_f32 v37, v120, v36
  v_mul_f32 v39, v124, v38
  v_sub_f32 v33, 0, v33
  v_sub_f32 v35, 0, v35
  v_sub_f32 v37, 0, v37
  v_sub_f32 v39, 0, v39
  s_waitcnt lgkmcnt(0)
  s_mul_i32 s32, s24, 56
  s_lshl_b32 s33, s25, 1
  s_add_u32 s32, s32, s33
  s_lshl_b32 s32, s32, 12
  s_add_u32 s32, s32, 0x2000000
  s_mov_b32 s38, 0xbfb8aa3b
  s_mov_b32 s39, 0xbfb8aa3b
  s_mov_b32 s36, 1.0
  s_mov_b32 s37, 1.0
  v_pk_fma_f32 v[4:5], v[48:49], v[32:33], v[80:81] op_sel:[0,1,0] op_sel_hi:[1,1,1]
  v_pk_fma_f32 v[8:9], v[64:65], v[32:33], v[96:97] op_sel:[0,1,0] op_sel_hi:[1,1,1]
  v_pk_fma_f32 v[4:5], v[128:129], v[32:33], v[4:5] op_sel:[0,0,0] op_sel_hi:[1,0,1]
  v_pk_fma_f32 v[8:9], v[144:145], v[32:33], v[8:9] op_sel:[0,0,0] op_sel_hi:[1,0,1]
  v_pk_fma_f32 v[6:7], v[50:51], v[32:33], v[82:83] op_sel:[0,1,0] op_sel_hi:[1,1,1]
  v_pk_fma_f32 v[10:11], v[66:67], v[32:33], v[98:99] op_sel:[0,1,0] op_sel_hi:[1,1,1]
  v_pk_fma_f32 v[6:7], v[130:131], v[32:33], v[6:7] op_sel:[0,0,0] op_sel_hi:[1,0,1]
  v_pk_fma_f32 v[10:11], v[146:147], v[32:33], v[10:11] op_sel:[0,0,0] op_sel_hi:[1,0,1]
  v_pk_mul_f32 v[12:13], v[4:5], s[38:39]
  v_pk_mul_f32 v[14:15], v[6:7], s[38:39]
  v_exp_f32 v12, v12
  v_exp_f32 v13, v13
  v_exp_f32 v14, v14
  v_exp_f32 v15, v15
  v_pk_mul_f32 v[4:5], v[4:5], v[8:9]
  v_pk_mul_f32 v[6:7], v[6:7], v[10:11]
  v_pk_add_f32 v[12:13], v[12:13], s[36:37]
  v_pk_add_f32 v[14:15], v[14:15], s[36:37]
  v_rcp_f32 v12, v12
  v_rcp_f32 v13, v13
  v_rcp_f32 v14, v14
  v_rcp_f32 v15, v15
  s_nop 0
  v_pk_mul_f32 v[4:5], v[4:5], v[12:13]
  v_pk_mul_f32 v[6:7], v[6:7], v[14:15]
  v_cvt_pk_bf16_f32 v16, v4, v5
  v_cvt_pk_bf16_f32 v17, v6, v7
  v_pk_fma_f32 v[4:5], v[52:53], v[32:33], v[84:85] op_sel:[0,1,0] op_sel_hi:[1,1,1]
  v_pk_fma_f32 v[8:9], v[68:69], v[32:33], v[100:101] op_sel:[0,1,0] op_sel_hi:[1,1,1]
  v_pk_fma_f32 v[4:5], v[132:133], v[32:33], v[4:5] op_sel:[0,0,0] op_sel_hi:[1,0,1]
  v_pk_fma_f32 v[8:9], v[148:149], v[32:33], v[8:9] op_sel:[0,0,0] op_sel_hi:[1,0,1]
  v_pk_fma_f32 v[6:7], v[54:55], v[32:33], v[86:87] op_sel:[0,1,0] op_sel_hi:[1,1,1]
  v_pk_fma_f32 v[10:11], v[70:71], v[32:33], v[102:103] op_sel:[0,1,0] op_sel_hi:[1,1,1]
  v_pk_fma_f32 v[6:7], v[134:135], v[32:33], v[6:7] op_sel:[0,0,0] op_sel_hi:[1,0,1]
  v_pk_fma_f32 v[10:11], v[150:151], v[32:33], v[10:11] op_sel:[0,0,0] op_sel_hi:[1,0,1]
  v_pk_mul_f32 v[12:13], v[4:5], s[38:39]
  v_pk_mul_f32 v[14:15], v[6:7], s[38:39]
  v_exp_f32 v12, v12
  v_exp_f32 v13, v13
  v_exp_f32 v14, v14
  v_exp_f32 v15, v15
  v_pk_mul_f32 v[4:5], v[4:5], v[8:9]
  v_pk_mul_f32 v[6:7], v[6:7], v[10:11]
  v_pk_add_f32 v[12:13], v[12:13], s[36:37]
  v_pk_add_f32 v[14:15], v[14:15], s[36:37]
  v_rcp_f32 v12, v12
  v_rcp_f32 v13, v13
  v_rcp_f32 v14, v14
  v_rcp_f32 v15, v15
  s_nop 0
  v_pk_mul_f32 v[4:5], v[4:5], v[12:13]
  v_pk_mul_f32 v[6:7], v[6:7], v[14:15]
  v_cvt_pk_bf16_f32 v18, v4, v5
  v_cvt_pk_bf16_f32 v19, v6, v7
  buffer_store_dwordx4 v[16:19], v3, s[16:19], s32 offen offset:0 sc1
  s_add_u32 s32, s32, 4096
  v_pk_fma_f32 v[4:5], v[56:57], v[32:33], v[88:89] op_sel:[0,1,0] op_sel_hi:[1,1,1]
  v_pk_fma_f32 v[8:9], v[72:73], v[32:33], v[104:105] op_sel:[0,1,0] op_sel_hi:[1,1,1]
  v_pk_fma_f32 v[4:5], v[136:137], v[32:33], v[4:5] op_sel:[0,0,0] op_sel_hi:[1,0,1]
  v_pk_fma_f32 v[8:9], v[152:153], v[32:33], v[8:9] op_sel:[0,0,0] op_sel_hi:[1,0,1]
  v_pk_fma_f32 v[6:7], v[58:59], v[32:33], v[90:91] op_sel:[0,1,0] op_sel_hi:[1,1,1]
  v_pk_fma_f32 v[10:11], v[74:75], v[32:33], v[106:107] op_sel:[0,1,0] op_sel_hi:[1,1,1]
  v_pk_fma_f32 v[6:7], v[138:139], v[32:33], v[6:7] op_sel:[0,0,0] op_sel_hi:[1,0,1]
  v_pk_fma_f32 v[10:11], v[154:155], v[32:33], v[10:11] op_sel:[0,0,0] op_sel_hi:[1,0,1]
  v_pk_mul_f32 v[12:13], v[4:5], s[38:39]
  v_pk_mul_f32 v[14:15], v[6:7], s[38:39]
  v_exp_f32 v12, v12
  v_exp_f32 v13, v13
  v_exp_f32 v14, v14
  v_exp_f32 v15, v15
  v_pk_mul_f32 v[4:5], v[4:5], v[8:9]
  v_pk_mul_f32 v[6:7], v[6:7], v[10:11]
  v_pk_add_f32 v[12:13], v[12:13], s[36:37]
  v_pk_add_f32 v[14:15], v[14:15], s[36:37]
  v_rcp_f32 v12, v12
  v_rcp_f32 v13, v13
  v_rcp_f32 v14, v14
  v_rcp_f32 v15, v15
  s_nop 0
  v_pk_mul_f32 v[4:5], v[4:5], v[12:13]
  v_pk_mul_f32 v[6:7], v[6:7], v[14:15]
  v_cvt_pk_bf16_f32 v24, v4, v5
  v_cvt_pk_bf16_f32 v25, v6, v7
  v_pk_fma_f32 v[4:5], v[60:61], v[32:33], v[92:93] op_sel:[0,1,0] op_sel_hi:[1,1,1]
  v_pk_fma_f32 v[8:9], v[76:77], v[32:33], v[108:109] op_sel:[0,1,0] op_sel_hi:[1,1,1]
  v_pk_fma_f32 v[4:5], v[140:141], v[32:33], v[4:5] op_sel:[0,0,0] op_sel_hi:[1,0,1]
  v_pk_fma_f32 v[8:9], v[156:157], v[32:33], v[8:9] op_sel:[0,0,0] op_sel_hi:[1,0,1]
  v_pk_fma_f32 v[6:7], v[62:63], v[32:33], v[94:95] op_sel:[0,1,0] op_sel_hi:[1,1,1]
  v_pk_fma_f32 v[10:11], v[78:79], v[32:33], v[110:111] op_sel:[0,1,0] op_sel_hi:[1,1,1]
  v_pk_fma_f32 v[6:7], v[142:143], v[32:33], v[6:7] op_sel:[0,0,0] op_sel_hi:[1,0,1]
  v_pk_fma_f32 v[10:11], v[158:159], v[32:33], v[10:11] op_sel:[0,0,0] op_sel_hi:[1,0,1]
  v_pk_mul_f32 v[12:13], v[4:5], s[38:39]
  v_pk_mul_f32 v[14:15], v[6:7], s[38:39]
  v_exp_f32 v12, v12
  v_exp_f32 v13, v13
  v_exp_f32 v14, v14
  v_exp_f32 v15, v15
  v_pk_mul_f32 v[4:5], v[4:5], v[8:9]
  v_pk_mul_f32 v[6:7], v[6:7], v[10:11]
  v_pk_add_f32 v[12:13], v[12:13], s[36:37]
  v_pk_add_f32 v[14:15], v[14:15], s[36:37]
  v_rcp_f32 v12, v12
  v_rcp_f32 v13, v13
  v_rcp_f32 v14, v14
  v_rcp_f32 v15, v15
  s_nop 0
  v_pk_mul_f32 v[4:5], v[4:5], v[12:13]
  v_pk_mul_f32 v[6:7], v[6:7], v[14:15]
  v_cvt_pk_bf16_f32 v26, v4, v5
  v_cvt_pk_bf16_f32 v27, v6, v7
  buffer_store_dwordx4 v[24:27], v3, s[16:19], s32 offen offset:0 sc1
  s_sub_u32 s32, s32, 4096
  v_pk_fma_f32 v[4:5], v[48:49], v[34:35], v[80:81] op_sel:[0,1,0] op_sel_hi:[1,1,1]
  v_pk_fma_f32 v[8:9], v[64:65], v[34:35], v[96:97] op_sel:[0,1,0] op_sel_hi:[1,1,1]
  v_pk_fma_f32 v[4:5], v[160:161], v[34:35], v[4:5] op_sel:[0,0,0] op_sel_hi:[1,0,1]
  v_pk_fma_f32 v[8:9], v[176:177], v[34:35], v[8:9] op_sel:[0,0,0] op_sel_hi:[1,0,1]
  v_pk_fma_f32 v[6:7], v[50:51], v[34:35], v[82:83] op_sel:[0,1,0] op_sel_hi:[1,1,1]
  v_pk_fma_f32 v[10:11], v[66:67], v[34:35], v[98:99] op_sel:[0,1,0] op_sel_hi:[1,1,1]
  v_pk_fma_f32 v[6:7], v[162:163], v[34:35], v[6:7] op_sel:[0,0,0] op_sel_hi:[1,0,1]
  v_pk_fma_f32 v[10:11], v[178:179], v[34:35], v[10:11] op_sel:[0,0,0] op_sel_hi:[1,0,1]
  v_pk_mul_f32 v[12:13], v[4:5], s[38:39]
  v_pk_mul_f32 v[14:15], v[6:7], s[38:39]
  v_exp_f32 v12, v12
  v_exp_f32 v13, v13
  v_exp_f32 v14, v14
  v_exp_f32 v15, v15
  v_pk_mul_f32 v[4:5], v[4:5], v[8:9]
  v_pk_mul_f32 v[6:7], v[6:7], v[10:11]
  v_pk_add_f32 v[12:13], v[12:13], s[36:37]
  v_pk_add_f32 v[14:15], v[14:15], s[36:37]
  v_rcp_f32 v12, v12
  v_rcp_f32 v13, v13
  v_rcp_f32 v14, v14
  v_rcp_f32 v15, v15
  s_nop 0
  v_pk_mul_f32 v[4:5], v[4:5], v[12:13]
  v_pk_mul_f32 v[6:7], v[6:7], v[14:15]
  v_cvt_pk_bf16_f32 v16, v4, v5
  v_cvt_pk_bf16_f32 v17, v6, v7
  v_pk_fma_f32 v[4:5], v[52:53], v[34:35], v[84:85] op_sel:[0,1,0] op_sel_hi:[1,1,1]
  v_pk_fma_f32 v[8:9], v[68:69], v[34:35], v[100:101] op_sel:[0,1,0] op_sel_hi:[1,1,1]
  v_pk_fma_f32 v[4:5], v[164:165], v[34:35], v[4:5] op_sel:[0,0,0] op_sel_hi:[1,0,1]
  v_pk_fma_f32 v[8:9], v[180:181], v[34:35], v[8:9] op_sel:[0,0,0] op_sel_hi:[1,0,1]
  v_pk_fma_f32 v[6:7], v[54:55], v[34:35], v[86:87] op_sel:[0,1,0] op_sel_hi:[1,1,1]
  v_pk_fma_f32 v[10:11], v[70:71], v[34:35], v[102:103] op_sel:[0,1,0] op_sel_hi:[1,1,1]
  v_pk_fma_f32 v[6:7], v[166:167], v[34:35], v[6:7] op_sel:[0,0,0] op_sel_hi:[1,0,1]
  v_pk_fma_f32 v[10:11], v[182:183], v[34:35], v[10:11] op_sel:[0,0,0] op_sel_hi:[1,0,1]
  v_pk_mul_f32 v[12:13], v[4:5], s[38:39]
  v_pk_mul_f32 v[14:15], v[6:7], s[38:39]
  v_exp_f32 v12, v12
  v_exp_f32 v13, v13
  v_exp_f32 v14, v14
  v_exp_f32 v15, v15
  v_pk_mul_f32 v[4:5], v[4:5], v[8:9]
  v_pk_mul_f32 v[6:7], v[6:7], v[10:11]
  v_pk_add_f32 v[12:13], v[12:13], s[36:37]
  v_pk_add_f32 v[14:15], v[14:15], s[36:37]
  v_rcp_f32 v12, v12
  v_rcp_f32 v13, v13
  v_rcp_f32 v14, v14
  v_rcp_f32 v15, v15
  s_nop 0
  v_pk_mul_f32 v[4:5], v[4:5], v[12:13]
  v_pk_mul_f32 v[6:7], v[6:7], v[14:15]
  v_cvt_pk_bf16_f32 v18, v4, v5
  v_cvt_pk_bf16_f32 v19, v6, v7
  buffer_store_dwordx4 v[16:19], v3, s[16:19], s32 offen offset:1024 sc1
  s_add_u32 s32, s32, 4096
  v_pk_fma_f32 v[4:5], v[56:57], v[34:35], v[88:89] op_sel:[0,1,0] op_sel_hi:[1,1,1]
  v_pk_fma_f32 v[8:9], v[72:73], v[34:35], v[104:105] op_sel:[0,1,0] op_sel_hi:[1,1,1]
  v_pk_fma_f32 v[4:5], v[168:169], v[34:35], v[4:5] op_sel:[0,0,0] op_sel_hi:[1,0,1]
  v_pk_fma_f32 v[8:9], v[184:185], v[34:35], v[8:9] op_sel:[0,0,0] op_sel_hi:[1,0,1]
  v_pk_fma_f32 v[6:7], v[58:59], v[34:35], v[90:91] op_sel:[0,1,0] op_sel_hi:[1,1,1]
  v_pk_fma_f32 v[10:11], v[74:75], v[34:35], v[106:107] op_sel:[0,1,0] op_sel_hi:[1,1,1]
  v_pk_fma_f32 v[6:7], v[170:171], v[34:35], v[6:7] op_sel:[0,0,0] op_sel_hi:[1,0,1]
  v_pk_fma_f32 v[10:11], v[186:187], v[34:35], v[10:11] op_sel:[0,0,0] op_sel_hi:[1,0,1]
  v_pk_mul_f32 v[12:13], v[4:5], s[38:39]
  v_pk_mul_f32 v[14:15], v[6:7], s[38:39]
  v_exp_f32 v12, v12
  v_exp_f32 v13, v13
  v_exp_f32 v14, v14
  v_exp_f32 v15, v15
  v_pk_mul_f32 v[4:5], v[4:5], v[8:9]
  v_pk_mul_f32 v[6:7], v[6:7], v[10:11]
  v_pk_add_f32 v[12:13], v[12:13], s[36:37]
  v_pk_add_f32 v[14:15], v[14:15], s[36:37]
  v_rcp_f32 v12, v12
  v_rcp_f32 v13, v13
  v_rcp_f32 v14, v14
  v_rcp_f32 v15, v15
  s_nop 0
  v_pk_mul_f32 v[4:5], v[4:5], v[12:13]
  v_pk_mul_f32 v[6:7], v[6:7], v[14:15]
  v_cvt_pk_bf16_f32 v24, v4, v5
  v_cvt_pk_bf16_f32 v25, v6, v7
  v_pk_fma_f32 v[4:5], v[60:61], v[34:35], v[92:93] op_sel:[0,1,0] op_sel_hi:[1,1,1]
  v_pk_fma_f32 v[8:9], v[76:77], v[34:35], v[108:109] op_sel:[0,1,0] op_sel_hi:[1,1,1]
  v_pk_fma_f32 v[4:5], v[172:173], v[34:35], v[4:5] op_sel:[0,0,0] op_sel_hi:[1,0,1]
  v_pk_fma_f32 v[8:9], v[188:189], v[34:35], v[8:9] op_sel:[0,0,0] op_sel_hi:[1,0,1]
  v_pk_fma_f32 v[6:7], v[62:63], v[34:35], v[94:95] op_sel:[0,1,0] op_sel_hi:[1,1,1]
  v_pk_fma_f32 v[10:11], v[78:79], v[34:35], v[110:111] op_sel:[0,1,0] op_sel_hi:[1,1,1]
  v_pk_fma_f32 v[6:7], v[174:175], v[34:35], v[6:7] op_sel:[0,0,0] op_sel_hi:[1,0,1]
  v_pk_fma_f32 v[10:11], v[190:191], v[34:35], v[10:11] op_sel:[0,0,0] op_sel_hi:[1,0,1]
  v_pk_mul_f32 v[12:13], v[4:5], s[38:39]
  v_pk_mul_f32 v[14:15], v[6:7], s[38:39]
  v_exp_f32 v12, v12
  v_exp_f32 v13, v13
  v_exp_f32 v14, v14
  v_exp_f32 v15, v15
  v_pk_mul_f32 v[4:5], v[4:5], v[8:9]
  v_pk_mul_f32 v[6:7], v[6:7], v[10:11]
  v_pk_add_f32 v[12:13], v[12:13], s[36:37]
  v_pk_add_f32 v[14:15], v[14:15], s[36:37]
  v_rcp_f32 v12, v12
  v_rcp_f32 v13, v13
  v_rcp_f32 v14, v14
  v_rcp_f32 v15, v15
  s_nop 0
  v_pk_mul_f32 v[4:5], v[4:5], v[12:13]
  v_pk_mul_f32 v[6:7], v[6:7], v[14:15]
  v_cvt_pk_bf16_f32 v26, v4, v5
  v_cvt_pk_bf16_f32 v27, v6, v7
  buffer_store_dwordx4 v[24:27], v3, s[16:19], s32 offen offset:1024 sc1
  s_sub_u32 s32, s32, 4096
  v_pk_fma_f32 v[4:5], v[48:49], v[36:37], v[80:81] op_sel:[0,1,0] op_sel_hi:[1,1,1]
  v_pk_fma_f32 v[8:9], v[64:65], v[36:37], v[96:97] op_sel:[0,1,0] op_sel_hi:[1,1,1]
  v_pk_fma_f32 v[4:5], v[192:193], v[36:37], v[4:5] op_sel:[0,0,0] op_sel_hi:[1,0,1]
  v_pk_fma_f32 v[8:9], v[208:209], v[36:37], v[8:9] op_sel:[0,0,0] op_sel_hi:[1,0,1]
  v_pk_fma_f32 v[6:7], v[50:51], v[36:37], v[82:83] op_sel:[0,1,0] op_sel_hi:[1,1,1]
  v_pk_fma_f32 v[10:11], v[66:67], v[36:37], v[98:99] op_sel:[0,1,0] op_sel_hi:[1,1,1]
  v_pk_fma_f32 v[6:7], v[194:195], v[36:37], v[6:7] op_sel:[0,0,0] op_sel_hi:[1,0,1]
  v_pk_fma_f32 v[10:11], v[210:211], v[36:37], v[10:11] op_sel:[0,0,0] op_sel_hi:[1,0,1]
  v_pk_mul_f32 v[12:13], v[4:5], s[38:39]
  v_pk_mul_f32 v[14:15], v[6:7], s[38:39]
  v_exp_f32 v12, v12
  v_exp_f32 v13, v13
  v_exp_f32 v14, v14
  v_exp_f32 v15, v15
  v_pk_mul_f32 v[4:5], v[4:5], v[8:9]
  v_pk_mul_f32 v[6:7], v[6:7], v[10:11]
  v_pk_add_f32 v[12:13], v[12:13], s[36:37]
  v_pk_add_f32 v[14:15], v[14:15], s[36:37]
  v_rcp_f32 v12, v12
  v_rcp_f32 v13, v13
  v_rcp_f32 v14, v14
  v_rcp_f32 v15, v15
  s_nop 0
  v_pk_mul_f32 v[4:5], v[4:5], v[12:13]
  v_pk_mul_f32 v[6:7], v[6:7], v[14:15]
  v_cvt_pk_bf16_f32 v16, v4, v5
  v_cvt_pk_bf16_f32 v17, v6, v7
  v_pk_fma_f32 v[4:5], v[52:53], v[36:37], v[84:85] op_sel:[0,1,0] op_sel_hi:[1,1,1]
  v_pk_fma_f32 v[8:9], v[68:69], v[36:37], v[100:101] op_sel:[0,1,0] op_sel_hi:[1,1,1]
  v_pk_fma_f32 v[4:5], v[196:197], v[36:37], v[4:5] op_sel:[0,0,0] op_sel_hi:[1,0,1]
  v_pk_fma_f32 v[8:9], v[212:213], v[36:37], v[8:9] op_sel:[0,0,0] op_sel_hi:[1,0,1]
  v_pk_fma_f32 v[6:7], v[54:55], v[36:37], v[86:87] op_sel:[0,1,0] op_sel_hi:[1,1,1]
  v_pk_fma_f32 v[10:11], v[70:71], v[36:37], v[102:103] op_sel:[0,1,0] op_sel_hi:[1,1,1]
  v_pk_fma_f32 v[6:7], v[198:199], v[36:37], v[6:7] op_sel:[0,0,0] op_sel_hi:[1,0,1]
  v_pk_fma_f32 v[10:11], v[214:215], v[36:37], v[10:11] op_sel:[0,0,0] op_sel_hi:[1,0,1]
  v_pk_mul_f32 v[12:13], v[4:5], s[38:39]
  v_pk_mul_f32 v[14:15], v[6:7], s[38:39]
  v_exp_f32 v12, v12
  v_exp_f32 v13, v13
  v_exp_f32 v14, v14
  v_exp_f32 v15, v15
  v_pk_mul_f32 v[4:5], v[4:5], v[8:9]
  v_pk_mul_f32 v[6:7], v[6:7], v[10:11]
  v_pk_add_f32 v[12:13], v[12:13], s[36:37]
  v_pk_add_f32 v[14:15], v[14:15], s[36:37]
  v_rcp_f32 v12, v12
  v_rcp_f32 v13, v13
  v_rcp_f32 v14, v14
  v_rcp_f32 v15, v15
  s_nop 0
  v_pk_mul_f32 v[4:5], v[4:5], v[12:13]
  v_pk_mul_f32 v[6:7], v[6:7], v[14:15]
  v_cvt_pk_bf16_f32 v18, v4, v5
  v_cvt_pk_bf16_f32 v19, v6, v7
  buffer_store_dwordx4 v[16:19], v3, s[16:19], s32 offen offset:2048 sc1
  s_add_u32 s32, s32, 4096
  v_pk_fma_f32 v[4:5], v[56:57], v[36:37], v[88:89] op_sel:[0,1,0] op_sel_hi:[1,1,1]
  v_pk_fma_f32 v[8:9], v[72:73], v[36:37], v[104:105] op_sel:[0,1,0] op_sel_hi:[1,1,1]
  v_pk_fma_f32 v[4:5], v[200:201], v[36:37], v[4:5] op_sel:[0,0,0] op_sel_hi:[1,0,1]
  v_pk_fma_f32 v[8:9], v[216:217], v[36:37], v[8:9] op_sel:[0,0,0] op_sel_hi:[1,0,1]
  v_pk_fma_f32 v[6:7], v[58:59], v[36:37], v[90:91] op_sel:[0,1,0] op_sel_hi:[1,1,1]
  v_pk_fma_f32 v[10:11], v[74:75], v[36:37], v[106:107] op_sel:[0,1,0] op_sel_hi:[1,1,1]
  v_pk_fma_f32 v[6:7], v[202:203], v[36:37], v[6:7] op_sel:[0,0,0] op_sel_hi:[1,0,1]
  v_pk_fma_f32 v[10:11], v[218:219], v[36:37], v[10:11] op_sel:[0,0,0] op_sel_hi:[1,0,1]
  v_pk_mul_f32 v[12:13], v[4:5], s[38:39]
  v_pk_mul_f32 v[14:15], v[6:7], s[38:39]
  v_exp_f32 v12, v12
  v_exp_f32 v13, v13
  v_exp_f32 v14, v14
  v_exp_f32 v15, v15
  v_pk_mul_f32 v[4:5], v[4:5], v[8:9]
  v_pk_mul_f32 v[6:7], v[6:7], v[10:11]
  v_pk_add_f32 v[12:13], v[12:13], s[36:37]
  v_pk_add_f32 v[14:15], v[14:15], s[36:37]
  v_rcp_f32 v12, v12
  v_rcp_f32 v13, v13
  v_rcp_f32 v14, v14
  v_rcp_f32 v15, v15
  s_nop 0
  v_pk_mul_f32 v[4:5], v[4:5], v[12:13]
  v_pk_mul_f32 v[6:7], v[6:7], v[14:15]
  v_cvt_pk_bf16_f32 v24, v4, v5
  v_cvt_pk_bf16_f32 v25, v6, v7
  v_pk_fma_f32 v[4:5], v[60:61], v[36:37], v[92:93] op_sel:[0,1,0] op_sel_hi:[1,1,1]
  v_pk_fma_f32 v[8:9], v[76:77], v[36:37], v[108:109] op_sel:[0,1,0] op_sel_hi:[1,1,1]
  v_pk_fma_f32 v[4:5], v[204:205], v[36:37], v[4:5] op_sel:[0,0,0] op_sel_hi:[1,0,1]
  v_pk_fma_f32 v[8:9], v[220:221], v[36:37], v[8:9] op_sel:[0,0,0] op_sel_hi:[1,0,1]
  v_pk_fma_f32 v[6:7], v[62:63], v[36:37], v[94:95] op_sel:[0,1,0] op_sel_hi:[1,1,1]
  v_pk_fma_f32 v[10:11], v[78:79], v[36:37], v[110:111] op_sel:[0,1,0] op_sel_hi:[1,1,1]
  v_pk_fma_f32 v[6:7], v[206:207], v[36:37], v[6:7] op_sel:[0,0,0] op_sel_hi:[1,0,1]
  v_pk_fma_f32 v[10:11], v[222:223], v[36:37], v[10:11] op_sel:[0,0,0] op_sel_hi:[1,0,1]
  v_pk_mul_f32 v[12:13], v[4:5], s[38:39]
  v_pk_mul_f32 v[14:15], v[6:7], s[38:39]
  v_exp_f32 v12, v12
  v_exp_f32 v13, v13
  v_exp_f32 v14, v14
  v_exp_f32 v15, v15
  v_pk_mul_f32 v[4:5], v[4:5], v[8:9]
  v_pk_mul_f32 v[6:7], v[6:7], v[10:11]
  v_pk_add_f32 v[12:13], v[12:13], s[36:37]
  v_pk_add_f32 v[14:15], v[14:15], s[36:37]
  v_rcp_f32 v12, v12
  v_rcp_f32 v13, v13
  v_rcp_f32 v14, v14
  v_rcp_f32 v15, v15
  s_nop 0
  v_pk_mul_f32 v[4:5], v[4:5], v[12:13]
  v_pk_mul_f32 v[6:7], v[6:7], v[14:15]
  v_cvt_pk_bf16_f32 v26, v4, v5
  v_cvt_pk_bf16_f32 v27, v6, v7
  buffer_store_dwordx4 v[24:27], v3, s[16:19], s32 offen offset:2048 sc1
  s_sub_u32 s32, s32, 4096
  v_pk_fma_f32 v[4:5], v[48:49], v[38:39], v[80:81] op_sel:[0,1,0] op_sel_hi:[1,1,1]
  v_pk_fma_f32 v[8:9], v[64:65], v[38:39], v[96:97] op_sel:[0,1,0] op_sel_hi:[1,1,1]
  v_pk_fma_f32 v[4:5], v[224:225], v[38:39], v[4:5] op_sel:[0,0,0] op_sel_hi:[1,0,1]
  v_pk_fma_f32 v[8:9], v[240:241], v[38:39], v[8:9] op_sel:[0,0,0] op_sel_hi:[1,0,1]
  v_pk_fma_f32 v[6:7], v[50:51], v[38:39], v[82:83] op_sel:[0,1,0] op_sel_hi:[1,1,1]
  v_pk_fma_f32 v[10:11], v[66:67], v[38:39], v[98:99] op_sel:[0,1,0] op_sel_hi:[1,1,1]
  v_pk_fma_f32 v[6:7], v[226:227], v[38:39], v[6:7] op_sel:[0,0,0] op_sel_hi:[1,0,1]
  v_pk_fma_f32 v[10:11], v[242:243], v[38:39], v[10:11] op_sel:[0,0,0] op_sel_hi:[1,0,1]
  v_pk_mul_f32 v[12:13], v[4:5], s[38:39]
  v_pk_mul_f32 v[14:15], v[6:7], s[38:39]
  v_exp_f32 v12, v12
  v_exp_f32 v13, v13
  v_exp_f32 v14, v14
  v_exp_f32 v15, v15
  v_pk_mul_f32 v[4:5], v[4:5], v[8:9]
  v_pk_mul_f32 v[6:7], v[6:7], v[10:11]
  v_pk_add_f32 v[12:13], v[12:13], s[36:37]
  v_pk_add_f32 v[14:15], v[14:15], s[36:37]
  v_rcp_f32 v12, v12
  v_rcp_f32 v13, v13
  v_rcp_f32 v14, v14
  v_rcp_f32 v15, v15
  s_nop 0
  v_pk_mul_f32 v[4:5], v[4:5], v[12:13]
  v_pk_mul_f32 v[6:7], v[6:7], v[14:15]
  v_cvt_pk_bf16_f32 v16, v4, v5
  v_cvt_pk_bf16_f32 v17, v6, v7
  v_pk_fma_f32 v[4:5], v[52:53], v[38:39], v[84:85] op_sel:[0,1,0] op_sel_hi:[1,1,1]
  v_pk_fma_f32 v[8:9], v[68:69], v[38:39], v[100:101] op_sel:[0,1,0] op_sel_hi:[1,1,1]
  v_pk_fma_f32 v[4:5], v[228:229], v[38:39], v[4:5] op_sel:[0,0,0] op_sel_hi:[1,0,1]
  v_pk_fma_f32 v[8:9], v[244:245], v[38:39], v[8:9] op_sel:[0,0,0] op_sel_hi:[1,0,1]
  v_pk_fma_f32 v[6:7], v[54:55], v[38:39], v[86:87] op_sel:[0,1,0] op_sel_hi:[1,1,1]
  v_pk_fma_f32 v[10:11], v[70:71], v[38:39], v[102:103] op_sel:[0,1,0] op_sel_hi:[1,1,1]
  v_pk_fma_f32 v[6:7], v[230:231], v[38:39], v[6:7] op_sel:[0,0,0] op_sel_hi:[1,0,1]
  v_pk_fma_f32 v[10:11], v[246:247], v[38:39], v[10:11] op_sel:[0,0,0] op_sel_hi:[1,0,1]
  v_pk_mul_f32 v[12:13], v[4:5], s[38:39]
  v_pk_mul_f32 v[14:15], v[6:7], s[38:39]
  v_exp_f32 v12, v12
  v_exp_f32 v13, v13
  v_exp_f32 v14, v14
  v_exp_f32 v15, v15
  v_pk_mul_f32 v[4:5], v[4:5], v[8:9]
  v_pk_mul_f32 v[6:7], v[6:7], v[10:11]
  v_pk_add_f32 v[12:13], v[12:13], s[36:37]
  v_pk_add_f32 v[14:15], v[14:15], s[36:37]
  v_rcp_f32 v12, v12
  v_rcp_f32 v13, v13
  v_rcp_f32 v14, v14
  v_rcp_f32 v15, v15
  s_nop 0
  v_pk_mul_f32 v[4:5], v[4:5], v[12:13]
  v_pk_mul_f32 v[6:7], v[6:7], v[14:15]
  v_cvt_pk_bf16_f32 v18, v4, v5
  v_cvt_pk_bf16_f32 v19, v6, v7
  buffer_store_dwordx4 v[16:19], v3, s[16:19], s32 offen offset:3072 sc1
  s_add_u32 s32, s32, 4096
  v_pk_fma_f32 v[4:5], v[56:57], v[38:39], v[88:89] op_sel:[0,1,0] op_sel_hi:[1,1,1]
  v_pk_fma_f32 v[8:9], v[72:73], v[38:39], v[104:105] op_sel:[0,1,0] op_sel_hi:[1,1,1]
  v_pk_fma_f32 v[4:5], v[232:233], v[38:39], v[4:5] op_sel:[0,0,0] op_sel_hi:[1,0,1]
  v_pk_fma_f32 v[8:9], v[248:249], v[38:39], v[8:9] op_sel:[0,0,0] op_sel_hi:[1,0,1]
  v_pk_fma_f32 v[6:7], v[58:59], v[38:39], v[90:91] op_sel:[0,1,0] op_sel_hi:[1,1,1]
  v_pk_fma_f32 v[10:11], v[74:75], v[38:39], v[106:107] op_sel:[0,1,0] op_sel_hi:[1,1,1]
  v_pk_fma_f32 v[6:7], v[234:235], v[38:39], v[6:7] op_sel:[0,0,0] op_sel_hi:[1,0,1]
  v_pk_fma_f32 v[10:11], v[250:251], v[38:39], v[10:11] op_sel:[0,0,0] op_sel_hi:[1,0,1]
  v_pk_mul_f32 v[12:13], v[4:5], s[38:39]
  v_pk_mul_f32 v[14:15], v[6:7], s[38:39]
  v_exp_f32 v12, v12
  v_exp_f32 v13, v13
  v_exp_f32 v14, v14
  v_exp_f32 v15, v15
  v_pk_mul_f32 v[4:5], v[4:5], v[8:9]
  v_pk_mul_f32 v[6:7], v[6:7], v[10:11]
  v_pk_add_f32 v[12:13], v[12:13], s[36:37]
  v_pk_add_f32 v[14:15], v[14:15], s[36:37]
  v_rcp_f32 v12, v12
  v_rcp_f32 v13, v13
  v_rcp_f32 v14, v14
  v_rcp_f32 v15, v15
  s_nop 0
  v_pk_mul_f32 v[4:5], v[4:5], v[12:13]
  v_pk_mul_f32 v[6:7], v[6:7], v[14:15]
  v_cvt_pk_bf16_f32 v24, v4, v5
  v_cvt_pk_bf16_f32 v25, v6, v7
  v_pk_fma_f32 v[4:5], v[60:61], v[38:39], v[92:93] op_sel:[0,1,0] op_sel_hi:[1,1,1]
  v_pk_fma_f32 v[8:9], v[76:77], v[38:39], v[108:109] op_sel:[0,1,0] op_sel_hi:[1,1,1]
  v_pk_fma_f32 v[4:5], v[236:237], v[38:39], v[4:5] op_sel:[0,0,0] op_sel_hi:[1,0,1]
  v_pk_fma_f32 v[8:9], v[252:253], v[38:39], v[8:9] op_sel:[0,0,0] op_sel_hi:[1,0,1]
  v_pk_fma_f32 v[6:7], v[62:63], v[38:39], v[94:95] op_sel:[0,1,0] op_sel_hi:[1,1,1]
  v_pk_fma_f32 v[10:11], v[78:79], v[38:39], v[110:111] op_sel:[0,1,0] op_sel_hi:[1,1,1]
  v_pk_fma_f32 v[6:7], v[238:239], v[38:39], v[6:7] op_sel:[0,0,0] op_sel_hi:[1,0,1]
  v_pk_fma_f32 v[10:11], v[254:255], v[38:39], v[10:11] op_sel:[0,0,0] op_sel_hi:[1,0,1]
  v_pk_mul_f32 v[12:13], v[4:5], s[38:39]
  v_pk_mul_f32 v[14:15], v[6:7], s[38:39]
  v_exp_f32 v12, v12
  v_exp_f32 v13, v13
  v_exp_f32 v14, v14
  v_exp_f32 v15, v15
  v_pk_mul_f32 v[4:5], v[4:5], v[8:9]
  v_pk_mul_f32 v[6:7], v[6:7], v[10:11]
  v_pk_add_f32 v[12:13], v[12:13], s[36:37]
  v_pk_add_f32 v[14:15], v[14:15], s[36:37]
  v_rcp_f32 v12, v12
  v_rcp_f32 v13, v13
  v_rcp_f32 v14, v14
  v_rcp_f32 v15, v15
  s_nop 0
  v_pk_mul_f32 v[4:5], v[4:5], v[12:13]
  v_pk_mul_f32 v[6:7], v[6:7], v[14:15]
  v_cvt_pk_bf16_f32 v26, v4, v5
  v_cvt_pk_bf16_f32 v27, v6, v7
  buffer_store_dwordx4 v[24:27], v3, s[16:19], s32 offen offset:3072 sc1
  s_sub_u32 s32, s32, 4096
  v_mov_b32 v28, 1
  v_mov_b32 v30, 0
  v_mov_b32 v29, 0x4000000
  v_cmp_eq_u32 vcc, 0, v2
  s_nop 1
  v_cndmask_b32 v29, v29, v30, vcc
  s_add_u32 s78, s78, 2048
  s_waitcnt vmcnt(0)
  s_barrier
  s_cmp_lg_u32 s3, 0
  s_cbranch_scc1 L_sg_75
  buffer_atomic_add v28, v29, s[16:19], s78 offen sc1
L_sg_75:
L_nog_70:
  v_accvgpr_read_b32 v200, a64
  v_accvgpr_read_b32 v201, a65
  v_accvgpr_read_b32 v202, a66
  v_accvgpr_read_b32 v203, a67
  v_accvgpr_read_b32 v204, a68
  v_accvgpr_read_b32 v205, a69
  v_accvgpr_read_b32 v206, a70
  v_accvgpr_read_b32 v207, a71
  s_mov_b32 s24, s66
  s_and_b32 s25, s67, 0xffff
  s_mov_b32 s26, 0x200000
  s_mov_b32 s27, 0x20000
  s_mov_b32 s28, s68
  s_and_b32 s29, s69, 0xffff
  s_mov_b32 s30, 0x200000
  s_mov_b32 s31, 0x20000
  s_and_b32 s32, s2, 7
  s_lshl_b32 s32, s32, 2
  s_lshr_b32 s37, s2, 3
  s_and_b32 s37, s37, 3
  s_add_u32 s32, s32, s37
  s_lshr_b32 s33, s2, 5
  v_lshlrev_b32 v3, 4, v2
  s_mul_i32 s34, s32, 56
  s_mul_i32 s37, s3, 14
  s_add_u32 s34, s34, s37
  s_lshl_b32 s34, s34, 12
  s_add_u32 s34, s34, 0x2000000
  s_mul_i32 s35, s33, 56
  s_add_u32 s35, s35, s37
  s_lshl_b32 s35, s35, 12
  s_add_u32 s35, s35, 0x800000
  buffer_load_dwordx4 a[128:131], v3, s[16:19], s35 offen offset:0 sc1
  buffer_load_dwordx4 a[132:135], v3, s[16:19], s35 offen offset:1024 sc1
  buffer_load_dwordx4 a[136:139], v3, s[16:19], s35 offen offset:2048 sc1
  buffer_load_dwordx4 a[140:143], v3, s[16:19], s35 offen offset:3072 sc1
  s_add_u32 s35, s35, 4096
  buffer_load_dwordx4 a[144:147], v3, s[16:19], s35 offen offset:0 sc1
  buffer_load_dwordx4 a[148:151], v3, s[16:19], s35 offen offset:1024 sc1
  buffer_load_dwordx4 a[152:155], v3, s[16:19], s35 offen offset:2048 sc1
  buffer_load_dwordx4 a[156:159], v3, s[16:19], s35 offen offset:3072 sc1
  s_add_u32 s35, s35, 4096
  buffer_load_dwordx4 a[160:163], v3, s[16:19], s35 offen offset:0 sc1
  buffer_load_dwordx4 a[164:167], v3, s[16:19], s35 offen offset:1024 sc1
  buffer_load_dwordx4 a[168:171], v3, s[16:19], s35 offen offset:2048 sc1
  buffer_load_dwordx4 a[172:175], v3, s[16:19], s35 offen offset:3072 sc1
  s_add_u32 s35, s35, 4096
  buffer_load_dwordx4 a[176:179], v3, s[16:19], s35 offen offset:0 sc1
  buffer_load_dwordx4 a[180:183], v3, s[16:19], s35 offen offset:1024 sc1
  buffer_load_dwordx4 a[184:187], v3, s[16:19], s35 offen offset:2048 sc1
  buffer_load_dwordx4 a[188:191], v3, s[16:19], s35 offen offset:3072 sc1
  s_add_u32 s35, s35, 4096
  buffer_load_dwordx4 a[192:195], v3, s[16:19], s35 offen offset:0 sc1
  buffer_load_dwordx4 a[196:199], v3, s[16:19], s35 offen offset:1024 sc1
  buffer_load_dwordx4 a[200:203], v3, s[16:19], s35 offen offset:2048 sc1
  buffer_load_dwordx4 a[204:207], v3, s[16:19], s35 offen offset:3072 sc1
  s_add_u32 s35, s35, 4096
  buffer_load_dwordx4 a[208:211], v3, s[16:19], s35 offen offset:0 sc1
  buffer_load_dwordx4 a[212:215], v3, s[16:19], s35 offen offset:1024 sc1
  buffer_load_dwordx4 a[216:219], v3, s[16:19], s35 offen offset:2048 sc1
  buffer_load_dwordx4 a[220:223], v3, s[16:19], s35 offen offset:3072 sc1
  s_add_u32 s35, s35, 4096
  v_mov_b32 v21, 0
  s_cmp_lg_u32 s3, 0
  s_cbranch_scc1 L_aw_76
  s_mov_b32 s81, 0
L_as_77:
  buffer_load_dword v22, v21, s[16:19], s77 offen sc1
  s_waitcnt vmcnt(0)
  v_readfirstlane_b32 s80, v22
  s_add_u32 s81, s81, 1
  s_nop 2
  s_cmp_ge_u32 s80, 28
  s_cbranch_scc1 L_ao_78
  s_sleep 4
  s_cmp_lt_u32 s81, 0x80000
  s_cbranch_scc1 L_as_77
L_ao_78:
L_aw_76:
  s_barrier
  buffer_load_dwordx4 a[0:3], v3, s[16:19], s34 offen offset:0 sc1
  buffer_load_dwordx4 a[4:7], v3, s[16:19], s34 offen offset:1024 sc1
  buffer_load_dwordx4 a[8:11], v3, s[16:19], s34 offen offset:2048 sc1
  buffer_load_dwordx4 a[12:15], v3, s[16:19], s34 offen offset:3072 sc1
  s_add_u32 s34, s34, 4096
  buffer_load_dwordx4 a[16:19], v3, s[16:19], s34 offen offset:0 sc1
  buffer_load_dwordx4 a[20:23], v3, s[16:19], s34 offen offset:1024 sc1
  buffer_load_dwordx4 a[24:27], v3, s[16:19], s34 offen offset:2048 sc1
  buffer_load_dwordx4 a[28:31], v3, s[16:19], s34 offen offset:3072 sc1
  s_add_u32 s34, s34, 4096
  buffer_load_dwordx4 a[32:35], v3, s[16:19], s34 offen offset:0 sc1
  buffer_load_dwordx4 a[36:39], v3, s[16:19], s34 offen offset:1024 sc1
  buffer_load_dwordx4 a[40:43], v3, s[16:19], s34 offen offset:2048 sc1
  buffer_load_dwordx4 a[44:47], v3, s[16:19], s34 offen offset:3072 sc1
  s_add_u32 s34, s34, 4096
  buffer_load_dwordx4 a[48:51], v3, s[16:19], s34 offen offset:0 sc1
  buffer_load_dwordx4 a[52:55], v3, s[16:19], s34 offen offset:1024 sc1
  buffer_load_dwordx4 a[56:59], v3, s[16:19], s34 offen offset:2048 sc1
  buffer_load_dwordx4 a[60:63], v3, s[16:19], s34 offen offset:3072 sc1
  s_add_u32 s34, s34, 4096
  s_waitcnt vmcnt(12)
  v_mfma_f32_16x16x32_bf16 v[64:67], a[128:131], a[0:3], 0
  v_mfma_f32_16x16x32_bf16 v[80:83], a[128:131], a[4:7], 0
  buffer_load_dwordx4 a[64:67], v3, s[16:19], s34 offen offset:0 sc1
  v_mfma_f32_16x16x32_bf16 v[96:99], a[128:131], a[8:11], 0
  v_mfma_f32_16x16x32_bf16 v[112:115], a[128:131], a[12:15], 0
  buffer_load_dwordx4 a[68:71], v3, s[16:19], s34 offen offset:1024 sc1
  v_mfma_f32_16x16x32_bf16 v[68:71], a[132:135], a[0:3], 0
  v_mfma_f32_16x16x32_bf16 v[84:87], a[132:135], a[4:7], 0
  buffer_load_dwordx4 a[72:75], v3, s[16:19], s34 offen offset:2048 sc1
  v_mfma_f32_16x16x32_bf16 v[100:103], a[132:135], a[8:11], 0
  v_mfma_f32_16x16x32_bf16 v[116:119], a[132:135], a[12:15], 0
  buffer_load_dwordx4 a[76:79], v3, s[16:19], s34 offen offset:3072 sc1
  v_mfma_f32_16x16x32_bf16 v[72:75], a[136:139], a[0:3], 0
  s_add_u32 s34, s34, 4096
  v_mfma_f32_16x16x32_bf16 v[88:91], a[136:139], a[4:7], 0
  buffer_load_dwordx4 a[80:83], v3, s[16:19], s34 offen offset:0 sc1
  v_mfma_f32_16x16x32_bf16 v[104:107], a[136:139], a[8:11], 0
  v_mfma_f32_16x16x32_bf16 v[120:123], a[136:139], a[12:15], 0
  buffer_load_dwordx4 a[84:87], v3, s[16:19], s34 offen offset:1024 sc1
  v_mfma_f32_16x16x32_bf16 v[76:79], a[140:143], a[0:3], 0
  v_mfma_f32_16x16x32_bf16 v[92:95], a[140:143], a[4:7], 0
  buffer_load_dwordx4 a[88:91], v3, s[16:19], s34 offen offset:2048 sc1
  v_mfma_f32_16x16x32_bf16 v[108:111], a[140:143], a[8:11], 0
  v_mfma_f32_16x16x32_bf16 v[124:127], a[140:143], a[12:15], 0
  buffer_load_dwordx4 a[92:95], v3, s[16:19], s34 offen offset:3072 sc1
  s_add_u32 s34, s34, 4096
  s_waitcnt vmcnt(16)
  v_mfma_f32_16x16x32_bf16 v[64:67], a[144:147], a[16:19], v[64:67]
  buffer_load_dwordx4 a[224:227], v3, s[16:19], s35 offen offset:0 sc1
  v_mfma_f32_16x16x32_bf16 v[80:83], a[144:147], a[20:23], v[80:83]
  buffer_load_dwordx4 a[228:231], v3, s[16:19], s35 offen offset:1024 sc1
  v_mfma_f32_16x16x32_bf16 v[96:99], a[144:147], a[24:27], v[96:99]
  buffer_load_dwordx4 a[232:235], v3, s[16:19], s35 offen offset:2048 sc1
  v_mfma_f32_16x16x32_bf16 v[112:115], a[144:147], a[28:31], v[112:115]
  buffer_load_dwordx4 a[236:239], v3, s[16:19], s35 offen offset:3072 sc1
  s_add_u32 s35, s35, 4096
  v_mfma_f32_16x16x32_bf16 v[68:71], a[148:151], a[16:19], v[68:71]
  buffer_load_dwordx4 a[96:99], v3, s[16:19], s34 offen offset:0 sc1
  v_mfma_f32_16x16x32_bf16 v[84:87], a[148:151], a[20:23], v[84:87]
  buffer_load_dwordx4 a[100:103], v3, s[16:19], s34 offen offset:1024 sc1
  v_mfma_f32_16x16x32_bf16 v[100:103], a[148:151], a[24:27], v[100:103]
  buffer_load_dwordx4 a[104:107], v3, s[16:19], s34 offen offset:2048 sc1
  v_mfma_f32_16x16x32_bf16 v[116:119], a[148:151], a[28:31], v[116:119]
  buffer_load_dwordx4 a[108:111], v3, s[16:19], s34 offen offset:3072 sc1
  s_add_u32 s34, s34, 4096
  v_mfma_f32_16x16x32_bf16 v[72:75], a[152:155], a[16:19], v[72:75]
  buffer_load_dwordx4 a[240:243], v3, s[16:19], s35 offen offset:0 sc1
  v_mfma_f32_16x16x32_bf16 v[88:91], a[152:155], a[20:23], v[88:91]
  buffer_load_dwordx4 a[244:247], v3, s[16:19], s35 offen offset:1024 sc1
  v_mfma_f32_16x16x32_bf16 v[104:107], a[152:155], a[24:27], v[104:107]
  buffer_load_dwordx4 a[248:251], v3, s[16:19], s35 offen offset:2048 sc1
  v_mfma_f32_16x16x32_bf16 v[120:123], a[152:155], a[28:31], v[120:123]
  buffer_load_dwordx4 a[252:255], v3, s[16:19], s35 offen offset:3072 sc1
  s_add_u32 s35, s35, 4096
  v_mfma_f32_16x16x32_bf16 v[76:79], a[156:159], a[16:19], v[76:79]
  buffer_load_dwordx4 a[112:115], v3, s[16:19], s34 offen offset:0 sc1
  v_mfma_f32_16x16x32_bf16 v[92:95], a[156:159], a[20:23], v[92:95]
  buffer_load_dwordx4 a[116:119], v3, s[16:19], s34 offen offset:1024 sc1
  v_mfma_f32_16x16x32_bf16 v[108:111], a[156:159], a[24:27], v[108:111]
  buffer_load_dwordx4 a[120:123], v3, s[16:19], s34 offen offset:2048 sc1
  v_mfma_f32_16x16x32_bf16 v[124:127], a[156:159], a[28:31], v[124:127]
  buffer_load_dwordx4 a[124:127], v3, s[16:19], s34 offen offset:3072 sc1
  s_add_u32 s34, s34, 4096
  s_waitcnt vmcnt(28)
  v_mfma_f32_16x16x32_bf16 v[64:67], a[160:163], a[32:35], v[64:67]
  buffer_load_dwordx4 a[128:131], v3, s[16:19], s35 offen offset:0 sc1
  v_mfma_f32_16x16x32_bf16 v[80:83], a[160:163], a[36:39], v[80:83]
  buffer_load_dwordx4 a[132:135], v3, s[16:19], s35 offen offset:1024 sc1
  v_mfma_f32_16x16x32_bf16 v[96:99], a[160:163], a[40:43], v[96:99]
  buffer_load_dwordx4 a[136:139], v3, s[16:19], s35 offen offset:2048 sc1
  v_mfma_f32_16x16x32_bf16 v[112:115], a[160:163], a[44:47], v[112:115]
  buffer_load_dwordx4 a[140:143], v3, s[16:19], s35 offen offset:3072 sc1
  s_add_u32 s35, s35, 4096
  v_mfma_f32_16x16x32_bf16 v[68:71], a[164:167], a[32:35], v[68:71]
  buffer_load_dwordx4 a[0:3], v3, s[16:19], s34 offen offset:0 sc1
  v_mfma_f32_16x16x32_bf16 v[84:87], a[164:167], a[36:39], v[84:87]
  buffer_load_dwordx4 a[4:7], v3, s[16:19], s34 offen offset:1024 sc1
  v_mfma_f32_16x16x32_bf16 v[100:103], a[164:167], a[40:43], v[100:103]
  buffer_load_dwordx4 a[8:11], v3, s[16:19], s34 offen offset:2048 sc1
  v_mfma_f32_16x16x32_bf16 v[116:119], a[164:167], a[44:47], v[116:119]
  buffer_load_dwordx4 a[12:15], v3, s[16:19], s34 offen offset:3072 sc1
  s_add_u32 s34, s34, 4096
  v_mfma_f32_16x16x32_bf16 v[72:75], a[168:171], a[32:35], v[72:75]
  buffer_load_dwordx4 a[144:147], v3, s[16:19], s35 offen offset:0 sc1
  v_mfma_f32_16x16x32_bf16 v[88:91], a[168:171], a[36:39], v[88:91]
  buffer_load_dwordx4 a[148:151], v3, s[16:19], s35 offen offset:1024 sc1
  v_mfma_f32_16x16x32_bf16 v[104:107], a[168:171], a[40:43], v[104:107]
  buffer_load_dwordx4 a[152:155], v3, s[16:19], s35 offen offset:2048 sc1
  v_mfma_f32_16x16x32_bf16 v[120:123], a[168:171], a[44:47], v[120:123]
  buffer_load_dwordx4 a[156:159], v3, s[16:19], s35 offen offset:3072 sc1
  s_add_u32 s35, s35, 4096
  v_mfma_f32_16x16x32_bf16 v[76:79], a[172:175], a[32:35], v[76:79]
  buffer_load_dwordx4 a[16:19], v3, s[16:19], s34 offen offset:0 sc1
  v_mfma_f32_16x16x32_bf16 v[92:95], a[172:175], a[36:39], v[92:95]
  buffer_load_dwordx4 a[20:23], v3, s[16:19], s34 offen offset:1024 sc1
  v_mfma_f32_16x16x32_bf16 v[108:111], a[172:175], a[40:43], v[108:111]
  buffer_load_dwordx4 a[24:27], v3, s[16:19], s34 offen offset:2048 sc1
  v_mfma_f32_16x16x32_bf16 v[124:127], a[172:175], a[44:47], v[124:127]
  buffer_load_dwordx4 a[28:31], v3, s[16:19], s34 offen offset:3072 sc1
  s_add_u32 s34, s34, 4096
  s_waitcnt vmcnt(40)
  v_mfma_f32_16x16x32_bf16 v[64:67], a[176:179], a[48:51], v[64:67]
  v_mfma_f32_16x16x32_bf16 v[80:83], a[176:179], a[52:55], v[80:83]
  buffer_load_dwordx4 a[160:163], v3, s[16:19], s35 offen offset:0 sc1
  v_mfma_f32_16x16x32_bf16 v[96:99], a[176:179], a[56:59], v[96:99]
  v_mfma_f32_16x16x32_bf16 v[112:115], a[176:179], a[60:63], v[112:115]
  buffer_load_dwordx4 a[164:167], v3, s[16:19], s35 offen offset:1024 sc1
  v_mfma_f32_16x16x32_bf16 v[68:71], a[180:183], a[48:51], v[68:71]
  v_mfma_f32_16x16x32_bf16 v[84:87], a[180:183], a[52:55], v[84:87]
  buffer_load_dwordx4 a[168:171], v3, s[16:19], s35 offen offset:2048 sc1
  v_mfma_f32_16x16x32_bf16 v[100:103], a[180:183], a[56:59], v[100:103]
  v_mfma_f32_16x16x32_bf16 v[116:119], a[180:183], a[60:63], v[116:119]
  buffer_load_dwordx4 a[172:175], v3, s[16:19], s35 offen offset:3072 sc1
  v_mfma_f32_16x16x32_bf16 v[72:75], a[184:187], a[48:51], v[72:75]
  s_add_u32 s35, s35, 4096
  v_mfma_f32_16x16x32_bf16 v[88:91], a[184:187], a[52:55], v[88:91]
  buffer_load_dwordx4 a[32:35], v3, s[16:19], s34 offen offset:0 sc1
  v_mfma_f32_16x16x32_bf16 v[104:107], a[184:187], a[56:59], v[104:107]
  v_mfma_f32_16x16x32_bf16 v[120:123], a[184:187], a[60:63], v[120:123]
  buffer_load_dwordx4 a[36:39], v3, s[16:19], s34 offen offset:1024 sc1
  v_mfma_f32_16x16x32_bf16 v[76:79], a[188:191], a[48:51], v[76:79]
  v_mfma_f32_16x16x32_bf16 v[92:95], a[188:191], a[52:55], v[92:95]
  buffer_load_dwordx4 a[40:43], v3, s[16:19], s34 offen offset:2048 sc1
  v_mfma_f32_16x16x32_bf16 v[108:111], a[188:191], a[56:59], v[108:111]
  v_mfma_f32_16x16x32_bf16 v[124:127], a[188:191], a[60:63], v[124:127]
  buffer_load_dwordx4 a[44:47], v3, s[16:19], s34 offen offset:3072 sc1
  s_add_u32 s34, s34, 4096
  s_waitcnt vmcnt(44)
  v_mfma_f32_16x16x32_bf16 v[64:67], a[192:195], a[64:67], v[64:67]
  v_mfma_f32_16x16x32_bf16 v[80:83], a[192:195], a[68:71], v[80:83]
  buffer_load_dwordx4 a[176:179], v3, s[16:19], s35 offen offset:0 sc1
  v_mfma_f32_16x16x32_bf16 v[96:99], a[192:195], a[72:75], v[96:99]
  v_mfma_f32_16x16x32_bf16 v[112:115], a[192:195], a[76:79], v[112:115]
  buffer_load_dwordx4 a[180:183], v3, s[16:19], s35 offen offset:1024 sc1
  v_mfma_f32_16x16x32_bf16 v[68:71], a[196:199], a[64:67], v[68:71]
  v_mfma_f32_16x16x32_bf16 v[84:87], a[196:199], a[68:71], v[84:87]
  buffer_load_dwordx4 a[184:187], v3, s[16:19], s35 offen offset:2048 sc1
  v_mfma_f32_16x16x32_bf16 v[100:103], a[196:199], a[72:75], v[100:103]
  v_mfma_f32_16x16x32_bf16 v[116:119], a[196:199], a[76:79], v[116:119]
  buffer_load_dwordx4 a[188:191], v3, s[16:19], s35 offen offset:3072 sc1
  v_mfma_f32_16x16x32_bf16 v[72:75], a[200:203], a[64:67], v[72:75]
  s_add_u32 s35, s35, 4096
  v_mfma_f32_16x16x32_bf16 v[88:91], a[200:203], a[68:71], v[88:91]
  buffer_load_dwordx4 a[48:51], v3, s[16:19], s34 offen offset:0 sc1
  v_mfma_f32_16x16x32_bf16 v[104:107], a[200:203], a[72:75], v[104:107]
  v_mfma_f32_16x16x32_bf16 v[120:123], a[200:203], a[76:79], v[120:123]
  buffer_load_dwordx4 a[52:55], v3, s[16:19], s34 offen offset:1024 sc1
  v_mfma_f32_16x16x32_bf16 v[76:79], a[204:207], a[64:67], v[76:79]
  v_mfma_f32_16x16x32_bf16 v[92:95], a[204:207], a[68:71], v[92:95]
  buffer_load_dwordx4 a[56:59], v3, s[16:19], s34 offen offset:2048 sc1
  v_mfma_f32_16x16x32_bf16 v[108:111], a[204:207], a[72:75], v[108:111]
  v_mfma_f32_16x16x32_bf16 v[124:127], a[204:207], a[76:79], v[124:127]
  buffer_load_dwordx4 a[60:63], v3, s[16:19], s34 offen offset:3072 sc1
  s_add_u32 s34, s34, 4096
  s_waitcnt vmcnt(48)
  v_mfma_f32_16x16x32_bf16 v[64:67], a[208:211], a[80:83], v[64:67]
  v_mfma_f32_16x16x32_bf16 v[80:83], a[208:211], a[84:87], v[80:83]
  buffer_load_dwordx4 a[192:195], v3, s[16:19], s35 offen offset:0 sc1
  v_mfma_f32_16x16x32_bf16 v[96:99], a[208:211], a[88:91], v[96:99]
  v_mfma_f32_16x16x32_bf16 v[112:115], a[208:211], a[92:95], v[112:115]
  buffer_load_dwordx4 a[196:199], v3, s[16:19], s35 offen offset:1024 sc1
  v_mfma_f32_16x16x32_bf16 v[68:71], a[212:215], a[80:83], v[68:71]
  v_mfma_f32_16x16x32_bf16 v[84:87], a[212:215], a[84:87], v[84:87]
  buffer_load_dwordx4 a[200:203], v3, s[16:19], s35 offen offset:2048 sc1
  v_mfma_f32_16x16x32_bf16 v[100:103], a[212:215], a[88:91], v[100:103]
  v_mfma_f32_16x16x32_bf16 v[116:119], a[212:215], a[92:95], v[116:119]
  buffer_load_dwordx4 a[204:207], v3, s[16:19], s35 offen offset:3072 sc1
  v_mfma_f32_16x16x32_bf16 v[72:75], a[216:219], a[80:83], v[72:75]
  s_add_u32 s35, s35, 4096
  v_mfma_f32_16x16x32_bf16 v[88:91], a[216:219], a[84:87], v[88:91]
  buffer_load_dwordx4 a[64:67], v3, s[16:19], s34 offen offset:0 sc1
  v_mfma_f32_16x16x32_bf16 v[104:107], a[216:219], a[88:91], v[104:107]
  v_mfma_f32_16x16x32_bf16 v[120:123], a[216:219], a[92:95], v[120:123]
  buffer_load_dwordx4 a[68:71], v3, s[16:19], s34 offen offset:1024 sc1
  v_mfma_f32_16x16x32_bf16 v[76:79], a[220:223], a[80:83], v[76:79]
  v_mfma_f32_16x16x32_bf16 v[92:95], a[220:223], a[84:87], v[92:95]
  buffer_load_dwordx4 a[72:75], v3, s[16:19], s34 offen offset:2048 sc1
  v_mfma_f32_16x16x32_bf16 v[108:111], a[220:223], a[88:91], v[108:111]
  v_mfma_f32_16x16x32_bf16 v[124:127], a[220:223], a[92:95], v[124:127]
  buffer_load_dwordx4 a[76:79], v3, s[16:19], s34 offen offset:3072 sc1
  s_add_u32 s34, s34, 4096
  s_waitcnt vmcnt(48)
  v_mfma_f32_16x16x32_bf16 v[64:67], a[224:227], a[96:99], v[64:67]
  v_mfma_f32_16x16x32_bf16 v[80:83], a[224:227], a[100:103], v[80:83]
  buffer_load_dwordx4 a[208:211], v3, s[16:19], s35 offen offset:0 sc1
  v_mfma_f32_16x16x32_bf16 v[96:99], a[224:227], a[104:107], v[96:99]
  v_mfma_f32_16x16x32_bf16 v[112:115], a[224:227], a[108:111], v[112:115]
  buffer_load_dwordx4 a[212:215], v3, s[16:19], s35 offen offset:1024 sc1
  v_mfma_f32_16x16x32_bf16 v[68:71], a[228:231], a[96:99], v[68:71]
  v_mfma_f32_16x16x32_bf16 v[84:87], a[228:231], a[100:103], v[84:87]
  buffer_load_dwordx4 a[216:219], v3, s[16:19], s35 offen offset:2048 sc1
  v_mfma_f32_16x16x32_bf16 v[100:103], a[228:231], a[104:107], v[100:103]
  v_mfma_f32_16x16x32_bf16 v[116:119], a[228:231], a[108:111], v[116:119]
  buffer_load_dwordx4 a[220:223], v3, s[16:19], s35 offen offset:3072 sc1
  v_mfma_f32_16x16x32_bf16 v[72:75], a[232:235], a[96:99], v[72:75]
  s_add_u32 s35, s35, 4096
  v_mfma_f32_16x16x32_bf16 v[88:91], a[232:235], a[100:103], v[88:91]
  buffer_load_dwordx4 a[80:83], v3, s[16:19], s34 offen offset:0 sc1
  v_mfma_f32_16x16x32_bf16 v[104:107], a[232:235], a[104:107], v[104:107]
  v_mfma_f32_16x16x32_bf16 v[120:123], a[232:235], a[108:111], v[120:123]
  buffer_load_dwordx4 a[84:87], v3, s[16:19], s34 offen offset:1024 sc1
  v_mfma_f32_16x16x32_bf16 v[76:79], a[236:239], a[96:99], v[76:79]
  v_mfma_f32_16x16x32_bf16 v[92:95], a[236:239], a[100:103], v[92:95]
  buffer_load_dwordx4 a[88:91], v3, s[16:19], s34 offen offset:2048 sc1
  v_mfma_f32_16x16x32_bf16 v[108:111], a[236:239], a[104:107], v[108:111]
  v_mfma_f32_16x16x32_bf16 v[124:127], a[236:239], a[108:111], v[124:127]
  buffer_load_dwordx4 a[92:95], v3, s[16:19], s34 offen offset:3072 sc1
  s_add_u32 s34, s34, 4096
  s_lshl_b32 s44, s32, 2
  s_add_u32 s44, s44, s3
  s_lshl_b32 s44, s44, 4
  s_lshl_b32 s37, s33, 1
  s_add_u32 s44, s44, s37
  s_lshl_b32 s44, s44, 10
  s_add_u32 s45, s44, 0x2800000
  v_lshrrev_b32 v18, 4, v2
  v_lshlrev_b32 v20, 5, v18
  s_lshl_b32 s42, s33, 8
  s_add_u32 s43, s42, 10240
  buffer_load_dwordx4 v[208:211], v20, s[16:19], s43 offen offset:0 sc1
  buffer_load_dwordx4 v[212:215], v20, s[16:19], s43 offen offset:16 sc1
  buffer_load_dwordx4 v[216:219], v20, s[16:19], s43 offen offset:128 sc1
  buffer_load_dwordx4 v[220:223], v20, s[16:19], s43 offen offset:144 sc1
  v_and_b32 v17, 15, v2
  v_lshlrev_b32 v19, 10, v17
  v_lshl_add_u32 v19, v18, 4, v19
  s_lshl_b32 s40, s32, 6
  s_lshl_b32 s37, s3, 4
  s_add_u32 s40, s40, s37
  s_lshl_b32 s41, s40, 10
  s_lshl_b32 s37, s33, 7
  s_add_u32 s41, s41, s37
  s_waitcnt vmcnt(52)
  v_mfma_f32_16x16x32_bf16 v[64:67], a[240:243], a[112:115], v[64:67]
  v_mfma_f32_16x16x32_bf16 v[80:83], a[240:243], a[116:119], v[80:83]
  v_mfma_f32_16x16x32_bf16 v[96:99], a[240:243], a[120:123], v[96:99]
  v_mfma_f32_16x16x32_bf16 v[112:115], a[240:243], a[124:127], v[112:115]
  v_mfma_f32_16x16x32_bf16 v[68:71], a[244:247], a[112:115], v[68:71]
  v_mfma_f32_16x16x32_bf16 v[84:87], a[244:247], a[116:119], v[84:87]
  v_mfma_f32_16x16x32_bf16 v[100:103], a[244:247], a[120:123], v[100:103]
  v_mfma_f32_16x16x32_bf16 v[116:119], a[244:247], a[124:127], v[116:119]
  v_mfma_f32_16x16x32_bf16 v[72:75], a[248:251], a[112:115], v[72:75]
  v_mfma_f32_16x16x32_bf16 v[88:91], a[248:251], a[116:119], v[88:91]
  v_mfma_f32_16x16x32_bf16 v[104:107], a[248:251], a[120:123], v[104:107]
  v_mfma_f32_16x16x32_bf16 v[120:123], a[248:251], a[124:127], v[120:123]
  v_mfma_f32_16x16x32_bf16 v[76:79], a[252:255], a[112:115], v[76:79]
  v_mfma_f32_16x16x32_bf16 v[92:95], a[252:255], a[116:119], v[92:95]
  v_mfma_f32_16x16x32_bf16 v[108:111], a[252:255], a[120:123], v[108:111]
  v_mfma_f32_16x16x32_bf16 v[124:127], a[252:255], a[124:127], v[124:127]
  s_waitcnt vmcnt(44)
  v_mfma_f32_16x16x32_bf16 v[64:67], a[128:131], a[0:3], v[64:67]
  v_mfma_f32_16x16x32_bf16 v[80:83], a[128:131], a[4:7], v[80:83]
  v_mfma_f32_16x16x32_bf16 v[96:99], a[128:131], a[8:11], v[96:99]
  v_mfma_f32_16x16x32_bf16 v[112:115], a[128:131], a[12:15], v[112:115]
  v_mfma_f32_16x16x32_bf16 v[68:71], a[132:135], a[0:3], v[68:71]
  v_mfma_f32_16x16x32_bf16 v[84:87], a[132:135], a[4:7], v[84:87]
  v_mfma_f32_16x16x32_bf16 v[100:103], a[132:135], a[8:11], v[100:103]
  v_mfma_f32_16x16x32_bf16 v[116:119], a[132:135], a[12:15], v[116:119]
  v_mfma_f32_16x16x32_bf16 v[72:75], a[136:139], a[0:3], v[72:75]
  v_mfma_f32_16x16x32_bf16 v[88:91], a[136:139], a[4:7], v[88:91]
  v_mfma_f32_16x16x32_bf16 v[104:107], a[136:139], a[8:11], v[104:107]
  v_mfma_f32_16x16x32_bf16 v[120:123], a[136:139], a[12:15], v[120:123]
  v_mfma_f32_16x16x32_bf16 v[76:79], a[140:143], a[0:3], v[76:79]
  v_mfma_f32_16x16x32_bf16 v[92:95], a[140:143], a[4:7], v[92:95]
  v_mfma_f32_16x16x32_bf16 v[108:111], a[140:143], a[8:11], v[108:111]
  v_mfma_f32_16x16x32_bf16 v[124:127], a[140:143], a[12:15], v[124:127]
  s_waitcnt vmcnt(36)
  v_mfma_f32_16x16x32_bf16 v[64:67], a[144:147], a[16:19], v[64:67]
  v_mfma_f32_16x16x32_bf16 v[80:83], a[144:147], a[20:23], v[80:83]
  v_mfma_f32_16x16x32_bf16 v[96:99], a[144:147], a[24:27], v[96:99]
  v_mfma_f32_16x16x32_bf16 v[112:115], a[144:147], a[28:31], v[112:115]
  v_mfma_f32_16x16x32_bf16 v[68:71], a[148:151], a[16:19], v[68:71]
  v_mfma_f32_16x16x32_bf16 v[84:87], a[148:151], a[20:23], v[84:87]
  v_mfma_f32_16x16x32_bf16 v[100:103], a[148:151], a[24:27], v[100:103]
  v_mfma_f32_16x16x32_bf16 v[116:119], a[148:151], a[28:31], v[116:119]
  v_mfma_f32_16x16x32_bf16 v[72:75], a[152:155], a[16:19], v[72:75]
  v_mfma_f32_16x16x32_bf16 v[88:91], a[152:155], a[20:23], v[88:91]
  v_mfma_f32_16x16x32_bf16 v[104:107], a[152:155], a[24:27], v[104:107]
  v_mfma_f32_16x16x32_bf16 v[120:123], a[152:155], a[28:31], v[120:123]
  v_mfma_f32_16x16x32_bf16 v[76:79], a[156:159], a[16:19], v[76:79]
  v_mfma_f32_16x16x32_bf16 v[92:95], a[156:159], a[20:23], v[92:95]
  v_mfma_f32_16x16x32_bf16 v[108:111], a[156:159], a[24:27], v[108:111]
  v_mfma_f32_16x16x32_bf16 v[124:127], a[156:159], a[28:31], v[124:127]
  s_waitcnt vmcnt(28)
  v_mfma_f32_16x16x32_bf16 v[64:67], a[160:163], a[32:35], v[64:67]
  v_mfma_f32_16x16x32_bf16 v[80:83], a[160:163], a[36:39], v[80:83]
  v_mfma_f32_16x16x32_bf16 v[96:99], a[160:163], a[40:43], v[96:99]
  v_mfma_f32_16x16x32_bf16 v[112:115], a[160:163], a[44:47], v[112:115]
  v_mfma_f32_16x16x32_bf16 v[68:71], a[164:167], a[32:35], v[68:71]
  v_mfma_f32_16x16x32_bf16 v[84:87], a[164:167], a[36:39], v[84:87]
  v_mfma_f32_16x16x32_bf16 v[100:103], a[164:167], a[40:43], v[100:103]
  v_mfma_f32_16x16x32_bf16 v[116:119], a[164:167], a[44:47], v[116:119]
  v_mfma_f32_16x16x32_bf16 v[72:75], a[168:171], a[32:35], v[72:75]
  v_mfma_f32_16x16x32_bf16 v[88:91], a[168:171], a[36:39], v[88:91]
  v_mfma_f32_16x16x32_bf16 v[104:107], a[168:171], a[40:43], v[104:107]
  v_mfma_f32_16x16x32_bf16 v[120:123], a[168:171], a[44:47], v[120:123]
  v_mfma_f32_16x16x32_bf16 v[76:79], a[172:175], a[32:35], v[76:79]
  v_mfma_f32_16x16x32_bf16 v[92:95], a[172:175], a[36:39], v[92:95]
  v_mfma_f32_16x16x32_bf16 v[108:111], a[172:175], a[40:43], v[108:111]
  v_mfma_f32_16x16x32_bf16 v[124:127], a[172:175], a[44:47], v[124:127]
  s_waitcnt vmcnt(20)
  v_mfma_f32_16x16x32_bf16 v[64:67], a[176:179], a[48:51], v[64:67]
  v_mfma_f32_16x16x32_bf16 v[80:83], a[176:179], a[52:55], v[80:83]
  v_mfma_f32_16x16x32_bf16 v[96:99], a[176:179], a[56:59], v[96:99]
  v_mfma_f32_16x16x32_bf16 v[112:115], a[176:179], a[60:63], v[112:115]
  v_mfma_f32_16x16x32_bf16 v[68:71], a[180:183], a[48:51], v[68:71]
  v_mfma_f32_16x16x32_bf16 v[84:87], a[180:183], a[52:55], v[84:87]
  v_mfma_f32_16x16x32_bf16 v[100:103], a[180:183], a[56:59], v[100:103]
  v_mfma_f32_16x16x32_bf16 v[116:119], a[180:183], a[60:63], v[116:119]
  v_mfma_f32_16x16x32_bf16 v[72:75], a[184:187], a[48:51], v[72:75]
  v_mfma_f32_16x16x32_bf16 v[88:91], a[184:187], a[52:55], v[88:91]
  v_mfma_f32_16x16x32_bf16 v[104:107], a[184:187], a[56:59], v[104:107]
  v_mfma_f32_16x16x32_bf16 v[120:123], a[184:187], a[60:63], v[120:123]
  v_mfma_f32_16x16x32_bf16 v[76:79], a[188:191], a[48:51], v[76:79]
  v_mfma_f32_16x16x32_bf16 v[92:95], a[188:191], a[52:55], v[92:95]
  v_mfma_f32_16x16x32_bf16 v[108:111], a[188:191], a[56:59], v[108:111]
  v_mfma_f32_16x16x32_bf16 v[124:127], a[188:191], a[60:63], v[124:127]
  s_waitcnt vmcnt(12)
  v_mfma_f32_16x16x32_bf16 v[64:67], a[192:195], a[64:67], v[64:67]
  v_mfma_f32_16x16x32_bf16 v[80:83], a[192:195], a[68:71], v[80:83]
  v_mfma_f32_16x16x32_bf16 v[96:99], a[192:195], a[72:75], v[96:99]
  v_mfma_f32_16x16x32_bf16 v[112:115], a[192:195], a[76:79], v[112:115]
  v_mfma_f32_16x16x32_bf16 v[68:71], a[196:199], a[64:67], v[68:71]
  v_mfma_f32_16x16x32_bf16 v[84:87], a[196:199], a[68:71], v[84:87]
  v_mfma_f32_16x16x32_bf16 v[100:103], a[196:199], a[72:75], v[100:103]
  v_mfma_f32_16x16x32_bf16 v[116:119], a[196:199], a[76:79], v[116:119]
  v_mfma_f32_16x16x32_bf16 v[72:75], a[200:203], a[64:67], v[72:75]
  v_mfma_f32_16x16x32_bf16 v[88:91], a[200:203], a[68:71], v[88:91]
  v_mfma_f32_16x16x32_bf16 v[104:107], a[200:203], a[72:75], v[104:107]
  v_mfma_f32_16x16x32_bf16 v[120:123], a[200:203], a[76:79], v[120:123]
  v_mfma_f32_16x16x32_bf16 v[76:79], a[204:207], a[64:67], v[76:79]
  v_mfma_f32_16x16x32_bf16 v[92:95], a[204:207], a[68:71], v[92:95]
  v_mfma_f32_16x16x32_bf16 v[108:111], a[204:207], a[72:75], v[108:111]
  v_mfma_f32_16x16x32_bf16 v[124:127], a[204:207], a[76:79], v[124:127]
  s_waitcnt vmcnt(4)
  v_mfma_f32_16x16x32_bf16 v[64:67], a[208:211], a[80:83], v[64:67]
  v_mfma_f32_16x16x32_bf16 v[80:83], a[208:211], a[84:87], v[80:83]
  v_mfma_f32_16x16x32_bf16 v[96:99], a[208:211], a[88:91], v[96:99]
  v_mfma_f32_16x16x32_bf16 v[112:115], a[208:211], a[92:95], v[112:115]
  v_mfma_f32_16x16x32_bf16 v[68:71], a[212:215], a[80:83], v[68:71]
  v_mfma_f32_16x16x32_bf16 v[84:87], a[212:215], a[84:87], v[84:87]
  v_mfma_f32_16x16x32_bf16 v[100:103], a[212:215], a[88:91], v[100:103]
  v_mfma_f32_16x16x32_bf16 v[116:119], a[212:215], a[92:95], v[116:119]
  v_mfma_f32_16x16x32_bf16 v[72:75], a[216:219], a[80:83], v[72:75]
  v_mfma_f32_16x16x32_bf16 v[88:91], a[216:219], a[84:87], v[88:91]
  v_mfma_f32_16x16x32_bf16 v[104:107], a[216:219], a[88:91], v[104:107]
  v_mfma_f32_16x16x32_bf16 v[120:123], a[216:219], a[92:95], v[120:123]
  v_mfma_f32_16x16x32_bf16 v[76:79], a[220:223], a[80:83], v[76:79]
  v_mfma_f32_16x16x32_bf16 v[92:95], a[220:223], a[84:87], v[92:95]
  v_mfma_f32_16x16x32_bf16 v[108:111], a[220:223], a[88:91], v[108:111]
  v_mfma_f32_16x16x32_bf16 v[124:127], a[220:223], a[92:95], v[124:127]
  s_barrier
  s_nop 4
  v_and_b32 v12, 15, v2
  v_lshrrev_b32 v13, 4, v2
  v_mul_u32_u24 v14, 272, v12
  v_lshl_add_u32 v14, v13, 4, v14
  s_mul_i32 s37, s3, 17408
  v_add_u32 v15, s37, v14
  ds_write_b128 v15, v[64:67] offset:0
  ds_write_b128 v15, v[68:71] offset:64
  ds_write_b128 v15, v[72:75] offset:128
  ds_write_b128 v15, v[76:79] offset:192
  ds_write_b128 v15, v[80:83] offset:4352
  ds_write_b128 v15, v[84:87] offset:4416
  ds_write_b128 v15, v[88:91] offset:4480
  ds_write_b128 v15, v[92:95] offset:4544
  ds_write_b128 v15, v[96:99] offset:8704
  ds_write_b128 v15, v[100:103] offset:8768
  ds_write_b128 v15, v[104:107] offset:8832
  ds_write_b128 v15, v[108:111] offset:8896
  ds_write_b128 v15, v[112:115] offset:13056
  ds_write_b128 v15, v[116:119] offset:13120
  ds_write_b128 v15, v[120:123] offset:13184
  ds_write_b128 v15, v[124:127] offset:13248
  s_waitcnt lgkmcnt(0)
  s_barrier
  v_mul_u32_u24 v14, 272, v12
  v_lshl_add_u32 v14, v13, 5, v14
  s_mul_i32 s37, s3, 4352
  v_add_u32 v14, s37, v14
  ds_read_b128 v[128:131], v14 offset:0
  ds_read_b128 v[132:135], v14 offset:16
  ds_read_b128 v[136:139], v14 offset:128
  ds_read_b128 v[140:143], v14 offset:144
  ds_read_b128 v[144:147], v14 offset:17408
  ds_read_b128 v[148:151], v14 offset:17424
  ds_read_b128 v[152:155], v14 offset:17536
  ds_read_b128 v[156:159], v14 offset:17552
  ds_read_b128 v[160:163], v14 offset:34816
  ds_read_b128 v[164:167], v14 offset:34832
  ds_read_b128 v[168:171], v14 offset:34944
  ds_read_b128 v[172:175], v14 offset:34960
  ds_read_b128 v[176:179], v14 offset:52224
  ds_read_b128 v[180:183], v14 offset:52240
  ds_read_b128 v[184:187], v14 offset:52352
  ds_read_b128 v[188:191], v14 offset:52368
  s_waitcnt lgkmcnt(0)
  v_pk_add_f32 v[128:129], v[128:129], v[144:145]
  v_pk_add_f32 v[160:161], v[160:161], v[176:177]
  v_pk_add_f32 v[130:131], v[130:131], v[146:147]
  v_pk_add_f32 v[162:163], v[162:163], v[178:179]
  v_pk_add_f32 v[132:133], v[132:133], v[148:149]
  v_pk_add_f32 v[164:165], v[164:165], v[180:181]
  v_pk_add_f32 v[134:135], v[134:135], v[150:151]
  v_pk_add_f32 v[166:167], v[166:167], v[182:183]
  v_pk_add_f32 v[136:137], v[136:137], v[152:153]
  v_pk_add_f32 v[168:169], v[168:169], v[184:185]
  v_pk_add_f32 v[138:139], v[138:139], v[154:155]
  v_pk_add_f32 v[170:171], v[170:171], v[186:187]
  v_pk_add_f32 v[140:141], v[140:141], v[156:157]
  v_pk_add_f32 v[172:173], v[172:173], v[188:189]
  v_pk_add_f32 v[142:143], v[142:143], v[158:159]
  v_pk_add_f32 v[174:175], v[174:175], v[190:191]
  v_pk_add_f32 v[128:129], v[128:129], v[160:161]
  v_pk_add_f32 v[130:131], v[130:131], v[162:163]
  v_pk_add_f32 v[132:133], v[132:133], v[164:165]
  v_pk_add_f32 v[134:135], v[134:135], v[166:167]
  v_pk_add_f32 v[136:137], v[136:137], v[168:169]
  v_pk_add_f32 v[138:139], v[138:139], v[170:171]
  v_pk_add_f32 v[140:141], v[140:141], v[172:173]
  v_pk_add_f32 v[142:143], v[142:143], v[174:175]
  s_waitcnt vmcnt(0)
  v_cvt_pk_bf16_f32 v48, v128, v129
  v_cvt_pk_bf16_f32 v49, v130, v131
  v_cvt_pk_bf16_f32 v50, v132, v133
  v_cvt_pk_bf16_f32 v51, v134, v135
  v_lshlrev_b32 v128, 16, v48
  v_and_b32 v129, 0xffff0000, v48
  v_lshlrev_b32 v130, 16, v49
  v_and_b32 v131, 0xffff0000, v49
  v_lshlrev_b32 v132, 16, v50
  v_and_b32 v133, 0xffff0000, v50
  v_lshlrev_b32 v134, 16, v51
  v_and_b32 v135, 0xffff0000, v51
  v_pk_mul_f32 v[128:129], v[128:129], v[208:209]
  v_pk_mul_f32 v[130:131], v[130:131], v[210:211]
  v_pk_mul_f32 v[132:133], v[132:133], v[212:213]
  v_pk_mul_f32 v[134:135], v[134:135], v[214:215]
  v_cvt_pk_bf16_f32 v48, v128, v129
  v_cvt_pk_bf16_f32 v49, v130, v131
  v_cvt_pk_bf16_f32 v50, v132, v133
  v_cvt_pk_bf16_f32 v51, v134, v135
  v_lshlrev_b32 v128, 16, v48
  v_and_b32 v129, 0xffff0000, v48
  v_lshlrev_b32 v130, 16, v49
  v_and_b32 v131, 0xffff0000, v49
  v_lshlrev_b32 v132, 16, v50
  v_and_b32 v133, 0xffff0000, v50
  v_lshlrev_b32 v134, 16, v51
  v_and_b32 v135, 0xffff0000, v51
  v_lshlrev_b32 v32, 16, v200
  v_and_b32 v33, 0xffff0000, v200
  v_lshlrev_b32 v34, 16, v201
  v_and_b32 v35, 0xffff0000, v201
  v_lshlrev_b32 v36, 16, v202
  v_and_b32 v37, 0xffff0000, v202
  v_lshlrev_b32 v38, 16, v203
  v_and_b32 v39, 0xffff0000, v203
  v_pk_add_f32 v[128:129], v[128:129], v[32:33]
  v_pk_add_f32 v[130:131], v[130:131], v[34:35]
  v_pk_add_f32 v[132:133], v[132:133], v[36:37]
  v_pk_add_f32 v[134:135], v[134:135], v[38:39]
  v_cvt_pk_bf16_f32 v40, v128, v129
  v_cvt_pk_bf16_f32 v41, v130, v131
  v_cvt_pk_bf16_f32 v42, v132, v133
  v_cvt_pk_bf16_f32 v43, v134, v135
  buffer_store_dwordx4 v[40:43], v19, s[28:31], s41 offen offset:0
  v_cvt_pk_bf16_f32 v48, v136, v137
  v_cvt_pk_bf16_f32 v49, v138, v139
  v_cvt_pk_bf16_f32 v50, v140, v141
  v_cvt_pk_bf16_f32 v51, v142, v143
  v_lshlrev_b32 v136, 16, v48
  v_and_b32 v137, 0xffff0000, v48
  v_lshlrev_b32 v138, 16, v49
  v_and_b32 v139, 0xffff0000, v49
  v_lshlrev_b32 v140, 16, v50
  v_and_b32 v141, 0xffff0000, v50
  v_lshlrev_b32 v142, 16, v51
  v_and_b32 v143, 0xffff0000, v51
  v_pk_mul_f32 v[136:137], v[136:137], v[216:217]
  v_pk_mul_f32 v[138:139], v[138:139], v[218:219]
  v_pk_mul_f32 v[140:141], v[140:141], v[220:221]
  v_pk_mul_f32 v[142:143], v[142:143], v[222:223]
  v_cvt_pk_bf16_f32 v48, v136, v137
  v_cvt_pk_bf16_f32 v49, v138, v139
  v_cvt_pk_bf16_f32 v50, v140, v141
  v_cvt_pk_bf16_f32 v51, v142, v143
  v_lshlrev_b32 v136, 16, v48
  v_and_b32 v137, 0xffff0000, v48
  v_lshlrev_b32 v138, 16, v49
  v_and_b32 v139, 0xffff0000, v49
  v_lshlrev_b32 v140, 16, v50
  v_and_b32 v141, 0xffff0000, v50
  v_lshlrev_b32 v142, 16, v51
  v_and_b32 v143, 0xffff0000, v51
  v_lshlrev_b32 v32, 16, v204
  v_and_b32 v33, 0xffff0000, v204
  v_lshlrev_b32 v34, 16, v205
  v_and_b32 v35, 0xffff0000, v205
  v_lshlrev_b32 v36, 16, v206
  v_and_b32 v37, 0xffff0000, v206
  v_lshlrev_b32 v38, 16, v207
  v_and_b32 v39, 0xffff0000, v207
  v_pk_add_f32 v[136:137], v[136:137], v[32:33]
  v_pk_add_f32 v[138:139], v[138:139], v[34:35]
  v_pk_add_f32 v[140:141], v[140:141], v[36:37]
  v_pk_add_f32 v[142:143], v[142:143], v[38:39]
  v_cvt_pk_bf16_f32 v44, v136, v137
  v_cvt_pk_bf16_f32 v45, v138, v139
  v_cvt_pk_bf16_f32 v46, v140, v141
  v_cvt_pk_bf16_f32 v47, v142, v143
  buffer_store_dwordx4 v[44:47], v19, s[28:31], s41 offen offset:64
L_adaLN_cond__compressed_kv_cla__swiglu_ffn__prompt_kernel_end:
  s_endpgm
L_adaLN_cond__compressed_kv_cla__swiglu_ffn__prompt_kernel_codeend:
.section .rodata,"a"
.p2align 6
.amdhsa_kernel adaLN_cond__compressed_kv_cla__swiglu_ffn__prompt_kernel
  .amdhsa_next_free_vgpr 512
  .amdhsa_next_free_sgpr 100
  .amdhsa_accum_offset 256
  .amdhsa_group_segment_fixed_size 0
  .amdhsa_kernarg_size 120
  .amdhsa_user_sgpr_count 2
  .amdhsa_user_sgpr_kernarg_segment_ptr 1
  .amdhsa_system_sgpr_workgroup_id_x 1
.end_amdhsa_kernel
```
